```python
import torch

def _softmax(x, axis=-1):
    return torch.softmax(x, dim=axis)
def _gelu(x):
    return torch.nn.functional.gelu(x, approximate="tanh")
def _silu(x):
    return torch.nn.functional.silu(x)
def _sigmoid(x):
    return torch.sigmoid(x)
def _layernorm(x, axis=-1, eps=1e-5):
    m = x.mean(dim=axis, keepdim=True)
    v = x.var(dim=axis, keepdim=True, unbiased=False)
    return (x - m) / torch.sqrt(v + eps)
def _scatter_add(tgt, idx, src, axis=0):
    return tgt.clone().index_add_(axis, idx, src)
def _segment_sum(src, seg, n):
    out = torch.zeros((n,) + src.shape[1:], dtype=src.dtype)
    return out.index_add_(0, seg, src)
def _pad(x, pw):
    flat = tuple(v for pair in reversed(pw) for v in pair)
    return torch.nn.functional.pad(x, flat)

kernel_name = 'parallel_sum__sliding_local_dilated__dense_activation_squared_relu__prompt'

def setup_inputs():

    _w = (lambda a: (lambda t: t.to(torch.bfloat16) if t.is_floating_point() else t)(torch.as_tensor(a)))
    def _A_setup():
        B, S, D = 1, 2048, 1024
        return {
            "x": _w((lambda *s: torch.randn(*s, dtype=torch.bfloat16) * 0.05)(B, S, D)),
            "wqkv": _w((lambda *s: torch.randn(*s, dtype=torch.bfloat16) * 0.1)(D, 3 * D)),
            "wo": _w((lambda *s: torch.randn(*s, dtype=torch.bfloat16) * 0.05)(D, D)),
        }
    _A_in = _A_setup()

    def _B_setup():
        B, S, D, F = 1, 2048, 1024, 3584
        return {
            "x": _w((lambda *s: torch.randn(*s, dtype=torch.bfloat16) * 0.05)(B, S, D)),
            "w1": _w((lambda *s: torch.randn(*s, dtype=torch.bfloat16) * 0.05)(D, F)),
            "b1": _w((lambda *s: torch.randn(*s, dtype=torch.bfloat16) * 0.4)(F)),
            "w2": _w((lambda *s: torch.randn(*s, dtype=torch.bfloat16) * 0.05)(F, D)),
            "b2": _w((lambda *s: torch.randn(*s, dtype=torch.bfloat16) * 3.2)(D)),
        }
    _B_in = _B_setup()

    return {
        "A_x": _A_in["x"],
        "A_wqkv": _A_in["wqkv"],
        "A_wo": _A_in["wo"],
        "B_x": _B_in["x"],
        "B_w1": _B_in["w1"],
        "B_b1": _B_in["b1"],
        "B_w2": _B_in["w2"],
        "B_b2": _B_in["b2"],
    }

def reference(A_x, A_wqkv, A_wo, B_x, B_w1, B_b1, B_w2, B_b2):
    def _A_ref(x, wqkv, wo):
        B, S, D = x.shape
        H = 32; Dh = D // H
        W, dil = 8, 2
        qkv = (lambda x, *d: x.permute(*d))((x @ wqkv).reshape(B, S, 3, H, Dh), 2, 0, 3, 1, 4)
        q, k, v = qkv[0], qkv[1], qkv[2]
        scale = Dh ** -0.5
        pos = torch.arange(S)
        off = torch.arange(W) * dil
        idx = pos[:, None] - off[None, :]
        mask = idx >= 0
        idx_c = torch.where(mask, idx, 0).reshape(-1)
        kg = k[:, :, idx_c, :].reshape(B, H, S, W, Dh)
        vg = v[:, :, idx_c, :].reshape(B, H, S, W, Dh)
        logits = torch.einsum("bhsd,bhswd->bhsw", q, kg) * scale
        logits = torch.where(mask[None, None, :, :], logits, -1e9)
        attn = _softmax(logits, axis=-1)
        o = torch.einsum("bhsw,bhswd->bhsd", attn, vg)
        return (lambda x, *d: x.permute(*d))(o, 0, 2, 1, 3).reshape(B, S, D) @ wo

    def _B_ref(x, w1, b1, w2, b2):
        h = torch.einsum("bsd,df->bsf", x, w1) + b1
        zero = torch.zeros_like(h)
        r = torch.where(h > zero, h, zero)
        h = r * r
        out = torch.einsum("bsf,fd->bsd", h, w2) + b2
        return out

    x = A_x
    xn = _layernorm(x, axis=-1)
    return x + _A_ref(xn, A_wqkv, A_wo) + _B_ref(xn, B_w1, B_b1, B_w2, B_b2)
```

```asm
; @launch grid=(256,1,1) block=(256,1,1) lds=163840
.amdgcn_target "amdgcn-amd-amdhsa--gfx950"
.text
.globl parallel_sum__sliding_local_dilated__dense_activation_squared_relu__prompt_kernel
.p2align 8
.type parallel_sum__sliding_local_dilated__dense_activation_squared_relu__prompt_kernel,@function
parallel_sum__sliding_local_dilated__dense_activation_squared_relu__prompt_kernel:
    s_cmp_ge_u32 s2, 256
    s_cbranch_scc1 L_end
    s_load_dwordx16 s[76:91], s[0:1], 0
    s_load_dwordx4 s[92:95], s[0:1], 64
    s_load_dwordx2 s[96:97], s[0:1], 80
    v_lshrrev_b32 v2, 6, v0
    v_and_b32 v1, 63, v0
    v_readfirstlane_b32 s5, v2
    s_and_b32 s6, s2, 1
    s_lshl_b32 s6, s6, 2
    s_bfe_u32 s7, s2, 0x20003
    s_add_u32 s34, s6, s7
    s_mov_b32 s3, s34
    s_bfe_u32 s6, s2, 0x20001
    s_lshl_b32 s6, s6, 2
    s_bfe_u32 s7, s2, 0x20005
    s_add_u32 s4, s6, s7
    s_lshr_b32 s6, s2, 7
    s_lshl_b32 s6, s6, 4
    s_add_u32 s6, s6, s4
    s_lshl_b32 s32, s3, 5
    s_add_u32 s32, s32, s6
    v_lshrrev_b32 v3, 5, v1
    v_and_b32 v2, 31, v1
    v_lshlrev_b32 v64, 11, v3
    v_lshl_add_u32 v64, v2, 4, v64
    s_lshl_b32 s24, s32, 14
    s_lshl_b32 s6, s5, 12
    s_add_u32 s24, s24, s6
    s_waitcnt lgkmcnt(0)
    s_mov_b32 s8, s76
    s_and_b32 s9, s77, 0xffff
    s_mov_b32 s10, 4194304
    s_mov_b32 s11, 0x20000
    buffer_load_dwordx4 v[68:71], v64, s[8:11], s24 offen offset:0 nt
    buffer_load_dwordx4 v[72:75], v64, s[8:11], s24 offen offset:512 nt
    buffer_load_dwordx4 v[76:79], v64, s[8:11], s24 offen offset:1024 nt
    buffer_load_dwordx4 v[80:83], v64, s[8:11], s24 offen offset:1536 nt
    s_mov_b32 s20, s94
    s_and_b32 s21, s95, 0xffff
    s_mov_b32 s22, 8
    s_mov_b32 s23, 0x20000
    v_mov_b32 v65, 0
    s_lshr_b32 s6, s2, 3
    s_or_b32 s6, s6, s5
    s_cbranch_scc1 L_notok
    s_memrealtime s[98:99]
    s_waitcnt lgkmcnt(0)
    s_or_b32 s98, s98, 1
    v_mov_b32 v120, s98
    v_mov_b32 v121, s99
    v_mov_b32 v122, 0
    v_mov_b32 v123, 0
    v_lshlrev_b32 v124, 3, v1
    buffer_atomic_cmpswap_x2 v[120:123], v124, s[20:23], 0 offen sc1
L_notok:
    s_add_u32 s16, s96, 33554432
    s_addc_u32 s17, s97, 0
    s_and_b32 s17, s17, 0xffff
    s_mov_b32 s18, 688128
    s_mov_b32 s19, 0x20000
    v_lshrrev_b32 v6, 4, v1
    v_and_b32 v7, 15, v1
    v_lshlrev_b32 v7, 3, v7
    v_mov_b32 v118, 0
    v_mov_b32 v119, 0
    v_lshl_add_u32 v8, v6, 15, v7
    s_lshl_b32 s6, s32, 7
    s_cmp_eq_u32 s5, 0
    s_cselect_b32 s18, s18, 0
    buffer_store_dwordx2 v[118:119], v8, s[16:19], s6 offen sc1
    s_mov_b32 s18, 688128
    s_lshl_b32 s6, s2, 2
    s_add_u32 s6, s6, s5
    v_max_u32 v6, 1, v6
    v_lshlrev_b32 v8, 3, v6
    v_xor_b32 v8, s6, v8
    v_lshlrev_b32 v8, 9, v8
    v_lshl_add_u32 v8, v6, 7, v8
    v_add_u32 v9, v8, v7
    s_mov_b32 s6, 130944
    buffer_store_dwordx2 v[118:119], v9, s[16:19], s6 offen sc1
    s_mul_i32 s38, s4, 448
    s_andn2_b32 s56, s38, 127
    s_lshl_b32 s6, s4, 7
    s_mov_b32 s14, 6291456
    s_movk_i32 s7, 6144
    s_cmp_ge_u32 s2, 128
    s_cselect_b32 s12, s84, s78
    s_cselect_b32 s13, s85, s79
    s_cselect_b32 s14, 7340032, s14
    s_cselect_b32 s7, 7168, s7
    s_cselect_b32 s36, 7, 11
    s_cselect_b32 s37, 3, 2
    s_cselect_b32 s56, s56, s6
    s_mov_b32 s15, 0x20000
    s_and_b32 s13, s13, 0xffff
    s_lshl_b32 s57, s7, 6
    s_mov_b32 s33, s56
    s_and_b32 s46, s3, 3
    s_lshl_b32 s46, s46, 2
    s_add_u32 s46, s46, s5
    s_lshl_b32 s46, s46, 2
    v_lshrrev_b32 v6, 4, v1
    v_add_u32 v6, s46, v6
    v_mul_lo_u32 v6, v6, s7
    v_bfe_u32 v7, v1, 2, 2
    v_min_u32 v7, s37, v7
    v_lshlrev_b32 v7, s36, v7
    v_add_u32 v11, v6, v7
    s_lshr_b32 s6, s2, 3
    s_lshl_b32 s6, s6, 2
    s_add_u32 s6, s6, s5
    s_lshl_b32 s6, s6, 10
    v_lshrrev_b32 v4, 3, v1
    v_lshlrev_b32 v4, 7, v4
    v_add_u32 v4, s6, v4
    s_getpc_b64 s[100:101]
L_pc_e:
    s_add_u32 s100, s100, parallel_sum__sliding_local_dilated__dense_activation_squared_relu__prompt_kernel-L_pc_e
    s_addc_u32 s101, s101, (parallel_sum__sliding_local_dilated__dense_activation_squared_relu__prompt_kernel-L_pc_e)>>32
    v_min_u32 v4, L_code_end-parallel_sum__sliding_local_dilated__dense_activation_squared_relu__prompt_kernel-4, v4
    v_mov_b32 v5, s101
    v_add_co_u32 v4, vcc, s100, v4
    s_nop 1
    v_addc_co_u32 v5, vcc, 0, v5, vcc
    s_mov_b32 s68, s86
    s_and_b32 s69, s87, 0xffff
    s_mov_b32 s70, 7168
    s_mov_b32 s71, 0x20000
    v_lshrrev_b32 v8, 4, v1
    v_lshlrev_b32 v8, 7, v8
    s_lshl_b32 s6, s5, 1
    v_add_u32 v6, s6, v3
    v_and_b32 v7, 7, v1
    v_xor_b32 v6, v6, v7
    v_lshlrev_b32 v6, 4, v6
    v_lshl_add_u32 v127, v2, 7, v6
    v_add_u32 v127, 147456, v127
    v_lshrrev_b32 v3, 3, v1
    v_xor_b32 v6, v3, v7
    v_lshlrev_b32 v6, 4, v6
    v_lshl_add_u32 v6, v3, 7, v6
    s_lshl_b32 s6, s5, 12
    s_add_u32 s6, s6, 147456
    v_add_u32 v126, s6, v6
    v_lshlrev_b32 v125, 8, v3
    v_lshl_add_u32 v125, v7, 4, v125
    s_mov_b32 s16, s96
    s_and_b32 s17, s97, 0xffff
    s_mov_b32 s18, 4194304
    s_mov_b32 s19, 0x20000
    s_lshl_b32 s24, s5, 20
    s_lshr_b32 s6, s32, 1
    s_lshl_b32 s6, s6, 11
    s_add_u32 s24, s24, s6
    s_and_b32 s6, s32, 1
    s_lshl_b32 s6, s6, 7
    s_add_u32 s24, s24, s6
    s_mov_b32 s46, 0xffff0000
    s_waitcnt vmcnt(5)
    v_lshlrev_b32 v84, 16, v68
    v_and_b32 v85, s46, v68
    v_lshlrev_b32 v86, 16, v69
    v_and_b32 v87, s46, v69
    v_lshlrev_b32 v88, 16, v70
    v_and_b32 v89, s46, v70
    v_lshlrev_b32 v90, 16, v71
    v_and_b32 v91, s46, v71
    v_pk_add_f32 v[116:117], v[84:85], v[86:87]
    v_pk_add_f32 v[118:119], v[88:89], v[90:91]
    s_waitcnt vmcnt(4)
    v_lshlrev_b32 v92, 16, v72
    v_and_b32 v93, s46, v72
    v_lshlrev_b32 v94, 16, v73
    v_and_b32 v95, s46, v73
    v_lshlrev_b32 v96, 16, v74
    v_and_b32 v97, s46, v74
    v_lshlrev_b32 v98, 16, v75
    v_and_b32 v99, s46, v75
    v_pk_add_f32 v[116:117], v[116:117], v[92:93]
    v_pk_add_f32 v[118:119], v[118:119], v[94:95]
    v_pk_add_f32 v[116:117], v[116:117], v[96:97]
    v_pk_add_f32 v[118:119], v[118:119], v[98:99]
    s_waitcnt vmcnt(3)
    v_lshlrev_b32 v100, 16, v76
    v_and_b32 v101, s46, v76
    v_lshlrev_b32 v102, 16, v77
    v_and_b32 v103, s46, v77
    v_lshlrev_b32 v104, 16, v78
    v_and_b32 v105, s46, v78
    v_lshlrev_b32 v106, 16, v79
    v_and_b32 v107, s46, v79
    v_pk_add_f32 v[116:117], v[116:117], v[100:101]
    v_pk_add_f32 v[118:119], v[118:119], v[102:103]
    v_pk_add_f32 v[116:117], v[116:117], v[104:105]
    v_pk_add_f32 v[118:119], v[118:119], v[106:107]
    s_waitcnt vmcnt(2)
    buffer_load_dwordx2 v[66:67], v65, s[20:23], 0 offen sc1
    global_load_dword a255, v[4:5], off
    buffer_load_dword a252, v11, s[12:15], s33 offen nt
    s_add_u32 s33, s33, s57
    buffer_load_dword a252, v11, s[12:15], s33 offen nt
    s_add_u32 s33, s33, s57
    buffer_load_dword a252, v8, s[68:71], s56 offen
    v_lshlrev_b32 v108, 16, v80
    v_and_b32 v109, s46, v80
    v_lshlrev_b32 v110, 16, v81
    v_and_b32 v111, s46, v81
    v_lshlrev_b32 v112, 16, v82
    v_and_b32 v113, s46, v82
    v_lshlrev_b32 v114, 16, v83
    v_and_b32 v115, s46, v83
    v_pk_add_f32 v[116:117], v[116:117], v[108:109]
    v_pk_add_f32 v[118:119], v[118:119], v[110:111]
    v_pk_add_f32 v[116:117], v[116:117], v[112:113]
    v_pk_add_f32 v[118:119], v[118:119], v[114:115]
    v_pk_add_f32 v[116:117], v[116:117], v[118:119]
    v_add_f32 v116, v116, v117
    s_nop 1
    v_add_f32_dpp v116, v116, v116 quad_perm:[1,0,3,2] row_mask:0xf bank_mask:0xf
    s_nop 1
    v_add_f32_dpp v116, v116, v116 quad_perm:[2,3,0,1] row_mask:0xf bank_mask:0xf
    s_nop 1
    v_add_f32_dpp v116, v116, v116 row_half_mirror row_mask:0xf bank_mask:0xf
    s_nop 1
    v_add_f32_dpp v116, v116, v116 row_mirror row_mask:0xf bank_mask:0xf
    v_mov_b32 v118, v116
    s_nop 1
    v_permlane16_swap_b32 v116, v118
    v_add_f32 v116, v116, v118
    v_mul_f32 v118, 0xba800000, v116
    v_mul_f32 v119, 0xba800000, v116
    v_pk_add_f32 v[128:129], v[84:85], v[118:119]
    v_pk_add_f32 v[130:131], v[86:87], v[118:119]
    v_pk_add_f32 v[132:133], v[88:89], v[118:119]
    v_pk_add_f32 v[134:135], v[90:91], v[118:119]
    v_pk_mul_f32 v[120:121], v[128:129], v[128:129]
    v_pk_mul_f32 v[122:123], v[130:131], v[130:131]
    v_pk_fma_f32 v[120:121], v[132:133], v[132:133], v[120:121]
    v_pk_fma_f32 v[122:123], v[134:135], v[134:135], v[122:123]
    v_pk_add_f32 v[128:129], v[92:93], v[118:119]
    v_pk_add_f32 v[130:131], v[94:95], v[118:119]
    v_pk_add_f32 v[132:133], v[96:97], v[118:119]
    v_pk_add_f32 v[134:135], v[98:99], v[118:119]
    v_pk_fma_f32 v[120:121], v[128:129], v[128:129], v[120:121]
    v_pk_fma_f32 v[122:123], v[130:131], v[130:131], v[122:123]
    v_pk_fma_f32 v[120:121], v[132:133], v[132:133], v[120:121]
    v_pk_fma_f32 v[122:123], v[134:135], v[134:135], v[122:123]
    v_pk_add_f32 v[128:129], v[100:101], v[118:119]
    v_pk_add_f32 v[130:131], v[102:103], v[118:119]
    v_pk_add_f32 v[132:133], v[104:105], v[118:119]
    v_pk_add_f32 v[134:135], v[106:107], v[118:119]
    v_pk_fma_f32 v[120:121], v[128:129], v[128:129], v[120:121]
    v_pk_fma_f32 v[122:123], v[130:131], v[130:131], v[122:123]
    v_pk_fma_f32 v[120:121], v[132:133], v[132:133], v[120:121]
    v_pk_fma_f32 v[122:123], v[134:135], v[134:135], v[122:123]
    v_pk_add_f32 v[128:129], v[108:109], v[118:119]
    v_pk_add_f32 v[130:131], v[110:111], v[118:119]
    v_pk_add_f32 v[132:133], v[112:113], v[118:119]
    v_pk_add_f32 v[134:135], v[114:115], v[118:119]
    v_pk_fma_f32 v[120:121], v[128:129], v[128:129], v[120:121]
    v_pk_fma_f32 v[122:123], v[130:131], v[130:131], v[122:123]
    v_pk_fma_f32 v[120:121], v[132:133], v[132:133], v[120:121]
    v_pk_fma_f32 v[122:123], v[134:135], v[134:135], v[122:123]
    v_pk_add_f32 v[120:121], v[120:121], v[122:123]
    v_add_f32 v117, v120, v121
    v_cvt_pk_bf16_f32 v118, v118, v118
    v_lshlrev_b32 v118, 16, v118
    v_mov_b32 v119, v118
    v_pk_add_f32 v[84:85], v[84:85], v[118:119]
    v_pk_add_f32 v[86:87], v[86:87], v[118:119]
    v_pk_add_f32 v[88:89], v[88:89], v[118:119]
    v_add_f32_dpp v117, v117, v117 quad_perm:[1,0,3,2] row_mask:0xf bank_mask:0xf
    v_pk_add_f32 v[90:91], v[90:91], v[118:119]
    v_pk_add_f32 v[92:93], v[92:93], v[118:119]
    v_pk_add_f32 v[94:95], v[94:95], v[118:119]
    v_add_f32_dpp v117, v117, v117 quad_perm:[2,3,0,1] row_mask:0xf bank_mask:0xf
    v_pk_add_f32 v[96:97], v[96:97], v[118:119]
    v_pk_add_f32 v[98:99], v[98:99], v[118:119]
    v_pk_add_f32 v[100:101], v[100:101], v[118:119]
    v_add_f32_dpp v117, v117, v117 row_half_mirror row_mask:0xf bank_mask:0xf
    v_pk_add_f32 v[102:103], v[102:103], v[118:119]
    v_pk_add_f32 v[104:105], v[104:105], v[118:119]
    v_pk_add_f32 v[106:107], v[106:107], v[118:119]
    v_add_f32_dpp v117, v117, v117 row_mirror row_mask:0xf bank_mask:0xf
    v_pk_add_f32 v[108:109], v[108:109], v[118:119]
    v_pk_add_f32 v[110:111], v[110:111], v[118:119]
    v_pk_add_f32 v[112:113], v[112:113], v[118:119]
    v_mov_b32 v120, v117
    v_pk_add_f32 v[114:115], v[114:115], v[118:119]
    v_cvt_pk_bf16_f32 v68, v84, v85
    v_cvt_pk_bf16_f32 v69, v86, v87
    v_permlane16_swap_b32 v117, v120
    v_cvt_pk_bf16_f32 v70, v88, v89
    v_cvt_pk_bf16_f32 v71, v90, v91
    v_cvt_pk_bf16_f32 v72, v92, v93
    v_add_f32 v117, v117, v120
    v_cvt_pk_bf16_f32 v73, v94, v95
    v_cvt_pk_bf16_f32 v74, v96, v97
    v_cvt_pk_bf16_f32 v75, v98, v99
    v_mul_f32 v117, 0x3a800000, v117
    v_cvt_pk_bf16_f32 v76, v100, v101
    v_cvt_pk_bf16_f32 v77, v102, v103
    v_cvt_pk_bf16_f32 v78, v104, v105
    v_cvt_pk_bf16_f32 v117, v117, v117
    v_cvt_pk_bf16_f32 v79, v106, v107
    v_cvt_pk_bf16_f32 v80, v108, v109
    v_cvt_pk_bf16_f32 v81, v110, v111
    v_lshlrev_b32 v117, 16, v117
    v_cvt_pk_bf16_f32 v82, v112, v113
    v_cvt_pk_bf16_f32 v83, v114, v115
    v_lshlrev_b32 v84, 16, v68
    v_add_f32 v117, 0x3727c5ac, v117
    v_and_b32 v85, s46, v68
    v_lshlrev_b32 v86, 16, v69
    v_and_b32 v87, s46, v69
    v_cvt_pk_bf16_f32 v117, v117, v117
    v_lshlrev_b32 v88, 16, v70
    v_and_b32 v89, s46, v70
    v_lshlrev_b32 v90, 16, v71
    v_lshlrev_b32 v117, 16, v117
    v_and_b32 v91, s46, v71
    v_lshlrev_b32 v92, 16, v72
    v_and_b32 v93, s46, v72
    v_sqrt_f32 v117, v117
    v_lshlrev_b32 v94, 16, v73
    v_and_b32 v95, s46, v73
    v_lshlrev_b32 v96, 16, v74
    v_cvt_pk_bf16_f32 v117, v117, v117
    v_and_b32 v97, s46, v74
    v_lshlrev_b32 v98, 16, v75
    v_and_b32 v99, s46, v75
    v_lshlrev_b32 v117, 16, v117
    v_lshlrev_b32 v100, 16, v76
    v_and_b32 v101, s46, v76
    v_lshlrev_b32 v102, 16, v77
    v_rcp_f32 v120, v117
    v_and_b32 v103, s46, v77
    v_lshlrev_b32 v104, 16, v78
    v_and_b32 v105, s46, v78
    v_rcp_f32 v121, v117
    v_lshlrev_b32 v106, 16, v79
    v_and_b32 v107, s46, v79
    v_lshlrev_b32 v108, 16, v80
    v_and_b32 v109, s46, v80
    v_lshlrev_b32 v110, 16, v81
    v_and_b32 v111, s46, v81
    v_lshlrev_b32 v112, 16, v82
    v_and_b32 v113, s46, v82
    v_lshlrev_b32 v114, 16, v83
    v_and_b32 v115, s46, v83
    v_pk_mul_f32 v[84:85], v[84:85], v[120:121]
    v_pk_mul_f32 v[86:87], v[86:87], v[120:121]
    v_pk_mul_f32 v[88:89], v[88:89], v[120:121]
    v_pk_mul_f32 v[90:91], v[90:91], v[120:121]
    v_cvt_pk_bf16_f32 v68, v84, v85
    v_cvt_pk_bf16_f32 v69, v86, v87
    v_cvt_pk_bf16_f32 v70, v88, v89
    v_cvt_pk_bf16_f32 v71, v90, v91
    ds_write_b128 v127, v[68:71] offset:0
    v_pk_mul_f32 v[92:93], v[92:93], v[120:121]
    v_pk_mul_f32 v[94:95], v[94:95], v[120:121]
    v_pk_mul_f32 v[96:97], v[96:97], v[120:121]
    v_pk_mul_f32 v[98:99], v[98:99], v[120:121]
    v_cvt_pk_bf16_f32 v72, v92, v93
    v_cvt_pk_bf16_f32 v73, v94, v95
    v_cvt_pk_bf16_f32 v74, v96, v97
    v_cvt_pk_bf16_f32 v75, v98, v99
    ds_write_b128 v127, v[72:75] offset:4096
    v_pk_mul_f32 v[100:101], v[100:101], v[120:121]
    v_pk_mul_f32 v[102:103], v[102:103], v[120:121]
    v_pk_mul_f32 v[104:105], v[104:105], v[120:121]
    v_pk_mul_f32 v[106:107], v[106:107], v[120:121]
    v_cvt_pk_bf16_f32 v76, v100, v101
    v_cvt_pk_bf16_f32 v77, v102, v103
    v_cvt_pk_bf16_f32 v78, v104, v105
    v_cvt_pk_bf16_f32 v79, v106, v107
    ds_write_b128 v127, v[76:79] offset:8192
    v_pk_mul_f32 v[108:109], v[108:109], v[120:121]
    v_pk_mul_f32 v[110:111], v[110:111], v[120:121]
    v_pk_mul_f32 v[112:113], v[112:113], v[120:121]
    v_pk_mul_f32 v[114:115], v[114:115], v[120:121]
    v_cvt_pk_bf16_f32 v80, v108, v109
    v_cvt_pk_bf16_f32 v81, v110, v111
    v_cvt_pk_bf16_f32 v82, v112, v113
    v_cvt_pk_bf16_f32 v83, v114, v115
    ds_write_b128 v127, v[80:83] offset:12288
    s_waitcnt lgkmcnt(0)
    s_barrier
    ds_read_b128 v[68:71], v126 offset:0
    ds_read_b128 v[72:75], v126 offset:1024
    ds_read_b128 v[76:79], v126 offset:2048
    ds_read_b128 v[80:83], v126 offset:3072
    s_waitcnt lgkmcnt(3)
    buffer_store_dwordx4 v[68:71], v125, s[16:19], s24 offen sc1
    s_add_u32 s24, s24, 0x40000
    s_waitcnt lgkmcnt(2)
    buffer_store_dwordx4 v[72:75], v125, s[16:19], s24 offen sc1
    s_add_u32 s24, s24, 0x40000
    s_waitcnt lgkmcnt(1)
    buffer_store_dwordx4 v[76:79], v125, s[16:19], s24 offen sc1
    s_add_u32 s24, s24, 0x40000
    s_waitcnt lgkmcnt(0)
    buffer_store_dwordx4 v[80:83], v125, s[16:19], s24 offen sc1
    s_mov_b32 s7, 40000
    s_waitcnt vmcnt(8)
L_tok:
    v_readfirstlane_b32 s98, v66
    v_readfirstlane_b32 s99, v67
    s_cmp_lg_u32 s98, 0
    s_cbranch_scc1 L_tokok
    buffer_load_dwordx2 v[66:67], v65, s[20:23], 0 offen sc1
    s_waitcnt vmcnt(0)
    s_sub_u32 s7, s7, 1
    s_cmp_lg_u32 s7, 0
    s_cbranch_scc1 L_tok
L_tokok:
    s_add_u32 s20, s96, 33554432
    s_addc_u32 s21, s97, 0
    s_and_b32 s21, s21, 0xffff
    s_mov_b32 s22, 688128
    s_mov_b32 s23, 0x20000
    v_and_b32 v65, 15, v1
    v_lshlrev_b32 v65, 3, v65
    v_lshrrev_b32 v2, 4, v1
    v_bfe_u32 v4, v1, 2, 2
    v_and_b32 v6, 3, v1
    v_lshl_add_u32 v2, v2, 2, v4
    v_bfe_u32 v4, v1, 3, 2
    s_and_b32 s7, s2, 2
    v_xor_b32 v4, s7, v4
    v_lshlrev_b32 v2, 7, v2
    v_lshl_add_u32 v2, v6, 3, v2
    s_bfe_u32 s7, s2, 0x10002
    s_lshl_b32 s36, s7, 13
    s_add_u32 s36, s36, 0x10000
    s_xor_b32 s37, s36, 8192
    v_xor_b32 v6, 0, v4
    v_lshl_add_u32 v6, v6, 5, v2
    v_add_u32 v7, s36, v6
    v_accvgpr_write_b32 a224, v7
    v_add_u32 v6, s37, v6
    v_accvgpr_write_b32 a228, v6
    v_xor_b32 v6, 1, v4
    v_lshl_add_u32 v6, v6, 5, v2
    v_add_u32 v7, s36, v6
    v_accvgpr_write_b32 a225, v7
    v_add_u32 v6, s37, v6
    v_accvgpr_write_b32 a229, v6
    v_xor_b32 v6, 2, v4
    v_lshl_add_u32 v6, v6, 5, v2
    v_add_u32 v7, s36, v6
    v_accvgpr_write_b32 a226, v7
    v_add_u32 v6, s37, v6
    v_accvgpr_write_b32 a230, v6
    v_xor_b32 v6, 3, v4
    v_lshl_add_u32 v6, v6, 5, v2
    v_add_u32 v7, s36, v6
    v_accvgpr_write_b32 a227, v7
    v_add_u32 v6, s37, v6
    v_accvgpr_write_b32 a231, v6
    v_min_u32 v132, 33, v1
    v_lshlrev_b32 v132, 7, v132
    s_lshl_b32 s6, s3, 12
    s_sub_u32 s6, s6, 256
    v_add_u32 v132, s6, v132
    v_max_i32 v132, 0, v132
    s_lshr_b32 s59, s2, 7
    s_lshl_b32 s59, s59, 10
    s_bfe_u32 s48, s2, 0x20005
    s_lshl_b32 s48, s48, 7
    s_add_u32 s59, s59, s48
    s_bfe_u32 s48, s2, 0x10002
    s_lshl_b32 s48, s48, 9
    s_add_u32 s74, s59, s48
    s_bfe_u32 s48, s2, 0x10001
    s_lshl_b32 s48, s48, 6
    s_add_u32 s74, s74, s48
    s_lshl_b32 s75, s34, 2
    s_add_u32 s75, s75, s5
    s_lshl_b32 s75, s75, 17
    s_add_u32 s75, s75, s74
    v_bfe_u32 v30, v1, 4, 1
    v_lshlrev_b32 v30, 5, v30
    v_lshrrev_b32 v31, 5, v1
    v_lshl_add_u32 v30, v31, 4, v30
    s_mov_b32 s40, s90
    s_and_b32 s41, s91, 0xffff
    s_mov_b32 s42, 2048
    s_mov_b32 s43, 0x20000
    buffer_load_dwordx4 a[248:251], v30, s[40:43], s74 offen
    v_and_b32 v31, 15, v1
    v_lshl_add_u32 v30, v31, 11, v30
    s_mov_b32 s40, s76
    s_and_b32 s41, s77, 0xffff
    s_mov_b32 s42, 4194304
    s_mov_b32 s43, 0x20000
    s_mov_b32 s60, s80
    s_and_b32 s61, s81, 0xffff
    s_mov_b32 s62, 2097152
    s_mov_b32 s63, 0x20000
    s_mov_b32 s64, s88
    s_and_b32 s65, s89, 0xffff
    s_mov_b32 s66, 7340032
    s_mov_b32 s67, 0x20000
    s_mov_b32 s8, s96
    s_and_b32 s9, s97, 0xffff
    s_mov_b32 s10, 4194304
    s_mov_b32 s11, 0x20000
    s_cmp_ge_u32 s2, 128
    s_cbranch_scc1 L_ffn
    s_lshl_b32 s35, s3, 2
    s_add_u32 s35, s35, s5
    s_lshl_b32 s52, s4, 7
    s_add_u32 s53, s52, 2048
    s_add_u32 s54, s52, 4096
    v_lshrrev_b32 v6, 3, v1
    v_and_b32 v7, 7, v1
    v_bfe_u32 v28, v1, 4, 1
    v_lshlrev_b32 v28, 1, v28
    v_xor_b32 v28, v28, v7
    s_lshl_b32 s46, s5, 4
    v_add_u32 v6, s46, v6
    v_mul_u32_u24 v6, 6144, v6
    v_lshl_add_u32 v13, v28, 4, v6
    v_xor_b32 v28, 4, v28
    v_lshl_add_u32 v14, v28, 4, v6
    v_add_u32 v14, 49152, v14
    s_lshl_b32 s29, s5, 11
    s_lshl_b32 s30, s5, 10
    s_add_u32 s30, s30, 24576
    s_mov_b32 s25, s52
    s_mov_b32 s26, s53
    s_mov_b32 s27, s54
    v_lshrrev_b32 v3, 4, v1
    v_lshlrev_b32 v12, 4, v1
    s_lshl_b32 s36, s35, 13
    v_add_u32 v8, s36, v12
    v_add_u32 v9, 4096, v8
    s_lshl_b32 s37, s3, 15
    s_sub_u32 s37, s37, 2048
    s_cmp_eq_u32 s3, 0
    s_cselect_b32 s37, 0, s37
    v_add_u32 v10, s37, v12
    s_lshl_b32 s6, s32, 7
    s_waitcnt vmcnt(1)
    s_barrier
    s_cmp_lg_u32 s5, 0
    s_cbranch_scc1 L_nofl_q
    buffer_store_dwordx2 v[66:67], v65, s[20:23], s6 offen sc1
L_nofl_q:
    buffer_load_dword a252, v11, s[12:15], s33 offen
    s_add_u32 s33, s33, s57
    buffer_load_dword a252, v11, s[12:15], s33 offen
    s_add_u32 s33, s33, s57
    s_add_u32 m0, s29, 0
    s_nop 0
    buffer_load_dwordx4 v13, s[12:15], s25 offen  lds
    s_add_u32 m0, s29, 1024
    s_nop 0
    buffer_load_dwordx4 v14, s[12:15], s25 offen  lds
    s_add_u32 m0, s29, 8192
    s_nop 0
    buffer_load_dwordx4 v13, s[12:15], s26 offen  lds
    s_add_u32 m0, s29, 9216
    s_nop 0
    buffer_load_dwordx4 v14, s[12:15], s26 offen  lds
    s_add_u32 m0, s29, 16384
    s_nop 0
    buffer_load_dwordx4 v13, s[12:15], s27 offen  lds
    s_add_u32 m0, s29, 17408
    s_nop 0
    buffer_load_dwordx4 v14, s[12:15], s27 offen  lds
    s_add_u32 s25, s25, 393216
    s_add_u32 s26, s26, 393216
    s_add_u32 s27, s27, 393216
    s_add_u32 m0, s29, 28672
    s_nop 0
    buffer_load_dwordx4 v13, s[12:15], s25 offen  lds
    s_add_u32 m0, s29, 29696
    s_nop 0
    buffer_load_dwordx4 v14, s[12:15], s25 offen  lds
    s_add_u32 m0, s29, 36864
    s_nop 0
    buffer_load_dwordx4 v13, s[12:15], s26 offen  lds
    s_add_u32 m0, s29, 37888
    s_nop 0
    buffer_load_dwordx4 v14, s[12:15], s26 offen  lds
    s_add_u32 m0, s29, 45056
    s_nop 0
    buffer_load_dwordx4 v13, s[12:15], s27 offen  lds
    s_add_u32 m0, s29, 46080
    s_nop 0
    buffer_load_dwordx4 v14, s[12:15], s27 offen  lds
    s_add_u32 s25, s25, 393216
    s_add_u32 s26, s26, 393216
    s_add_u32 s27, s27, 393216
    s_cmp_lg_u32 s5, 0
    s_cbranch_scc1 L_np0_q1
    buffer_load_dwordx2 v[134:135], v132, s[20:23], 0 offen sc1
L_np0_q1:
    v_bfe_u32 v6, v1, 2, 2
    v_and_b32 v7, 3, v1
    v_lshl_add_u32 v28, v3, 3, v6
    v_bfe_u32 v29, v1, 3, 2
    v_xor_b32 v29, s5, v29
    v_lshlrev_b32 v2, 7, v28
    v_lshl_add_u32 v2, v7, 3, v2
    v_xor_b32 v4, 0, v29
    v_lshl_add_u32 v16, v4, 5, v2
    v_add_u32 v20, 57344, v16
    v_xor_b32 v4, 1, v29
    v_lshl_add_u32 v17, v4, 5, v2
    v_add_u32 v21, 57344, v17
    v_xor_b32 v4, 2, v29
    v_lshl_add_u32 v18, v4, 5, v2
    v_add_u32 v22, 57344, v18
    v_xor_b32 v4, 3, v29
    v_lshl_add_u32 v19, v4, 5, v2
    v_add_u32 v23, 57344, v19
    v_mov_b32 v32, 0
    v_mov_b32 v33, 0
    v_mov_b32 v34, 0
    v_mov_b32 v35, 0
    v_mov_b32 v36, 0
    v_mov_b32 v37, 0
    v_mov_b32 v38, 0
    v_mov_b32 v39, 0
    v_mov_b32 v40, 0
    v_mov_b32 v41, 0
    v_mov_b32 v42, 0
    v_mov_b32 v43, 0
    v_mov_b32 v44, 0
    v_mov_b32 v45, 0
    v_mov_b32 v46, 0
    v_mov_b32 v47, 0
    v_mov_b32 v48, 0
    v_mov_b32 v49, 0
    v_mov_b32 v50, 0
    v_mov_b32 v51, 0
    v_mov_b32 v52, 0
    v_mov_b32 v53, 0
    v_mov_b32 v54, 0
    v_mov_b32 v55, 0
    v_mov_b32 v56, 0
    v_mov_b32 v57, 0
    v_mov_b32 v58, 0
    v_mov_b32 v59, 0
    v_mov_b32 v60, 0
    v_mov_b32 v61, 0
    v_mov_b32 v62, 0
    v_mov_b32 v63, 0
    v_mov_b32 v84, 0
    v_mov_b32 v85, 0
    v_mov_b32 v86, 0
    v_mov_b32 v87, 0
    v_mov_b32 v88, 0
    v_mov_b32 v89, 0
    v_mov_b32 v90, 0
    v_mov_b32 v91, 0
    v_mov_b32 v92, 0
    v_mov_b32 v93, 0
    v_mov_b32 v94, 0
    v_mov_b32 v95, 0
    v_mov_b32 v96, 0
    v_mov_b32 v97, 0
    v_mov_b32 v98, 0
    v_mov_b32 v99, 0
    v_mov_b32 v100, 0
    v_mov_b32 v101, 0
    v_mov_b32 v102, 0
    v_mov_b32 v103, 0
    v_mov_b32 v104, 0
    v_mov_b32 v105, 0
    v_mov_b32 v106, 0
    v_mov_b32 v107, 0
    v_mov_b32 v108, 0
    v_mov_b32 v109, 0
    v_mov_b32 v110, 0
    v_mov_b32 v111, 0
    v_mov_b32 v112, 0
    v_mov_b32 v113, 0
    v_mov_b32 v114, 0
    v_mov_b32 v115, 0
    v_mov_b32 v116, 0
    v_mov_b32 v117, 0
    v_mov_b32 v118, 0
    v_mov_b32 v119, 0
    v_mov_b32 v120, 0
    v_mov_b32 v121, 0
    v_mov_b32 v122, 0
    v_mov_b32 v123, 0
    v_mov_b32 v136, 0
    v_mov_b32 v137, 0
    v_mov_b32 v138, 0
    v_mov_b32 v139, 0
    v_mov_b32 v140, 0
    v_mov_b32 v141, 0
    v_mov_b32 v142, 0
    v_mov_b32 v143, 0
    v_mov_b32 v144, 0
    v_mov_b32 v145, 0
    v_mov_b32 v146, 0
    v_mov_b32 v147, 0
    v_mov_b32 v148, 0
    v_mov_b32 v149, 0
    v_mov_b32 v150, 0
    v_mov_b32 v151, 0
    v_mov_b32 v152, 0
    v_mov_b32 v153, 0
    v_mov_b32 v154, 0
    v_mov_b32 v155, 0
    v_mov_b32 v156, 0
    v_mov_b32 v157, 0
    v_mov_b32 v158, 0
    v_mov_b32 v159, 0
    v_mov_b32 v160, 0
    v_mov_b32 v161, 0
    v_mov_b32 v162, 0
    v_mov_b32 v163, 0
    v_mov_b32 v164, 0
    v_mov_b32 v165, 0
    v_mov_b32 v166, 0
    v_mov_b32 v167, 0
    v_mov_b32 v168, 0
    v_mov_b32 v169, 0
    v_mov_b32 v170, 0
    v_mov_b32 v171, 0
    v_mov_b32 v172, 0
    v_mov_b32 v173, 0
    v_mov_b32 v174, 0
    v_mov_b32 v175, 0
    v_mov_b32 v176, 0
    v_mov_b32 v177, 0
    v_mov_b32 v178, 0
    v_mov_b32 v179, 0
    v_mov_b32 v180, 0
    v_mov_b32 v181, 0
    v_mov_b32 v182, 0
    v_mov_b32 v183, 0
    v_mov_b32 v184, 0
    v_mov_b32 v185, 0
    v_mov_b32 v186, 0
    v_mov_b32 v187, 0
    v_mov_b32 v188, 0
    v_mov_b32 v189, 0
    v_mov_b32 v190, 0
    v_mov_b32 v191, 0
    v_mov_b32 v192, 0
    v_mov_b32 v193, 0
    v_mov_b32 v194, 0
    v_mov_b32 v195, 0
    v_mov_b32 v196, 0
    v_mov_b32 v197, 0
    v_mov_b32 v198, 0
    v_mov_b32 v199, 0
    v_mov_b32 v200, 0
    v_mov_b32 v201, 0
    v_mov_b32 v202, 0
    v_mov_b32 v203, 0
    v_mov_b32 v204, 0
    v_mov_b32 v205, 0
    v_mov_b32 v206, 0
    v_mov_b32 v207, 0
    v_mov_b32 v208, 0
    v_mov_b32 v209, 0
    v_mov_b32 v210, 0
    v_mov_b32 v211, 0
    v_mov_b32 v212, 0
    v_mov_b32 v213, 0
    v_mov_b32 v214, 0
    v_mov_b32 v215, 0
    v_mov_b32 v216, 0
    v_mov_b32 v217, 0
    v_mov_b32 v218, 0
    v_mov_b32 v219, 0
    v_mov_b32 v220, 0
    v_mov_b32 v221, 0
    v_mov_b32 v222, 0
    v_mov_b32 v223, 0
    v_mov_b32 v224, 0
    v_mov_b32 v225, 0
    v_mov_b32 v226, 0
    v_mov_b32 v227, 0
    v_mov_b32 v228, 0
    v_mov_b32 v229, 0
    v_mov_b32 v230, 0
    v_mov_b32 v231, 0
    s_cmp_lg_u32 s5, 0
    s_cbranch_scc1 L_np_q1
    s_mov_b32 s7, 40000
L_poll_q1:
    s_waitcnt vmcnt(0)
    v_cmp_ne_u64 vcc, s[98:99], v[134:135]
    s_nop 1
    s_cmp_eq_u64 vcc, 0
    s_cbranch_scc1 L_pok_q1
    buffer_load_dwordx2 v[134:135], v132, s[20:23], 0 offen sc1
    s_sub_u32 s7, s7, 1
    s_cmp_lg_u32 s7, 0
    s_cbranch_scc1 L_poll_q1
L_pok_q1:
L_np_q1:
    s_waitcnt vmcnt(0)
    s_barrier
    s_mov_b32 s24, 0
    buffer_load_dwordx4 a[0:3], v8, s[8:11], s24 offen offset:0 sc1
    buffer_load_dwordx4 a[4:7], v8, s[8:11], s24 offen offset:1024 sc1
    buffer_load_dwordx4 a[8:11], v8, s[8:11], s24 offen offset:2048 sc1
    buffer_load_dwordx4 a[12:15], v8, s[8:11], s24 offen offset:3072 sc1
    buffer_load_dwordx4 a[16:19], v9, s[8:11], s24 offen offset:0 sc1
    buffer_load_dwordx4 a[20:23], v9, s[8:11], s24 offen offset:1024 sc1
    buffer_load_dwordx4 a[24:27], v9, s[8:11], s24 offen offset:2048 sc1
    buffer_load_dwordx4 a[28:31], v9, s[8:11], s24 offen offset:3072 sc1
    buffer_load_dwordx4 a[32:35], v10, s[8:11], s24 offen offset:0 sc1
    buffer_load_dwordx4 a[36:39], v10, s[8:11], s24 offen offset:1024 sc1
    s_add_u32 s24, s24, 0x40000
    buffer_load_dwordx4 a[40:43], v8, s[8:11], s24 offen offset:0 sc1
    buffer_load_dwordx4 a[44:47], v8, s[8:11], s24 offen offset:1024 sc1
    buffer_load_dwordx4 a[48:51], v8, s[8:11], s24 offen offset:2048 sc1
    buffer_load_dwordx4 a[52:55], v8, s[8:11], s24 offen offset:3072 sc1
    buffer_load_dwordx4 a[56:59], v9, s[8:11], s24 offen offset:0 sc1
    buffer_load_dwordx4 a[60:63], v9, s[8:11], s24 offen offset:1024 sc1
    buffer_load_dwordx4 a[64:67], v9, s[8:11], s24 offen offset:2048 sc1
    buffer_load_dwordx4 a[68:71], v9, s[8:11], s24 offen offset:3072 sc1
    buffer_load_dwordx4 a[72:75], v10, s[8:11], s24 offen offset:0 sc1
    buffer_load_dwordx4 a[76:79], v10, s[8:11], s24 offen offset:1024 sc1
    s_add_u32 s24, s24, 0x40000
    s_mov_b32 s46, s2
    s_lshl_b32 s46, s46, 2
    s_add_u32 s46, s46, s5
    s_lshl_b32 s68, s46, 9
    s_mov_b32 s69, s68
    v_lshrrev_b32 v5, 4, v1
    v_lshlrev_b32 v5, 7, v5
    s_add_u32 s16, s96, 4194304
    s_addc_u32 s17, s97, 0
    s_and_b32 s17, s17, 0xffff
    s_mov_b32 s18, 50331648
    s_mov_b32 s19, 0x20000
    v_mov_b32 v64, 0
    v_mov_b32 v65, 0
    v_mov_b32 v66, 0
    v_mov_b32 v67, 0
    v_mov_b32 v68, 0
    v_mov_b32 v69, 0
    v_mov_b32 v70, 0
    v_mov_b32 v71, 0
    v_mov_b32 v72, 0
    v_mov_b32 v73, 0
    v_mov_b32 v74, 0
    v_mov_b32 v75, 0
    v_mov_b32 v76, 0
    v_mov_b32 v77, 0
    v_mov_b32 v78, 0
    v_mov_b32 v79, 0
    v_mov_b32 v80, 0
    v_mov_b32 v81, 0
    v_mov_b32 v82, 0
    v_mov_b32 v83, 0
    v_mov_b32 v124, 0
    v_mov_b32 v125, 0
    v_mov_b32 v126, 0
    v_mov_b32 v127, 0
    v_mov_b32 v128, 0
    v_mov_b32 v129, 0
    v_mov_b32 v130, 0
    v_mov_b32 v131, 0
    v_mov_b32 v132, 0
    v_mov_b32 v133, 0
    v_mov_b32 v134, 0
    v_mov_b32 v135, 0
    ds_read_b64_tr_b16 a[160:161], v16 offset:0
    ds_read_b64_tr_b16 a[162:163], v16 offset:512
    ds_read_b64_tr_b16 a[164:165], v16 offset:4096
    ds_read_b64_tr_b16 a[166:167], v16 offset:4608
    ds_read_b64_tr_b16 a[168:169], v17 offset:0
    ds_read_b64_tr_b16 a[170:171], v17 offset:512
    ds_read_b64_tr_b16 a[172:173], v17 offset:4096
    ds_read_b64_tr_b16 a[174:175], v17 offset:4608
    ds_read_b64_tr_b16 a[176:177], v18 offset:0
    ds_read_b64_tr_b16 a[178:179], v18 offset:512
    ds_read_b64_tr_b16 a[180:181], v18 offset:4096
    ds_read_b64_tr_b16 a[182:183], v18 offset:4608
    s_waitcnt vmcnt(10)
    s_mov_b32 s31, 0
L_g1q_loop:
    s_waitcnt lgkmcnt(8)
    v_mfma_f32_16x16x32_bf16 v[32:35], a[160:163], a[0:3], v[32:35]
    ds_read_b64_tr_b16 a[184:185], v19 offset:0
    v_mfma_f32_16x16x32_bf16 v[32:35], a[164:167], a[4:7], v[32:35]
    ds_read_b64_tr_b16 a[186:187], v19 offset:512
    v_mfma_f32_16x16x32_bf16 v[36:39], a[164:167], a[12:15], v[36:39]
    buffer_load_dwordx4 a[80:83], v8, s[8:11], s24 offen offset:0 sc1
    v_mfma_f32_16x16x32_bf16 v[36:39], a[160:163], a[8:11], v[36:39]
    v_mfma_f32_16x16x32_bf16 v[40:43], a[160:163], a[16:19], v[40:43]
    ds_read_b64_tr_b16 a[188:189], v19 offset:4096
    v_mfma_f32_16x16x32_bf16 v[40:43], a[164:167], a[20:23], v[40:43]
    ds_read_b64_tr_b16 a[190:191], v19 offset:4608
    s_add_u32 m0, s29, 57344
    v_mfma_f32_16x16x32_bf16 v[44:47], a[164:167], a[28:31], v[44:47]
    buffer_load_dwordx4 v13, s[12:15], s25 offen  lds
    v_mfma_f32_16x16x32_bf16 v[44:47], a[160:163], a[24:27], v[44:47]
    s_waitcnt lgkmcnt(8)
    v_mfma_f32_16x16x32_bf16 v[60:63], a[168:171], a[24:27], v[60:63]
    ds_read_b64_tr_b16 a[160:161], v16 offset:8192
    v_mfma_f32_16x16x32_bf16 v[60:63], a[172:175], a[28:31], v[60:63]
    ds_read_b64_tr_b16 a[162:163], v16 offset:8704
    v_mfma_f32_16x16x32_bf16 v[56:59], a[172:175], a[20:23], v[56:59]
    buffer_load_dwordx4 a[84:87], v8, s[8:11], s24 offen offset:1024 sc1
    v_mfma_f32_16x16x32_bf16 v[56:59], a[168:171], a[16:19], v[56:59]
    v_mfma_f32_16x16x32_bf16 v[52:55], a[168:171], a[8:11], v[52:55]
    ds_read_b64_tr_b16 a[164:165], v16 offset:12288
    v_mfma_f32_16x16x32_bf16 v[52:55], a[172:175], a[12:15], v[52:55]
    ds_read_b64_tr_b16 a[166:167], v16 offset:12800
    v_mfma_f32_16x16x32_bf16 v[48:51], a[172:175], a[4:7], v[48:51]
    buffer_load_dwordx4 a[88:91], v8, s[8:11], s24 offen offset:2048 sc1
    v_mfma_f32_16x16x32_bf16 v[48:51], a[168:171], a[0:3], v[48:51]
    s_waitcnt lgkmcnt(8)
    v_mfma_f32_16x16x32_bf16 v[64:67], a[176:179], a[0:3], v[64:67]
    ds_read_b64_tr_b16 a[168:169], v17 offset:8192
    v_mfma_f32_16x16x32_bf16 v[64:67], a[180:183], a[4:7], v[64:67]
    ds_read_b64_tr_b16 a[170:171], v17 offset:8704
    s_add_u32 m0, s29, 58368
    v_mfma_f32_16x16x32_bf16 v[68:71], a[180:183], a[12:15], v[68:71]
    buffer_load_dwordx4 v14, s[12:15], s25 offen  lds
    v_mfma_f32_16x16x32_bf16 v[68:71], a[176:179], a[8:11], v[68:71]
    v_mfma_f32_16x16x32_bf16 v[72:75], a[176:179], a[16:19], v[72:75]
    ds_read_b64_tr_b16 a[172:173], v17 offset:12288
    v_mfma_f32_16x16x32_bf16 v[72:75], a[180:183], a[20:23], v[72:75]
    ds_read_b64_tr_b16 a[174:175], v17 offset:12800
    v_mfma_f32_16x16x32_bf16 v[76:79], a[180:183], a[28:31], v[76:79]
    buffer_load_dwordx4 a[92:95], v8, s[8:11], s24 offen offset:3072 sc1
    v_mfma_f32_16x16x32_bf16 v[76:79], a[176:179], a[24:27], v[76:79]
    s_waitcnt lgkmcnt(8)
    v_mfma_f32_16x16x32_bf16 v[92:95], a[184:187], a[24:27], v[92:95]
    ds_read_b64_tr_b16 a[176:177], v18 offset:8192
    v_mfma_f32_16x16x32_bf16 v[92:95], a[188:191], a[28:31], v[92:95]
    ds_read_b64_tr_b16 a[178:179], v18 offset:8704
    s_add_u32 m0, s29, 65536
    v_mfma_f32_16x16x32_bf16 v[88:91], a[188:191], a[20:23], v[88:91]
    buffer_load_dwordx4 v13, s[12:15], s26 offen  lds
    v_mfma_f32_16x16x32_bf16 v[88:91], a[184:187], a[16:19], v[88:91]
    v_mfma_f32_16x16x32_bf16 v[84:87], a[184:187], a[8:11], v[84:87]
    ds_read_b64_tr_b16 a[180:181], v18 offset:12288
    v_mfma_f32_16x16x32_bf16 v[84:87], a[188:191], a[12:15], v[84:87]
    ds_read_b64_tr_b16 a[182:183], v18 offset:12800
    v_mfma_f32_16x16x32_bf16 v[80:83], a[188:191], a[4:7], v[80:83]
    buffer_load_dwordx4 a[96:99], v9, s[8:11], s24 offen offset:0 sc1
    v_mfma_f32_16x16x32_bf16 v[80:83], a[184:187], a[0:3], v[80:83]
    s_waitcnt lgkmcnt(8)
    v_mfma_f32_16x16x32_bf16 v[224:227], a[160:163], a[32:35], v[224:227]
    ds_read_b64_tr_b16 a[184:185], v19 offset:8192
    v_mfma_f32_16x16x32_bf16 v[224:227], a[164:167], a[36:39], v[224:227]
    ds_read_b64_tr_b16 a[186:187], v19 offset:8704
    v_mfma_f32_16x16x32_bf16 v[96:99], a[164:167], a[4:7], v[96:99]
    buffer_load_dwordx4 a[100:103], v9, s[8:11], s24 offen offset:1024 sc1
    v_mfma_f32_16x16x32_bf16 v[96:99], a[160:163], a[0:3], v[96:99]
    v_mfma_f32_16x16x32_bf16 v[100:103], a[160:163], a[8:11], v[100:103]
    v_mfma_f32_16x16x32_bf16 v[100:103], a[164:167], a[12:15], v[100:103]
    ds_read_b64_tr_b16 a[188:189], v19 offset:12288
    v_mfma_f32_16x16x32_bf16 v[104:107], a[164:167], a[20:23], v[104:107]
    ds_read_b64_tr_b16 a[190:191], v19 offset:12800
    s_add_u32 m0, s29, 66560
    v_mfma_f32_16x16x32_bf16 v[104:107], a[160:163], a[16:19], v[104:107]
    buffer_load_dwordx4 v14, s[12:15], s26 offen  lds
    v_mfma_f32_16x16x32_bf16 v[108:111], a[160:163], a[24:27], v[108:111]
    v_mfma_f32_16x16x32_bf16 v[108:111], a[164:167], a[28:31], v[108:111]
    s_waitcnt lgkmcnt(8)
    v_mfma_f32_16x16x32_bf16 v[124:127], a[168:171], a[24:27], v[124:127]
    ds_read_b64_tr_b16 a[160:161], v16 offset:16384
    v_mfma_f32_16x16x32_bf16 v[124:127], a[172:175], a[28:31], v[124:127]
    ds_read_b64_tr_b16 a[162:163], v16 offset:16896
    v_mfma_f32_16x16x32_bf16 v[120:123], a[172:175], a[20:23], v[120:123]
    buffer_load_dwordx4 a[104:107], v9, s[8:11], s24 offen offset:2048 sc1
    v_mfma_f32_16x16x32_bf16 v[120:123], a[168:171], a[16:19], v[120:123]
    v_mfma_f32_16x16x32_bf16 v[116:119], a[168:171], a[8:11], v[116:119]
    ds_read_b64_tr_b16 a[164:165], v16 offset:20480
    v_mfma_f32_16x16x32_bf16 v[116:119], a[172:175], a[12:15], v[116:119]
    ds_read_b64_tr_b16 a[166:167], v16 offset:20992
    s_add_u32 m0, s29, 73728
    v_mfma_f32_16x16x32_bf16 v[112:115], a[172:175], a[4:7], v[112:115]
    buffer_load_dwordx4 v13, s[12:15], s27 offen  lds
    v_mfma_f32_16x16x32_bf16 v[112:115], a[168:171], a[0:3], v[112:115]
    s_waitcnt lgkmcnt(8)
    v_mfma_f32_16x16x32_bf16 v[128:131], a[176:179], a[0:3], v[128:131]
    ds_read_b64_tr_b16 a[168:169], v17 offset:16384
    v_mfma_f32_16x16x32_bf16 v[128:131], a[180:183], a[4:7], v[128:131]
    ds_read_b64_tr_b16 a[170:171], v17 offset:16896
    v_mfma_f32_16x16x32_bf16 v[132:135], a[180:183], a[12:15], v[132:135]
    buffer_load_dwordx4 a[108:111], v9, s[8:11], s24 offen offset:3072 sc1
    v_mfma_f32_16x16x32_bf16 v[132:135], a[176:179], a[8:11], v[132:135]
    v_mfma_f32_16x16x32_bf16 v[136:139], a[176:179], a[16:19], v[136:139]
    ds_read_b64_tr_b16 a[172:173], v17 offset:20480
    v_mfma_f32_16x16x32_bf16 v[136:139], a[180:183], a[20:23], v[136:139]
    ds_read_b64_tr_b16 a[174:175], v17 offset:20992
    v_mfma_f32_16x16x32_bf16 v[140:143], a[180:183], a[28:31], v[140:143]
    buffer_load_dwordx4 a[112:115], v10, s[8:11], s24 offen offset:0 sc1
    v_mfma_f32_16x16x32_bf16 v[140:143], a[176:179], a[24:27], v[140:143]
    s_waitcnt lgkmcnt(8)
    v_mfma_f32_16x16x32_bf16 v[156:159], a[184:187], a[24:27], v[156:159]
    ds_read_b64_tr_b16 a[176:177], v18 offset:16384
    v_mfma_f32_16x16x32_bf16 v[156:159], a[188:191], a[28:31], v[156:159]
    ds_read_b64_tr_b16 a[178:179], v18 offset:16896
    s_add_u32 m0, s29, 74752
    v_mfma_f32_16x16x32_bf16 v[152:155], a[188:191], a[20:23], v[152:155]
    buffer_load_dwordx4 v14, s[12:15], s27 offen  lds
    v_mfma_f32_16x16x32_bf16 v[152:155], a[184:187], a[16:19], v[152:155]
    v_mfma_f32_16x16x32_bf16 v[148:151], a[184:187], a[8:11], v[148:151]
    ds_read_b64_tr_b16 a[180:181], v18 offset:20480
    v_mfma_f32_16x16x32_bf16 v[148:151], a[188:191], a[12:15], v[148:151]
    ds_read_b64_tr_b16 a[182:183], v18 offset:20992
    v_mfma_f32_16x16x32_bf16 v[144:147], a[188:191], a[4:7], v[144:147]
    buffer_load_dwordx4 a[116:119], v10, s[8:11], s24 offen offset:1024 sc1
    v_mfma_f32_16x16x32_bf16 v[144:147], a[184:187], a[0:3], v[144:147]
    s_add_u32 s24, s24, 0x40000
    s_add_u32 s25, s25, 393216
    s_add_u32 s26, s26, 393216
    s_add_u32 s27, s27, 393216
    s_waitcnt lgkmcnt(8)
    v_mfma_f32_16x16x32_bf16 v[228:231], a[32:35], a[160:163], v[228:231]
    ds_read_b64_tr_b16 a[184:185], v19 offset:16384
    v_mfma_f32_16x16x32_bf16 v[228:231], a[36:39], a[164:167], v[228:231]
    ds_read_b64_tr_b16 a[186:187], v19 offset:16896
    v_mfma_f32_16x16x32_bf16 v[160:163], a[4:7], a[164:167], v[160:163]
    buffer_load_dword a252, v11, s[12:15], s33 offen
    s_add_u32 s33, s33, 393216
    v_mfma_f32_16x16x32_bf16 v[160:163], a[0:3], a[160:163], v[160:163]
    v_mfma_f32_16x16x32_bf16 v[164:167], a[8:11], a[160:163], v[164:167]
    v_mfma_f32_16x16x32_bf16 v[164:167], a[12:15], a[164:167], v[164:167]
    ds_read_b64_tr_b16 a[188:189], v19 offset:20480
    v_mfma_f32_16x16x32_bf16 v[168:171], a[20:23], a[164:167], v[168:171]
    ds_read_b64_tr_b16 a[190:191], v19 offset:20992
    buffer_load_dword a253, v5, s[64:67], s68 offen
    s_add_u32 s68, s68, 524288
    v_mfma_f32_16x16x32_bf16 v[168:171], a[16:19], a[160:163], v[168:171]
    v_mfma_f32_16x16x32_bf16 v[172:175], a[24:27], a[160:163], v[172:175]
    buffer_load_dword a253, v5, s[60:63], s69 offen
    s_add_u32 s69, s69, 524288
    s_cmp_lg_u32 s31, 1
    s_cbranch_scc1 L_xr0
    s_add_u32 s48, s75, 0
    buffer_load_dwordx4 a[232:235], v30, s[40:43], s48 offen nt
L_xr0:
    v_mfma_f32_16x16x32_bf16 v[172:175], a[28:31], a[164:167], v[172:175]
    s_waitcnt lgkmcnt(8)
    v_mfma_f32_16x16x32_bf16 v[188:191], a[24:27], a[168:171], v[188:191]
    s_waitcnt vmcnt(19)
    s_barrier
    ds_read_b64_tr_b16 a[160:161], v16 offset:28672
    v_mfma_f32_16x16x32_bf16 v[188:191], a[28:31], a[172:175], v[188:191]
    ds_read_b64_tr_b16 a[162:163], v16 offset:29184
    v_mfma_f32_16x16x32_bf16 v[184:187], a[20:23], a[172:175], v[184:187]
    v_mfma_f32_16x16x32_bf16 v[184:187], a[16:19], a[168:171], v[184:187]
    v_mfma_f32_16x16x32_bf16 v[180:183], a[8:11], a[168:171], v[180:183]
    ds_read_b64_tr_b16 a[164:165], v16 offset:32768
    v_mfma_f32_16x16x32_bf16 v[180:183], a[12:15], a[172:175], v[180:183]
    ds_read_b64_tr_b16 a[166:167], v16 offset:33280
    v_mfma_f32_16x16x32_bf16 v[176:179], a[4:7], a[172:175], v[176:179]
    v_mfma_f32_16x16x32_bf16 v[176:179], a[0:3], a[168:171], v[176:179]
    s_waitcnt lgkmcnt(8)
    v_mfma_f32_16x16x32_bf16 v[192:195], a[0:3], a[176:179], v[192:195]
    ds_read_b64_tr_b16 a[168:169], v17 offset:28672
    v_mfma_f32_16x16x32_bf16 v[192:195], a[4:7], a[180:183], v[192:195]
    ds_read_b64_tr_b16 a[170:171], v17 offset:29184
    v_mfma_f32_16x16x32_bf16 v[196:199], a[12:15], a[180:183], v[196:199]
    v_mfma_f32_16x16x32_bf16 v[196:199], a[8:11], a[176:179], v[196:199]
    v_mfma_f32_16x16x32_bf16 v[200:203], a[16:19], a[176:179], v[200:203]
    ds_read_b64_tr_b16 a[172:173], v17 offset:32768
    v_mfma_f32_16x16x32_bf16 v[200:203], a[20:23], a[180:183], v[200:203]
    ds_read_b64_tr_b16 a[174:175], v17 offset:33280
    v_mfma_f32_16x16x32_bf16 v[204:207], a[28:31], a[180:183], v[204:207]
    v_mfma_f32_16x16x32_bf16 v[204:207], a[24:27], a[176:179], v[204:207]
    s_waitcnt lgkmcnt(8)
    v_mfma_f32_16x16x32_bf16 v[220:223], a[24:27], a[184:187], v[220:223]
    ds_read_b64_tr_b16 a[176:177], v18 offset:28672
    v_mfma_f32_16x16x32_bf16 v[220:223], a[28:31], a[188:191], v[220:223]
    ds_read_b64_tr_b16 a[178:179], v18 offset:29184
    v_mfma_f32_16x16x32_bf16 v[216:219], a[20:23], a[188:191], v[216:219]
    v_mfma_f32_16x16x32_bf16 v[216:219], a[16:19], a[184:187], v[216:219]
    v_mfma_f32_16x16x32_bf16 v[212:215], a[8:11], a[184:187], v[212:215]
    ds_read_b64_tr_b16 a[180:181], v18 offset:32768
    v_mfma_f32_16x16x32_bf16 v[212:215], a[12:15], a[188:191], v[212:215]
    ds_read_b64_tr_b16 a[182:183], v18 offset:33280
    v_mfma_f32_16x16x32_bf16 v[208:211], a[4:7], a[188:191], v[208:211]
    v_mfma_f32_16x16x32_bf16 v[208:211], a[0:3], a[184:187], v[208:211]
    s_waitcnt lgkmcnt(8)
    v_mfma_f32_16x16x32_bf16 v[32:35], a[160:163], a[40:43], v[32:35]
    ds_read_b64_tr_b16 a[184:185], v19 offset:28672
    v_mfma_f32_16x16x32_bf16 v[32:35], a[164:167], a[44:47], v[32:35]
    ds_read_b64_tr_b16 a[186:187], v19 offset:29184
    v_mfma_f32_16x16x32_bf16 v[36:39], a[164:167], a[52:55], v[36:39]
    buffer_load_dwordx4 a[120:123], v8, s[8:11], s24 offen offset:0 sc1
    v_mfma_f32_16x16x32_bf16 v[36:39], a[160:163], a[48:51], v[36:39]
    v_mfma_f32_16x16x32_bf16 v[40:43], a[160:163], a[56:59], v[40:43]
    ds_read_b64_tr_b16 a[188:189], v19 offset:32768
    v_mfma_f32_16x16x32_bf16 v[40:43], a[164:167], a[60:63], v[40:43]
    ds_read_b64_tr_b16 a[190:191], v19 offset:33280
    s_add_u32 m0, s29, 81920
    v_mfma_f32_16x16x32_bf16 v[44:47], a[164:167], a[68:71], v[44:47]
    buffer_load_dwordx4 v13, s[12:15], s25 offen  lds
    v_mfma_f32_16x16x32_bf16 v[44:47], a[160:163], a[64:67], v[44:47]
    s_waitcnt lgkmcnt(8)
    v_mfma_f32_16x16x32_bf16 v[60:63], a[168:171], a[64:67], v[60:63]
    ds_read_b64_tr_b16 a[160:161], v16 offset:36864
    v_mfma_f32_16x16x32_bf16 v[60:63], a[172:175], a[68:71], v[60:63]
    ds_read_b64_tr_b16 a[162:163], v16 offset:37376
    v_mfma_f32_16x16x32_bf16 v[56:59], a[172:175], a[60:63], v[56:59]
    buffer_load_dwordx4 a[124:127], v8, s[8:11], s24 offen offset:1024 sc1
    v_mfma_f32_16x16x32_bf16 v[56:59], a[168:171], a[56:59], v[56:59]
    v_mfma_f32_16x16x32_bf16 v[52:55], a[168:171], a[48:51], v[52:55]
    ds_read_b64_tr_b16 a[164:165], v16 offset:40960
    v_mfma_f32_16x16x32_bf16 v[52:55], a[172:175], a[52:55], v[52:55]
    ds_read_b64_tr_b16 a[166:167], v16 offset:41472
    v_mfma_f32_16x16x32_bf16 v[48:51], a[172:175], a[44:47], v[48:51]
    buffer_load_dwordx4 a[128:131], v8, s[8:11], s24 offen offset:2048 sc1
    v_mfma_f32_16x16x32_bf16 v[48:51], a[168:171], a[40:43], v[48:51]
    s_waitcnt lgkmcnt(8)
    v_mfma_f32_16x16x32_bf16 v[64:67], a[176:179], a[40:43], v[64:67]
    ds_read_b64_tr_b16 a[168:169], v17 offset:36864
    v_mfma_f32_16x16x32_bf16 v[64:67], a[180:183], a[44:47], v[64:67]
    ds_read_b64_tr_b16 a[170:171], v17 offset:37376
    s_add_u32 m0, s29, 82944
    v_mfma_f32_16x16x32_bf16 v[68:71], a[180:183], a[52:55], v[68:71]
    buffer_load_dwordx4 v14, s[12:15], s25 offen  lds
    v_mfma_f32_16x16x32_bf16 v[68:71], a[176:179], a[48:51], v[68:71]
    v_mfma_f32_16x16x32_bf16 v[72:75], a[176:179], a[56:59], v[72:75]
    ds_read_b64_tr_b16 a[172:173], v17 offset:40960
    v_mfma_f32_16x16x32_bf16 v[72:75], a[180:183], a[60:63], v[72:75]
    ds_read_b64_tr_b16 a[174:175], v17 offset:41472
    v_mfma_f32_16x16x32_bf16 v[76:79], a[180:183], a[68:71], v[76:79]
    buffer_load_dwordx4 a[132:135], v8, s[8:11], s24 offen offset:3072 sc1
    v_mfma_f32_16x16x32_bf16 v[76:79], a[176:179], a[64:67], v[76:79]
    s_waitcnt lgkmcnt(8)
    v_mfma_f32_16x16x32_bf16 v[92:95], a[184:187], a[64:67], v[92:95]
    ds_read_b64_tr_b16 a[176:177], v18 offset:36864
    v_mfma_f32_16x16x32_bf16 v[92:95], a[188:191], a[68:71], v[92:95]
    ds_read_b64_tr_b16 a[178:179], v18 offset:37376
    s_add_u32 m0, s29, 90112
    v_mfma_f32_16x16x32_bf16 v[88:91], a[188:191], a[60:63], v[88:91]
    buffer_load_dwordx4 v13, s[12:15], s26 offen  lds
    v_mfma_f32_16x16x32_bf16 v[88:91], a[184:187], a[56:59], v[88:91]
    v_mfma_f32_16x16x32_bf16 v[84:87], a[184:187], a[48:51], v[84:87]
    ds_read_b64_tr_b16 a[180:181], v18 offset:40960
    v_mfma_f32_16x16x32_bf16 v[84:87], a[188:191], a[52:55], v[84:87]
    ds_read_b64_tr_b16 a[182:183], v18 offset:41472
    v_mfma_f32_16x16x32_bf16 v[80:83], a[188:191], a[44:47], v[80:83]
    buffer_load_dwordx4 a[136:139], v9, s[8:11], s24 offen offset:0 sc1
    v_mfma_f32_16x16x32_bf16 v[80:83], a[184:187], a[40:43], v[80:83]
    s_waitcnt lgkmcnt(8)
    v_mfma_f32_16x16x32_bf16 v[224:227], a[160:163], a[72:75], v[224:227]
    ds_read_b64_tr_b16 a[184:185], v19 offset:36864
    v_mfma_f32_16x16x32_bf16 v[224:227], a[164:167], a[76:79], v[224:227]
    ds_read_b64_tr_b16 a[186:187], v19 offset:37376
    v_mfma_f32_16x16x32_bf16 v[96:99], a[164:167], a[44:47], v[96:99]
    buffer_load_dwordx4 a[140:143], v9, s[8:11], s24 offen offset:1024 sc1
    v_mfma_f32_16x16x32_bf16 v[96:99], a[160:163], a[40:43], v[96:99]
    v_mfma_f32_16x16x32_bf16 v[100:103], a[160:163], a[48:51], v[100:103]
    v_mfma_f32_16x16x32_bf16 v[100:103], a[164:167], a[52:55], v[100:103]
    ds_read_b64_tr_b16 a[188:189], v19 offset:40960
    v_mfma_f32_16x16x32_bf16 v[104:107], a[164:167], a[60:63], v[104:107]
    ds_read_b64_tr_b16 a[190:191], v19 offset:41472
    s_add_u32 m0, s29, 91136
    v_mfma_f32_16x16x32_bf16 v[104:107], a[160:163], a[56:59], v[104:107]
    buffer_load_dwordx4 v14, s[12:15], s26 offen  lds
    v_mfma_f32_16x16x32_bf16 v[108:111], a[160:163], a[64:67], v[108:111]
    v_mfma_f32_16x16x32_bf16 v[108:111], a[164:167], a[68:71], v[108:111]
    s_waitcnt lgkmcnt(8)
    v_mfma_f32_16x16x32_bf16 v[124:127], a[168:171], a[64:67], v[124:127]
    ds_read_b64_tr_b16 a[160:161], v16 offset:45056
    v_mfma_f32_16x16x32_bf16 v[124:127], a[172:175], a[68:71], v[124:127]
    ds_read_b64_tr_b16 a[162:163], v16 offset:45568
    v_mfma_f32_16x16x32_bf16 v[120:123], a[172:175], a[60:63], v[120:123]
    buffer_load_dwordx4 a[144:147], v9, s[8:11], s24 offen offset:2048 sc1
    v_mfma_f32_16x16x32_bf16 v[120:123], a[168:171], a[56:59], v[120:123]
    v_mfma_f32_16x16x32_bf16 v[116:119], a[168:171], a[48:51], v[116:119]
    ds_read_b64_tr_b16 a[164:165], v16 offset:49152
    v_mfma_f32_16x16x32_bf16 v[116:119], a[172:175], a[52:55], v[116:119]
    ds_read_b64_tr_b16 a[166:167], v16 offset:49664
    s_add_u32 m0, s29, 98304
    v_mfma_f32_16x16x32_bf16 v[112:115], a[172:175], a[44:47], v[112:115]
    buffer_load_dwordx4 v13, s[12:15], s27 offen  lds
    v_mfma_f32_16x16x32_bf16 v[112:115], a[168:171], a[40:43], v[112:115]
    s_waitcnt lgkmcnt(8)
    v_mfma_f32_16x16x32_bf16 v[128:131], a[176:179], a[40:43], v[128:131]
    ds_read_b64_tr_b16 a[168:169], v17 offset:45056
    v_mfma_f32_16x16x32_bf16 v[128:131], a[180:183], a[44:47], v[128:131]
    ds_read_b64_tr_b16 a[170:171], v17 offset:45568
    v_mfma_f32_16x16x32_bf16 v[132:135], a[180:183], a[52:55], v[132:135]
    buffer_load_dwordx4 a[148:151], v9, s[8:11], s24 offen offset:3072 sc1
    v_mfma_f32_16x16x32_bf16 v[132:135], a[176:179], a[48:51], v[132:135]
    v_mfma_f32_16x16x32_bf16 v[136:139], a[176:179], a[56:59], v[136:139]
    ds_read_b64_tr_b16 a[172:173], v17 offset:49152
    v_mfma_f32_16x16x32_bf16 v[136:139], a[180:183], a[60:63], v[136:139]
    ds_read_b64_tr_b16 a[174:175], v17 offset:49664
    v_mfma_f32_16x16x32_bf16 v[140:143], a[180:183], a[68:71], v[140:143]
    buffer_load_dwordx4 a[152:155], v10, s[8:11], s24 offen offset:0 sc1
    v_mfma_f32_16x16x32_bf16 v[140:143], a[176:179], a[64:67], v[140:143]
    s_waitcnt lgkmcnt(8)
    v_mfma_f32_16x16x32_bf16 v[156:159], a[184:187], a[64:67], v[156:159]
    ds_read_b64_tr_b16 a[176:177], v18 offset:45056
    v_mfma_f32_16x16x32_bf16 v[156:159], a[188:191], a[68:71], v[156:159]
    ds_read_b64_tr_b16 a[178:179], v18 offset:45568
    s_add_u32 m0, s29, 99328
    v_mfma_f32_16x16x32_bf16 v[152:155], a[188:191], a[60:63], v[152:155]
    buffer_load_dwordx4 v14, s[12:15], s27 offen  lds
    v_mfma_f32_16x16x32_bf16 v[152:155], a[184:187], a[56:59], v[152:155]
    v_mfma_f32_16x16x32_bf16 v[148:151], a[184:187], a[48:51], v[148:151]
    ds_read_b64_tr_b16 a[180:181], v18 offset:49152
    v_mfma_f32_16x16x32_bf16 v[148:151], a[188:191], a[52:55], v[148:151]
    ds_read_b64_tr_b16 a[182:183], v18 offset:49664
    v_mfma_f32_16x16x32_bf16 v[144:147], a[188:191], a[44:47], v[144:147]
    buffer_load_dwordx4 a[156:159], v10, s[8:11], s24 offen offset:1024 sc1
    v_mfma_f32_16x16x32_bf16 v[144:147], a[184:187], a[40:43], v[144:147]
    s_add_u32 s24, s24, 0x40000
    s_add_u32 s25, s25, 393216
    s_add_u32 s26, s26, 393216
    s_add_u32 s27, s27, 393216
    s_waitcnt lgkmcnt(8)
    v_mfma_f32_16x16x32_bf16 v[228:231], a[72:75], a[160:163], v[228:231]
    ds_read_b64_tr_b16 a[184:185], v19 offset:45056
    v_mfma_f32_16x16x32_bf16 v[228:231], a[76:79], a[164:167], v[228:231]
    ds_read_b64_tr_b16 a[186:187], v19 offset:45568
    v_mfma_f32_16x16x32_bf16 v[160:163], a[44:47], a[164:167], v[160:163]
    buffer_load_dword a252, v11, s[12:15], s33 offen
    s_add_u32 s33, s33, 393216
    v_mfma_f32_16x16x32_bf16 v[160:163], a[40:43], a[160:163], v[160:163]
    v_mfma_f32_16x16x32_bf16 v[164:167], a[48:51], a[160:163], v[164:167]
    v_mfma_f32_16x16x32_bf16 v[164:167], a[52:55], a[164:167], v[164:167]
    ds_read_b64_tr_b16 a[188:189], v19 offset:49152
    v_mfma_f32_16x16x32_bf16 v[168:171], a[60:63], a[164:167], v[168:171]
    ds_read_b64_tr_b16 a[190:191], v19 offset:49664
    v_mfma_f32_16x16x32_bf16 v[168:171], a[56:59], a[160:163], v[168:171]
    buffer_load_dword a253, v5, s[64:67], s68 offen
    s_add_u32 s68, s68, 524288
    v_mfma_f32_16x16x32_bf16 v[172:175], a[64:67], a[160:163], v[172:175]
    s_cmp_lg_u32 s31, 1
    s_cbranch_scc1 L_xr1
    s_add_u32 s48, s75, 32768
    buffer_load_dwordx4 a[236:239], v30, s[40:43], s48 offen nt
L_xr1:
    v_mfma_f32_16x16x32_bf16 v[172:175], a[68:71], a[164:167], v[172:175]
    s_waitcnt lgkmcnt(8)
    v_mfma_f32_16x16x32_bf16 v[188:191], a[64:67], a[168:171], v[188:191]
    s_waitcnt vmcnt(21)
    s_barrier
    ds_read_b64_tr_b16 a[160:161], v20 offset:0
    v_mfma_f32_16x16x32_bf16 v[188:191], a[68:71], a[172:175], v[188:191]
    ds_read_b64_tr_b16 a[162:163], v20 offset:512
    v_mfma_f32_16x16x32_bf16 v[184:187], a[60:63], a[172:175], v[184:187]
    v_mfma_f32_16x16x32_bf16 v[184:187], a[56:59], a[168:171], v[184:187]
    v_mfma_f32_16x16x32_bf16 v[180:183], a[48:51], a[168:171], v[180:183]
    ds_read_b64_tr_b16 a[164:165], v20 offset:4096
    v_mfma_f32_16x16x32_bf16 v[180:183], a[52:55], a[172:175], v[180:183]
    ds_read_b64_tr_b16 a[166:167], v20 offset:4608
    v_mfma_f32_16x16x32_bf16 v[176:179], a[44:47], a[172:175], v[176:179]
    v_mfma_f32_16x16x32_bf16 v[176:179], a[40:43], a[168:171], v[176:179]
    s_waitcnt lgkmcnt(8)
    v_mfma_f32_16x16x32_bf16 v[192:195], a[40:43], a[176:179], v[192:195]
    ds_read_b64_tr_b16 a[168:169], v21 offset:0
    v_mfma_f32_16x16x32_bf16 v[192:195], a[44:47], a[180:183], v[192:195]
    ds_read_b64_tr_b16 a[170:171], v21 offset:512
    v_mfma_f32_16x16x32_bf16 v[196:199], a[52:55], a[180:183], v[196:199]
    v_mfma_f32_16x16x32_bf16 v[196:199], a[48:51], a[176:179], v[196:199]
    v_mfma_f32_16x16x32_bf16 v[200:203], a[56:59], a[176:179], v[200:203]
    ds_read_b64_tr_b16 a[172:173], v21 offset:4096
    v_mfma_f32_16x16x32_bf16 v[200:203], a[60:63], a[180:183], v[200:203]
    ds_read_b64_tr_b16 a[174:175], v21 offset:4608
    v_mfma_f32_16x16x32_bf16 v[204:207], a[68:71], a[180:183], v[204:207]
    v_mfma_f32_16x16x32_bf16 v[204:207], a[64:67], a[176:179], v[204:207]
    s_waitcnt lgkmcnt(8)
    v_mfma_f32_16x16x32_bf16 v[220:223], a[64:67], a[184:187], v[220:223]
    ds_read_b64_tr_b16 a[176:177], v22 offset:0
    v_mfma_f32_16x16x32_bf16 v[220:223], a[68:71], a[188:191], v[220:223]
    ds_read_b64_tr_b16 a[178:179], v22 offset:512
    v_mfma_f32_16x16x32_bf16 v[216:219], a[60:63], a[188:191], v[216:219]
    v_mfma_f32_16x16x32_bf16 v[216:219], a[56:59], a[184:187], v[216:219]
    v_mfma_f32_16x16x32_bf16 v[212:215], a[48:51], a[184:187], v[212:215]
    ds_read_b64_tr_b16 a[180:181], v22 offset:4096
    v_mfma_f32_16x16x32_bf16 v[212:215], a[52:55], a[188:191], v[212:215]
    ds_read_b64_tr_b16 a[182:183], v22 offset:4608
    v_mfma_f32_16x16x32_bf16 v[208:211], a[44:47], a[188:191], v[208:211]
    v_mfma_f32_16x16x32_bf16 v[208:211], a[40:43], a[184:187], v[208:211]
    s_waitcnt lgkmcnt(8)
    v_mfma_f32_16x16x32_bf16 v[32:35], a[160:163], a[80:83], v[32:35]
    ds_read_b64_tr_b16 a[184:185], v23 offset:0
    v_mfma_f32_16x16x32_bf16 v[32:35], a[164:167], a[84:87], v[32:35]
    ds_read_b64_tr_b16 a[186:187], v23 offset:512
    v_mfma_f32_16x16x32_bf16 v[36:39], a[164:167], a[92:95], v[36:39]
    buffer_load_dwordx4 a[0:3], v8, s[8:11], s24 offen offset:0 sc1
    v_mfma_f32_16x16x32_bf16 v[36:39], a[160:163], a[88:91], v[36:39]
    v_mfma_f32_16x16x32_bf16 v[40:43], a[160:163], a[96:99], v[40:43]
    ds_read_b64_tr_b16 a[188:189], v23 offset:4096
    v_mfma_f32_16x16x32_bf16 v[40:43], a[164:167], a[100:103], v[40:43]
    ds_read_b64_tr_b16 a[190:191], v23 offset:4608
    s_add_u32 m0, s29, 0
    v_mfma_f32_16x16x32_bf16 v[44:47], a[164:167], a[108:111], v[44:47]
    buffer_load_dwordx4 v13, s[12:15], s25 offen  lds
    v_mfma_f32_16x16x32_bf16 v[44:47], a[160:163], a[104:107], v[44:47]
    s_waitcnt lgkmcnt(8)
    v_mfma_f32_16x16x32_bf16 v[60:63], a[168:171], a[104:107], v[60:63]
    ds_read_b64_tr_b16 a[160:161], v20 offset:8192
    v_mfma_f32_16x16x32_bf16 v[60:63], a[172:175], a[108:111], v[60:63]
    ds_read_b64_tr_b16 a[162:163], v20 offset:8704
    v_mfma_f32_16x16x32_bf16 v[56:59], a[172:175], a[100:103], v[56:59]
    buffer_load_dwordx4 a[4:7], v8, s[8:11], s24 offen offset:1024 sc1
    v_mfma_f32_16x16x32_bf16 v[56:59], a[168:171], a[96:99], v[56:59]
    v_mfma_f32_16x16x32_bf16 v[52:55], a[168:171], a[88:91], v[52:55]
    ds_read_b64_tr_b16 a[164:165], v20 offset:12288
    v_mfma_f32_16x16x32_bf16 v[52:55], a[172:175], a[92:95], v[52:55]
    ds_read_b64_tr_b16 a[166:167], v20 offset:12800
    v_mfma_f32_16x16x32_bf16 v[48:51], a[172:175], a[84:87], v[48:51]
    buffer_load_dwordx4 a[8:11], v8, s[8:11], s24 offen offset:2048 sc1
    v_mfma_f32_16x16x32_bf16 v[48:51], a[168:171], a[80:83], v[48:51]
    s_waitcnt lgkmcnt(8)
    v_mfma_f32_16x16x32_bf16 v[64:67], a[176:179], a[80:83], v[64:67]
    ds_read_b64_tr_b16 a[168:169], v21 offset:8192
    v_mfma_f32_16x16x32_bf16 v[64:67], a[180:183], a[84:87], v[64:67]
    ds_read_b64_tr_b16 a[170:171], v21 offset:8704
    s_add_u32 m0, s29, 1024
    v_mfma_f32_16x16x32_bf16 v[68:71], a[180:183], a[92:95], v[68:71]
    buffer_load_dwordx4 v14, s[12:15], s25 offen  lds
    v_mfma_f32_16x16x32_bf16 v[68:71], a[176:179], a[88:91], v[68:71]
    v_mfma_f32_16x16x32_bf16 v[72:75], a[176:179], a[96:99], v[72:75]
    ds_read_b64_tr_b16 a[172:173], v21 offset:12288
    v_mfma_f32_16x16x32_bf16 v[72:75], a[180:183], a[100:103], v[72:75]
    ds_read_b64_tr_b16 a[174:175], v21 offset:12800
    v_mfma_f32_16x16x32_bf16 v[76:79], a[180:183], a[108:111], v[76:79]
    buffer_load_dwordx4 a[12:15], v8, s[8:11], s24 offen offset:3072 sc1
    v_mfma_f32_16x16x32_bf16 v[76:79], a[176:179], a[104:107], v[76:79]
    s_waitcnt lgkmcnt(8)
    v_mfma_f32_16x16x32_bf16 v[92:95], a[184:187], a[104:107], v[92:95]
    ds_read_b64_tr_b16 a[176:177], v22 offset:8192
    v_mfma_f32_16x16x32_bf16 v[92:95], a[188:191], a[108:111], v[92:95]
    ds_read_b64_tr_b16 a[178:179], v22 offset:8704
    s_add_u32 m0, s29, 8192
    v_mfma_f32_16x16x32_bf16 v[88:91], a[188:191], a[100:103], v[88:91]
    buffer_load_dwordx4 v13, s[12:15], s26 offen  lds
    v_mfma_f32_16x16x32_bf16 v[88:91], a[184:187], a[96:99], v[88:91]
    v_mfma_f32_16x16x32_bf16 v[84:87], a[184:187], a[88:91], v[84:87]
    ds_read_b64_tr_b16 a[180:181], v22 offset:12288
    v_mfma_f32_16x16x32_bf16 v[84:87], a[188:191], a[92:95], v[84:87]
    ds_read_b64_tr_b16 a[182:183], v22 offset:12800
    v_mfma_f32_16x16x32_bf16 v[80:83], a[188:191], a[84:87], v[80:83]
    buffer_load_dwordx4 a[16:19], v9, s[8:11], s24 offen offset:0 sc1
    v_mfma_f32_16x16x32_bf16 v[80:83], a[184:187], a[80:83], v[80:83]
    s_waitcnt lgkmcnt(8)
    v_mfma_f32_16x16x32_bf16 v[224:227], a[160:163], a[112:115], v[224:227]
    ds_read_b64_tr_b16 a[184:185], v23 offset:8192
    v_mfma_f32_16x16x32_bf16 v[224:227], a[164:167], a[116:119], v[224:227]
    ds_read_b64_tr_b16 a[186:187], v23 offset:8704
    v_mfma_f32_16x16x32_bf16 v[96:99], a[164:167], a[84:87], v[96:99]
    buffer_load_dwordx4 a[20:23], v9, s[8:11], s24 offen offset:1024 sc1
    v_mfma_f32_16x16x32_bf16 v[96:99], a[160:163], a[80:83], v[96:99]
    v_mfma_f32_16x16x32_bf16 v[100:103], a[160:163], a[88:91], v[100:103]
    v_mfma_f32_16x16x32_bf16 v[100:103], a[164:167], a[92:95], v[100:103]
    ds_read_b64_tr_b16 a[188:189], v23 offset:12288
    v_mfma_f32_16x16x32_bf16 v[104:107], a[164:167], a[100:103], v[104:107]
    ds_read_b64_tr_b16 a[190:191], v23 offset:12800
    s_add_u32 m0, s29, 9216
    v_mfma_f32_16x16x32_bf16 v[104:107], a[160:163], a[96:99], v[104:107]
    buffer_load_dwordx4 v14, s[12:15], s26 offen  lds
    v_mfma_f32_16x16x32_bf16 v[108:111], a[160:163], a[104:107], v[108:111]
    v_mfma_f32_16x16x32_bf16 v[108:111], a[164:167], a[108:111], v[108:111]
    s_waitcnt lgkmcnt(8)
    v_mfma_f32_16x16x32_bf16 v[124:127], a[168:171], a[104:107], v[124:127]
    ds_read_b64_tr_b16 a[160:161], v20 offset:16384
    v_mfma_f32_16x16x32_bf16 v[124:127], a[172:175], a[108:111], v[124:127]
    ds_read_b64_tr_b16 a[162:163], v20 offset:16896
    v_mfma_f32_16x16x32_bf16 v[120:123], a[172:175], a[100:103], v[120:123]
    buffer_load_dwordx4 a[24:27], v9, s[8:11], s24 offen offset:2048 sc1
    v_mfma_f32_16x16x32_bf16 v[120:123], a[168:171], a[96:99], v[120:123]
    v_mfma_f32_16x16x32_bf16 v[116:119], a[168:171], a[88:91], v[116:119]
    ds_read_b64_tr_b16 a[164:165], v20 offset:20480
    v_mfma_f32_16x16x32_bf16 v[116:119], a[172:175], a[92:95], v[116:119]
    ds_read_b64_tr_b16 a[166:167], v20 offset:20992
    s_add_u32 m0, s29, 16384
    v_mfma_f32_16x16x32_bf16 v[112:115], a[172:175], a[84:87], v[112:115]
    buffer_load_dwordx4 v13, s[12:15], s27 offen  lds
    v_mfma_f32_16x16x32_bf16 v[112:115], a[168:171], a[80:83], v[112:115]
    s_waitcnt lgkmcnt(8)
    v_mfma_f32_16x16x32_bf16 v[128:131], a[176:179], a[80:83], v[128:131]
    ds_read_b64_tr_b16 a[168:169], v21 offset:16384
    v_mfma_f32_16x16x32_bf16 v[128:131], a[180:183], a[84:87], v[128:131]
    ds_read_b64_tr_b16 a[170:171], v21 offset:16896
    v_mfma_f32_16x16x32_bf16 v[132:135], a[180:183], a[92:95], v[132:135]
    buffer_load_dwordx4 a[28:31], v9, s[8:11], s24 offen offset:3072 sc1
    v_mfma_f32_16x16x32_bf16 v[132:135], a[176:179], a[88:91], v[132:135]
    v_mfma_f32_16x16x32_bf16 v[136:139], a[176:179], a[96:99], v[136:139]
    ds_read_b64_tr_b16 a[172:173], v21 offset:20480
    v_mfma_f32_16x16x32_bf16 v[136:139], a[180:183], a[100:103], v[136:139]
    ds_read_b64_tr_b16 a[174:175], v21 offset:20992
    v_mfma_f32_16x16x32_bf16 v[140:143], a[180:183], a[108:111], v[140:143]
    buffer_load_dwordx4 a[32:35], v10, s[8:11], s24 offen offset:0 sc1
    v_mfma_f32_16x16x32_bf16 v[140:143], a[176:179], a[104:107], v[140:143]
    s_waitcnt lgkmcnt(8)
    v_mfma_f32_16x16x32_bf16 v[156:159], a[184:187], a[104:107], v[156:159]
    ds_read_b64_tr_b16 a[176:177], v22 offset:16384
    v_mfma_f32_16x16x32_bf16 v[156:159], a[188:191], a[108:111], v[156:159]
    ds_read_b64_tr_b16 a[178:179], v22 offset:16896
    s_add_u32 m0, s29, 17408
    v_mfma_f32_16x16x32_bf16 v[152:155], a[188:191], a[100:103], v[152:155]
    buffer_load_dwordx4 v14, s[12:15], s27 offen  lds
    v_mfma_f32_16x16x32_bf16 v[152:155], a[184:187], a[96:99], v[152:155]
    v_mfma_f32_16x16x32_bf16 v[148:151], a[184:187], a[88:91], v[148:151]
    ds_read_b64_tr_b16 a[180:181], v22 offset:20480
    v_mfma_f32_16x16x32_bf16 v[148:151], a[188:191], a[92:95], v[148:151]
    ds_read_b64_tr_b16 a[182:183], v22 offset:20992
    v_mfma_f32_16x16x32_bf16 v[144:147], a[188:191], a[84:87], v[144:147]
    buffer_load_dwordx4 a[36:39], v10, s[8:11], s24 offen offset:1024 sc1
    v_mfma_f32_16x16x32_bf16 v[144:147], a[184:187], a[80:83], v[144:147]
    s_add_u32 s24, s24, 0x40000
    s_add_u32 s25, s25, 393216
    s_add_u32 s26, s26, 393216
    s_add_u32 s27, s27, 393216
    s_waitcnt lgkmcnt(8)
    v_mfma_f32_16x16x32_bf16 v[228:231], a[112:115], a[160:163], v[228:231]
    ds_read_b64_tr_b16 a[184:185], v23 offset:16384
    v_mfma_f32_16x16x32_bf16 v[228:231], a[116:119], a[164:167], v[228:231]
    ds_read_b64_tr_b16 a[186:187], v23 offset:16896
    v_mfma_f32_16x16x32_bf16 v[160:163], a[84:87], a[164:167], v[160:163]
    buffer_load_dword a252, v11, s[12:15], s33 offen
    s_add_u32 s33, s33, 393216
    v_mfma_f32_16x16x32_bf16 v[160:163], a[80:83], a[160:163], v[160:163]
    v_mfma_f32_16x16x32_bf16 v[164:167], a[88:91], a[160:163], v[164:167]
    v_mfma_f32_16x16x32_bf16 v[164:167], a[92:95], a[164:167], v[164:167]
    ds_read_b64_tr_b16 a[188:189], v23 offset:20480
    v_mfma_f32_16x16x32_bf16 v[168:171], a[100:103], a[164:167], v[168:171]
    ds_read_b64_tr_b16 a[190:191], v23 offset:20992
    buffer_load_dword a253, v5, s[64:67], s68 offen
    s_add_u32 s68, s68, 524288
    v_mfma_f32_16x16x32_bf16 v[168:171], a[96:99], a[160:163], v[168:171]
    v_mfma_f32_16x16x32_bf16 v[172:175], a[104:107], a[160:163], v[172:175]
    buffer_load_dword a253, v5, s[64:67], s68 offen
    s_add_u32 s68, s68, 524288
    s_cmp_lg_u32 s31, 1
    s_cbranch_scc1 L_xr2
    s_add_u32 s48, s75, 65536
    buffer_load_dwordx4 a[240:243], v30, s[40:43], s48 offen nt
L_xr2:
    v_mfma_f32_16x16x32_bf16 v[172:175], a[108:111], a[164:167], v[172:175]
    s_waitcnt lgkmcnt(8)
    v_mfma_f32_16x16x32_bf16 v[188:191], a[104:107], a[168:171], v[188:191]
    s_waitcnt vmcnt(21)
    s_barrier
    ds_read_b64_tr_b16 a[160:161], v20 offset:24576
    v_mfma_f32_16x16x32_bf16 v[188:191], a[108:111], a[172:175], v[188:191]
    ds_read_b64_tr_b16 a[162:163], v20 offset:25088
    v_mfma_f32_16x16x32_bf16 v[184:187], a[100:103], a[172:175], v[184:187]
    v_mfma_f32_16x16x32_bf16 v[184:187], a[96:99], a[168:171], v[184:187]
    v_mfma_f32_16x16x32_bf16 v[180:183], a[88:91], a[168:171], v[180:183]
    ds_read_b64_tr_b16 a[164:165], v20 offset:28672
    v_mfma_f32_16x16x32_bf16 v[180:183], a[92:95], a[172:175], v[180:183]
    ds_read_b64_tr_b16 a[166:167], v20 offset:29184
    v_mfma_f32_16x16x32_bf16 v[176:179], a[84:87], a[172:175], v[176:179]
    v_mfma_f32_16x16x32_bf16 v[176:179], a[80:83], a[168:171], v[176:179]
    s_waitcnt lgkmcnt(8)
    v_mfma_f32_16x16x32_bf16 v[192:195], a[80:83], a[176:179], v[192:195]
    ds_read_b64_tr_b16 a[168:169], v21 offset:24576
    v_mfma_f32_16x16x32_bf16 v[192:195], a[84:87], a[180:183], v[192:195]
    ds_read_b64_tr_b16 a[170:171], v21 offset:25088
    v_mfma_f32_16x16x32_bf16 v[196:199], a[92:95], a[180:183], v[196:199]
    v_mfma_f32_16x16x32_bf16 v[196:199], a[88:91], a[176:179], v[196:199]
    v_mfma_f32_16x16x32_bf16 v[200:203], a[96:99], a[176:179], v[200:203]
    ds_read_b64_tr_b16 a[172:173], v21 offset:28672
    v_mfma_f32_16x16x32_bf16 v[200:203], a[100:103], a[180:183], v[200:203]
    ds_read_b64_tr_b16 a[174:175], v21 offset:29184
    v_mfma_f32_16x16x32_bf16 v[204:207], a[108:111], a[180:183], v[204:207]
    v_mfma_f32_16x16x32_bf16 v[204:207], a[104:107], a[176:179], v[204:207]
    s_waitcnt lgkmcnt(8)
    v_mfma_f32_16x16x32_bf16 v[220:223], a[104:107], a[184:187], v[220:223]
    ds_read_b64_tr_b16 a[176:177], v22 offset:24576
    v_mfma_f32_16x16x32_bf16 v[220:223], a[108:111], a[188:191], v[220:223]
    ds_read_b64_tr_b16 a[178:179], v22 offset:25088
    v_mfma_f32_16x16x32_bf16 v[216:219], a[100:103], a[188:191], v[216:219]
    v_mfma_f32_16x16x32_bf16 v[216:219], a[96:99], a[184:187], v[216:219]
    v_mfma_f32_16x16x32_bf16 v[212:215], a[88:91], a[184:187], v[212:215]
    ds_read_b64_tr_b16 a[180:181], v22 offset:28672
    v_mfma_f32_16x16x32_bf16 v[212:215], a[92:95], a[188:191], v[212:215]
    ds_read_b64_tr_b16 a[182:183], v22 offset:29184
    v_mfma_f32_16x16x32_bf16 v[208:211], a[84:87], a[188:191], v[208:211]
    v_mfma_f32_16x16x32_bf16 v[208:211], a[80:83], a[184:187], v[208:211]
    s_waitcnt lgkmcnt(8)
    v_mfma_f32_16x16x32_bf16 v[32:35], a[160:163], a[120:123], v[32:35]
    ds_read_b64_tr_b16 a[184:185], v23 offset:24576
    v_mfma_f32_16x16x32_bf16 v[32:35], a[164:167], a[124:127], v[32:35]
    ds_read_b64_tr_b16 a[186:187], v23 offset:25088
    v_mfma_f32_16x16x32_bf16 v[36:39], a[164:167], a[132:135], v[36:39]
    buffer_load_dwordx4 a[40:43], v8, s[8:11], s24 offen offset:0 sc1
    v_mfma_f32_16x16x32_bf16 v[36:39], a[160:163], a[128:131], v[36:39]
    v_mfma_f32_16x16x32_bf16 v[40:43], a[160:163], a[136:139], v[40:43]
    ds_read_b64_tr_b16 a[188:189], v23 offset:28672
    v_mfma_f32_16x16x32_bf16 v[40:43], a[164:167], a[140:143], v[40:43]
    ds_read_b64_tr_b16 a[190:191], v23 offset:29184
    s_add_u32 m0, s29, 28672
    v_mfma_f32_16x16x32_bf16 v[44:47], a[164:167], a[148:151], v[44:47]
    buffer_load_dwordx4 v13, s[12:15], s25 offen  lds
    v_mfma_f32_16x16x32_bf16 v[44:47], a[160:163], a[144:147], v[44:47]
    s_waitcnt lgkmcnt(8)
    v_mfma_f32_16x16x32_bf16 v[60:63], a[168:171], a[144:147], v[60:63]
    ds_read_b64_tr_b16 a[160:161], v20 offset:32768
    v_mfma_f32_16x16x32_bf16 v[60:63], a[172:175], a[148:151], v[60:63]
    ds_read_b64_tr_b16 a[162:163], v20 offset:33280
    v_mfma_f32_16x16x32_bf16 v[56:59], a[172:175], a[140:143], v[56:59]
    buffer_load_dwordx4 a[44:47], v8, s[8:11], s24 offen offset:1024 sc1
    v_mfma_f32_16x16x32_bf16 v[56:59], a[168:171], a[136:139], v[56:59]
    v_mfma_f32_16x16x32_bf16 v[52:55], a[168:171], a[128:131], v[52:55]
    ds_read_b64_tr_b16 a[164:165], v20 offset:36864
    v_mfma_f32_16x16x32_bf16 v[52:55], a[172:175], a[132:135], v[52:55]
    ds_read_b64_tr_b16 a[166:167], v20 offset:37376
    v_mfma_f32_16x16x32_bf16 v[48:51], a[172:175], a[124:127], v[48:51]
    buffer_load_dwordx4 a[48:51], v8, s[8:11], s24 offen offset:2048 sc1
    v_mfma_f32_16x16x32_bf16 v[48:51], a[168:171], a[120:123], v[48:51]
    s_waitcnt lgkmcnt(8)
    v_mfma_f32_16x16x32_bf16 v[64:67], a[176:179], a[120:123], v[64:67]
    ds_read_b64_tr_b16 a[168:169], v21 offset:32768
    v_mfma_f32_16x16x32_bf16 v[64:67], a[180:183], a[124:127], v[64:67]
    ds_read_b64_tr_b16 a[170:171], v21 offset:33280
    s_add_u32 m0, s29, 29696
    v_mfma_f32_16x16x32_bf16 v[68:71], a[180:183], a[132:135], v[68:71]
    buffer_load_dwordx4 v14, s[12:15], s25 offen  lds
    v_mfma_f32_16x16x32_bf16 v[68:71], a[176:179], a[128:131], v[68:71]
    v_mfma_f32_16x16x32_bf16 v[72:75], a[176:179], a[136:139], v[72:75]
    ds_read_b64_tr_b16 a[172:173], v21 offset:36864
    v_mfma_f32_16x16x32_bf16 v[72:75], a[180:183], a[140:143], v[72:75]
    ds_read_b64_tr_b16 a[174:175], v21 offset:37376
    v_mfma_f32_16x16x32_bf16 v[76:79], a[180:183], a[148:151], v[76:79]
    buffer_load_dwordx4 a[52:55], v8, s[8:11], s24 offen offset:3072 sc1
    v_mfma_f32_16x16x32_bf16 v[76:79], a[176:179], a[144:147], v[76:79]
    s_waitcnt lgkmcnt(8)
    v_mfma_f32_16x16x32_bf16 v[92:95], a[184:187], a[144:147], v[92:95]
    ds_read_b64_tr_b16 a[176:177], v22 offset:32768
    v_mfma_f32_16x16x32_bf16 v[92:95], a[188:191], a[148:151], v[92:95]
    ds_read_b64_tr_b16 a[178:179], v22 offset:33280
    s_add_u32 m0, s29, 36864
    v_mfma_f32_16x16x32_bf16 v[88:91], a[188:191], a[140:143], v[88:91]
    buffer_load_dwordx4 v13, s[12:15], s26 offen  lds
    v_mfma_f32_16x16x32_bf16 v[88:91], a[184:187], a[136:139], v[88:91]
    v_mfma_f32_16x16x32_bf16 v[84:87], a[184:187], a[128:131], v[84:87]
    ds_read_b64_tr_b16 a[180:181], v22 offset:36864
    v_mfma_f32_16x16x32_bf16 v[84:87], a[188:191], a[132:135], v[84:87]
    ds_read_b64_tr_b16 a[182:183], v22 offset:37376
    v_mfma_f32_16x16x32_bf16 v[80:83], a[188:191], a[124:127], v[80:83]
    buffer_load_dwordx4 a[56:59], v9, s[8:11], s24 offen offset:0 sc1
    v_mfma_f32_16x16x32_bf16 v[80:83], a[184:187], a[120:123], v[80:83]
    s_waitcnt lgkmcnt(8)
    v_mfma_f32_16x16x32_bf16 v[224:227], a[160:163], a[152:155], v[224:227]
    ds_read_b64_tr_b16 a[184:185], v23 offset:32768
    v_mfma_f32_16x16x32_bf16 v[224:227], a[164:167], a[156:159], v[224:227]
    ds_read_b64_tr_b16 a[186:187], v23 offset:33280
    v_mfma_f32_16x16x32_bf16 v[96:99], a[164:167], a[124:127], v[96:99]
    buffer_load_dwordx4 a[60:63], v9, s[8:11], s24 offen offset:1024 sc1
    v_mfma_f32_16x16x32_bf16 v[96:99], a[160:163], a[120:123], v[96:99]
    v_mfma_f32_16x16x32_bf16 v[100:103], a[160:163], a[128:131], v[100:103]
    v_mfma_f32_16x16x32_bf16 v[100:103], a[164:167], a[132:135], v[100:103]
    ds_read_b64_tr_b16 a[188:189], v23 offset:36864
    v_mfma_f32_16x16x32_bf16 v[104:107], a[164:167], a[140:143], v[104:107]
    ds_read_b64_tr_b16 a[190:191], v23 offset:37376
    s_add_u32 m0, s29, 37888
    v_mfma_f32_16x16x32_bf16 v[104:107], a[160:163], a[136:139], v[104:107]
    buffer_load_dwordx4 v14, s[12:15], s26 offen  lds
    v_mfma_f32_16x16x32_bf16 v[108:111], a[160:163], a[144:147], v[108:111]
    v_mfma_f32_16x16x32_bf16 v[108:111], a[164:167], a[148:151], v[108:111]
    s_waitcnt lgkmcnt(8)
    v_mfma_f32_16x16x32_bf16 v[124:127], a[168:171], a[144:147], v[124:127]
    ds_read_b64_tr_b16 a[160:161], v20 offset:40960
    v_mfma_f32_16x16x32_bf16 v[124:127], a[172:175], a[148:151], v[124:127]
    ds_read_b64_tr_b16 a[162:163], v20 offset:41472
    v_mfma_f32_16x16x32_bf16 v[120:123], a[172:175], a[140:143], v[120:123]
    buffer_load_dwordx4 a[64:67], v9, s[8:11], s24 offen offset:2048 sc1
    v_mfma_f32_16x16x32_bf16 v[120:123], a[168:171], a[136:139], v[120:123]
    v_mfma_f32_16x16x32_bf16 v[116:119], a[168:171], a[128:131], v[116:119]
    ds_read_b64_tr_b16 a[164:165], v20 offset:45056
    v_mfma_f32_16x16x32_bf16 v[116:119], a[172:175], a[132:135], v[116:119]
    ds_read_b64_tr_b16 a[166:167], v20 offset:45568
    s_add_u32 m0, s29, 45056
    v_mfma_f32_16x16x32_bf16 v[112:115], a[172:175], a[124:127], v[112:115]
    buffer_load_dwordx4 v13, s[12:15], s27 offen  lds
    v_mfma_f32_16x16x32_bf16 v[112:115], a[168:171], a[120:123], v[112:115]
    s_waitcnt lgkmcnt(8)
    v_mfma_f32_16x16x32_bf16 v[128:131], a[176:179], a[120:123], v[128:131]
    ds_read_b64_tr_b16 a[168:169], v21 offset:40960
    v_mfma_f32_16x16x32_bf16 v[128:131], a[180:183], a[124:127], v[128:131]
    ds_read_b64_tr_b16 a[170:171], v21 offset:41472
    v_mfma_f32_16x16x32_bf16 v[132:135], a[180:183], a[132:135], v[132:135]
    buffer_load_dwordx4 a[68:71], v9, s[8:11], s24 offen offset:3072 sc1
    v_mfma_f32_16x16x32_bf16 v[132:135], a[176:179], a[128:131], v[132:135]
    v_mfma_f32_16x16x32_bf16 v[136:139], a[176:179], a[136:139], v[136:139]
    ds_read_b64_tr_b16 a[172:173], v21 offset:45056
    v_mfma_f32_16x16x32_bf16 v[136:139], a[180:183], a[140:143], v[136:139]
    ds_read_b64_tr_b16 a[174:175], v21 offset:45568
    v_mfma_f32_16x16x32_bf16 v[140:143], a[180:183], a[148:151], v[140:143]
    buffer_load_dwordx4 a[72:75], v10, s[8:11], s24 offen offset:0 sc1
    v_mfma_f32_16x16x32_bf16 v[140:143], a[176:179], a[144:147], v[140:143]
    s_waitcnt lgkmcnt(8)
    v_mfma_f32_16x16x32_bf16 v[156:159], a[184:187], a[144:147], v[156:159]
    ds_read_b64_tr_b16 a[176:177], v22 offset:40960
    v_mfma_f32_16x16x32_bf16 v[156:159], a[188:191], a[148:151], v[156:159]
    ds_read_b64_tr_b16 a[178:179], v22 offset:41472
    s_add_u32 m0, s29, 46080
    v_mfma_f32_16x16x32_bf16 v[152:155], a[188:191], a[140:143], v[152:155]
    buffer_load_dwordx4 v14, s[12:15], s27 offen  lds
    v_mfma_f32_16x16x32_bf16 v[152:155], a[184:187], a[136:139], v[152:155]
    v_mfma_f32_16x16x32_bf16 v[148:151], a[184:187], a[128:131], v[148:151]
    ds_read_b64_tr_b16 a[180:181], v22 offset:45056
    v_mfma_f32_16x16x32_bf16 v[148:151], a[188:191], a[132:135], v[148:151]
    ds_read_b64_tr_b16 a[182:183], v22 offset:45568
    v_mfma_f32_16x16x32_bf16 v[144:147], a[188:191], a[124:127], v[144:147]
    buffer_load_dwordx4 a[76:79], v10, s[8:11], s24 offen offset:1024 sc1
    v_mfma_f32_16x16x32_bf16 v[144:147], a[184:187], a[120:123], v[144:147]
    s_add_u32 s24, s24, 0x40000
    s_add_u32 s25, s25, 393216
    s_add_u32 s26, s26, 393216
    s_add_u32 s27, s27, 393216
    s_waitcnt lgkmcnt(8)
    v_mfma_f32_16x16x32_bf16 v[228:231], a[152:155], a[160:163], v[228:231]
    ds_read_b64_tr_b16 a[184:185], v23 offset:40960
    v_mfma_f32_16x16x32_bf16 v[228:231], a[156:159], a[164:167], v[228:231]
    ds_read_b64_tr_b16 a[186:187], v23 offset:41472
    v_mfma_f32_16x16x32_bf16 v[160:163], a[124:127], a[164:167], v[160:163]
    buffer_load_dword a252, v11, s[12:15], s33 offen
    s_add_u32 s33, s33, 393216
    v_mfma_f32_16x16x32_bf16 v[160:163], a[120:123], a[160:163], v[160:163]
    v_mfma_f32_16x16x32_bf16 v[164:167], a[128:131], a[160:163], v[164:167]
    v_mfma_f32_16x16x32_bf16 v[164:167], a[132:135], a[164:167], v[164:167]
    ds_read_b64_tr_b16 a[188:189], v23 offset:45056
    v_mfma_f32_16x16x32_bf16 v[168:171], a[140:143], a[164:167], v[168:171]
    ds_read_b64_tr_b16 a[190:191], v23 offset:45568
    v_mfma_f32_16x16x32_bf16 v[168:171], a[136:139], a[160:163], v[168:171]
    buffer_load_dword a253, v5, s[64:67], s68 offen
    s_add_u32 s68, s68, 524288
    v_mfma_f32_16x16x32_bf16 v[172:175], a[144:147], a[160:163], v[172:175]
    s_cmp_lg_u32 s31, 1
    s_cbranch_scc1 L_xr3
    s_add_u32 s48, s75, 98304
    buffer_load_dwordx4 a[244:247], v30, s[40:43], s48 offen nt
L_xr3:
    v_mfma_f32_16x16x32_bf16 v[172:175], a[148:151], a[164:167], v[172:175]
    s_waitcnt lgkmcnt(8)
    v_mfma_f32_16x16x32_bf16 v[188:191], a[144:147], a[168:171], v[188:191]
    s_waitcnt vmcnt(21)
    s_barrier
    ds_read_b64_tr_b16 a[160:161], v16 offset:0
    v_mfma_f32_16x16x32_bf16 v[188:191], a[148:151], a[172:175], v[188:191]
    ds_read_b64_tr_b16 a[162:163], v16 offset:512
    v_mfma_f32_16x16x32_bf16 v[184:187], a[140:143], a[172:175], v[184:187]
    v_mfma_f32_16x16x32_bf16 v[184:187], a[136:139], a[168:171], v[184:187]
    v_mfma_f32_16x16x32_bf16 v[180:183], a[128:131], a[168:171], v[180:183]
    ds_read_b64_tr_b16 a[164:165], v16 offset:4096
    v_mfma_f32_16x16x32_bf16 v[180:183], a[132:135], a[172:175], v[180:183]
    ds_read_b64_tr_b16 a[166:167], v16 offset:4608
    v_mfma_f32_16x16x32_bf16 v[176:179], a[124:127], a[172:175], v[176:179]
    v_mfma_f32_16x16x32_bf16 v[176:179], a[120:123], a[168:171], v[176:179]
    s_waitcnt lgkmcnt(8)
    v_mfma_f32_16x16x32_bf16 v[192:195], a[120:123], a[176:179], v[192:195]
    ds_read_b64_tr_b16 a[168:169], v17 offset:0
    v_mfma_f32_16x16x32_bf16 v[192:195], a[124:127], a[180:183], v[192:195]
    ds_read_b64_tr_b16 a[170:171], v17 offset:512
    v_mfma_f32_16x16x32_bf16 v[196:199], a[132:135], a[180:183], v[196:199]
    v_mfma_f32_16x16x32_bf16 v[196:199], a[128:131], a[176:179], v[196:199]
    v_mfma_f32_16x16x32_bf16 v[200:203], a[136:139], a[176:179], v[200:203]
    ds_read_b64_tr_b16 a[172:173], v17 offset:4096
    v_mfma_f32_16x16x32_bf16 v[200:203], a[140:143], a[180:183], v[200:203]
    ds_read_b64_tr_b16 a[174:175], v17 offset:4608
    v_mfma_f32_16x16x32_bf16 v[204:207], a[148:151], a[180:183], v[204:207]
    v_mfma_f32_16x16x32_bf16 v[204:207], a[144:147], a[176:179], v[204:207]
    s_waitcnt lgkmcnt(8)
    v_mfma_f32_16x16x32_bf16 v[220:223], a[144:147], a[184:187], v[220:223]
    ds_read_b64_tr_b16 a[176:177], v18 offset:0
    v_mfma_f32_16x16x32_bf16 v[220:223], a[148:151], a[188:191], v[220:223]
    ds_read_b64_tr_b16 a[178:179], v18 offset:512
    v_mfma_f32_16x16x32_bf16 v[216:219], a[140:143], a[188:191], v[216:219]
    v_mfma_f32_16x16x32_bf16 v[216:219], a[136:139], a[184:187], v[216:219]
    v_mfma_f32_16x16x32_bf16 v[212:215], a[128:131], a[184:187], v[212:215]
    ds_read_b64_tr_b16 a[180:181], v18 offset:4096
    v_mfma_f32_16x16x32_bf16 v[212:215], a[132:135], a[188:191], v[212:215]
    ds_read_b64_tr_b16 a[182:183], v18 offset:4608
    v_mfma_f32_16x16x32_bf16 v[208:211], a[124:127], a[188:191], v[208:211]
    v_mfma_f32_16x16x32_bf16 v[208:211], a[120:123], a[184:187], v[208:211]
    s_add_u32 s31, s31, 1
    s_cmp_lt_u32 s31, 3
    s_cbranch_scc1 L_g1q_loop
L_attn_start:
    s_waitcnt lgkmcnt(8)
    v_mfma_f32_16x16x32_bf16 v[32:35], a[160:163], a[0:3], v[32:35]
    ds_read_b64_tr_b16 a[184:185], v19 offset:0
    v_mfma_f32_16x16x32_bf16 v[32:35], a[164:167], a[4:7], v[32:35]
    ds_read_b64_tr_b16 a[186:187], v19 offset:512
    s_add_u32 m0, s29, 57344
    v_mfma_f32_16x16x32_bf16 v[36:39], a[164:167], a[12:15], v[36:39]
    buffer_load_dwordx4 v13, s[12:15], s25 offen  lds
    v_mfma_f32_16x16x32_bf16 v[36:39], a[160:163], a[8:11], v[36:39]
    v_mfma_f32_16x16x32_bf16 v[40:43], a[160:163], a[16:19], v[40:43]
    ds_read_b64_tr_b16 a[188:189], v19 offset:4096
    v_mfma_f32_16x16x32_bf16 v[40:43], a[164:167], a[20:23], v[40:43]
    ds_read_b64_tr_b16 a[190:191], v19 offset:4608
    v_mfma_f32_16x16x32_bf16 v[44:47], a[164:167], a[28:31], v[44:47]
    buffer_load_dwordx4 a[80:83], v8, s[8:11], s24 offen offset:0 sc1
    v_mfma_f32_16x16x32_bf16 v[44:47], a[160:163], a[24:27], v[44:47]
    s_waitcnt lgkmcnt(8)
    v_lshlrev_b32 v2, 3, v1
    s_lshr_b32 s47, s5, 1
    s_mul_i32 s47, s47, 28672
    v_mfma_f32_16x16x32_bf16 v[60:63], a[168:171], a[24:27], v[60:63]
    ds_read_b64_tr_b16 a[160:161], v16 offset:8192
    s_and_b32 s7, s5, 1
    s_lshl_b32 s7, s7, 11
    s_add_u32 s47, s47, s7
    v_mfma_f32_16x16x32_bf16 v[60:63], a[172:175], a[28:31], v[60:63]
    ds_read_b64_tr_b16 a[162:163], v16 offset:8704
    s_add_u32 m0, s29, 58368
    s_add_u32 s47, s47, 24576
    s_mov_b32 s46, s47
    v_mfma_f32_16x16x32_bf16 v[56:59], a[172:175], a[20:23], v[56:59]
    buffer_load_dwordx4 v14, s[12:15], s25 offen  lds
    s_add_u32 s36, s5, 1
    s_lshr_b32 s47, s36, 1
    s_mul_i32 s47, s47, 28672
    v_mfma_f32_16x16x32_bf16 v[56:59], a[168:171], a[16:19], v[56:59]
    s_and_b32 s7, s36, 1
    s_lshl_b32 s7, s7, 11
    s_add_u32 s47, s47, s7
    s_add_u32 s47, s47, 24576
    v_mfma_f32_16x16x32_bf16 v[52:55], a[168:171], a[8:11], v[52:55]
    ds_read_b64_tr_b16 a[164:165], v16 offset:12288
    s_cmp_eq_u32 s5, 3
    s_cselect_b32 s47, 106496, s47
    s_xor_b32 s7, s5, 0
    s_lshl_b32 s7, s7, 9
    v_mfma_f32_16x16x32_bf16 v[52:55], a[172:175], a[12:15], v[52:55]
    ds_read_b64_tr_b16 a[166:167], v16 offset:12800
    v_add_u32 v3, s7, v2
    v_add_u32 v232, s46, v3
    v_add_u32 v236, s47, v3
    v_mfma_f32_16x16x32_bf16 v[48:51], a[172:175], a[4:7], v[48:51]
    buffer_load_dwordx4 a[84:87], v8, s[8:11], s24 offen offset:1024 sc1
    s_xor_b32 s7, s5, 1
    s_lshl_b32 s7, s7, 9
    v_add_u32 v3, s7, v2
    v_mfma_f32_16x16x32_bf16 v[48:51], a[168:171], a[0:3], v[48:51]
    s_waitcnt lgkmcnt(8)
    v_add_u32 v233, s46, v3
    v_add_u32 v237, s47, v3
    s_xor_b32 s7, s5, 2
    v_mfma_f32_16x16x32_bf16 v[64:67], a[176:179], a[0:3], v[64:67]
    ds_read_b64_tr_b16 a[168:169], v17 offset:8192
    s_lshl_b32 s7, s7, 9
    v_add_u32 v3, s7, v2
    v_add_u32 v234, s46, v3
    v_mfma_f32_16x16x32_bf16 v[64:67], a[180:183], a[4:7], v[64:67]
    ds_read_b64_tr_b16 a[170:171], v17 offset:8704
    s_add_u32 m0, s29, 65536
    v_add_u32 v238, s47, v3
    s_xor_b32 s7, s5, 3
    v_mfma_f32_16x16x32_bf16 v[68:71], a[180:183], a[12:15], v[68:71]
    buffer_load_dwordx4 v13, s[12:15], s26 offen  lds
    s_lshl_b32 s7, s7, 9
    v_add_u32 v3, s7, v2
    v_add_u32 v235, s46, v3
    v_mfma_f32_16x16x32_bf16 v[68:71], a[176:179], a[8:11], v[68:71]
    v_add_u32 v239, s47, v3
    s_lshl_b32 s7, s5, 9
    s_add_u32 s7, s7, 24576
    v_add_u32 v240, s7, v2
    v_mfma_f32_16x16x32_bf16 v[72:75], a[176:179], a[16:19], v[72:75]
    ds_read_b64_tr_b16 a[172:173], v17 offset:12288
    v_and_b32 v3, 15, v1
    v_lshrrev_b32 v4, 4, v1
    v_and_b32 v2, 1, v1
    v_mfma_f32_16x16x32_bf16 v[72:75], a[180:183], a[20:23], v[72:75]
    ds_read_b64_tr_b16 a[174:175], v17 offset:12800
    v_lshl_add_u32 v6, v4, 2, v2
    v_add_u32 v7, 2, v6
    v_cmp_eq_u32 s[50:51], 1, v2
    v_mfma_f32_16x16x32_bf16 v[76:79], a[180:183], a[28:31], v[76:79]
    buffer_load_dwordx4 a[88:91], v8, s[8:11], s24 offen offset:2048 sc1
    v_cmp_le_u32 s[52:53], v6, v3
    v_cmp_le_u32 s[54:55], v7, v3
    v_lshlrev_b32 v241, 4, v2
    v_mfma_f32_16x16x32_bf16 v[76:79], a[176:179], a[24:27], v[76:79]
    s_waitcnt lgkmcnt(8)
    s_cmp_eq_u32 s35, 0
    s_cselect_b32 s46, 0xf149f2ca, 0
    v_mov_b32 v4, s46
    v_cndmask_b32 v242, v4, 0, s[52:53]
    v_mfma_f32_16x16x32_bf16 v[92:95], a[184:187], a[24:27], v[92:95]
    ds_read_b64_tr_b16 a[176:177], v18 offset:8192
    v_cndmask_b32 v243, v4, 0, s[54:55]
    s_mov_b32 s47, 0x3e8293ee
    v_mfma_f32_16x16x32_bf16 v[92:95], a[188:191], a[28:31], v[92:95]
    ds_read_b64_tr_b16 a[178:179], v18 offset:8704
    s_add_u32 m0, s29, 66560
    v_mfma_f32_16x16x32_bf16 v[88:91], a[188:191], a[20:23], v[88:91]
    buffer_load_dwordx4 v14, s[12:15], s26 offen  lds
    v_mfma_f32_16x16x32_bf16 v[88:91], a[184:187], a[16:19], v[88:91]
    v_mfma_f32_16x16x32_bf16 v[84:87], a[184:187], a[8:11], v[84:87]
    ds_read_b64_tr_b16 a[180:181], v18 offset:12288
    v_mfma_f32_16x16x32_bf16 v[84:87], a[188:191], a[12:15], v[84:87]
    ds_read_b64_tr_b16 a[182:183], v18 offset:12800
    v_mfma_f32_16x16x32_bf16 v[80:83], a[188:191], a[4:7], v[80:83]
    buffer_load_dwordx4 a[92:95], v8, s[8:11], s24 offen offset:3072 sc1
    v_mfma_f32_16x16x32_bf16 v[80:83], a[184:187], a[0:3], v[80:83]
    s_waitcnt lgkmcnt(8)
    v_mfma_f32_16x16x32_bf16 v[224:227], a[160:163], a[32:35], v[224:227]
    ds_read_b64_tr_b16 a[184:185], v19 offset:8192
    v_mfma_f32_16x16x32_bf16 v[224:227], a[164:167], a[36:39], v[224:227]
    ds_read_b64_tr_b16 a[186:187], v19 offset:8704
    s_add_u32 m0, s29, 73728
    v_mfma_f32_16x16x32_bf16 v[96:99], a[164:167], a[4:7], v[96:99]
    buffer_load_dwordx4 v13, s[12:15], s27 offen  lds
    v_mfma_f32_16x16x32_bf16 v[96:99], a[160:163], a[0:3], v[96:99]
    v_mfma_f32_16x16x32_bf16 v[100:103], a[160:163], a[8:11], v[100:103]
    v_mfma_f32_16x16x32_bf16 v[100:103], a[164:167], a[12:15], v[100:103]
    ds_read_b64_tr_b16 a[188:189], v19 offset:12288
    v_mfma_f32_16x16x32_bf16 v[104:107], a[164:167], a[20:23], v[104:107]
    ds_read_b64_tr_b16 a[190:191], v19 offset:12800
    v_mfma_f32_16x16x32_bf16 v[104:107], a[160:163], a[16:19], v[104:107]
    buffer_load_dwordx4 a[96:99], v9, s[8:11], s24 offen offset:0 sc1
    v_mfma_f32_16x16x32_bf16 v[108:111], a[160:163], a[24:27], v[108:111]
    v_mfma_f32_16x16x32_bf16 v[108:111], a[164:167], a[28:31], v[108:111]
    s_waitcnt lgkmcnt(8)
    v_mfma_f32_16x16x32_bf16 v[124:127], a[168:171], a[24:27], v[124:127]
    s_waitcnt vmcnt(12)
    s_barrier
    ds_read_b64_tr_b16 a[160:161], v16 offset:28672
    v_mfma_f32_16x16x32_bf16 v[124:127], a[172:175], a[28:31], v[124:127]
    ds_read_b64_tr_b16 a[162:163], v16 offset:29184
    s_add_u32 m0, s29, 74752
    v_mfma_f32_16x16x32_bf16 v[120:123], a[172:175], a[20:23], v[120:123]
    buffer_load_dwordx4 v14, s[12:15], s27 offen  lds
    v_mfma_f32_16x16x32_bf16 v[120:123], a[168:171], a[16:19], v[120:123]
    v_mfma_f32_16x16x32_bf16 v[116:119], a[168:171], a[8:11], v[116:119]
    ds_read_b64_tr_b16 a[164:165], v16 offset:32768
    v_mfma_f32_16x16x32_bf16 v[116:119], a[172:175], a[12:15], v[116:119]
    ds_read_b64_tr_b16 a[166:167], v16 offset:33280
    v_mfma_f32_16x16x32_bf16 v[112:115], a[172:175], a[4:7], v[112:115]
    buffer_load_dwordx4 a[100:103], v9, s[8:11], s24 offen offset:1024 sc1
    v_mfma_f32_16x16x32_bf16 v[112:115], a[168:171], a[0:3], v[112:115]
    s_waitcnt lgkmcnt(8)
    v_mfma_f32_16x16x32_bf16 v[128:131], a[176:179], a[0:3], v[128:131]
    ds_read_b64_tr_b16 a[168:169], v17 offset:28672
    v_mfma_f32_16x16x32_bf16 v[128:131], a[180:183], a[4:7], v[128:131]
    ds_read_b64_tr_b16 a[170:171], v17 offset:29184
    v_mfma_f32_16x16x32_bf16 v[132:135], a[180:183], a[12:15], v[132:135]
    buffer_load_dwordx4 a[104:107], v9, s[8:11], s24 offen offset:2048 sc1
    v_mfma_f32_16x16x32_bf16 v[132:135], a[176:179], a[8:11], v[132:135]
    v_mfma_f32_16x16x32_bf16 v[136:139], a[176:179], a[16:19], v[136:139]
    ds_read_b64_tr_b16 a[172:173], v17 offset:32768
    v_mfma_f32_16x16x32_bf16 v[136:139], a[180:183], a[20:23], v[136:139]
    ds_read_b64_tr_b16 a[174:175], v17 offset:33280
    v_mfma_f32_16x16x32_bf16 v[140:143], a[180:183], a[28:31], v[140:143]
    buffer_load_dwordx4 a[108:111], v9, s[8:11], s24 offen offset:3072 sc1
    v_mfma_f32_16x16x32_bf16 v[140:143], a[176:179], a[24:27], v[140:143]
    s_waitcnt lgkmcnt(8)
    v_mfma_f32_16x16x32_bf16 v[156:159], a[184:187], a[24:27], v[156:159]
    ds_read_b64_tr_b16 a[176:177], v18 offset:28672
    v_mfma_f32_16x16x32_bf16 v[156:159], a[188:191], a[28:31], v[156:159]
    ds_read_b64_tr_b16 a[178:179], v18 offset:29184
    v_mfma_f32_16x16x32_bf16 v[152:155], a[188:191], a[20:23], v[152:155]
    buffer_load_dwordx4 a[112:115], v10, s[8:11], s24 offen offset:0 sc1
    v_mfma_f32_16x16x32_bf16 v[152:155], a[184:187], a[16:19], v[152:155]
    v_mfma_f32_16x16x32_bf16 v[148:151], a[184:187], a[8:11], v[148:151]
    ds_read_b64_tr_b16 a[180:181], v18 offset:32768
    v_mfma_f32_16x16x32_bf16 v[148:151], a[188:191], a[12:15], v[148:151]
    ds_read_b64_tr_b16 a[182:183], v18 offset:33280
    v_mfma_f32_16x16x32_bf16 v[144:147], a[188:191], a[4:7], v[144:147]
    buffer_load_dwordx4 a[116:119], v10, s[8:11], s24 offen offset:1024 sc1
    v_mfma_f32_16x16x32_bf16 v[144:147], a[184:187], a[0:3], v[144:147]
    s_waitcnt lgkmcnt(8)
    v_mfma_f32_16x16x32_bf16 v[32:35], a[160:163], a[40:43], v[32:35]
    ds_read_b64_tr_b16 a[184:185], v19 offset:28672
    v_mfma_f32_16x16x32_bf16 v[32:35], a[164:167], a[44:47], v[32:35]
    ds_read_b64_tr_b16 a[186:187], v19 offset:29184
    s_add_u32 s24, s24, 0x40000
    s_add_u32 s25, s25, 393216
    s_add_u32 s26, s26, 393216
    s_add_u32 s27, s27, 393216
    s_add_u32 m0, s29, 81920
    v_mfma_f32_16x16x32_bf16 v[36:39], a[164:167], a[52:55], v[36:39]
    buffer_load_dwordx4 v13, s[12:15], s25 offen  lds
    v_mfma_f32_16x16x32_bf16 v[36:39], a[160:163], a[48:51], v[36:39]
    v_mfma_f32_16x16x32_bf16 v[40:43], a[160:163], a[56:59], v[40:43]
    ds_read_b64_tr_b16 a[188:189], v19 offset:32768
    v_mfma_f32_16x16x32_bf16 v[40:43], a[164:167], a[60:63], v[40:43]
    ds_read_b64_tr_b16 a[190:191], v19 offset:33280
    s_add_u32 m0, s29, 82944
    v_mfma_f32_16x16x32_bf16 v[44:47], a[164:167], a[68:71], v[44:47]
    buffer_load_dwordx4 v14, s[12:15], s25 offen  lds
    v_mfma_f32_16x16x32_bf16 v[44:47], a[160:163], a[64:67], v[44:47]
    s_waitcnt lgkmcnt(8)
    v_mfma_f32_16x16x32_bf16 v[60:63], a[168:171], a[64:67], v[60:63]
    ds_read_b64_tr_b16 a[160:161], v16 offset:36864
    v_mfma_f32_16x16x32_bf16 v[60:63], a[172:175], a[68:71], v[60:63]
    ds_read_b64_tr_b16 a[162:163], v16 offset:37376
    s_add_u32 m0, s29, 90112
    v_mfma_f32_16x16x32_bf16 v[56:59], a[172:175], a[60:63], v[56:59]
    buffer_load_dwordx4 v13, s[12:15], s26 offen  lds
    v_mfma_f32_16x16x32_bf16 v[56:59], a[168:171], a[56:59], v[56:59]
    v_mfma_f32_16x16x32_bf16 v[52:55], a[168:171], a[48:51], v[52:55]
    ds_read_b64_tr_b16 a[164:165], v16 offset:40960
    v_mfma_f32_16x16x32_bf16 v[52:55], a[172:175], a[52:55], v[52:55]
    ds_read_b64_tr_b16 a[166:167], v16 offset:41472
    s_add_u32 m0, s29, 91136
    v_mfma_f32_16x16x32_bf16 v[48:51], a[172:175], a[44:47], v[48:51]
    buffer_load_dwordx4 v14, s[12:15], s26 offen  lds
    v_mfma_f32_16x16x32_bf16 v[48:51], a[168:171], a[40:43], v[48:51]
    s_waitcnt lgkmcnt(8)
    v_mfma_f32_16x16x32_bf16 v[64:67], a[176:179], a[40:43], v[64:67]
    ds_read_b64_tr_b16 a[168:169], v17 offset:36864
    v_mfma_f32_16x16x32_bf16 v[64:67], a[180:183], a[44:47], v[64:67]
    ds_read_b64_tr_b16 a[170:171], v17 offset:37376
    s_add_u32 m0, s29, 98304
    v_mfma_f32_16x16x32_bf16 v[68:71], a[180:183], a[52:55], v[68:71]
    buffer_load_dwordx4 v13, s[12:15], s27 offen  lds
    v_mfma_f32_16x16x32_bf16 v[68:71], a[176:179], a[48:51], v[68:71]
    v_mfma_f32_16x16x32_bf16 v[72:75], a[176:179], a[56:59], v[72:75]
    ds_read_b64_tr_b16 a[172:173], v17 offset:40960
    v_mfma_f32_16x16x32_bf16 v[72:75], a[180:183], a[60:63], v[72:75]
    ds_read_b64_tr_b16 a[174:175], v17 offset:41472
    s_add_u32 m0, s29, 99328
    v_mfma_f32_16x16x32_bf16 v[76:79], a[180:183], a[68:71], v[76:79]
    buffer_load_dwordx4 v14, s[12:15], s27 offen  lds
    v_mfma_f32_16x16x32_bf16 v[76:79], a[176:179], a[64:67], v[76:79]
    s_waitcnt lgkmcnt(8)
    v_mfma_f32_16x16x32_bf16 v[92:95], a[184:187], a[64:67], v[92:95]
    ds_read_b64_tr_b16 a[176:177], v18 offset:36864
    v_mfma_f32_16x16x32_bf16 v[92:95], a[188:191], a[68:71], v[92:95]
    ds_read_b64_tr_b16 a[178:179], v18 offset:37376
    v_mfma_f32_16x16x32_bf16 v[88:91], a[188:191], a[60:63], v[88:91]
    buffer_load_dwordx4 a[120:123], v8, s[8:11], s24 offen offset:0 sc1
    v_mfma_f32_16x16x32_bf16 v[88:91], a[184:187], a[56:59], v[88:91]
    v_mfma_f32_16x16x32_bf16 v[84:87], a[184:187], a[48:51], v[84:87]
    ds_read_b64_tr_b16 a[180:181], v18 offset:40960
    v_mfma_f32_16x16x32_bf16 v[84:87], a[188:191], a[52:55], v[84:87]
    ds_read_b64_tr_b16 a[182:183], v18 offset:41472
    v_mfma_f32_16x16x32_bf16 v[80:83], a[188:191], a[44:47], v[80:83]
    buffer_load_dwordx4 a[124:127], v8, s[8:11], s24 offen offset:1024 sc1
    v_mfma_f32_16x16x32_bf16 v[80:83], a[184:187], a[40:43], v[80:83]
    s_waitcnt lgkmcnt(8)
    v_mfma_f32_16x16x32_bf16 v[224:227], a[160:163], a[72:75], v[224:227]
    ds_read_b64_tr_b16 a[184:185], v19 offset:36864
    v_mfma_f32_16x16x32_bf16 v[224:227], a[164:167], a[76:79], v[224:227]
    ds_read_b64_tr_b16 a[186:187], v19 offset:37376
    v_mfma_f32_16x16x32_bf16 v[96:99], a[164:167], a[44:47], v[96:99]
    buffer_load_dwordx4 a[128:131], v8, s[8:11], s24 offen offset:2048 sc1
    v_mfma_f32_16x16x32_bf16 v[96:99], a[160:163], a[40:43], v[96:99]
    v_mfma_f32_16x16x32_bf16 v[100:103], a[160:163], a[48:51], v[100:103]
    v_mfma_f32_16x16x32_bf16 v[100:103], a[164:167], a[52:55], v[100:103]
    ds_read_b64_tr_b16 a[188:189], v19 offset:40960
    v_mfma_f32_16x16x32_bf16 v[104:107], a[164:167], a[60:63], v[104:107]
    ds_read_b64_tr_b16 a[190:191], v19 offset:41472
    v_mfma_f32_16x16x32_bf16 v[104:107], a[160:163], a[56:59], v[104:107]
    buffer_load_dwordx4 a[132:135], v8, s[8:11], s24 offen offset:3072 sc1
    v_mfma_f32_16x16x32_bf16 v[108:111], a[160:163], a[64:67], v[108:111]
    v_mfma_f32_16x16x32_bf16 v[108:111], a[164:167], a[68:71], v[108:111]
    s_waitcnt lgkmcnt(8)
    v_mfma_f32_16x16x32_bf16 v[124:127], a[168:171], a[64:67], v[124:127]
    s_waitcnt vmcnt(15)
    s_barrier
    ds_read_b64_tr_b16 a[160:161], v20 offset:8192
    v_mfma_f32_16x16x32_bf16 v[124:127], a[172:175], a[68:71], v[124:127]
    ds_read_b64_tr_b16 a[162:163], v20 offset:8704
    v_mfma_f32_16x16x32_bf16 v[120:123], a[172:175], a[60:63], v[120:123]
    buffer_load_dwordx4 a[136:139], v9, s[8:11], s24 offen offset:0 sc1
    v_mfma_f32_16x16x32_bf16 v[120:123], a[168:171], a[56:59], v[120:123]
    v_mfma_f32_16x16x32_bf16 v[116:119], a[168:171], a[48:51], v[116:119]
    ds_read_b64_tr_b16 a[164:165], v20 offset:12288
    v_mfma_f32_16x16x32_bf16 v[116:119], a[172:175], a[52:55], v[116:119]
    ds_read_b64_tr_b16 a[166:167], v20 offset:12800
    v_mfma_f32_16x16x32_bf16 v[112:115], a[172:175], a[44:47], v[112:115]
    buffer_load_dwordx4 a[140:143], v9, s[8:11], s24 offen offset:1024 sc1
    v_mfma_f32_16x16x32_bf16 v[112:115], a[168:171], a[40:43], v[112:115]
    s_waitcnt lgkmcnt(8)
    v_mfma_f32_16x16x32_bf16 v[128:131], a[176:179], a[40:43], v[128:131]
    ds_read_b64_tr_b16 a[168:169], v21 offset:8192
    v_mfma_f32_16x16x32_bf16 v[128:131], a[180:183], a[44:47], v[128:131]
    ds_read_b64_tr_b16 a[170:171], v21 offset:8704
    v_mfma_f32_16x16x32_bf16 v[132:135], a[180:183], a[52:55], v[132:135]
    buffer_load_dwordx4 a[144:147], v9, s[8:11], s24 offen offset:2048 sc1
    v_mfma_f32_16x16x32_bf16 v[132:135], a[176:179], a[48:51], v[132:135]
    v_mfma_f32_16x16x32_bf16 v[136:139], a[176:179], a[56:59], v[136:139]
    ds_read_b64_tr_b16 a[172:173], v21 offset:12288
    v_mfma_f32_16x16x32_bf16 v[136:139], a[180:183], a[60:63], v[136:139]
    ds_read_b64_tr_b16 a[174:175], v21 offset:12800
    v_mfma_f32_16x16x32_bf16 v[140:143], a[180:183], a[68:71], v[140:143]
    buffer_load_dwordx4 a[148:151], v9, s[8:11], s24 offen offset:3072 sc1
    v_mfma_f32_16x16x32_bf16 v[140:143], a[176:179], a[64:67], v[140:143]
    s_waitcnt lgkmcnt(8)
    v_mfma_f32_16x16x32_bf16 v[156:159], a[184:187], a[64:67], v[156:159]
    ds_read_b64_tr_b16 a[176:177], v22 offset:8192
    v_mfma_f32_16x16x32_bf16 v[156:159], a[188:191], a[68:71], v[156:159]
    ds_read_b64_tr_b16 a[178:179], v22 offset:8704
    v_mfma_f32_16x16x32_bf16 v[152:155], a[188:191], a[60:63], v[152:155]
    buffer_load_dwordx4 a[152:155], v10, s[8:11], s24 offen offset:0 sc1
    v_mfma_f32_16x16x32_bf16 v[152:155], a[184:187], a[56:59], v[152:155]
    v_mfma_f32_16x16x32_bf16 v[148:151], a[184:187], a[48:51], v[148:151]
    ds_read_b64_tr_b16 a[180:181], v22 offset:12288
    v_mfma_f32_16x16x32_bf16 v[148:151], a[188:191], a[52:55], v[148:151]
    ds_read_b64_tr_b16 a[182:183], v22 offset:12800
    v_mfma_f32_16x16x32_bf16 v[144:147], a[188:191], a[44:47], v[144:147]
    buffer_load_dwordx4 a[156:159], v10, s[8:11], s24 offen offset:1024 sc1
    v_mfma_f32_16x16x32_bf16 v[144:147], a[184:187], a[40:43], v[144:147]
    s_waitcnt lgkmcnt(8)
    s_waitcnt vmcnt(16)
    s_mov_b32 s66, 7340032
    s_bfe_u32 s26, s2, 0x20001
    v_mfma_f32_16x16x32_bf16 v[224:227], a[160:163], a[112:115], v[224:227]
    ds_read_b64_tr_b16 a[184:185], v23 offset:8192
    s_lshr_b32 s27, s5, 1
    s_lshl_b32 s25, s26, 1
    s_add_u32 s25, s25, s27
    v_mfma_f32_16x16x32_bf16 v[224:227], a[164:167], a[116:119], v[224:227]
    ds_read_b64_tr_b16 a[186:187], v23 offset:8704
    s_mul_i32 s25, s25, 14
    s_lshl_b32 s25, s25, 16
    s_add_u32 s25, s25, s59
    v_mfma_f32_16x16x32_bf16 v[96:99], a[164:167], a[84:87], v[96:99]
    buffer_load_dword a253, v5, s[60:63], s69 offen
    s_lshl_b32 s28, s4, 1
    s_add_u32 s28, s28, s27
    s_lshl_b32 s28, s28, 16
    v_mfma_f32_16x16x32_bf16 v[96:99], a[160:163], a[80:83], v[96:99]
    s_add_u32 s28, s28, s59
    v_and_b32 v13, 7, v1
    v_bfe_u32 v14, v1, 4, 2
    v_lshlrev_b32 v14, 1, v14
    v_mfma_f32_16x16x32_bf16 v[100:103], a[160:163], a[88:91], v[100:103]
    v_xor_b32 v14, v14, v13
    v_lshrrev_b32 v15, 3, v1
    s_and_b32 s27, s5, 1
    s_lshl_b32 s27, s27, 4
    v_mfma_f32_16x16x32_bf16 v[100:103], a[164:167], a[92:95], v[100:103]
    ds_read_b64_tr_b16 a[188:189], v23 offset:12288
    v_add_u32 v15, s27, v15
    v_lshlrev_b32 v15, 11, v15
    v_lshl_add_u32 v13, v14, 4, v15
    v_mfma_f32_16x16x32_bf16 v[104:107], a[164:167], a[100:103], v[104:107]
    ds_read_b64_tr_b16 a[190:191], v23 offset:12800
    v_add_u32 v14, 16384, v13
    v_mfma_f32_16x16x32_bf16 v[104:107], a[160:163], a[96:99], v[104:107]
    v_mfma_f32_16x16x32_bf16 v[108:111], a[160:163], a[104:107], v[108:111]
    v_mfma_f32_16x16x32_bf16 v[108:111], a[164:167], a[108:111], v[108:111]
    s_waitcnt lgkmcnt(8)
    v_mfma_f32_16x16x32_bf16 v[124:127], a[168:171], a[104:107], v[124:127]
    s_waitcnt vmcnt(11)
    s_barrier
    ds_read_b64_tr_b16 a[160:161], v20 offset:32768
    v_mfma_f32_16x16x32_bf16 v[124:127], a[172:175], a[108:111], v[124:127]
    ds_read_b64_tr_b16 a[162:163], v20 offset:33280
    v_mfma_f32_16x16x32_bf16 v[120:123], a[172:175], a[100:103], v[120:123]
    v_mfma_f32_16x16x32_bf16 v[120:123], a[168:171], a[96:99], v[120:123]
    v_mfma_f32_16x16x32_bf16 v[116:119], a[168:171], a[88:91], v[116:119]
    ds_read_b64_tr_b16 a[164:165], v20 offset:36864
    v_mfma_f32_16x16x32_bf16 v[116:119], a[172:175], a[92:95], v[116:119]
    ds_read_b64_tr_b16 a[166:167], v20 offset:37376
    v_mfma_f32_16x16x32_bf16 v[112:115], a[172:175], a[84:87], v[112:115]
    v_mfma_f32_16x16x32_bf16 v[112:115], a[168:171], a[80:83], v[112:115]
    s_waitcnt lgkmcnt(8)
    v_mfma_f32_16x16x32_bf16 v[128:131], a[176:179], a[80:83], v[128:131]
    ds_read_b64_tr_b16 a[168:169], v21 offset:32768
    v_mfma_f32_16x16x32_bf16 v[128:131], a[180:183], a[84:87], v[128:131]
    ds_read_b64_tr_b16 a[170:171], v21 offset:33280
    v_mfma_f32_16x16x32_bf16 v[132:135], a[180:183], a[92:95], v[132:135]
    v_mfma_f32_16x16x32_bf16 v[132:135], a[176:179], a[88:91], v[132:135]
    v_mfma_f32_16x16x32_bf16 v[136:139], a[176:179], a[96:99], v[136:139]
    ds_read_b64_tr_b16 a[172:173], v21 offset:36864
    v_mfma_f32_16x16x32_bf16 v[136:139], a[180:183], a[100:103], v[136:139]
    ds_read_b64_tr_b16 a[174:175], v21 offset:37376
    s_add_u32 m0, s29, 114688
    v_mfma_f32_16x16x32_bf16 v[140:143], a[180:183], a[108:111], v[140:143]
    buffer_load_dwordx4 v13, s[60:63], s28 offen offset:0 lds
    v_mfma_f32_16x16x32_bf16 v[140:143], a[176:179], a[104:107], v[140:143]
    s_waitcnt lgkmcnt(8)
    v_mfma_f32_16x16x32_bf16 v[156:159], a[184:187], a[104:107], v[156:159]
    ds_read_b64_tr_b16 a[176:177], v22 offset:32768
    v_mfma_f32_16x16x32_bf16 v[156:159], a[188:191], a[108:111], v[156:159]
    ds_read_b64_tr_b16 a[178:179], v22 offset:33280
    s_add_u32 m0, s29, 122368
    v_mfma_f32_16x16x32_bf16 v[152:155], a[188:191], a[100:103], v[152:155]
    buffer_load_dwordx4 v13, s[60:63], s28 offen offset:512 lds
    v_mfma_f32_16x16x32_bf16 v[152:155], a[184:187], a[96:99], v[152:155]
    v_mfma_f32_16x16x32_bf16 v[148:151], a[184:187], a[88:91], v[148:151]
    ds_read_b64_tr_b16 a[180:181], v22 offset:36864
    v_mfma_f32_16x16x32_bf16 v[148:151], a[188:191], a[92:95], v[148:151]
    ds_read_b64_tr_b16 a[182:183], v22 offset:37376
    s_add_u32 m0, s29, 115712
    v_mfma_f32_16x16x32_bf16 v[144:147], a[188:191], a[84:87], v[144:147]
    buffer_load_dwordx4 v14, s[60:63], s28 offen offset:0 lds
    v_mfma_f32_16x16x32_bf16 v[144:147], a[184:187], a[80:83], v[144:147]
    s_waitcnt lgkmcnt(8)
    s_waitcnt vmcnt(4)
    v_mfma_f32_16x16x32_bf16 v[224:227], a[160:163], a[152:155], v[224:227]
    ds_read_b64_tr_b16 a[184:185], v23 offset:32768
    v_mfma_f32_16x16x32_bf16 v[224:227], a[164:167], a[156:159], v[224:227]
    ds_read_b64_tr_b16 a[186:187], v23 offset:33280
    s_add_u32 m0, s29, 123392
    v_mfma_f32_16x16x32_bf16 v[96:99], a[164:167], a[124:127], v[96:99]
    buffer_load_dwordx4 v14, s[60:63], s28 offen offset:512 lds
    v_mfma_f32_16x16x32_bf16 v[96:99], a[160:163], a[120:123], v[96:99]
    v_mfma_f32_16x16x32_bf16 v[100:103], a[160:163], a[128:131], v[100:103]
    v_mfma_f32_16x16x32_bf16 v[100:103], a[164:167], a[132:135], v[100:103]
    ds_read_b64_tr_b16 a[188:189], v23 offset:36864
    v_mfma_f32_16x16x32_bf16 v[104:107], a[164:167], a[140:143], v[104:107]
    ds_read_b64_tr_b16 a[190:191], v23 offset:37376
    s_add_u32 s27, s25, 0
    s_add_u32 m0, s29, 131072
    v_mfma_f32_16x16x32_bf16 v[104:107], a[160:163], a[136:139], v[104:107]
    buffer_load_dwordx4 v13, s[64:67], s27 offen offset:0 lds
    v_mfma_f32_16x16x32_bf16 v[108:111], a[160:163], a[144:147], v[108:111]
    v_mfma_f32_16x16x32_bf16 v[108:111], a[164:167], a[148:151], v[108:111]
    s_waitcnt lgkmcnt(8)
    v_mfma_f32_16x16x32_bf16 v[124:127], a[168:171], a[144:147], v[124:127]
    ds_read_b64_tr_b16 a[160:161], v20 offset:0
    v_mfma_f32_16x16x32_bf16 v[124:127], a[172:175], a[148:151], v[124:127]
    ds_read_b64_tr_b16 a[162:163], v20 offset:512
    s_add_u32 m0, s29, 138752
    v_mfma_f32_16x16x32_bf16 v[120:123], a[172:175], a[140:143], v[120:123]
    buffer_load_dwordx4 v13, s[64:67], s27 offen offset:512 lds
    v_mfma_f32_16x16x32_bf16 v[120:123], a[168:171], a[136:139], v[120:123]
    v_mfma_f32_16x16x32_bf16 v[116:119], a[168:171], a[128:131], v[116:119]
    ds_read_b64_tr_b16 a[164:165], v20 offset:4096
    v_mfma_f32_16x16x32_bf16 v[116:119], a[172:175], a[132:135], v[116:119]
    ds_read_b64_tr_b16 a[166:167], v20 offset:4608
    s_add_u32 m0, s29, 132096
    v_mfma_f32_16x16x32_bf16 v[112:115], a[172:175], a[124:127], v[112:115]
    buffer_load_dwordx4 v14, s[64:67], s27 offen offset:0 lds
    v_mfma_f32_16x16x32_bf16 v[112:115], a[168:171], a[120:123], v[112:115]
    s_waitcnt lgkmcnt(8)
    v_mfma_f32_16x16x32_bf16 v[128:131], a[176:179], a[120:123], v[128:131]
    ds_read_b64_tr_b16 a[168:169], v21 offset:0
    v_mfma_f32_16x16x32_bf16 v[128:131], a[180:183], a[124:127], v[128:131]
    ds_read_b64_tr_b16 a[170:171], v21 offset:512
    s_add_u32 m0, s29, 139776
    v_mfma_f32_16x16x32_bf16 v[132:135], a[180:183], a[132:135], v[132:135]
    buffer_load_dwordx4 v14, s[64:67], s27 offen offset:512 lds
    v_mfma_f32_16x16x32_bf16 v[132:135], a[176:179], a[128:131], v[132:135]
    v_mfma_f32_16x16x32_bf16 v[136:139], a[176:179], a[136:139], v[136:139]
    ds_read_b64_tr_b16 a[172:173], v21 offset:4096
    v_mfma_f32_16x16x32_bf16 v[136:139], a[180:183], a[140:143], v[136:139]
    ds_read_b64_tr_b16 a[174:175], v21 offset:4608
    s_add_u32 s27, s25, 65536
    s_add_u32 m0, s29, 147456
    v_mfma_f32_16x16x32_bf16 v[140:143], a[180:183], a[148:151], v[140:143]
    buffer_load_dwordx4 v13, s[64:67], s27 offen offset:0 lds
    v_mfma_f32_16x16x32_bf16 v[140:143], a[176:179], a[144:147], v[140:143]
    s_waitcnt lgkmcnt(8)
    v_mfma_f32_16x16x32_bf16 v[156:159], a[184:187], a[144:147], v[156:159]
    ds_read_b64_tr_b16 a[176:177], v22 offset:0
    v_mfma_f32_16x16x32_bf16 v[156:159], a[188:191], a[148:151], v[156:159]
    ds_read_b64_tr_b16 a[178:179], v22 offset:512
    s_add_u32 m0, s29, 155136
    v_mfma_f32_16x16x32_bf16 v[152:155], a[188:191], a[140:143], v[152:155]
    buffer_load_dwordx4 v13, s[64:67], s27 offen offset:512 lds
    v_mfma_f32_16x16x32_bf16 v[152:155], a[184:187], a[136:139], v[152:155]
    v_mfma_f32_16x16x32_bf16 v[148:151], a[184:187], a[128:131], v[148:151]
    ds_read_b64_tr_b16 a[180:181], v22 offset:4096
    v_mfma_f32_16x16x32_bf16 v[148:151], a[188:191], a[132:135], v[148:151]
    ds_read_b64_tr_b16 a[182:183], v22 offset:4608
    s_add_u32 m0, s29, 148480
    v_mfma_f32_16x16x32_bf16 v[144:147], a[188:191], a[124:127], v[144:147]
    buffer_load_dwordx4 v14, s[64:67], s27 offen offset:0 lds
    v_mfma_f32_16x16x32_bf16 v[144:147], a[184:187], a[120:123], v[144:147]
    s_waitcnt lgkmcnt(8)
    v_mfma_f32_16x16x32_bf16 v[32:35], a[160:163], a[80:83], v[32:35]
    ds_read_b64_tr_b16 a[184:185], v23 offset:0
    v_mfma_f32_16x16x32_bf16 v[32:35], a[164:167], a[84:87], v[32:35]
    ds_read_b64_tr_b16 a[186:187], v23 offset:512
    s_add_u32 m0, s29, 156160
    v_mfma_f32_16x16x32_bf16 v[36:39], a[164:167], a[92:95], v[36:39]
    buffer_load_dwordx4 v14, s[64:67], s27 offen offset:512 lds
    v_mfma_f32_16x16x32_bf16 v[36:39], a[160:163], a[88:91], v[36:39]
    v_cvt_pk_bf16_f32 v224, v224, v225
    v_cvt_pk_bf16_f32 v225, v226, v227
    ds_write_b64 v240, v[224:225]
    v_cvt_pk_bf16_f32 v108, v108, v109
    v_mfma_f32_16x16x32_bf16 v[40:43], a[160:163], a[96:99], v[40:43]
    ds_read_b64_tr_b16 a[188:189], v23 offset:4096
    v_cvt_pk_bf16_f32 v109, v110, v111
    v_cvt_pk_bf16_f32 v110, v124, v125
    v_cvt_pk_bf16_f32 v111, v126, v127
    v_mfma_f32_16x16x32_bf16 v[40:43], a[164:167], a[100:103], v[40:43]
    ds_read_b64_tr_b16 a[190:191], v23 offset:4608
    ds_write_b64 v236, v[108:109]
    ds_write_b64 v237, v[110:111]
    v_cvt_pk_bf16_f32 v140, v140, v141
    v_mfma_f32_16x16x32_bf16 v[44:47], a[164:167], a[108:111], v[44:47]
    v_cvt_pk_bf16_f32 v141, v142, v143
    v_cvt_pk_bf16_f32 v142, v156, v157
    v_cvt_pk_bf16_f32 v143, v158, v159
    ds_write_b64 v238, v[140:141]
    v_mfma_f32_16x16x32_bf16 v[44:47], a[160:163], a[104:107], v[44:47]
    s_waitcnt lgkmcnt(12)
    ds_write_b64 v239, v[142:143]
    v_cvt_pk_bf16_f32 v96, v96, v97
    v_cvt_pk_bf16_f32 v97, v98, v99
    v_mfma_f32_16x16x32_bf16 v[60:63], a[168:171], a[104:107], v[60:63]
    ds_read_b64_tr_b16 a[160:161], v20 offset:24576
    v_cvt_pk_bf16_f32 v98, v112, v113
    v_cvt_pk_bf16_f32 v99, v114, v115
    v_cvt_pk_bf16_f32 v100, v100, v101
    v_mfma_f32_16x16x32_bf16 v[60:63], a[172:175], a[108:111], v[60:63]
    ds_read_b64_tr_b16 a[162:163], v20 offset:25088
    v_cvt_pk_bf16_f32 v101, v102, v103
    v_cvt_pk_bf16_f32 v102, v116, v117
    v_cvt_pk_bf16_f32 v103, v118, v119
    v_mfma_f32_16x16x32_bf16 v[56:59], a[172:175], a[100:103], v[56:59]
    v_cvt_pk_bf16_f32 v104, v104, v105
    v_cvt_pk_bf16_f32 v105, v106, v107
    v_cvt_pk_bf16_f32 v106, v120, v121
    v_cvt_pk_bf16_f32 v107, v122, v123
    v_mfma_f32_16x16x32_bf16 v[56:59], a[168:171], a[96:99], v[56:59]
    v_cvt_pk_bf16_f32 v128, v128, v129
    v_cvt_pk_bf16_f32 v129, v130, v131
    v_cvt_pk_bf16_f32 v130, v144, v145
    v_cvt_pk_bf16_f32 v131, v146, v147
    v_mfma_f32_16x16x32_bf16 v[52:55], a[168:171], a[88:91], v[52:55]
    ds_read_b64_tr_b16 a[164:165], v20 offset:28672
    v_cvt_pk_bf16_f32 v132, v132, v133
    v_cvt_pk_bf16_f32 v133, v134, v135
    v_cvt_pk_bf16_f32 v134, v148, v149
    v_mfma_f32_16x16x32_bf16 v[52:55], a[172:175], a[92:95], v[52:55]
    ds_read_b64_tr_b16 a[166:167], v20 offset:29184
    v_cvt_pk_bf16_f32 v135, v150, v151
    v_cvt_pk_bf16_f32 v136, v136, v137
    v_cvt_pk_bf16_f32 v137, v138, v139
    v_mfma_f32_16x16x32_bf16 v[48:51], a[172:175], a[84:87], v[48:51]
    v_cvt_pk_bf16_f32 v138, v152, v153
    v_cvt_pk_bf16_f32 v139, v154, v155
    s_waitcnt lgkmcnt(4)
    s_barrier
    v_mfma_f32_16x16x32_bf16 v[48:51], a[168:171], a[80:83], v[48:51]
    s_waitcnt lgkmcnt(13)
    ds_read_b64 v[248:249], v232
    ds_read_b64 v[250:251], v233
    ds_read_b64 v[252:253], v234
    v_mfma_f32_16x16x32_bf16 v[64:67], a[176:179], a[80:83], v[64:67]
    ds_read_b64_tr_b16 a[168:169], v21 offset:24576
    ds_read_b64 v[254:255], v235
    v_mfma_f32_16x16x32_bf16 v[64:67], a[180:183], a[84:87], v[64:67]
    ds_read_b64_tr_b16 a[170:171], v21 offset:25088
    v_mfma_f32_16x16x32_bf16 v[68:71], a[180:183], a[92:95], v[68:71]
    v_mfma_f32_16x16x32_bf16 v[68:71], a[176:179], a[88:91], v[68:71]
    v_mfma_f32_16x16x32_bf16 v[72:75], a[176:179], a[96:99], v[72:75]
    ds_read_b64_tr_b16 a[172:173], v21 offset:28672
    v_mfma_f32_16x16x32_bf16 v[72:75], a[180:183], a[100:103], v[72:75]
    ds_read_b64_tr_b16 a[174:175], v21 offset:29184
    v_mfma_f32_16x16x32_bf16 v[76:79], a[180:183], a[108:111], v[76:79]
    v_mfma_f32_16x16x32_bf16 v[76:79], a[176:179], a[104:107], v[76:79]
    s_waitcnt lgkmcnt(15)
    v_mfma_f32_16x16x32_bf16 v[92:95], a[184:187], a[104:107], v[92:95]
    ds_read_b64_tr_b16 a[176:177], v22 offset:24576
    v_mfma_f32_16x16x32_bf16 v[92:95], a[188:191], a[108:111], v[92:95]
    ds_read_b64_tr_b16 a[178:179], v22 offset:25088
    v_mfma_f32_16x16x32_bf16 v[88:91], a[188:191], a[100:103], v[88:91]
    v_mfma_f32_16x16x32_bf16 v[88:91], a[184:187], a[96:99], v[88:91]
    v_mfma_f32_16x16x32_bf16 v[84:87], a[184:187], a[88:91], v[84:87]
    ds_read_b64_tr_b16 a[180:181], v22 offset:28672
    v_mfma_f32_16x16x32_bf16 v[84:87], a[188:191], a[92:95], v[84:87]
    ds_read_b64_tr_b16 a[182:183], v22 offset:29184
    v_mfma_f32_16x16x32_bf16 v[80:83], a[188:191], a[84:87], v[80:83]
    v_mfma_f32_16x16x32_bf16 v[80:83], a[184:187], a[80:83], v[80:83]
    s_waitcnt lgkmcnt(12)
    v_mfma_f32_16x16x32_bf16 v[32:35], a[160:163], a[120:123], v[32:35]
    ds_read_b64_tr_b16 a[184:185], v23 offset:24576
    v_mfma_f32_16x16x32_bf16 v[32:35], a[164:167], a[124:127], v[32:35]
    ds_read_b64_tr_b16 a[186:187], v23 offset:25088
    v_mfma_f32_16x16x32_bf16 v[36:39], a[164:167], a[132:135], v[36:39]
    v_mfma_f32_16x16x32_bf16 v[36:39], a[160:163], a[128:131], v[36:39]
    v_mfma_f32_16x16x32_bf16 v[40:43], a[160:163], a[136:139], v[40:43]
    ds_read_b64_tr_b16 a[188:189], v23 offset:28672
    v_mfma_f32_16x16x32_bf16 v[40:43], a[164:167], a[140:143], v[40:43]
    ds_read_b64_tr_b16 a[190:191], v23 offset:29184
    v_mfma_f32_16x16x32_bf16 v[44:47], a[164:167], a[148:151], v[44:47]
    v_mfma_f32_16x16x32_bf16 v[44:47], a[160:163], a[144:147], v[44:47]
    s_waitcnt lgkmcnt(8)
    v_mfma_f32_16x16x32_bf16 v[60:63], a[168:171], a[144:147], v[60:63]
    ds_read_b64_tr_b16 a[160:161], v16 offset:16384
    v_mfma_f32_16x16x32_bf16 v[60:63], a[172:175], a[148:151], v[60:63]
    ds_read_b64_tr_b16 a[162:163], v16 offset:16896
    v_mfma_f32_16x16x32_bf16 v[56:59], a[172:175], a[140:143], v[56:59]
    v_mfma_f32_16x16x32_bf16 v[56:59], a[168:171], a[136:139], v[56:59]
    v_mfma_f32_16x16x32_bf16 v[52:55], a[168:171], a[128:131], v[52:55]
    ds_read_b64_tr_b16 a[164:165], v16 offset:20480
    v_mfma_f32_16x16x32_bf16 v[52:55], a[172:175], a[132:135], v[52:55]
    ds_read_b64_tr_b16 a[166:167], v16 offset:20992
    v_mfma_f32_16x16x32_bf16 v[48:51], a[172:175], a[124:127], v[48:51]
    v_mfma_f32_16x16x32_bf16 v[48:51], a[168:171], a[120:123], v[48:51]
    s_waitcnt lgkmcnt(8)
    v_mfma_f32_16x16x32_bf16 v[64:67], a[176:179], a[120:123], v[64:67]
    ds_read_b64_tr_b16 a[168:169], v16 offset:45056
    v_mfma_f32_16x16x32_bf16 v[64:67], a[180:183], a[124:127], v[64:67]
    ds_read_b64_tr_b16 a[170:171], v16 offset:45568
    v_mfma_f32_16x16x32_bf16 v[68:71], a[180:183], a[132:135], v[68:71]
    v_mfma_f32_16x16x32_bf16 v[68:71], a[176:179], a[128:131], v[68:71]
    v_mfma_f32_16x16x32_bf16 v[72:75], a[176:179], a[136:139], v[72:75]
    ds_read_b64_tr_b16 a[172:173], v16 offset:49152
    v_mfma_f32_16x16x32_bf16 v[72:75], a[180:183], a[140:143], v[72:75]
    ds_read_b64_tr_b16 a[174:175], v16 offset:49664
    v_mfma_f32_16x16x32_bf16 v[76:79], a[180:183], a[148:151], v[76:79]
    v_mfma_f32_16x16x32_bf16 v[76:79], a[176:179], a[144:147], v[76:79]
    s_waitcnt lgkmcnt(8)
    v_mfma_f32_16x16x32_bf16 v[92:95], a[184:187], a[144:147], v[92:95]
    ds_read_b64_tr_b16 a[176:177], v20 offset:16384
    v_mfma_f32_16x16x32_bf16 v[92:95], a[188:191], a[148:151], v[92:95]
    ds_read_b64_tr_b16 a[178:179], v20 offset:16896
    v_mfma_f32_16x16x32_bf16 v[88:91], a[188:191], a[140:143], v[88:91]
    v_mfma_f32_16x16x32_bf16 v[88:91], a[184:187], a[136:139], v[88:91]
    v_mfma_f32_16x16x32_bf16 v[84:87], a[184:187], a[128:131], v[84:87]
    ds_read_b64_tr_b16 a[180:181], v20 offset:20480
    v_mfma_f32_16x16x32_bf16 v[84:87], a[188:191], a[132:135], v[84:87]
    ds_read_b64_tr_b16 a[182:183], v20 offset:20992
    v_mfma_f32_16x16x32_bf16 v[80:83], a[188:191], a[124:127], v[80:83]
    v_mfma_f32_16x16x32_bf16 v[80:83], a[184:187], a[120:123], v[80:83]
    s_waitcnt lgkmcnt(8)
    v_mfma_f32_16x16x32_bf16 v[228:231], a[32:35], a[160:163], v[228:231]
    ds_read_b64_tr_b16 a[184:185], v20 offset:40960
    v_mfma_f32_16x16x32_bf16 v[228:231], a[36:39], a[164:167], v[228:231]
    ds_read_b64_tr_b16 a[186:187], v20 offset:41472
    v_mfma_f32_16x16x32_bf16 v[160:163], a[4:7], a[164:167], v[160:163]
    v_mfma_f32_16x16x32_bf16 v[160:163], a[0:3], a[160:163], v[160:163]
    v_mfma_f32_16x16x32_bf16 v[164:167], a[8:11], a[160:163], v[164:167]
    s_waitcnt lgkmcnt(15)
    s_barrier
    v_cvt_pk_bf16_f32 v32, v32, v33
    v_cvt_pk_bf16_f32 v33, v34, v35
    v_mfma_f32_16x16x32_bf16 v[164:167], a[12:15], a[164:167], v[164:167]
    ds_read_b64_tr_b16 a[188:189], v20 offset:45056
    v_cvt_pk_bf16_f32 v34, v48, v49
    v_cvt_pk_bf16_f32 v35, v50, v51
    v_cvt_pk_bf16_f32 v36, v36, v37
    v_mfma_f32_16x16x32_bf16 v[168:171], a[20:23], a[164:167], v[168:171]
    ds_read_b64_tr_b16 a[190:191], v20 offset:45568
    v_cvt_pk_bf16_f32 v37, v38, v39
    v_cvt_pk_bf16_f32 v38, v52, v53
    v_cvt_pk_bf16_f32 v39, v54, v55
    v_mfma_f32_16x16x32_bf16 v[168:171], a[16:19], a[160:163], v[168:171]
    v_cvt_pk_bf16_f32 v40, v40, v41
    v_cvt_pk_bf16_f32 v41, v42, v43
    v_cvt_pk_bf16_f32 v42, v56, v57
    v_cvt_pk_bf16_f32 v43, v58, v59
    v_mfma_f32_16x16x32_bf16 v[172:175], a[24:27], a[160:163], v[172:175]
    v_cvt_pk_bf16_f32 v44, v44, v45
    v_cvt_pk_bf16_f32 v45, v46, v47
    v_cvt_pk_bf16_f32 v46, v60, v61
    v_cvt_pk_bf16_f32 v47, v62, v63
    v_mfma_f32_16x16x32_bf16 v[172:175], a[28:31], a[164:167], v[172:175]
    s_waitcnt lgkmcnt(8)
    v_cvt_pk_bf16_f32 v64, v64, v65
    v_cvt_pk_bf16_f32 v65, v66, v67
    v_cvt_pk_bf16_f32 v66, v80, v81
    v_mfma_f32_16x16x32_bf16 v[172:175], a[64:67], a[168:171], v[172:175]
    ds_read_b64_tr_b16 a[160:161], v17 offset:16384
    v_cvt_pk_bf16_f32 v67, v82, v83
    v_cvt_pk_bf16_f32 v68, v68, v69
    v_cvt_pk_bf16_f32 v69, v70, v71
    v_mfma_f32_16x16x32_bf16 v[172:175], a[68:71], a[172:175], v[172:175]
    ds_read_b64_tr_b16 a[162:163], v17 offset:16896
    s_add_u32 s27, s25, 524288
    s_add_u32 m0, s29, 28672
    v_cvt_pk_bf16_f32 v70, v84, v85
    v_mfma_f32_16x16x32_bf16 v[168:171], a[60:63], a[172:175], v[168:171]
    buffer_load_dwordx4 v13, s[64:67], s27 offen offset:0 lds
    v_cvt_pk_bf16_f32 v71, v86, v87
    v_cvt_pk_bf16_f32 v72, v72, v73
    v_cvt_pk_bf16_f32 v73, v74, v75
    v_mfma_f32_16x16x32_bf16 v[168:171], a[56:59], a[168:171], v[168:171]
    v_cvt_pk_bf16_f32 v74, v88, v89
    v_cvt_pk_bf16_f32 v75, v90, v91
    v_cvt_pk_bf16_f32 v76, v76, v77
    v_cvt_pk_bf16_f32 v77, v78, v79
    v_mfma_f32_16x16x32_bf16 v[164:167], a[48:51], a[168:171], v[164:167]
    v_cvt_pk_bf16_f32 v78, v92, v93
    v_cvt_pk_bf16_f32 v79, v94, v95
    s_waitcnt lgkmcnt(15)
    v_mfma_f32_16x16x32_bf16 v[124:127], v[248:251], v[32:35], 0
    v_mfma_f32_16x16x32_bf16 v[164:167], a[52:55], a[172:175], v[164:167]
    ds_read_b64_tr_b16 a[164:165], v17 offset:20480
    v_mfma_f32_16x16x32_bf16 v[156:159], v[96:99], v[32:35], 0
    v_mfma_f32_16x16x32_bf16 v[112:115], v[96:99], v[36:39], 0
    v_mfma_f32_16x16x32_bf16 v[116:119], v[100:103], v[36:39], 0
    v_mfma_f32_16x16x32_bf16 v[160:163], a[44:47], a[172:175], v[160:163]
    ds_read_b64_tr_b16 a[166:167], v17 offset:20992
    s_add_u32 m0, s29, 36352
    v_mfma_f32_16x16x32_bf16 v[120:123], v[100:103], v[40:43], 0
    v_mfma_f32_16x16x32_bf16 v[144:147], v[104:107], v[40:43], 0
    v_mfma_f32_16x16x32_bf16 v[160:163], a[40:43], a[168:171], v[160:163]
    buffer_load_dwordx4 v13, s[64:67], s27 offen offset:512 lds
    v_mfma_f32_16x16x32_bf16 v[148:151], v[104:107], v[44:47], 0
    v_mfma_f32_16x16x32_bf16 v[152:155], v[108:111], v[44:47], 0
    v_mfma_f32_16x16x32_bf16 v[48:51], v[252:255], v[64:67], 0
    v_mfma_f32_16x16x32_bf16 v[228:231], a[72:75], a[168:171], v[228:231]
    v_mfma_f32_16x16x32_bf16 v[52:55], v[128:131], v[64:67], 0
    v_mfma_f32_16x16x32_bf16 v[56:59], v[128:131], v[68:71], 0
    v_mfma_f32_16x16x32_bf16 v[60:63], v[132:135], v[68:71], 0
    v_mfma_f32_16x16x32_bf16 v[80:83], v[132:135], v[72:75], 0
    v_mfma_f32_16x16x32_bf16 v[228:231], a[76:79], a[172:175], v[228:231]
    s_waitcnt lgkmcnt(8)
    v_mfma_f32_16x16x32_bf16 v[84:87], v[136:139], v[72:75], 0
    v_mfma_f32_16x16x32_bf16 v[88:91], v[136:139], v[76:79], 0
    v_mfma_f32_16x16x32_bf16 v[92:95], v[140:143], v[76:79], 0
    v_mfma_f32_16x16x32_bf16 v[228:231], a[112:115], a[176:179], v[228:231]
    ds_read_b64_tr_b16 a[168:169], v17 offset:45056
    s_mov_b64 vcc, s[50:51]
    v_cndmask_b32_e32 v124, v124, v125, vcc
    v_cndmask_b32_e32 v125, v126, v127, vcc
    v_mfma_f32_16x16x32_bf16 v[228:231], a[116:119], a[180:183], v[228:231]
    ds_read_b64_tr_b16 a[170:171], v17 offset:45568
    s_add_u32 m0, s29, 29696
    v_cndmask_b32_e32 v156, v156, v157, vcc
    v_cndmask_b32_e32 v157, v158, v159, vcc
    v_mfma_f32_16x16x32_bf16 v[160:163], a[84:87], a[180:183], v[160:163]
    buffer_load_dwordx4 v14, s[64:67], s27 offen offset:0 lds
    v_cndmask_b32_e32 v112, v112, v113, vcc
    v_cndmask_b32_e32 v113, v114, v115, vcc
    v_cndmask_b32_e32 v116, v116, v117, vcc
    v_mfma_f32_16x16x32_bf16 v[160:163], a[80:83], a[176:179], v[160:163]
    v_cndmask_b32_e32 v117, v118, v119, vcc
    v_cndmask_b32_e32 v120, v120, v121, vcc
    v_cndmask_b32_e32 v121, v122, v123, vcc
    v_cndmask_b32_e32 v144, v144, v145, vcc
    v_mfma_f32_16x16x32_bf16 v[164:167], a[88:91], a[176:179], v[164:167]
    v_cndmask_b32_e32 v145, v146, v147, vcc
    v_cndmask_b32_e32 v148, v148, v149, vcc
    v_cndmask_b32_e32 v149, v150, v151, vcc
    v_cndmask_b32_e32 v152, v152, v153, vcc
    v_mfma_f32_16x16x32_bf16 v[164:167], a[92:95], a[180:183], v[164:167]
    ds_read_b64_tr_b16 a[172:173], v17 offset:49152
    v_cndmask_b32_e32 v153, v154, v155, vcc
    v_cndmask_b32_e32 v48, v48, v49, vcc
    v_cndmask_b32_e32 v49, v50, v51, vcc
    v_mfma_f32_16x16x32_bf16 v[168:171], a[100:103], a[180:183], v[168:171]
    ds_read_b64_tr_b16 a[174:175], v17 offset:49664
    s_add_u32 m0, s29, 37376
    v_cndmask_b32_e32 v52, v52, v53, vcc
    v_cndmask_b32_e32 v53, v54, v55, vcc
    v_mfma_f32_16x16x32_bf16 v[168:171], a[96:99], a[176:179], v[168:171]
    buffer_load_dwordx4 v14, s[64:67], s27 offen offset:512 lds
    v_cndmask_b32_e32 v56, v56, v57, vcc
    v_cndmask_b32_e32 v57, v58, v59, vcc
    v_cndmask_b32_e32 v60, v60, v61, vcc
    v_mfma_f32_16x16x32_bf16 v[172:175], a[104:107], a[176:179], v[172:175]
    v_cndmask_b32_e32 v61, v62, v63, vcc
    v_cndmask_b32_e32 v80, v80, v81, vcc
    v_cndmask_b32_e32 v81, v82, v83, vcc
    v_cndmask_b32_e32 v84, v84, v85, vcc
    v_mfma_f32_16x16x32_bf16 v[172:175], a[108:111], a[180:183], v[172:175]
    s_waitcnt lgkmcnt(8)
    v_cndmask_b32_e32 v85, v86, v87, vcc
    v_cndmask_b32_e32 v88, v88, v89, vcc
    v_cndmask_b32_e32 v89, v90, v91, vcc
    v_mfma_f32_16x16x32_bf16 v[172:175], a[144:147], a[184:187], v[172:175]
    ds_read_b64_tr_b16 a[176:177], v21 offset:16384
    v_cndmask_b32_e32 v92, v92, v93, vcc
    v_cndmask_b32_e32 v93, v94, v95, vcc
    s_mov_b64 vcc, s[52:53]
    v_mfma_f32_16x16x32_bf16 v[172:175], a[148:151], a[188:191], v[172:175]
    ds_read_b64_tr_b16 a[178:179], v21 offset:16896
    s_add_u32 s27, s25, 589824
    s_add_u32 m0, s29, 57344
    v_cndmask_b32_e32 v124, v124, v156, vcc
    v_mfma_f32_16x16x32_bf16 v[168:171], a[140:143], a[188:191], v[168:171]
    buffer_load_dwordx4 v13, s[64:67], s27 offen offset:0 lds
    v_cndmask_b32_e32 v112, v112, v116, vcc
    v_cndmask_b32_e32 v120, v120, v144, vcc
    v_cndmask_b32_e32 v148, v148, v152, vcc
    v_mfma_f32_16x16x32_bf16 v[168:171], a[136:139], a[184:187], v[168:171]
    v_cndmask_b32_e32 v48, v48, v52, vcc
    v_cndmask_b32_e32 v56, v56, v60, vcc
    v_cndmask_b32_e32 v80, v80, v84, vcc
    v_cndmask_b32_e32 v88, v88, v92, vcc
    v_mfma_f32_16x16x32_bf16 v[164:167], a[128:131], a[184:187], v[164:167]
    s_mov_b64 vcc, s[54:55]
    v_cndmask_b32_e32 v125, v125, v157, vcc
    v_cndmask_b32_e32 v113, v113, v117, vcc
    v_cndmask_b32_e32 v121, v121, v145, vcc
    v_mfma_f32_16x16x32_bf16 v[164:167], a[132:135], a[188:191], v[164:167]
    ds_read_b64_tr_b16 a[180:181], v21 offset:20480
    v_cndmask_b32_e32 v149, v149, v153, vcc
    v_cndmask_b32_e32 v49, v49, v53, vcc
    v_cndmask_b32_e32 v57, v57, v61, vcc
    v_mfma_f32_16x16x32_bf16 v[160:163], a[124:127], a[188:191], v[160:163]
    ds_read_b64_tr_b16 a[182:183], v21 offset:20992
    s_add_u32 m0, s29, 65024
    v_cndmask_b32_e32 v81, v81, v85, vcc
    v_cndmask_b32_e32 v89, v89, v93, vcc
    v_mfma_f32_16x16x32_bf16 v[160:163], a[120:123], a[184:187], v[160:163]
    buffer_load_dwordx4 v13, s[64:67], s27 offen offset:512 lds
    v_add_f32 v124, v124, v242
    v_add_f32 v125, v125, v243
    v_add_f32 v48, v48, v242
    v_mfma_f32_16x16x32_bf16 v[228:231], a[152:155], a[184:187], v[228:231]
    v_add_f32 v49, v49, v243
    v_max_f32 v126, v124, v125
    v_max_f32 v114, v112, v113
    v_max_f32 v122, v120, v121
    v_mfma_f32_16x16x32_bf16 v[228:231], a[156:159], a[188:191], v[228:231]
    s_waitcnt lgkmcnt(8)
    v_max_f32 v150, v148, v149
    v_max_f32 v50, v48, v49
    v_max_f32 v58, v56, v57
    v_mfma_f32_16x16x32_bf16 v[176:179], a[0:3], a[160:163], v[176:179]
    ds_read_b64_tr_b16 a[184:185], v21 offset:40960
    v_max_f32 v82, v80, v81
    v_max_f32 v90, v88, v89
    v_mov_b32 v127, v126
    v_mfma_f32_16x16x32_bf16 v[176:179], a[4:7], a[164:167], v[176:179]
    ds_read_b64_tr_b16 a[186:187], v21 offset:41472
    s_add_u32 m0, s29, 58368
    v_mov_b32 v115, v114
    v_mov_b32 v123, v122
    v_mfma_f32_16x16x32_bf16 v[180:183], a[12:15], a[164:167], v[180:183]
    buffer_load_dwordx4 v14, s[64:67], s27 offen offset:0 lds
    v_mov_b32 v151, v150
    v_mov_b32 v51, v50
    v_mov_b32 v59, v58
    v_mfma_f32_16x16x32_bf16 v[180:183], a[8:11], a[160:163], v[180:183]
    v_mov_b32 v83, v82
    v_mov_b32 v91, v90
    v_permlane16_swap_b32 v126, v127
    v_permlane16_swap_b32 v114, v115
    v_mfma_f32_16x16x32_bf16 v[184:187], a[16:19], a[160:163], v[184:187]
    ds_read_b64_tr_b16 a[188:189], v21 offset:45056
    v_permlane16_swap_b32 v122, v123
    v_permlane16_swap_b32 v150, v151
    v_permlane16_swap_b32 v50, v51
    v_mfma_f32_16x16x32_bf16 v[184:187], a[20:23], a[164:167], v[184:187]
    ds_read_b64_tr_b16 a[190:191], v21 offset:45568
    s_add_u32 m0, s29, 66048
    v_permlane16_swap_b32 v58, v59
    v_permlane16_swap_b32 v82, v83
    v_mfma_f32_16x16x32_bf16 v[188:191], a[28:31], a[164:167], v[188:191]
    buffer_load_dwordx4 v14, s[64:67], s27 offen offset:512 lds
    v_permlane16_swap_b32 v90, v91
    v_max_f32 v126, v126, v127
    v_max_f32 v114, v114, v115
    v_mfma_f32_16x16x32_bf16 v[188:191], a[24:27], a[160:163], v[188:191]
    s_waitcnt lgkmcnt(8)
    v_max_f32 v122, v122, v123
    v_max_f32 v150, v150, v151
    v_max_f32 v50, v50, v51
    v_mfma_f32_16x16x32_bf16 v[188:191], a[64:67], a[168:171], v[188:191]
    ds_read_b64_tr_b16 a[160:161], v18 offset:16384
    v_max_f32 v58, v58, v59
    v_max_f32 v82, v82, v83
    v_max_f32 v90, v90, v91
    v_mfma_f32_16x16x32_bf16 v[188:191], a[68:71], a[172:175], v[188:191]
    ds_read_b64_tr_b16 a[162:163], v18 offset:16896
    s_add_u32 s27, s25, 655360
    s_add_u32 m0, s29, 0
    v_mov_b32 v127, v126
    v_mfma_f32_16x16x32_bf16 v[184:187], a[60:63], a[172:175], v[184:187]
    buffer_load_dwordx4 v13, s[64:67], s27 offen offset:0 lds
    v_mov_b32 v115, v114
    v_mov_b32 v123, v122
    v_mov_b32 v151, v150
    v_mfma_f32_16x16x32_bf16 v[184:187], a[56:59], a[168:171], v[184:187]
    v_mov_b32 v51, v50
    v_mov_b32 v59, v58
    v_mov_b32 v83, v82
    v_mov_b32 v91, v90
    v_mfma_f32_16x16x32_bf16 v[180:183], a[48:51], a[168:171], v[180:183]
    ds_read_b64_tr_b16 a[164:165], v18 offset:20480
    v_permlane32_swap_b32 v126, v127
    v_permlane32_swap_b32 v114, v115
    v_permlane32_swap_b32 v122, v123
    v_mfma_f32_16x16x32_bf16 v[180:183], a[52:55], a[172:175], v[180:183]
    ds_read_b64_tr_b16 a[166:167], v18 offset:20992
    s_add_u32 m0, s29, 7680
    v_permlane32_swap_b32 v150, v151
    v_permlane32_swap_b32 v50, v51
    v_mfma_f32_16x16x32_bf16 v[176:179], a[44:47], a[172:175], v[176:179]
    buffer_load_dwordx4 v13, s[64:67], s27 offen offset:512 lds
    v_permlane32_swap_b32 v58, v59
    v_permlane32_swap_b32 v82, v83
    v_permlane32_swap_b32 v90, v91
    v_mfma_f32_16x16x32_bf16 v[176:179], a[40:43], a[168:171], v[176:179]
    s_waitcnt lgkmcnt(8)
    v_max_f32 v126, v126, v127
    v_max_f32 v114, v114, v115
    v_max_f32 v122, v122, v123
    v_mfma_f32_16x16x32_bf16 v[176:179], a[80:83], a[176:179], v[176:179]
    ds_read_b64_tr_b16 a[168:169], v18 offset:45056
    v_max_f32 v150, v150, v151
    v_max_f32 v50, v50, v51
    v_max_f32 v58, v58, v59
    v_mfma_f32_16x16x32_bf16 v[176:179], a[84:87], a[180:183], v[176:179]
    ds_read_b64_tr_b16 a[170:171], v18 offset:45568
    s_add_u32 m0, s29, 1024
    v_max_f32 v82, v82, v83
    v_max_f32 v90, v90, v91
    v_mfma_f32_16x16x32_bf16 v[180:183], a[92:95], a[180:183], v[180:183]
    buffer_load_dwordx4 v14, s[64:67], s27 offen offset:0 lds
    v_sub_f32 v124, v124, v126
    v_sub_f32 v125, v125, v126
    v_sub_f32 v112, v112, v114
    v_mfma_f32_16x16x32_bf16 v[180:183], a[88:91], a[176:179], v[180:183]
    v_sub_f32 v113, v113, v114
    v_sub_f32 v120, v120, v122
    v_sub_f32 v121, v121, v122
    v_sub_f32 v148, v148, v150
    v_mfma_f32_16x16x32_bf16 v[184:187], a[96:99], a[176:179], v[184:187]
    ds_read_b64_tr_b16 a[172:173], v18 offset:49152
    v_sub_f32 v149, v149, v150
    v_sub_f32 v48, v48, v50
    v_sub_f32 v49, v49, v50
    v_mfma_f32_16x16x32_bf16 v[184:187], a[100:103], a[180:183], v[184:187]
    ds_read_b64_tr_b16 a[174:175], v18 offset:49664
    s_add_u32 m0, s29, 8704
    v_sub_f32 v56, v56, v58
    v_sub_f32 v57, v57, v58
    v_mfma_f32_16x16x32_bf16 v[188:191], a[108:111], a[180:183], v[188:191]
    buffer_load_dwordx4 v14, s[64:67], s27 offen offset:512 lds
    v_sub_f32 v80, v80, v82
    v_sub_f32 v81, v81, v82
    v_sub_f32 v88, v88, v90
    v_mfma_f32_16x16x32_bf16 v[188:191], a[104:107], a[176:179], v[188:191]
    s_waitcnt lgkmcnt(8)
    v_sub_f32 v89, v89, v90
    v_mul_f32 v124, s47, v124
    v_mul_f32 v125, s47, v125
    v_mfma_f32_16x16x32_bf16 v[188:191], a[144:147], a[184:187], v[188:191]
    ds_read_b64_tr_b16 a[176:177], v22 offset:16384
    v_mul_f32 v112, s47, v112
    v_mul_f32 v113, s47, v113
    v_mul_f32 v120, s47, v120
    v_mfma_f32_16x16x32_bf16 v[188:191], a[148:151], a[188:191], v[188:191]
    ds_read_b64_tr_b16 a[178:179], v22 offset:16896
    v_mul_f32 v121, s47, v121
    v_mul_f32 v148, s47, v148
    v_mul_f32 v149, s47, v149
    v_mfma_f32_16x16x32_bf16 v[184:187], a[140:143], a[188:191], v[184:187]
    v_mul_f32 v48, s47, v48
    v_mul_f32 v49, s47, v49
    v_mul_f32 v56, s47, v56
    v_mul_f32 v57, s47, v57
    v_mfma_f32_16x16x32_bf16 v[184:187], a[136:139], a[184:187], v[184:187]
    v_mul_f32 v80, s47, v80
    v_mul_f32 v81, s47, v81
    v_mul_f32 v88, s47, v88
    v_mul_f32 v89, s47, v89
    v_mfma_f32_16x16x32_bf16 v[180:183], a[128:131], a[184:187], v[180:183]
    ds_read_b64_tr_b16 a[180:181], v22 offset:20480
    v_exp_f32 v124, v124
    v_exp_f32 v125, v125
    v_exp_f32 v112, v112
    v_mfma_f32_16x16x32_bf16 v[180:183], a[132:135], a[188:191], v[180:183]
    ds_read_b64_tr_b16 a[182:183], v22 offset:20992
    v_exp_f32 v113, v113
    v_exp_f32 v120, v120
    v_exp_f32 v121, v121
    v_mfma_f32_16x16x32_bf16 v[176:179], a[124:127], a[188:191], v[176:179]
    v_exp_f32 v148, v148
    v_exp_f32 v149, v149
    v_exp_f32 v48, v48
    v_exp_f32 v49, v49
    v_mfma_f32_16x16x32_bf16 v[176:179], a[120:123], a[184:187], v[176:179]
    s_waitcnt lgkmcnt(8)
    v_exp_f32 v56, v56
    v_exp_f32 v57, v57
    v_exp_f32 v80, v80
    v_mfma_f32_16x16x32_bf16 v[192:195], a[0:3], a[160:163], v[192:195]
    ds_read_b64_tr_b16 a[184:185], v22 offset:40960
    v_exp_f32 v81, v81
    v_exp_f32 v88, v88
    v_exp_f32 v89, v89
    v_mfma_f32_16x16x32_bf16 v[192:195], a[4:7], a[164:167], v[192:195]
    ds_read_b64_tr_b16 a[186:187], v22 offset:41472
    v_add_f32 v126, v124, v125
    v_add_f32 v114, v112, v113
    v_add_f32 v122, v120, v121
    v_mfma_f32_16x16x32_bf16 v[196:199], a[12:15], a[164:167], v[196:199]
    v_add_f32 v150, v148, v149
    v_add_f32 v50, v48, v49
    v_add_f32 v58, v56, v57
    v_add_f32 v82, v80, v81
    v_mfma_f32_16x16x32_bf16 v[196:199], a[8:11], a[160:163], v[196:199]
    v_add_f32 v90, v88, v89
    v_mov_b32 v127, v126
    v_mov_b32 v115, v114
    v_mov_b32 v123, v122
    v_mfma_f32_16x16x32_bf16 v[200:203], a[16:19], a[160:163], v[200:203]
    ds_read_b64_tr_b16 a[188:189], v22 offset:45056
    v_mov_b32 v151, v150
    v_mov_b32 v51, v50
    v_mov_b32 v59, v58
    v_mfma_f32_16x16x32_bf16 v[200:203], a[20:23], a[164:167], v[200:203]
    ds_read_b64_tr_b16 a[190:191], v22 offset:45568
    v_mov_b32 v83, v82
    v_mov_b32 v91, v90
    v_permlane16_swap_b32 v126, v127
    v_mfma_f32_16x16x32_bf16 v[204:207], a[28:31], a[164:167], v[204:207]
    v_permlane16_swap_b32 v114, v115
    v_permlane16_swap_b32 v122, v123
    v_permlane16_swap_b32 v150, v151
    v_permlane16_swap_b32 v50, v51
    v_mfma_f32_16x16x32_bf16 v[204:207], a[24:27], a[160:163], v[204:207]
    s_waitcnt lgkmcnt(8)
    v_permlane16_swap_b32 v58, v59
    v_permlane16_swap_b32 v82, v83
    v_permlane16_swap_b32 v90, v91
    v_mfma_f32_16x16x32_bf16 v[204:207], a[64:67], a[168:171], v[204:207]
    ds_read_b64_tr_b16 a[160:161], v19 offset:16384
    v_add_f32 v126, v126, v127
    v_add_f32 v114, v114, v115
    v_add_f32 v122, v122, v123
    v_mfma_f32_16x16x32_bf16 v[204:207], a[68:71], a[172:175], v[204:207]
    ds_read_b64_tr_b16 a[162:163], v19 offset:16896
    v_add_f32 v150, v150, v151
    v_add_f32 v50, v50, v51
    v_add_f32 v58, v58, v59
    v_mfma_f32_16x16x32_bf16 v[200:203], a[60:63], a[172:175], v[200:203]
    v_add_f32 v82, v82, v83
    v_add_f32 v90, v90, v91
    v_mov_b32 v127, v126
    v_mov_b32 v115, v114
    v_mfma_f32_16x16x32_bf16 v[200:203], a[56:59], a[168:171], v[200:203]
    v_mov_b32 v123, v122
    v_mov_b32 v151, v150
    v_mov_b32 v51, v50
    v_mov_b32 v59, v58
    v_mfma_f32_16x16x32_bf16 v[196:199], a[48:51], a[168:171], v[196:199]
    ds_read_b64_tr_b16 a[164:165], v19 offset:20480
    v_mov_b32 v83, v82
    v_mov_b32 v91, v90
    v_permlane32_swap_b32 v126, v127
    v_mfma_f32_16x16x32_bf16 v[196:199], a[52:55], a[172:175], v[196:199]
    ds_read_b64_tr_b16 a[166:167], v19 offset:20992
    v_permlane32_swap_b32 v114, v115
    v_permlane32_swap_b32 v122, v123
    v_permlane32_swap_b32 v150, v151
    v_mfma_f32_16x16x32_bf16 v[192:195], a[44:47], a[172:175], v[192:195]
    v_permlane32_swap_b32 v50, v51
    v_permlane32_swap_b32 v58, v59
    v_permlane32_swap_b32 v82, v83
    v_permlane32_swap_b32 v90, v91
    v_mfma_f32_16x16x32_bf16 v[192:195], a[40:43], a[168:171], v[192:195]
    s_waitcnt lgkmcnt(8)
    v_add_f32 v126, v126, v127
    v_add_f32 v114, v114, v115
    v_add_f32 v122, v122, v123
    v_mfma_f32_16x16x32_bf16 v[192:195], a[80:83], a[176:179], v[192:195]
    ds_read_b64_tr_b16 a[168:169], v19 offset:45056
    v_add_f32 v150, v150, v151
    v_add_f32 v50, v50, v51
    v_add_f32 v58, v58, v59
    v_mfma_f32_16x16x32_bf16 v[192:195], a[84:87], a[180:183], v[192:195]
    ds_read_b64_tr_b16 a[170:171], v19 offset:45568
    v_add_f32 v82, v82, v83
    v_add_f32 v90, v90, v91
    v_rcp_f32 v126, v126
    v_mfma_f32_16x16x32_bf16 v[196:199], a[92:95], a[180:183], v[196:199]
    v_rcp_f32 v114, v114
    v_rcp_f32 v122, v122
    v_rcp_f32 v150, v150
    v_rcp_f32 v50, v50
    v_mfma_f32_16x16x32_bf16 v[196:199], a[88:91], a[176:179], v[196:199]
    v_rcp_f32 v58, v58
    v_rcp_f32 v82, v82
    v_rcp_f32 v90, v90
    v_mul_f32 v124, v124, v126
    v_mfma_f32_16x16x32_bf16 v[200:203], a[96:99], a[176:179], v[200:203]
    ds_read_b64_tr_b16 a[172:173], v19 offset:49152
    v_mul_f32 v125, v125, v126
    v_mul_f32 v112, v112, v114
    v_mul_f32 v113, v113, v114
    v_mfma_f32_16x16x32_bf16 v[200:203], a[100:103], a[180:183], v[200:203]
    ds_read_b64_tr_b16 a[174:175], v19 offset:49664
    v_mul_f32 v120, v120, v122
    v_mul_f32 v121, v121, v122
    v_mul_f32 v148, v148, v150
    v_mfma_f32_16x16x32_bf16 v[204:207], a[108:111], a[180:183], v[204:207]
    v_mul_f32 v149, v149, v150
    v_mul_f32 v48, v48, v50
    v_mul_f32 v49, v49, v50
    v_mul_f32 v56, v56, v58
    v_mfma_f32_16x16x32_bf16 v[204:207], a[104:107], a[176:179], v[204:207]
    s_waitcnt lgkmcnt(8)
    v_mul_f32 v57, v57, v58
    v_mul_f32 v80, v80, v82
    v_mul_f32 v81, v81, v82
    v_mfma_f32_16x16x32_bf16 v[204:207], a[144:147], a[184:187], v[204:207]
    ds_read_b64_tr_b16 a[176:177], v23 offset:16384
    v_mul_f32 v88, v88, v90
    v_mul_f32 v89, v89, v90
    v_cvt_pk_bf16_f32 v124, v124, 0
    v_mfma_f32_16x16x32_bf16 v[204:207], a[148:151], a[188:191], v[204:207]
    ds_read_b64_tr_b16 a[178:179], v23 offset:16896
    v_cvt_pk_bf16_f32 v125, v125, 0
    v_cvt_pk_bf16_f32 v112, v112, 0
    v_cvt_pk_bf16_f32 v113, v113, 0
    v_mfma_f32_16x16x32_bf16 v[200:203], a[140:143], a[188:191], v[200:203]
    v_cvt_pk_bf16_f32 v120, v120, 0
    v_cvt_pk_bf16_f32 v121, v121, 0
    v_cvt_pk_bf16_f32 v148, v148, 0
    v_cvt_pk_bf16_f32 v149, v149, 0
    v_mfma_f32_16x16x32_bf16 v[200:203], a[136:139], a[184:187], v[200:203]
    v_cvt_pk_bf16_f32 v48, v48, 0
    v_cvt_pk_bf16_f32 v49, v49, 0
    v_cvt_pk_bf16_f32 v56, v56, 0
    v_cvt_pk_bf16_f32 v57, v57, 0
    v_mfma_f32_16x16x32_bf16 v[196:199], a[128:131], a[184:187], v[196:199]
    ds_read_b64_tr_b16 a[180:181], v23 offset:20480
    v_cvt_pk_bf16_f32 v80, v80, 0
    v_cvt_pk_bf16_f32 v81, v81, 0
    v_cvt_pk_bf16_f32 v88, v88, 0
    v_mfma_f32_16x16x32_bf16 v[196:199], a[132:135], a[188:191], v[196:199]
    ds_read_b64_tr_b16 a[182:183], v23 offset:20992
    v_cvt_pk_bf16_f32 v89, v89, 0
    v_lshlrev_b32 v124, v241, v124
    v_lshlrev_b32 v125, v241, v125
    v_mfma_f32_16x16x32_bf16 v[192:195], a[124:127], a[188:191], v[192:195]
    v_lshlrev_b32 v112, v241, v112
    v_lshlrev_b32 v113, v241, v113
    v_lshlrev_b32 v120, v241, v120
    v_lshlrev_b32 v121, v241, v121
    v_mfma_f32_16x16x32_bf16 v[192:195], a[120:123], a[184:187], v[192:195]
    s_waitcnt lgkmcnt(8)
    v_lshlrev_b32 v148, v241, v148
    v_lshlrev_b32 v149, v241, v149
    v_lshlrev_b32 v48, v241, v48
    v_mfma_f32_16x16x32_bf16 v[208:211], a[0:3], a[160:163], v[208:211]
    ds_read_b64_tr_b16 a[184:185], v23 offset:40960
    v_lshlrev_b32 v49, v241, v49
    v_lshlrev_b32 v56, v241, v56
    v_lshlrev_b32 v57, v241, v57
    v_mfma_f32_16x16x32_bf16 v[208:211], a[4:7], a[164:167], v[208:211]
    ds_read_b64_tr_b16 a[186:187], v23 offset:41472
    v_lshlrev_b32 v80, v241, v80
    v_lshlrev_b32 v81, v241, v81
    v_lshlrev_b32 v88, v241, v88
    v_mfma_f32_16x16x32_bf16 v[212:215], a[12:15], a[164:167], v[212:215]
    v_lshlrev_b32 v89, v241, v89
    s_mov_b64 vcc, s[52:53]
    v_cndmask_b32_e32 v158, 0, v124, vcc
    v_cndmask_b32_e32 v118, 0, v112, vcc
    v_mfma_f32_16x16x32_bf16 v[212:215], a[8:11], a[160:163], v[212:215]
    v_cndmask_b32_e32 v146, 0, v120, vcc
    v_cndmask_b32_e32 v154, 0, v148, vcc
    v_cndmask_b32_e32 v54, 0, v48, vcc
    v_cndmask_b32_e32 v62, 0, v56, vcc
    v_mfma_f32_16x16x32_bf16 v[216:219], a[16:19], a[160:163], v[216:219]
    ds_read_b64_tr_b16 a[188:189], v23 offset:45056
    v_cndmask_b32_e32 v86, 0, v80, vcc
    v_cndmask_b32_e32 v94, 0, v88, vcc
    v_xor_b32_e32 v156, v124, v158
    v_mfma_f32_16x16x32_bf16 v[216:219], a[20:23], a[164:167], v[216:219]
    ds_read_b64_tr_b16 a[190:191], v23 offset:45568
    v_xor_b32_e32 v116, v112, v118
    v_xor_b32_e32 v144, v120, v146
    v_xor_b32_e32 v152, v148, v154
    v_mfma_f32_16x16x32_bf16 v[220:223], a[28:31], a[164:167], v[220:223]
    v_xor_b32_e32 v52, v48, v54
    v_xor_b32_e32 v60, v56, v62
    v_xor_b32_e32 v84, v80, v86
    v_xor_b32_e32 v92, v88, v94
    v_mfma_f32_16x16x32_bf16 v[220:223], a[24:27], a[160:163], v[220:223]
    s_waitcnt lgkmcnt(8)
    s_mov_b64 vcc, s[54:55]
    v_cndmask_b32_e32 v159, 0, v125, vcc
    v_cndmask_b32_e32 v119, 0, v113, vcc
    v_mfma_f32_16x16x32_bf16 v[220:223], a[64:67], a[168:171], v[220:223]
    v_cndmask_b32_e32 v147, 0, v121, vcc
    v_cndmask_b32_e32 v155, 0, v149, vcc
    v_cndmask_b32_e32 v55, 0, v49, vcc
    v_cndmask_b32_e32 v63, 0, v57, vcc
    v_mfma_f32_16x16x32_bf16 v[220:223], a[68:71], a[172:175], v[220:223]
    v_cndmask_b32_e32 v87, 0, v81, vcc
    v_cndmask_b32_e32 v95, 0, v89, vcc
    v_xor_b32_e32 v157, v125, v159
    v_xor_b32_e32 v117, v113, v119
    v_mfma_f32_16x16x32_bf16 v[216:219], a[60:63], a[172:175], v[216:219]
    v_xor_b32_e32 v145, v121, v147
    v_xor_b32_e32 v153, v149, v155
    v_xor_b32_e32 v53, v49, v55
    v_xor_b32_e32 v61, v57, v63
    v_mfma_f32_16x16x32_bf16 v[216:219], a[56:59], a[168:171], v[216:219]
    v_xor_b32_e32 v85, v81, v87
    v_xor_b32_e32 v93, v89, v95
    v_cvt_pk_bf16_f32 v228, v228, v229
    v_cvt_pk_bf16_f32 v229, v230, v231
    v_mfma_f32_16x16x32_bf16 v[212:215], a[48:51], a[168:171], v[212:215]
    ds_write_b64 v240, v[228:229]
    v_cvt_pk_bf16_f32 v163, v162, v163
    v_cvt_pk_bf16_f32 v162, v160, v161
    v_cvt_pk_bf16_f32 v164, v164, v165
    v_mfma_f32_16x16x32_bf16 v[212:215], a[52:55], a[172:175], v[212:215]
    v_cvt_pk_bf16_f32 v165, v166, v167
    v_cvt_pk_bf16_f32 v166, v168, v169
    v_cvt_pk_bf16_f32 v167, v170, v171
    v_cvt_pk_bf16_f32 v168, v172, v173
    v_mfma_f32_16x16x32_bf16 v[208:211], a[44:47], a[172:175], v[208:211]
    v_cvt_pk_bf16_f32 v169, v174, v175
    ds_write_b64 v236, v[168:169]
    v_cvt_pk_bf16_f32 v179, v178, v179
    v_cvt_pk_bf16_f32 v178, v176, v177
    v_mfma_f32_16x16x32_bf16 v[208:211], a[40:43], a[168:171], v[208:211]
    s_waitcnt lgkmcnt(6)
    s_lshl_b32 s49, s34, 3
    s_bfe_u32 s48, s2, 0x20001
    s_add_u32 s49, s49, s48
    v_mfma_f32_16x16x32_bf16 v[208:211], a[80:83], a[176:179], v[208:211]
    s_lshl_b32 s49, s49, 9
    v_lshrrev_b32 v31, 4, v1
    v_lshlrev_b32 v31, 7, v31
    s_add_u32 s48, s49, 34816
    v_mfma_f32_16x16x32_bf16 v[208:211], a[84:87], a[180:183], v[208:211]
    buffer_load_dwordx2 v[28:29], v31, s[20:23], s48 offen sc1
    v_cvt_pk_bf16_f32 v180, v180, v181
    v_cvt_pk_bf16_f32 v181, v182, v183
    v_cvt_pk_bf16_f32 v182, v184, v185
    v_mfma_f32_16x16x32_bf16 v[212:215], a[92:95], a[180:183], v[212:215]
    v_cvt_pk_bf16_f32 v183, v186, v187
    v_cvt_pk_bf16_f32 v184, v188, v189
    v_cvt_pk_bf16_f32 v185, v190, v191
    ds_write_b64 v237, v[184:185]
    v_mfma_f32_16x16x32_bf16 v[212:215], a[88:91], a[176:179], v[212:215]
    v_cvt_pk_bf16_f32 v195, v194, v195
    v_cvt_pk_bf16_f32 v194, v192, v193
    v_cvt_pk_bf16_f32 v196, v196, v197
    v_cvt_pk_bf16_f32 v197, v198, v199
    v_mfma_f32_16x16x32_bf16 v[216:219], a[96:99], a[176:179], v[216:219]
    v_cvt_pk_bf16_f32 v198, v200, v201
    v_cvt_pk_bf16_f32 v199, v202, v203
    v_cvt_pk_bf16_f32 v200, v204, v205
    v_cvt_pk_bf16_f32 v201, v206, v207
    v_mfma_f32_16x16x32_bf16 v[216:219], a[100:103], a[180:183], v[216:219]
    ds_write_b64 v238, v[200:201]
    v_mfma_f32_16x16x32_bf16 v[220:223], a[108:111], a[180:183], v[220:223]
    v_mfma_f32_16x16x32_bf16 v[220:223], a[104:107], a[176:179], v[220:223]
    s_waitcnt lgkmcnt(4)
    v_mfma_f32_16x16x32_bf16 v[220:223], a[144:147], a[184:187], v[220:223]
    v_mfma_f32_16x16x32_bf16 v[220:223], a[148:151], a[188:191], v[220:223]
    v_mfma_f32_16x16x32_bf16 v[216:219], a[140:143], a[188:191], v[216:219]
    v_mfma_f32_16x16x32_bf16 v[216:219], a[136:139], a[184:187], v[216:219]
    v_mfma_f32_16x16x32_bf16 v[212:215], a[128:131], a[184:187], v[212:215]
    v_mfma_f32_16x16x32_bf16 v[212:215], a[132:135], a[188:191], v[212:215]
    v_mfma_f32_16x16x32_bf16 v[208:211], a[124:127], a[188:191], v[208:211]
    v_mfma_f32_16x16x32_bf16 v[208:211], a[120:123], a[184:187], v[208:211]
    s_nop 7
    v_cvt_pk_bf16_f32 v211, v210, v211
    v_cvt_pk_bf16_f32 v210, v208, v209
    v_cvt_pk_bf16_f32 v212, v212, v213
    v_cvt_pk_bf16_f32 v213, v214, v215
    v_cvt_pk_bf16_f32 v214, v216, v217
    v_cvt_pk_bf16_f32 v215, v218, v219
    v_cvt_pk_bf16_f32 v216, v220, v221
    v_cvt_pk_bf16_f32 v217, v222, v223
    ds_write_b64 v239, v[216:217]
    s_waitcnt lgkmcnt(0)
    s_barrier
    ds_read_b64 v[160:161], v232
    ds_read_b64 v[176:177], v233
    ds_read_b64 v[192:193], v234
    ds_read_b64 v[208:209], v235
    s_add_u32 s27, s25, 131072
    s_add_u32 m0, s29, 98304
    s_nop 0
    buffer_load_dwordx4 v13, s[64:67], s27 offen offset:0 lds
    s_add_u32 m0, s29, 105984
    s_nop 0
    buffer_load_dwordx4 v13, s[64:67], s27 offen offset:512 lds
    s_add_u32 m0, s29, 99328
    s_nop 0
    buffer_load_dwordx4 v14, s[64:67], s27 offen offset:0 lds
    s_add_u32 m0, s29, 107008
    s_nop 0
    buffer_load_dwordx4 v14, s[64:67], s27 offen offset:512 lds
    s_lshl_b32 s36, s35, 12
    s_lshl_b32 s38, s4, 1
    s_lshr_b32 s46, s5, 1
    s_add_u32 s38, s38, s46
    s_xor_b32 s46, s38, 1
    s_lshl_b32 s38, s38, 17
    s_lshl_b32 s46, s46, 17
    s_add_u32 s38, s38, s36
    s_add_u32 s46, s46, s36
    s_waitcnt lgkmcnt(0)
    s_bitcmp1_b32 s5, 0
    s_cbranch_scc1 L_attn_odd
    v_mfma_f32_16x16x32_bf16 v[124:127], v[160:163], v[156:159], 0
    v_mfma_f32_16x16x32_bf16 v[32:35], v[176:179], v[156:159], 0
    v_mfma_f32_16x16x32_bf16 v[112:115], v[162:165], v[116:119], 0
    v_mfma_f32_16x16x32_bf16 v[36:39], v[178:181], v[116:119], 0
    v_mfma_f32_16x16x32_bf16 v[120:123], v[164:167], v[144:147], 0
    v_mfma_f32_16x16x32_bf16 v[40:43], v[180:183], v[144:147], 0
    v_mfma_f32_16x16x32_bf16 v[148:151], v[166:169], v[152:155], 0
    v_mfma_f32_16x16x32_bf16 v[44:47], v[182:185], v[152:155], 0
    v_mfma_f32_16x16x32_bf16 v[48:51], v[192:195], v[52:55], 0
    v_mfma_f32_16x16x32_bf16 v[64:67], v[208:211], v[52:55], 0
    v_mfma_f32_16x16x32_bf16 v[56:59], v[194:197], v[60:63], 0
    v_mfma_f32_16x16x32_bf16 v[68:71], v[210:213], v[60:63], 0
    v_mfma_f32_16x16x32_bf16 v[80:83], v[196:199], v[84:87], 0
    v_mfma_f32_16x16x32_bf16 v[72:75], v[212:215], v[84:87], 0
    v_mfma_f32_16x16x32_bf16 v[88:91], v[198:201], v[92:95], 0
    v_mfma_f32_16x16x32_bf16 v[76:79], v[214:217], v[92:95], 0
    s_branch L_attn_join
L_attn_odd:
    s_nop 1
    v_mfma_f32_16x16x32_bf16 v[124:127], v[176:179], v[156:159], 0
    v_mfma_f32_16x16x32_bf16 v[32:35], v[160:163], v[156:159], 0
    v_mfma_f32_16x16x32_bf16 v[112:115], v[178:181], v[116:119], 0
    v_mfma_f32_16x16x32_bf16 v[36:39], v[162:165], v[116:119], 0
    v_mfma_f32_16x16x32_bf16 v[120:123], v[180:183], v[144:147], 0
    v_mfma_f32_16x16x32_bf16 v[40:43], v[164:167], v[144:147], 0
    v_mfma_f32_16x16x32_bf16 v[148:151], v[182:185], v[152:155], 0
    v_mfma_f32_16x16x32_bf16 v[44:47], v[166:169], v[152:155], 0
    v_mfma_f32_16x16x32_bf16 v[48:51], v[208:211], v[52:55], 0
    v_mfma_f32_16x16x32_bf16 v[64:67], v[192:195], v[52:55], 0
    v_mfma_f32_16x16x32_bf16 v[56:59], v[210:213], v[60:63], 0
    v_mfma_f32_16x16x32_bf16 v[68:71], v[194:197], v[60:63], 0
    v_mfma_f32_16x16x32_bf16 v[80:83], v[212:215], v[84:87], 0
    v_mfma_f32_16x16x32_bf16 v[72:75], v[196:199], v[84:87], 0
    v_mfma_f32_16x16x32_bf16 v[88:91], v[214:217], v[92:95], 0
    v_mfma_f32_16x16x32_bf16 v[76:79], v[198:201], v[92:95], 0
L_attn_join:
    v_cvt_pk_bf16_f32 v192, v124, v125
    v_cvt_pk_bf16_f32 v193, v126, v127
    v_cvt_pk_bf16_f32 v194, v32, v33
    v_cvt_pk_bf16_f32 v195, v34, v35
    v_cvt_pk_bf16_f32 v196, v112, v113
    v_cvt_pk_bf16_f32 v197, v114, v115
    v_cvt_pk_bf16_f32 v198, v36, v37
    v_cvt_pk_bf16_f32 v199, v38, v39
    v_cvt_pk_bf16_f32 v200, v120, v121
    v_cvt_pk_bf16_f32 v201, v122, v123
    v_cvt_pk_bf16_f32 v202, v40, v41
    v_cvt_pk_bf16_f32 v203, v42, v43
    v_cvt_pk_bf16_f32 v204, v148, v149
    v_cvt_pk_bf16_f32 v205, v150, v151
    v_cvt_pk_bf16_f32 v206, v44, v45
    v_cvt_pk_bf16_f32 v207, v46, v47
    v_cvt_pk_bf16_f32 v224, v48, v49
    v_cvt_pk_bf16_f32 v225, v50, v51
    v_cvt_pk_bf16_f32 v226, v64, v65
    v_cvt_pk_bf16_f32 v227, v66, v67
    v_cvt_pk_bf16_f32 v228, v56, v57
    v_cvt_pk_bf16_f32 v229, v58, v59
    v_cvt_pk_bf16_f32 v230, v68, v69
    v_cvt_pk_bf16_f32 v231, v70, v71
    v_cvt_pk_bf16_f32 v232, v80, v81
    v_cvt_pk_bf16_f32 v233, v82, v83
    v_cvt_pk_bf16_f32 v234, v72, v73
    v_cvt_pk_bf16_f32 v235, v74, v75
    v_cvt_pk_bf16_f32 v236, v88, v89
    v_cvt_pk_bf16_f32 v237, v90, v91
    v_cvt_pk_bf16_f32 v238, v76, v77
    v_cvt_pk_bf16_f32 v239, v78, v79
    s_min_u32 s50, s38, s46
    s_max_u32 s51, s38, s46
    s_cmp_lt_u32 s5, 2
    s_cbranch_scc1 L_noswap
    v_swap_b32 v192, v224
    v_swap_b32 v193, v225
    v_swap_b32 v194, v226
    v_swap_b32 v195, v227
    v_swap_b32 v196, v228
    v_swap_b32 v197, v229
    v_swap_b32 v198, v230
    v_swap_b32 v199, v231
    v_swap_b32 v200, v232
    v_swap_b32 v201, v233
    v_swap_b32 v202, v234
    v_swap_b32 v203, v235
    v_swap_b32 v204, v236
    v_swap_b32 v205, v237
    v_swap_b32 v206, v238
    v_swap_b32 v207, v239
L_noswap:
    s_branch L_g2
L_ffn:
    s_lshl_b32 s35, s3, 2
    s_add_u32 s35, s35, s5
    s_mul_i32 s38, s4, 448
    s_and_b32 s39, s4, 1
    s_lshl_b32 s46, s39, 6
    s_add_u32 s52, s38, s46
    s_cmp_eq_u32 s39, 0
    s_cselect_b32 s46, 384, 0
    s_add_u32 s55, s38, s46
    s_add_u32 s53, s52, 128
    s_add_u32 s54, s52, 256
    v_lshrrev_b32 v6, 3, v1
    v_and_b32 v7, 7, v1
    v_bfe_u32 v28, v1, 4, 1
    v_lshlrev_b32 v28, 1, v28
    v_xor_b32 v28, v28, v7
    s_lshl_b32 s46, s5, 4
    v_add_u32 v6, s46, v6
    v_mul_u32_u24 v6, 7168, v6
    v_lshl_add_u32 v13, v28, 4, v6
    v_xor_b32 v28, 4, v28
    v_lshl_add_u32 v14, v28, 4, v6
    v_add_u32 v14, 57344, v14
    v_lshrrev_b32 v6, 2, v1
    v_and_b32 v7, 3, v1
    v_bfe_u32 v28, v1, 5, 1
    v_lshlrev_b32 v28, 1, v28
    v_xor_b32 v28, v28, v7
    v_add_u32 v6, s46, v6
    v_mul_u32_u24 v6, 7168, v6
    v_lshl_add_u32 v15, v28, 4, v6
    s_lshl_b32 s29, s5, 11
    s_lshl_b32 s30, s5, 10
    s_add_u32 s30, s30, 24576
    v_lshrrev_b32 v3, 4, v1
    v_lshlrev_b32 v12, 4, v1
    s_lshl_b32 s36, s35, 13
    v_add_u32 v8, s36, v12
    v_add_u32 v9, 4096, v8
    v_and_b32 v5, 15, v1
    s_sub_u32 s46, s55, 384
    v_mov_b32 v6, s52
    v_mov_b32 v7, s46
    v_cmp_gt_u32 vcc, 12, v5
    v_lshlrev_b32 v5, 5, v5
    v_lshl_add_u32 v5, v3, 3, v5
    v_cndmask_b32 v6, v7, v6, vcc
    v_add_u32 v5, v5, v6
    s_lshl_b32 s6, s32, 7
    s_waitcnt vmcnt(1)
    s_barrier
    s_cmp_lg_u32 s5, 0
    s_cbranch_scc1 L_nofl_f
    buffer_store_dwordx2 v[66:67], v65, s[20:23], s6 offen sc1
L_nofl_f:
    buffer_load_dword a252, v11, s[12:15], s33 offen
    s_add_u32 s33, s33, s57
    buffer_load_dword a252, v11, s[12:15], s33 offen
    s_add_u32 s33, s33, s57
    buffer_load_dwordx2 v[128:129], v5, s[68:71], 0 offen
    s_add_u32 s25, s52, 0
    s_add_u32 s26, s53, 0
    s_add_u32 s27, s54, 0
    s_add_u32 s28, s55, 0
    s_add_u32 m0, s29, 86016
    s_nop 0
    buffer_load_dwordx4 v13, s[12:15], s25 offen  lds
    s_add_u32 m0, s29, 87040
    s_nop 0
    buffer_load_dwordx4 v14, s[12:15], s25 offen  lds
    s_add_u32 m0, s29, 94208
    s_nop 0
    buffer_load_dwordx4 v13, s[12:15], s26 offen  lds
    s_add_u32 m0, s29, 95232
    s_nop 0
    buffer_load_dwordx4 v14, s[12:15], s26 offen  lds
    s_add_u32 m0, s29, 102400
    s_nop 0
    buffer_load_dwordx4 v13, s[12:15], s27 offen  lds
    s_add_u32 m0, s29, 103424
    s_nop 0
    buffer_load_dwordx4 v14, s[12:15], s27 offen  lds
    s_add_u32 m0, s30, 86016
    s_nop 0
    buffer_load_dwordx4 v15, s[12:15], s28 offen  lds
    s_cmp_lg_u32 s5, 0
    s_cbranch_scc1 L_np0_f1
    buffer_load_dwordx2 v[134:135], v132, s[20:23], 0 offen sc1
L_np0_f1:
    v_bfe_u32 v6, v1, 2, 2
    v_and_b32 v7, 3, v1
    v_lshl_add_u32 v28, v3, 3, v6
    v_bfe_u32 v29, v1, 3, 2
    v_lshlrev_b32 v2, 7, v28
    v_lshl_add_u32 v2, v7, 3, v2
    v_xor_b32 v4, 0, v29
    v_lshl_add_u32 v16, v4, 5, v2
    v_add_u32 v20, 57344, v16
    v_xor_b32 v4, 1, v29
    v_lshl_add_u32 v17, v4, 5, v2
    v_add_u32 v21, 57344, v17
    v_xor_b32 v4, 2, v29
    v_lshl_add_u32 v18, v4, 5, v2
    v_add_u32 v22, 57344, v18
    v_xor_b32 v4, 3, v29
    v_lshl_add_u32 v19, v4, 5, v2
    v_add_u32 v23, 57344, v19
    v_lshlrev_b32 v2, 6, v28
    v_lshl_add_u32 v2, v7, 3, v2
    v_bfe_u32 v29, v1, 4, 1
    v_xor_b32 v4, 0, v29
    v_lshl_add_u32 v24, v4, 5, v2
    v_add_u32 v26, 57344, v24
    v_xor_b32 v4, 1, v29
    v_lshl_add_u32 v25, v4, 5, v2
    v_add_u32 v27, 57344, v25
    s_lshl_b32 s36, s35, 12
    s_mul_i32 s37, s4, 7
    s_add_u32 s37, s37, 32
    s_add_u32 s38, s37, s39
    s_lshl_b32 s38, s38, 17
    s_add_u32 s38, s38, s36
    s_cmp_eq_u32 s39, 0
    s_cselect_b32 s47, 6, 0
    s_add_u32 s47, s47, s37
    s_lshl_b32 s47, s47, 17
    s_add_u32 s47, s47, s36
    v_add_u32 v2, 114688, v16
    v_add_u32 v3, 114688, v17
    v_add_u32 v4, 114688, v18
    v_add_u32 v10, 114688, v19
    v_add_u32 v6, 114688, v24
    v_add_u32 v7, 114688, v25
    s_bfe_u32 s6, s2, 0x40003
    s_lshl_b32 s6, s6, 2
    s_add_u32 s6, s6, s5
    s_lshl_b32 s6, s6, 10
    v_lshrrev_b32 v28, 3, v1
    v_lshlrev_b32 v28, 7, v28
    v_add_u32 v28, s6, v28
    s_getpc_b64 s[100:101]
L_pc_f:
    s_add_u32 s100, s100, L_attn_start-L_pc_f
    s_addc_u32 s101, s101, (L_attn_start-L_pc_f)>>32
    v_min_u32 v28, L_code_end-L_attn_start-4, v28
    v_mov_b32 v29, s101
    v_add_co_u32 v28, vcc, s100, v28
    s_nop 1
    v_addc_co_u32 v29, vcc, 0, v29, vcc
    s_cmp_lg_u32 s5, 0
    s_cbranch_scc1 L_np_f1
    s_mov_b32 s7, 40000
L_poll_f1:
    s_waitcnt vmcnt(0)
    v_cmp_ne_u64 vcc, s[98:99], v[134:135]
    s_nop 1
    s_cmp_eq_u64 vcc, 0
    s_cbranch_scc1 L_pok_f1
    buffer_load_dwordx2 v[134:135], v132, s[20:23], 0 offen sc1
    s_sub_u32 s7, s7, 1
    s_cmp_lg_u32 s7, 0
    s_cbranch_scc1 L_poll_f1
L_pok_f1:
L_np_f1:
    s_waitcnt vmcnt(0)
    s_barrier
    s_mov_b32 s24, 0
    buffer_load_dwordx4 a[0:3], v8, s[8:11], s24 offen offset:0 sc1
    buffer_load_dwordx4 a[4:7], v8, s[8:11], s24 offen offset:1024 sc1
    buffer_load_dwordx4 a[8:11], v8, s[8:11], s24 offen offset:2048 sc1
    buffer_load_dwordx4 a[12:15], v8, s[8:11], s24 offen offset:3072 sc1
    buffer_load_dwordx4 a[16:19], v9, s[8:11], s24 offen offset:0 sc1
    buffer_load_dwordx4 a[20:23], v9, s[8:11], s24 offen offset:1024 sc1
    buffer_load_dwordx4 a[24:27], v9, s[8:11], s24 offen offset:2048 sc1
    buffer_load_dwordx4 a[28:31], v9, s[8:11], s24 offen offset:3072 sc1
    s_mov_b32 s46, s2
    s_lshl_b32 s46, s46, 2
    s_add_u32 s46, s46, s5
    s_lshl_b32 s68, s46, 9
    s_mov_b32 s69, s68
    v_lshrrev_b32 v5, 4, v1
    v_lshlrev_b32 v5, 7, v5
    s_add_u32 s16, s96, 4194304
    s_addc_u32 s17, s97, 0
    s_and_b32 s17, s17, 0xffff
    s_mov_b32 s18, 50331648
    s_mov_b32 s19, 0x20000
    s_mov_b32 s46, 0xffff0000
    v_mov_b32_dpp v45, v128 row_newbcast:0 row_mask:0xf bank_mask:0xf
    v_mov_b32_dpp v47, v129 row_newbcast:0 row_mask:0xf bank_mask:0xf
    v_lshlrev_b32 v44, 16, v45
    v_and_b32 v45, s46, v45
    v_lshlrev_b32 v46, 16, v47
    v_and_b32 v47, s46, v47
    v_mov_b32_dpp v61, v128 row_newbcast:1 row_mask:0xf bank_mask:0xf
    v_mov_b32_dpp v63, v129 row_newbcast:1 row_mask:0xf bank_mask:0xf
    v_lshlrev_b32 v60, 16, v61
    v_and_b32 v61, s46, v61
    v_lshlrev_b32 v62, 16, v63
    v_and_b32 v63, s46, v63
    v_mov_b32_dpp v77, v128 row_newbcast:2 row_mask:0xf bank_mask:0xf
    v_mov_b32_dpp v79, v129 row_newbcast:2 row_mask:0xf bank_mask:0xf
    v_lshlrev_b32 v76, 16, v77
    v_and_b32 v77, s46, v77
    v_lshlrev_b32 v78, 16, v79
    v_and_b32 v79, s46, v79
    v_mov_b32_dpp v93, v128 row_newbcast:3 row_mask:0xf bank_mask:0xf
    v_mov_b32_dpp v95, v129 row_newbcast:3 row_mask:0xf bank_mask:0xf
    v_lshlrev_b32 v92, 16, v93
    v_and_b32 v93, s46, v93
    v_lshlrev_b32 v94, 16, v95
    v_and_b32 v95, s46, v95
    v_mov_b32_dpp v109, v128 row_newbcast:4 row_mask:0xf bank_mask:0xf
    v_mov_b32_dpp v111, v129 row_newbcast:4 row_mask:0xf bank_mask:0xf
    v_lshlrev_b32 v108, 16, v109
    v_and_b32 v109, s46, v109
    v_lshlrev_b32 v110, 16, v111
    v_and_b32 v111, s46, v111
    v_mov_b32_dpp v125, v128 row_newbcast:5 row_mask:0xf bank_mask:0xf
    v_mov_b32_dpp v127, v129 row_newbcast:5 row_mask:0xf bank_mask:0xf
    v_lshlrev_b32 v124, 16, v125
    v_and_b32 v125, s46, v125
    v_lshlrev_b32 v126, 16, v127
    v_and_b32 v127, s46, v127
    v_mov_b32_dpp v141, v128 row_newbcast:6 row_mask:0xf bank_mask:0xf
    v_mov_b32_dpp v143, v129 row_newbcast:6 row_mask:0xf bank_mask:0xf
    v_lshlrev_b32 v140, 16, v141
    v_and_b32 v141, s46, v141
    v_lshlrev_b32 v142, 16, v143
    v_and_b32 v143, s46, v143
    v_mov_b32_dpp v157, v128 row_newbcast:7 row_mask:0xf bank_mask:0xf
    v_mov_b32_dpp v159, v129 row_newbcast:7 row_mask:0xf bank_mask:0xf
    v_lshlrev_b32 v156, 16, v157
    v_and_b32 v157, s46, v157
    v_lshlrev_b32 v158, 16, v159
    v_and_b32 v159, s46, v159
    v_mov_b32_dpp v173, v128 row_newbcast:8 row_mask:0xf bank_mask:0xf
    v_mov_b32_dpp v175, v129 row_newbcast:8 row_mask:0xf bank_mask:0xf
    v_lshlrev_b32 v172, 16, v173
    v_and_b32 v173, s46, v173
    v_lshlrev_b32 v174, 16, v175
    v_and_b32 v175, s46, v175
    v_mov_b32_dpp v189, v128 row_newbcast:9 row_mask:0xf bank_mask:0xf
    v_mov_b32_dpp v191, v129 row_newbcast:9 row_mask:0xf bank_mask:0xf
    v_lshlrev_b32 v188, 16, v189
    v_and_b32 v189, s46, v189
    v_lshlrev_b32 v190, 16, v191
    v_and_b32 v191, s46, v191
    v_mov_b32_dpp v205, v128 row_newbcast:10 row_mask:0xf bank_mask:0xf
    v_mov_b32_dpp v207, v129 row_newbcast:10 row_mask:0xf bank_mask:0xf
    v_lshlrev_b32 v204, 16, v205
    v_and_b32 v205, s46, v205
    v_lshlrev_b32 v206, 16, v207
    v_and_b32 v207, s46, v207
    v_mov_b32_dpp v221, v128 row_newbcast:11 row_mask:0xf bank_mask:0xf
    v_mov_b32_dpp v223, v129 row_newbcast:11 row_mask:0xf bank_mask:0xf
    v_lshlrev_b32 v220, 16, v221
    v_and_b32 v221, s46, v221
    v_lshlrev_b32 v222, 16, v223
    v_and_b32 v223, s46, v223
    v_mov_b32_dpp v237, v128 row_newbcast:12 row_mask:0xf bank_mask:0xf
    v_mov_b32_dpp v239, v129 row_newbcast:12 row_mask:0xf bank_mask:0xf
    v_lshlrev_b32 v236, 16, v237
    v_and_b32 v237, s46, v237
    v_lshlrev_b32 v238, 16, v239
    v_and_b32 v239, s46, v239
    v_mov_b32_dpp v253, v128 row_newbcast:13 row_mask:0xf bank_mask:0xf
    v_mov_b32_dpp v255, v129 row_newbcast:13 row_mask:0xf bank_mask:0xf
    v_lshlrev_b32 v252, 16, v253
    v_and_b32 v253, s46, v253
    v_lshlrev_b32 v254, 16, v255
    v_and_b32 v255, s46, v255
    ds_read_b64_tr_b16 a[160:161], v20 offset:28672
    ds_read_b64_tr_b16 a[162:163], v20 offset:29184
    ds_read_b64_tr_b16 a[164:165], v20 offset:32768
    ds_read_b64_tr_b16 a[166:167], v20 offset:33280
    ds_read_b64_tr_b16 a[168:169], v21 offset:28672
    ds_read_b64_tr_b16 a[170:171], v21 offset:29184
    ds_read_b64_tr_b16 a[172:173], v21 offset:32768
    ds_read_b64_tr_b16 a[174:175], v21 offset:33280
    ds_read_b64_tr_b16 a[176:177], v22 offset:28672
    ds_read_b64_tr_b16 a[178:179], v22 offset:29184
    ds_read_b64_tr_b16 a[180:181], v22 offset:32768
    ds_read_b64_tr_b16 a[182:183], v22 offset:33280
    s_waitcnt vmcnt(0)
    s_waitcnt lgkmcnt(8)
    v_mfma_f32_16x16x32_bf16 v[32:35], a[160:163], a[0:3], v[44:47]
    ds_read_b64_tr_b16 a[184:185], v23 offset:28672
    v_mfma_f32_16x16x32_bf16 v[32:35], a[164:167], a[4:7], v[32:35]
    ds_read_b64_tr_b16 a[186:187], v23 offset:29184
    s_add_u32 s25, s52, 458752
    s_add_u32 s26, s53, 458752
    s_add_u32 s27, s54, 458752
    s_add_u32 s28, s55, 458752
    s_add_u32 m0, s29, 0
    v_mfma_f32_16x16x32_bf16 v[36:39], a[164:167], a[12:15], v[44:47]
    buffer_load_dwordx4 v13, s[12:15], s25 offen  lds
    v_mfma_f32_16x16x32_bf16 v[36:39], a[160:163], a[8:11], v[36:39]
    v_mfma_f32_16x16x32_bf16 v[40:43], a[160:163], a[16:19], v[44:47]
    ds_read_b64_tr_b16 a[188:189], v23 offset:32768
    v_mfma_f32_16x16x32_bf16 v[40:43], a[164:167], a[20:23], v[40:43]
    ds_read_b64_tr_b16 a[190:191], v23 offset:33280
    s_add_u32 m0, s29, 1024
    v_mfma_f32_16x16x32_bf16 v[44:47], a[164:167], a[28:31], v[44:47]
    buffer_load_dwordx4 v14, s[12:15], s25 offen  lds
    v_mfma_f32_16x16x32_bf16 v[44:47], a[160:163], a[24:27], v[44:47]
    s_waitcnt lgkmcnt(8)
    v_mfma_f32_16x16x32_bf16 v[48:51], a[168:171], a[0:3], v[60:63]
    ds_read_b64_tr_b16 a[160:161], v20 offset:36864
    v_mfma_f32_16x16x32_bf16 v[48:51], a[172:175], a[4:7], v[48:51]
    ds_read_b64_tr_b16 a[162:163], v20 offset:37376
    s_add_u32 m0, s29, 8192
    v_mfma_f32_16x16x32_bf16 v[52:55], a[172:175], a[12:15], v[60:63]
    buffer_load_dwordx4 v13, s[12:15], s26 offen  lds
    v_mfma_f32_16x16x32_bf16 v[52:55], a[168:171], a[8:11], v[52:55]
    v_mfma_f32_16x16x32_bf16 v[56:59], a[168:171], a[16:19], v[60:63]
    ds_read_b64_tr_b16 a[164:165], v20 offset:40960
    v_mfma_f32_16x16x32_bf16 v[56:59], a[172:175], a[20:23], v[56:59]
    ds_read_b64_tr_b16 a[166:167], v20 offset:41472
    s_add_u32 m0, s29, 9216
    v_mfma_f32_16x16x32_bf16 v[60:63], a[172:175], a[28:31], v[60:63]
    buffer_load_dwordx4 v14, s[12:15], s26 offen  lds
    v_mfma_f32_16x16x32_bf16 v[60:63], a[168:171], a[24:27], v[60:63]
    s_waitcnt lgkmcnt(8)
    v_mfma_f32_16x16x32_bf16 v[64:67], a[176:179], a[0:3], v[76:79]
    ds_read_b64_tr_b16 a[168:169], v21 offset:36864
    v_mfma_f32_16x16x32_bf16 v[64:67], a[180:183], a[4:7], v[64:67]
    ds_read_b64_tr_b16 a[170:171], v21 offset:37376
    s_add_u32 m0, s29, 16384
    v_mfma_f32_16x16x32_bf16 v[68:71], a[180:183], a[12:15], v[76:79]
    buffer_load_dwordx4 v13, s[12:15], s27 offen  lds
    v_mfma_f32_16x16x32_bf16 v[68:71], a[176:179], a[8:11], v[68:71]
    v_mfma_f32_16x16x32_bf16 v[72:75], a[176:179], a[16:19], v[76:79]
    ds_read_b64_tr_b16 a[172:173], v21 offset:40960
    v_mfma_f32_16x16x32_bf16 v[72:75], a[180:183], a[20:23], v[72:75]
    ds_read_b64_tr_b16 a[174:175], v21 offset:41472
    s_add_u32 m0, s29, 17408
    v_mfma_f32_16x16x32_bf16 v[76:79], a[180:183], a[28:31], v[76:79]
    buffer_load_dwordx4 v14, s[12:15], s27 offen  lds
    v_mfma_f32_16x16x32_bf16 v[76:79], a[176:179], a[24:27], v[76:79]
    s_waitcnt lgkmcnt(8)
    v_mfma_f32_16x16x32_bf16 v[80:83], a[184:187], a[0:3], v[92:95]
    ds_read_b64_tr_b16 a[176:177], v22 offset:36864
    v_mfma_f32_16x16x32_bf16 v[80:83], a[188:191], a[4:7], v[80:83]
    ds_read_b64_tr_b16 a[178:179], v22 offset:37376
    s_add_u32 m0, s30, 0
    v_mfma_f32_16x16x32_bf16 v[84:87], a[188:191], a[12:15], v[92:95]
    buffer_load_dwordx4 v15, s[12:15], s28 offen  lds
    v_mfma_f32_16x16x32_bf16 v[84:87], a[184:187], a[8:11], v[84:87]
    v_mfma_f32_16x16x32_bf16 v[88:91], a[184:187], a[16:19], v[92:95]
    ds_read_b64_tr_b16 a[180:181], v22 offset:40960
    v_mfma_f32_16x16x32_bf16 v[88:91], a[188:191], a[20:23], v[88:91]
    ds_read_b64_tr_b16 a[182:183], v22 offset:41472
    s_mov_b32 s24, 262144
    v_mfma_f32_16x16x32_bf16 v[92:95], a[188:191], a[28:31], v[92:95]
    buffer_load_dwordx4 a[40:43], v8, s[8:11], s24 offen offset:0 sc1
    v_mfma_f32_16x16x32_bf16 v[92:95], a[184:187], a[24:27], v[92:95]
    s_waitcnt lgkmcnt(8)
    v_mfma_f32_16x16x32_bf16 v[96:99], a[160:163], a[0:3], v[108:111]
    ds_read_b64_tr_b16 a[184:185], v23 offset:36864
    v_mfma_f32_16x16x32_bf16 v[96:99], a[164:167], a[4:7], v[96:99]
    ds_read_b64_tr_b16 a[186:187], v23 offset:37376
    v_mfma_f32_16x16x32_bf16 v[100:103], a[164:167], a[12:15], v[108:111]
    buffer_load_dwordx4 a[44:47], v8, s[8:11], s24 offen offset:1024 sc1
    v_mfma_f32_16x16x32_bf16 v[100:103], a[160:163], a[8:11], v[100:103]
    v_mfma_f32_16x16x32_bf16 v[104:107], a[160:163], a[16:19], v[108:111]
    ds_read_b64_tr_b16 a[188:189], v23 offset:40960
    v_mfma_f32_16x16x32_bf16 v[104:107], a[164:167], a[20:23], v[104:107]
    ds_read_b64_tr_b16 a[190:191], v23 offset:41472
    v_mfma_f32_16x16x32_bf16 v[108:111], a[164:167], a[28:31], v[108:111]
    buffer_load_dwordx4 a[48:51], v8, s[8:11], s24 offen offset:2048 sc1
    v_mfma_f32_16x16x32_bf16 v[108:111], a[160:163], a[24:27], v[108:111]
    s_waitcnt lgkmcnt(8)
    v_mfma_f32_16x16x32_bf16 v[112:115], a[168:171], a[0:3], v[124:127]
    ds_read_b64_tr_b16 a[160:161], v20 offset:45056
    v_mfma_f32_16x16x32_bf16 v[112:115], a[172:175], a[4:7], v[112:115]
    ds_read_b64_tr_b16 a[162:163], v20 offset:45568
    v_mfma_f32_16x16x32_bf16 v[116:119], a[172:175], a[12:15], v[124:127]
    buffer_load_dwordx4 a[52:55], v8, s[8:11], s24 offen offset:3072 sc1
    v_mfma_f32_16x16x32_bf16 v[116:119], a[168:171], a[8:11], v[116:119]
    v_mfma_f32_16x16x32_bf16 v[120:123], a[168:171], a[16:19], v[124:127]
    ds_read_b64_tr_b16 a[164:165], v20 offset:49152
    v_mfma_f32_16x16x32_bf16 v[120:123], a[172:175], a[20:23], v[120:123]
    ds_read_b64_tr_b16 a[166:167], v20 offset:49664
    v_mfma_f32_16x16x32_bf16 v[124:127], a[172:175], a[28:31], v[124:127]
    buffer_load_dwordx4 a[56:59], v9, s[8:11], s24 offen offset:0 sc1
    v_mfma_f32_16x16x32_bf16 v[124:127], a[168:171], a[24:27], v[124:127]
    s_waitcnt lgkmcnt(8)
    v_mfma_f32_16x16x32_bf16 v[128:131], a[176:179], a[0:3], v[140:143]
    ds_read_b64_tr_b16 a[168:169], v21 offset:45056
    v_mfma_f32_16x16x32_bf16 v[128:131], a[180:183], a[4:7], v[128:131]
    ds_read_b64_tr_b16 a[170:171], v21 offset:45568
    v_mfma_f32_16x16x32_bf16 v[132:135], a[180:183], a[12:15], v[140:143]
    buffer_load_dwordx4 a[60:63], v9, s[8:11], s24 offen offset:1024 sc1
    v_mfma_f32_16x16x32_bf16 v[132:135], a[176:179], a[8:11], v[132:135]
    v_mfma_f32_16x16x32_bf16 v[136:139], a[176:179], a[16:19], v[140:143]
    ds_read_b64_tr_b16 a[172:173], v21 offset:49152
    v_mfma_f32_16x16x32_bf16 v[136:139], a[180:183], a[20:23], v[136:139]
    ds_read_b64_tr_b16 a[174:175], v21 offset:49664
    v_mfma_f32_16x16x32_bf16 v[140:143], a[180:183], a[28:31], v[140:143]
    buffer_load_dwordx4 a[64:67], v9, s[8:11], s24 offen offset:2048 sc1
    v_mfma_f32_16x16x32_bf16 v[140:143], a[176:179], a[24:27], v[140:143]
    s_waitcnt lgkmcnt(8)
    v_mfma_f32_16x16x32_bf16 v[144:147], a[184:187], a[0:3], v[156:159]
    ds_read_b64_tr_b16 a[176:177], v22 offset:45056
    v_mfma_f32_16x16x32_bf16 v[144:147], a[188:191], a[4:7], v[144:147]
    ds_read_b64_tr_b16 a[178:179], v22 offset:45568
    v_mfma_f32_16x16x32_bf16 v[148:151], a[188:191], a[12:15], v[156:159]
    buffer_load_dwordx4 a[68:71], v9, s[8:11], s24 offen offset:3072 sc1
    v_mfma_f32_16x16x32_bf16 v[148:151], a[184:187], a[8:11], v[148:151]
    v_mfma_f32_16x16x32_bf16 v[152:155], a[184:187], a[16:19], v[156:159]
    ds_read_b64_tr_b16 a[180:181], v22 offset:49152
    v_mfma_f32_16x16x32_bf16 v[152:155], a[188:191], a[20:23], v[152:155]
    ds_read_b64_tr_b16 a[182:183], v22 offset:49664
    s_mov_b32 s24, 524288
    v_mfma_f32_16x16x32_bf16 v[156:159], a[188:191], a[28:31], v[156:159]
    buffer_load_dwordx4 a[80:83], v8, s[8:11], s24 offen offset:0 sc1
    v_mfma_f32_16x16x32_bf16 v[156:159], a[184:187], a[24:27], v[156:159]
    s_waitcnt lgkmcnt(8)
    v_mfma_f32_16x16x32_bf16 v[160:163], a[160:163], a[0:3], v[172:175]
    ds_read_b64_tr_b16 a[184:185], v23 offset:45056
    v_mfma_f32_16x16x32_bf16 v[160:163], a[164:167], a[4:7], v[160:163]
    ds_read_b64_tr_b16 a[186:187], v23 offset:45568
    v_mfma_f32_16x16x32_bf16 v[164:167], a[164:167], a[12:15], v[172:175]
    buffer_load_dwordx4 a[84:87], v8, s[8:11], s24 offen offset:1024 sc1
    v_mfma_f32_16x16x32_bf16 v[164:167], a[160:163], a[8:11], v[164:167]
    v_mfma_f32_16x16x32_bf16 v[168:171], a[160:163], a[16:19], v[172:175]
    ds_read_b64_tr_b16 a[188:189], v23 offset:49152
    v_mfma_f32_16x16x32_bf16 v[168:171], a[164:167], a[20:23], v[168:171]
    ds_read_b64_tr_b16 a[190:191], v23 offset:49664
    v_mfma_f32_16x16x32_bf16 v[172:175], a[164:167], a[28:31], v[172:175]
    buffer_load_dwordx4 a[88:91], v8, s[8:11], s24 offen offset:2048 sc1
    v_mfma_f32_16x16x32_bf16 v[172:175], a[160:163], a[24:27], v[172:175]
    s_waitcnt lgkmcnt(8)
    v_mfma_f32_16x16x32_bf16 v[176:179], a[168:171], a[0:3], v[188:191]
    ds_read_b64_tr_b16 a[160:161], v26 offset:53248
    v_mfma_f32_16x16x32_bf16 v[176:179], a[172:175], a[4:7], v[176:179]
    ds_read_b64_tr_b16 a[162:163], v26 offset:53504
    v_mfma_f32_16x16x32_bf16 v[180:183], a[172:175], a[12:15], v[188:191]
    buffer_load_dwordx4 a[92:95], v8, s[8:11], s24 offen offset:3072 sc1
    v_mfma_f32_16x16x32_bf16 v[180:183], a[168:171], a[8:11], v[180:183]
    v_mfma_f32_16x16x32_bf16 v[184:187], a[168:171], a[16:19], v[188:191]
    ds_read_b64_tr_b16 a[164:165], v26 offset:55296
    v_mfma_f32_16x16x32_bf16 v[184:187], a[172:175], a[20:23], v[184:187]
    ds_read_b64_tr_b16 a[166:167], v26 offset:55552
    v_mfma_f32_16x16x32_bf16 v[188:191], a[172:175], a[28:31], v[188:191]
    buffer_load_dwordx4 a[96:99], v9, s[8:11], s24 offen offset:0 sc1
    v_mfma_f32_16x16x32_bf16 v[188:191], a[168:171], a[24:27], v[188:191]
    s_waitcnt lgkmcnt(8)
    v_mfma_f32_16x16x32_bf16 v[192:195], a[176:179], a[0:3], v[204:207]
    ds_read_b64_tr_b16 a[168:169], v27 offset:53248
    v_mfma_f32_16x16x32_bf16 v[192:195], a[180:183], a[4:7], v[192:195]
    ds_read_b64_tr_b16 a[170:171], v27 offset:53504
    v_mfma_f32_16x16x32_bf16 v[196:199], a[180:183], a[12:15], v[204:207]
    buffer_load_dwordx4 a[100:103], v9, s[8:11], s24 offen offset:1024 sc1
    v_mfma_f32_16x16x32_bf16 v[196:199], a[176:179], a[8:11], v[196:199]
    v_mfma_f32_16x16x32_bf16 v[200:203], a[176:179], a[16:19], v[204:207]
    ds_read_b64_tr_b16 a[172:173], v27 offset:55296
    v_mfma_f32_16x16x32_bf16 v[200:203], a[180:183], a[20:23], v[200:203]
    ds_read_b64_tr_b16 a[174:175], v27 offset:55552
    v_mfma_f32_16x16x32_bf16 v[204:207], a[180:183], a[28:31], v[204:207]
    buffer_load_dwordx4 a[104:107], v9, s[8:11], s24 offen offset:2048 sc1
    v_mfma_f32_16x16x32_bf16 v[204:207], a[176:179], a[24:27], v[204:207]
    s_waitcnt lgkmcnt(8)
    v_mfma_f32_16x16x32_bf16 v[208:211], a[184:187], a[0:3], v[220:223]
    s_waitcnt vmcnt(7)
    s_barrier
    ds_read_b64_tr_b16 a[176:177], v16 offset:0
    v_mfma_f32_16x16x32_bf16 v[208:211], a[188:191], a[4:7], v[208:211]
    ds_read_b64_tr_b16 a[178:179], v16 offset:512
    v_mfma_f32_16x16x32_bf16 v[212:215], a[188:191], a[12:15], v[220:223]
    buffer_load_dwordx4 a[108:111], v9, s[8:11], s24 offen offset:3072 sc1
    v_mfma_f32_16x16x32_bf16 v[212:215], a[184:187], a[8:11], v[212:215]
    v_mfma_f32_16x16x32_bf16 v[216:219], a[184:187], a[16:19], v[220:223]
    ds_read_b64_tr_b16 a[180:181], v16 offset:4096
    v_mfma_f32_16x16x32_bf16 v[216:219], a[188:191], a[20:23], v[216:219]
    ds_read_b64_tr_b16 a[182:183], v16 offset:4608
    s_add_u32 s25, s52, 917504
    s_add_u32 s26, s53, 917504
    s_add_u32 s27, s54, 917504
    s_add_u32 s28, s55, 917504
    s_add_u32 m0, s29, 28672
    v_mfma_f32_16x16x32_bf16 v[220:223], a[188:191], a[28:31], v[220:223]
    buffer_load_dwordx4 v13, s[12:15], s25 offen  lds
    v_mfma_f32_16x16x32_bf16 v[220:223], a[184:187], a[24:27], v[220:223]
    s_waitcnt lgkmcnt(8)
    v_mfma_f32_16x16x32_bf16 v[224:227], a[160:163], a[0:3], v[236:239]
    ds_read_b64_tr_b16 a[184:185], v17 offset:0
    s_add_u32 m0, s29, 29696
    v_mfma_f32_16x16x32_bf16 v[224:227], a[164:167], a[4:7], v[224:227]
    ds_read_b64_tr_b16 a[186:187], v17 offset:512
    buffer_load_dwordx4 v14, s[12:15], s25 offen  lds
    v_mfma_f32_16x16x32_bf16 v[228:231], a[164:167], a[12:15], v[236:239]
    s_add_u32 m0, s29, 36864
    v_mfma_f32_16x16x32_bf16 v[228:231], a[160:163], a[8:11], v[228:231]
    buffer_load_dwordx4 v13, s[12:15], s26 offen  lds
    v_mfma_f32_16x16x32_bf16 v[232:235], a[160:163], a[16:19], v[236:239]
    ds_read_b64_tr_b16 a[188:189], v17 offset:4096
    s_add_u32 m0, s29, 37888
    v_mfma_f32_16x16x32_bf16 v[232:235], a[164:167], a[20:23], v[232:235]
    ds_read_b64_tr_b16 a[190:191], v17 offset:4608
    buffer_load_dwordx4 v14, s[12:15], s26 offen  lds
    v_mfma_f32_16x16x32_bf16 v[236:239], a[164:167], a[28:31], v[236:239]
    s_add_u32 m0, s29, 45056
    v_mfma_f32_16x16x32_bf16 v[236:239], a[160:163], a[24:27], v[236:239]
    buffer_load_dwordx4 v13, s[12:15], s27 offen  lds
    s_waitcnt lgkmcnt(8)
    v_mfma_f32_16x16x32_bf16 v[240:243], a[168:171], a[0:3], v[252:255]
    ds_read_b64_tr_b16 a[160:161], v18 offset:0
    s_add_u32 m0, s29, 46080
    v_mfma_f32_16x16x32_bf16 v[240:243], a[172:175], a[4:7], v[240:243]
    ds_read_b64_tr_b16 a[162:163], v18 offset:512
    buffer_load_dwordx4 v14, s[12:15], s27 offen  lds
    v_mfma_f32_16x16x32_bf16 v[244:247], a[172:175], a[12:15], v[252:255]
    s_add_u32 m0, s30, 28672
    v_mfma_f32_16x16x32_bf16 v[244:247], a[168:171], a[8:11], v[244:247]
    buffer_load_dwordx4 v15, s[12:15], s28 offen  lds
    v_mfma_f32_16x16x32_bf16 v[248:251], a[168:171], a[16:19], v[252:255]
    ds_read_b64_tr_b16 a[164:165], v18 offset:4096
    s_add_u32 s33, s56, 1835008
    v_mfma_f32_16x16x32_bf16 v[248:251], a[172:175], a[20:23], v[248:251]
    ds_read_b64_tr_b16 a[166:167], v18 offset:4608
    buffer_load_dword a252, v11, s[12:15], s33 offen
    v_mfma_f32_16x16x32_bf16 v[252:255], a[172:175], a[28:31], v[252:255]
    s_add_u32 s33, s68, 1572864
    v_mfma_f32_16x16x32_bf16 v[252:255], a[168:171], a[24:27], v[252:255]
    buffer_load_dword a253, v5, s[60:63], s33 offen
    s_waitcnt lgkmcnt(8)
    v_mfma_f32_16x16x32_bf16 v[32:35], a[176:179], a[40:43], v[32:35]
    ds_read_b64_tr_b16 a[168:169], v19 offset:0
    v_mfma_f32_16x16x32_bf16 v[32:35], a[180:183], a[44:47], v[32:35]
    ds_read_b64_tr_b16 a[170:171], v19 offset:512
    s_mov_b32 s24, 786432
    v_mfma_f32_16x16x32_bf16 v[36:39], a[180:183], a[52:55], v[36:39]
    buffer_load_dwordx4 a[120:123], v8, s[8:11], s24 offen offset:0 sc1
    v_mfma_f32_16x16x32_bf16 v[36:39], a[176:179], a[48:51], v[36:39]
    v_mfma_f32_16x16x32_bf16 v[40:43], a[176:179], a[56:59], v[40:43]
    ds_read_b64_tr_b16 a[172:173], v19 offset:4096
    v_mfma_f32_16x16x32_bf16 v[40:43], a[180:183], a[60:63], v[40:43]
    ds_read_b64_tr_b16 a[174:175], v19 offset:4608
    v_mfma_f32_16x16x32_bf16 v[44:47], a[180:183], a[68:71], v[44:47]
    buffer_load_dwordx4 a[124:127], v8, s[8:11], s24 offen offset:1024 sc1
    v_mfma_f32_16x16x32_bf16 v[44:47], a[176:179], a[64:67], v[44:47]
    s_waitcnt lgkmcnt(8)
    v_mfma_f32_16x16x32_bf16 v[60:63], a[184:187], a[64:67], v[60:63]
    ds_read_b64_tr_b16 a[176:177], v16 offset:8192
    v_mfma_f32_16x16x32_bf16 v[60:63], a[188:191], a[68:71], v[60:63]
    ds_read_b64_tr_b16 a[178:179], v16 offset:8704
    v_mfma_f32_16x16x32_bf16 v[56:59], a[188:191], a[60:63], v[56:59]
    buffer_load_dwordx4 a[128:131], v8, s[8:11], s24 offen offset:2048 sc1
    v_mfma_f32_16x16x32_bf16 v[56:59], a[184:187], a[56:59], v[56:59]
    v_mfma_f32_16x16x32_bf16 v[52:55], a[184:187], a[48:51], v[52:55]
    ds_read_b64_tr_b16 a[180:181], v16 offset:12288
    v_mfma_f32_16x16x32_bf16 v[52:55], a[188:191], a[52:55], v[52:55]
    ds_read_b64_tr_b16 a[182:183], v16 offset:12800
    v_mfma_f32_16x16x32_bf16 v[48:51], a[188:191], a[44:47], v[48:51]
    buffer_load_dwordx4 a[132:135], v8, s[8:11], s24 offen offset:3072 sc1
    v_mfma_f32_16x16x32_bf16 v[48:51], a[184:187], a[40:43], v[48:51]
    s_waitcnt lgkmcnt(8)
    v_mfma_f32_16x16x32_bf16 v[64:67], a[160:163], a[40:43], v[64:67]
    ds_read_b64_tr_b16 a[184:185], v17 offset:8192
    v_mfma_f32_16x16x32_bf16 v[64:67], a[164:167], a[44:47], v[64:67]
    ds_read_b64_tr_b16 a[186:187], v17 offset:8704
    v_mfma_f32_16x16x32_bf16 v[68:71], a[164:167], a[52:55], v[68:71]
    buffer_load_dwordx4 a[136:139], v9, s[8:11], s24 offen offset:0 sc1
    v_mfma_f32_16x16x32_bf16 v[68:71], a[160:163], a[48:51], v[68:71]
    v_mfma_f32_16x16x32_bf16 v[72:75], a[160:163], a[56:59], v[72:75]
    ds_read_b64_tr_b16 a[188:189], v17 offset:12288
    v_mfma_f32_16x16x32_bf16 v[72:75], a[164:167], a[60:63], v[72:75]
    ds_read_b64_tr_b16 a[190:191], v17 offset:12800
    v_mfma_f32_16x16x32_bf16 v[76:79], a[164:167], a[68:71], v[76:79]
    buffer_load_dwordx4 a[140:143], v9, s[8:11], s24 offen offset:1024 sc1
    v_mfma_f32_16x16x32_bf16 v[76:79], a[160:163], a[64:67], v[76:79]
    s_waitcnt lgkmcnt(8)
    v_mfma_f32_16x16x32_bf16 v[92:95], a[168:171], a[64:67], v[92:95]
    ds_read_b64_tr_b16 a[160:161], v18 offset:8192
    v_mfma_f32_16x16x32_bf16 v[92:95], a[172:175], a[68:71], v[92:95]
    ds_read_b64_tr_b16 a[162:163], v18 offset:8704
    v_mfma_f32_16x16x32_bf16 v[88:91], a[172:175], a[60:63], v[88:91]
    buffer_load_dwordx4 a[144:147], v9, s[8:11], s24 offen offset:2048 sc1
    v_mfma_f32_16x16x32_bf16 v[88:91], a[168:171], a[56:59], v[88:91]
    v_mfma_f32_16x16x32_bf16 v[84:87], a[168:171], a[48:51], v[84:87]
    ds_read_b64_tr_b16 a[164:165], v18 offset:12288
    v_mfma_f32_16x16x32_bf16 v[84:87], a[172:175], a[52:55], v[84:87]
    ds_read_b64_tr_b16 a[166:167], v18 offset:12800
    v_mfma_f32_16x16x32_bf16 v[80:83], a[172:175], a[44:47], v[80:83]
    buffer_load_dwordx4 a[148:151], v9, s[8:11], s24 offen offset:3072 sc1
    v_mfma_f32_16x16x32_bf16 v[80:83], a[168:171], a[40:43], v[80:83]
    s_waitcnt lgkmcnt(8)
    v_mfma_f32_16x16x32_bf16 v[96:99], a[176:179], a[40:43], v[96:99]
    ds_read_b64_tr_b16 a[168:169], v19 offset:8192
    v_mfma_f32_16x16x32_bf16 v[96:99], a[180:183], a[44:47], v[96:99]
    ds_read_b64_tr_b16 a[170:171], v19 offset:8704
    s_add_u32 s25, s52, 1376256
    s_add_u32 s26, s53, 1376256
    s_add_u32 s27, s54, 1376256
    s_add_u32 s28, s55, 1376256
    s_add_u32 m0, s29, 114688
    v_mfma_f32_16x16x32_bf16 v[100:103], a[180:183], a[52:55], v[100:103]
    buffer_load_dwordx4 v13, s[12:15], s25 offen  lds
    v_mfma_f32_16x16x32_bf16 v[100:103], a[176:179], a[48:51], v[100:103]
    v_mfma_f32_16x16x32_bf16 v[104:107], a[176:179], a[56:59], v[104:107]
    ds_read_b64_tr_b16 a[172:173], v19 offset:12288
    v_mfma_f32_16x16x32_bf16 v[104:107], a[180:183], a[60:63], v[104:107]
    ds_read_b64_tr_b16 a[174:175], v19 offset:12800
    s_add_u32 m0, s29, 115712
    v_mfma_f32_16x16x32_bf16 v[108:111], a[180:183], a[68:71], v[108:111]
    buffer_load_dwordx4 v14, s[12:15], s25 offen  lds
    v_mfma_f32_16x16x32_bf16 v[108:111], a[176:179], a[64:67], v[108:111]
    s_waitcnt lgkmcnt(8)
    v_mfma_f32_16x16x32_bf16 v[124:127], a[184:187], a[64:67], v[124:127]
    ds_read_b64_tr_b16 a[176:177], v16 offset:16384
    v_mfma_f32_16x16x32_bf16 v[124:127], a[188:191], a[68:71], v[124:127]
    ds_read_b64_tr_b16 a[178:179], v16 offset:16896
    s_add_u32 m0, s29, 122880
    v_mfma_f32_16x16x32_bf16 v[120:123], a[188:191], a[60:63], v[120:123]
    buffer_load_dwordx4 v13, s[12:15], s26 offen  lds
    v_mfma_f32_16x16x32_bf16 v[120:123], a[184:187], a[56:59], v[120:123]
    v_mfma_f32_16x16x32_bf16 v[116:119], a[184:187], a[48:51], v[116:119]
    ds_read_b64_tr_b16 a[180:181], v16 offset:20480
    v_mfma_f32_16x16x32_bf16 v[116:119], a[188:191], a[52:55], v[116:119]
    ds_read_b64_tr_b16 a[182:183], v16 offset:20992
    s_add_u32 m0, s29, 123904
    v_mfma_f32_16x16x32_bf16 v[112:115], a[188:191], a[44:47], v[112:115]
    buffer_load_dwordx4 v14, s[12:15], s26 offen  lds
    v_mfma_f32_16x16x32_bf16 v[112:115], a[184:187], a[40:43], v[112:115]
    s_waitcnt lgkmcnt(8)
    v_mfma_f32_16x16x32_bf16 v[128:131], a[160:163], a[40:43], v[128:131]
    ds_read_b64_tr_b16 a[184:185], v17 offset:16384
    v_mfma_f32_16x16x32_bf16 v[128:131], a[164:167], a[44:47], v[128:131]
    ds_read_b64_tr_b16 a[186:187], v17 offset:16896
    s_add_u32 m0, s29, 131072
    v_mfma_f32_16x16x32_bf16 v[132:135], a[164:167], a[52:55], v[132:135]
    buffer_load_dwordx4 v13, s[12:15], s27 offen  lds
    v_mfma_f32_16x16x32_bf16 v[132:135], a[160:163], a[48:51], v[132:135]
    v_mfma_f32_16x16x32_bf16 v[136:139], a[160:163], a[56:59], v[136:139]
    ds_read_b64_tr_b16 a[188:189], v17 offset:20480
    v_mfma_f32_16x16x32_bf16 v[136:139], a[164:167], a[60:63], v[136:139]
    ds_read_b64_tr_b16 a[190:191], v17 offset:20992
    s_add_u32 m0, s29, 132096
    v_mfma_f32_16x16x32_bf16 v[140:143], a[164:167], a[68:71], v[140:143]
    buffer_load_dwordx4 v14, s[12:15], s27 offen  lds
    v_mfma_f32_16x16x32_bf16 v[140:143], a[160:163], a[64:67], v[140:143]
    s_waitcnt lgkmcnt(8)
    v_mfma_f32_16x16x32_bf16 v[156:159], a[168:171], a[64:67], v[156:159]
    ds_read_b64_tr_b16 a[160:161], v18 offset:16384
    v_mfma_f32_16x16x32_bf16 v[156:159], a[172:175], a[68:71], v[156:159]
    ds_read_b64_tr_b16 a[162:163], v18 offset:16896
    s_add_u32 m0, s30, 114688
    v_mfma_f32_16x16x32_bf16 v[152:155], a[172:175], a[60:63], v[152:155]
    buffer_load_dwordx4 v15, s[12:15], s28 offen  lds
    v_mfma_f32_16x16x32_bf16 v[152:155], a[168:171], a[56:59], v[152:155]
    v_mfma_f32_16x16x32_bf16 v[148:151], a[168:171], a[48:51], v[148:151]
    ds_read_b64_tr_b16 a[164:165], v18 offset:20480
    v_mfma_f32_16x16x32_bf16 v[148:151], a[172:175], a[52:55], v[148:151]
    ds_read_b64_tr_b16 a[166:167], v18 offset:20992
    s_add_u32 s33, s56, 2293760
    v_mfma_f32_16x16x32_bf16 v[144:147], a[172:175], a[44:47], v[144:147]
    buffer_load_dword a252, v11, s[12:15], s33 offen
    v_mfma_f32_16x16x32_bf16 v[144:147], a[168:171], a[40:43], v[144:147]
    s_waitcnt lgkmcnt(8)
    v_mfma_f32_16x16x32_bf16 v[160:163], a[176:179], a[40:43], v[160:163]
    ds_read_b64_tr_b16 a[168:169], v19 offset:16384
    v_mfma_f32_16x16x32_bf16 v[160:163], a[180:183], a[44:47], v[160:163]
    ds_read_b64_tr_b16 a[170:171], v19 offset:16896
    s_add_u32 s33, s68, 0
    v_mfma_f32_16x16x32_bf16 v[164:167], a[180:183], a[52:55], v[164:167]
    buffer_load_dword a253, v5, s[64:67], s33 offen
    v_mfma_f32_16x16x32_bf16 v[164:167], a[176:179], a[48:51], v[164:167]
    v_mfma_f32_16x16x32_bf16 v[168:171], a[176:179], a[56:59], v[168:171]
    ds_read_b64_tr_b16 a[172:173], v19 offset:20480
    v_mfma_f32_16x16x32_bf16 v[168:171], a[180:183], a[60:63], v[168:171]
    ds_read_b64_tr_b16 a[174:175], v19 offset:20992
    s_add_u32 s33, s68, 1048576
    v_mfma_f32_16x16x32_bf16 v[172:175], a[180:183], a[68:71], v[172:175]
    buffer_load_dword a253, v5, s[60:63], s33 offen
    v_mfma_f32_16x16x32_bf16 v[172:175], a[176:179], a[64:67], v[172:175]
    s_waitcnt lgkmcnt(8)
    v_mfma_f32_16x16x32_bf16 v[188:191], a[184:187], a[64:67], v[188:191]
    ds_read_b64_tr_b16 a[176:177], v24 offset:24576
    v_mfma_f32_16x16x32_bf16 v[188:191], a[188:191], a[68:71], v[188:191]
    ds_read_b64_tr_b16 a[178:179], v24 offset:24832
    v_mfma_f32_16x16x32_bf16 v[184:187], a[188:191], a[60:63], v[184:187]
    v_mfma_f32_16x16x32_bf16 v[184:187], a[184:187], a[56:59], v[184:187]
    v_mfma_f32_16x16x32_bf16 v[180:183], a[184:187], a[48:51], v[180:183]
    ds_read_b64_tr_b16 a[180:181], v24 offset:26624
    v_mfma_f32_16x16x32_bf16 v[180:183], a[188:191], a[52:55], v[180:183]
    ds_read_b64_tr_b16 a[182:183], v24 offset:26880
    v_mfma_f32_16x16x32_bf16 v[176:179], a[188:191], a[44:47], v[176:179]
    v_mfma_f32_16x16x32_bf16 v[176:179], a[184:187], a[40:43], v[176:179]
    s_waitcnt lgkmcnt(8)
    v_mfma_f32_16x16x32_bf16 v[192:195], a[160:163], a[40:43], v[192:195]
    ds_read_b64_tr_b16 a[184:185], v25 offset:24576
    v_mfma_f32_16x16x32_bf16 v[192:195], a[164:167], a[44:47], v[192:195]
    ds_read_b64_tr_b16 a[186:187], v25 offset:24832
    v_mfma_f32_16x16x32_bf16 v[196:199], a[164:167], a[52:55], v[196:199]
    v_mfma_f32_16x16x32_bf16 v[196:199], a[160:163], a[48:51], v[196:199]
    v_mfma_f32_16x16x32_bf16 v[200:203], a[160:163], a[56:59], v[200:203]
    ds_read_b64_tr_b16 a[188:189], v25 offset:26624
    v_mfma_f32_16x16x32_bf16 v[200:203], a[164:167], a[60:63], v[200:203]
    ds_read_b64_tr_b16 a[190:191], v25 offset:26880
    v_mfma_f32_16x16x32_bf16 v[204:207], a[164:167], a[68:71], v[204:207]
    v_mfma_f32_16x16x32_bf16 v[204:207], a[160:163], a[64:67], v[204:207]
    s_waitcnt lgkmcnt(8)
    v_mfma_f32_16x16x32_bf16 v[220:223], a[168:171], a[64:67], v[220:223]
    s_waitcnt vmcnt(20)
    s_barrier
    ds_read_b64_tr_b16 a[160:161], v16 offset:28672
    v_mfma_f32_16x16x32_bf16 v[220:223], a[172:175], a[68:71], v[220:223]
    ds_read_b64_tr_b16 a[162:163], v16 offset:29184
    v_mfma_f32_16x16x32_bf16 v[216:219], a[172:175], a[60:63], v[216:219]
    v_mfma_f32_16x16x32_bf16 v[216:219], a[168:171], a[56:59], v[216:219]
    v_mfma_f32_16x16x32_bf16 v[212:215], a[168:171], a[48:51], v[212:215]
    ds_read_b64_tr_b16 a[164:165], v16 offset:32768
    v_mfma_f32_16x16x32_bf16 v[212:215], a[172:175], a[52:55], v[212:215]
    ds_read_b64_tr_b16 a[166:167], v16 offset:33280
    v_mfma_f32_16x16x32_bf16 v[208:211], a[172:175], a[44:47], v[208:211]
    v_mfma_f32_16x16x32_bf16 v[208:211], a[168:171], a[40:43], v[208:211]
    s_waitcnt lgkmcnt(8)
    v_mfma_f32_16x16x32_bf16 v[224:227], a[176:179], a[40:43], v[224:227]
    ds_read_b64_tr_b16 a[168:169], v17 offset:28672
    v_mfma_f32_16x16x32_bf16 v[224:227], a[180:183], a[44:47], v[224:227]
    ds_read_b64_tr_b16 a[170:171], v17 offset:29184
    v_mfma_f32_16x16x32_bf16 v[228:231], a[180:183], a[52:55], v[228:231]
    v_mfma_f32_16x16x32_bf16 v[228:231], a[176:179], a[48:51], v[228:231]
    v_mfma_f32_16x16x32_bf16 v[232:235], a[176:179], a[56:59], v[232:235]
    ds_read_b64_tr_b16 a[172:173], v17 offset:32768
    v_mfma_f32_16x16x32_bf16 v[232:235], a[180:183], a[60:63], v[232:235]
    ds_read_b64_tr_b16 a[174:175], v17 offset:33280
    v_mfma_f32_16x16x32_bf16 v[236:239], a[180:183], a[68:71], v[236:239]
    v_mfma_f32_16x16x32_bf16 v[236:239], a[176:179], a[64:67], v[236:239]
    s_waitcnt lgkmcnt(8)
    v_mfma_f32_16x16x32_bf16 v[252:255], a[184:187], a[64:67], v[252:255]
    ds_read_b64_tr_b16 a[176:177], v18 offset:28672
    v_mfma_f32_16x16x32_bf16 v[252:255], a[188:191], a[68:71], v[252:255]
    ds_read_b64_tr_b16 a[178:179], v18 offset:29184
    v_mfma_f32_16x16x32_bf16 v[248:251], a[188:191], a[60:63], v[248:251]
    v_mfma_f32_16x16x32_bf16 v[248:251], a[184:187], a[56:59], v[248:251]
    v_mfma_f32_16x16x32_bf16 v[244:247], a[184:187], a[48:51], v[244:247]
    ds_read_b64_tr_b16 a[180:181], v18 offset:32768
    v_mfma_f32_16x16x32_bf16 v[244:247], a[188:191], a[52:55], v[244:247]
    ds_read_b64_tr_b16 a[182:183], v18 offset:33280
    v_mfma_f32_16x16x32_bf16 v[240:243], a[188:191], a[44:47], v[240:243]
    v_mfma_f32_16x16x32_bf16 v[240:243], a[184:187], a[40:43], v[240:243]
    s_waitcnt lgkmcnt(8)
    v_mfma_f32_16x16x32_bf16 v[32:35], a[160:163], a[80:83], v[32:35]
    ds_read_b64_tr_b16 a[184:185], v19 offset:28672
    v_mfma_f32_16x16x32_bf16 v[32:35], a[164:167], a[84:87], v[32:35]
    ds_read_b64_tr_b16 a[186:187], v19 offset:29184
    s_mov_b32 s24, 1048576
    v_mfma_f32_16x16x32_bf16 v[36:39], a[164:167], a[92:95], v[36:39]
    buffer_load_dwordx4 a[0:3], v8, s[8:11], s24 offen offset:0 sc1
    v_mfma_f32_16x16x32_bf16 v[36:39], a[160:163], a[88:91], v[36:39]
    v_mfma_f32_16x16x32_bf16 v[40:43], a[160:163], a[96:99], v[40:43]
    ds_read_b64_tr_b16 a[188:189], v19 offset:32768
    v_mfma_f32_16x16x32_bf16 v[40:43], a[164:167], a[100:103], v[40:43]
    ds_read_b64_tr_b16 a[190:191], v19 offset:33280
    v_mfma_f32_16x16x32_bf16 v[44:47], a[164:167], a[108:111], v[44:47]
    buffer_load_dwordx4 a[4:7], v8, s[8:11], s24 offen offset:1024 sc1
    v_mfma_f32_16x16x32_bf16 v[44:47], a[160:163], a[104:107], v[44:47]
    s_waitcnt lgkmcnt(8)
    v_mfma_f32_16x16x32_bf16 v[60:63], a[168:171], a[104:107], v[60:63]
    ds_read_b64_tr_b16 a[160:161], v16 offset:36864
    v_mfma_f32_16x16x32_bf16 v[60:63], a[172:175], a[108:111], v[60:63]
    ds_read_b64_tr_b16 a[162:163], v16 offset:37376
    v_mfma_f32_16x16x32_bf16 v[56:59], a[172:175], a[100:103], v[56:59]
    buffer_load_dwordx4 a[8:11], v8, s[8:11], s24 offen offset:2048 sc1
    v_mfma_f32_16x16x32_bf16 v[56:59], a[168:171], a[96:99], v[56:59]
    v_mfma_f32_16x16x32_bf16 v[52:55], a[168:171], a[88:91], v[52:55]
    ds_read_b64_tr_b16 a[164:165], v16 offset:40960
    v_mfma_f32_16x16x32_bf16 v[52:55], a[172:175], a[92:95], v[52:55]
    ds_read_b64_tr_b16 a[166:167], v16 offset:41472
    v_mfma_f32_16x16x32_bf16 v[48:51], a[172:175], a[84:87], v[48:51]
    buffer_load_dwordx4 a[12:15], v8, s[8:11], s24 offen offset:3072 sc1
    v_mfma_f32_16x16x32_bf16 v[48:51], a[168:171], a[80:83], v[48:51]
    s_waitcnt lgkmcnt(8)
    v_mfma_f32_16x16x32_bf16 v[64:67], a[176:179], a[80:83], v[64:67]
    ds_read_b64_tr_b16 a[168:169], v17 offset:36864
    v_mfma_f32_16x16x32_bf16 v[64:67], a[180:183], a[84:87], v[64:67]
    ds_read_b64_tr_b16 a[170:171], v17 offset:37376
    v_mfma_f32_16x16x32_bf16 v[68:71], a[180:183], a[92:95], v[68:71]
    buffer_load_dwordx4 a[16:19], v9, s[8:11], s24 offen offset:0 sc1
    v_mfma_f32_16x16x32_bf16 v[68:71], a[176:179], a[88:91], v[68:71]
    v_mfma_f32_16x16x32_bf16 v[72:75], a[176:179], a[96:99], v[72:75]
    ds_read_b64_tr_b16 a[172:173], v17 offset:40960
    v_mfma_f32_16x16x32_bf16 v[72:75], a[180:183], a[100:103], v[72:75]
    ds_read_b64_tr_b16 a[174:175], v17 offset:41472
    v_mfma_f32_16x16x32_bf16 v[76:79], a[180:183], a[108:111], v[76:79]
    buffer_load_dwordx4 a[20:23], v9, s[8:11], s24 offen offset:1024 sc1
    v_mfma_f32_16x16x32_bf16 v[76:79], a[176:179], a[104:107], v[76:79]
    s_waitcnt lgkmcnt(8)
    v_mfma_f32_16x16x32_bf16 v[92:95], a[184:187], a[104:107], v[92:95]
    ds_read_b64_tr_b16 a[176:177], v18 offset:36864
    v_mfma_f32_16x16x32_bf16 v[92:95], a[188:191], a[108:111], v[92:95]
    ds_read_b64_tr_b16 a[178:179], v18 offset:37376
    v_mfma_f32_16x16x32_bf16 v[88:91], a[188:191], a[100:103], v[88:91]
    buffer_load_dwordx4 a[24:27], v9, s[8:11], s24 offen offset:2048 sc1
    v_mfma_f32_16x16x32_bf16 v[88:91], a[184:187], a[96:99], v[88:91]
    v_mfma_f32_16x16x32_bf16 v[84:87], a[184:187], a[88:91], v[84:87]
    ds_read_b64_tr_b16 a[180:181], v18 offset:40960
    v_mfma_f32_16x16x32_bf16 v[84:87], a[188:191], a[92:95], v[84:87]
    ds_read_b64_tr_b16 a[182:183], v18 offset:41472
    v_mfma_f32_16x16x32_bf16 v[80:83], a[188:191], a[84:87], v[80:83]
    buffer_load_dwordx4 a[28:31], v9, s[8:11], s24 offen offset:3072 sc1
    v_mfma_f32_16x16x32_bf16 v[80:83], a[184:187], a[80:83], v[80:83]
    s_waitcnt lgkmcnt(8)
    v_mfma_f32_16x16x32_bf16 v[96:99], a[160:163], a[80:83], v[96:99]
    ds_read_b64_tr_b16 a[184:185], v19 offset:36864
    v_mfma_f32_16x16x32_bf16 v[96:99], a[164:167], a[84:87], v[96:99]
    ds_read_b64_tr_b16 a[186:187], v19 offset:37376
    s_add_u32 s25, s52, 1835008
    s_add_u32 s26, s53, 1835008
    s_add_u32 s27, s54, 1835008
    s_add_u32 s28, s55, 1835008
    s_add_u32 m0, s29, 86016
    v_mfma_f32_16x16x32_bf16 v[100:103], a[164:167], a[92:95], v[100:103]
    buffer_load_dwordx4 v13, s[12:15], s25 offen  lds
    v_mfma_f32_16x16x32_bf16 v[100:103], a[160:163], a[88:91], v[100:103]
    v_mfma_f32_16x16x32_bf16 v[104:107], a[160:163], a[96:99], v[104:107]
    ds_read_b64_tr_b16 a[188:189], v19 offset:40960
    v_mfma_f32_16x16x32_bf16 v[104:107], a[164:167], a[100:103], v[104:107]
    ds_read_b64_tr_b16 a[190:191], v19 offset:41472
    s_add_u32 m0, s29, 87040
    v_mfma_f32_16x16x32_bf16 v[108:111], a[164:167], a[108:111], v[108:111]
    buffer_load_dwordx4 v14, s[12:15], s25 offen  lds
    v_mfma_f32_16x16x32_bf16 v[108:111], a[160:163], a[104:107], v[108:111]
    s_waitcnt lgkmcnt(8)
    v_mfma_f32_16x16x32_bf16 v[124:127], a[168:171], a[104:107], v[124:127]
    ds_read_b64_tr_b16 a[160:161], v16 offset:45056
    v_mfma_f32_16x16x32_bf16 v[124:127], a[172:175], a[108:111], v[124:127]
    ds_read_b64_tr_b16 a[162:163], v16 offset:45568
    s_add_u32 m0, s29, 94208
    v_mfma_f32_16x16x32_bf16 v[120:123], a[172:175], a[100:103], v[120:123]
    buffer_load_dwordx4 v13, s[12:15], s26 offen  lds
    v_mfma_f32_16x16x32_bf16 v[120:123], a[168:171], a[96:99], v[120:123]
    v_mfma_f32_16x16x32_bf16 v[116:119], a[168:171], a[88:91], v[116:119]
    ds_read_b64_tr_b16 a[164:165], v16 offset:49152
    v_mfma_f32_16x16x32_bf16 v[116:119], a[172:175], a[92:95], v[116:119]
    ds_read_b64_tr_b16 a[166:167], v16 offset:49664
    s_add_u32 m0, s29, 95232
    v_mfma_f32_16x16x32_bf16 v[112:115], a[172:175], a[84:87], v[112:115]
    buffer_load_dwordx4 v14, s[12:15], s26 offen  lds
    v_mfma_f32_16x16x32_bf16 v[112:115], a[168:171], a[80:83], v[112:115]
    s_waitcnt lgkmcnt(8)
    v_mfma_f32_16x16x32_bf16 v[128:131], a[176:179], a[80:83], v[128:131]
    ds_read_b64_tr_b16 a[168:169], v17 offset:45056
    v_mfma_f32_16x16x32_bf16 v[128:131], a[180:183], a[84:87], v[128:131]
    ds_read_b64_tr_b16 a[170:171], v17 offset:45568
    s_add_u32 m0, s29, 102400
    v_mfma_f32_16x16x32_bf16 v[132:135], a[180:183], a[92:95], v[132:135]
    buffer_load_dwordx4 v13, s[12:15], s27 offen  lds
    v_mfma_f32_16x16x32_bf16 v[132:135], a[176:179], a[88:91], v[132:135]
    v_mfma_f32_16x16x32_bf16 v[136:139], a[176:179], a[96:99], v[136:139]
    ds_read_b64_tr_b16 a[172:173], v17 offset:49152
    v_mfma_f32_16x16x32_bf16 v[136:139], a[180:183], a[100:103], v[136:139]
    ds_read_b64_tr_b16 a[174:175], v17 offset:49664
    s_add_u32 m0, s29, 103424
    v_mfma_f32_16x16x32_bf16 v[140:143], a[180:183], a[108:111], v[140:143]
    buffer_load_dwordx4 v14, s[12:15], s27 offen  lds
    v_mfma_f32_16x16x32_bf16 v[140:143], a[176:179], a[104:107], v[140:143]
    s_waitcnt lgkmcnt(8)
    v_mfma_f32_16x16x32_bf16 v[156:159], a[184:187], a[104:107], v[156:159]
    ds_read_b64_tr_b16 a[176:177], v18 offset:45056
    v_mfma_f32_16x16x32_bf16 v[156:159], a[188:191], a[108:111], v[156:159]
    ds_read_b64_tr_b16 a[178:179], v18 offset:45568
    s_add_u32 m0, s30, 86016
    v_mfma_f32_16x16x32_bf16 v[152:155], a[188:191], a[100:103], v[152:155]
    buffer_load_dwordx4 v15, s[12:15], s28 offen  lds
    v_mfma_f32_16x16x32_bf16 v[152:155], a[184:187], a[96:99], v[152:155]
    v_mfma_f32_16x16x32_bf16 v[148:151], a[184:187], a[88:91], v[148:151]
    ds_read_b64_tr_b16 a[180:181], v18 offset:49152
    v_mfma_f32_16x16x32_bf16 v[148:151], a[188:191], a[92:95], v[148:151]
    ds_read_b64_tr_b16 a[182:183], v18 offset:49664
    s_add_u32 s33, s56, 2752512
    v_mfma_f32_16x16x32_bf16 v[144:147], a[188:191], a[84:87], v[144:147]
    buffer_load_dword a252, v11, s[12:15], s33 offen
    v_mfma_f32_16x16x32_bf16 v[144:147], a[184:187], a[80:83], v[144:147]
    s_waitcnt lgkmcnt(8)
    v_mfma_f32_16x16x32_bf16 v[160:163], a[160:163], a[80:83], v[160:163]
    ds_read_b64_tr_b16 a[184:185], v19 offset:45056
    v_mfma_f32_16x16x32_bf16 v[160:163], a[164:167], a[84:87], v[160:163]
    ds_read_b64_tr_b16 a[186:187], v19 offset:45568
    s_add_u32 s33, s68, 524288
    v_mfma_f32_16x16x32_bf16 v[164:167], a[164:167], a[92:95], v[164:167]
    buffer_load_dword a253, v5, s[64:67], s33 offen
    v_mfma_f32_16x16x32_bf16 v[164:167], a[160:163], a[88:91], v[164:167]
    v_mfma_f32_16x16x32_bf16 v[168:171], a[160:163], a[96:99], v[168:171]
    ds_read_b64_tr_b16 a[188:189], v19 offset:49152
    v_mfma_f32_16x16x32_bf16 v[168:171], a[164:167], a[100:103], v[168:171]
    ds_read_b64_tr_b16 a[190:191], v19 offset:49664
    s_add_u32 s33, s68, 1048576
    v_mfma_f32_16x16x32_bf16 v[172:175], a[164:167], a[108:111], v[172:175]
    buffer_load_dword a253, v5, s[64:67], s33 offen
    v_mfma_f32_16x16x32_bf16 v[172:175], a[160:163], a[104:107], v[172:175]
    s_waitcnt lgkmcnt(8)
    v_mfma_f32_16x16x32_bf16 v[188:191], a[168:171], a[104:107], v[188:191]
    ds_read_b64_tr_b16 a[160:161], v24 offset:53248
    v_mfma_f32_16x16x32_bf16 v[188:191], a[172:175], a[108:111], v[188:191]
    ds_read_b64_tr_b16 a[162:163], v24 offset:53504
    v_mfma_f32_16x16x32_bf16 v[184:187], a[172:175], a[100:103], v[184:187]
    v_mfma_f32_16x16x32_bf16 v[184:187], a[168:171], a[96:99], v[184:187]
    v_mfma_f32_16x16x32_bf16 v[180:183], a[168:171], a[88:91], v[180:183]
    ds_read_b64_tr_b16 a[164:165], v24 offset:55296
    v_mfma_f32_16x16x32_bf16 v[180:183], a[172:175], a[92:95], v[180:183]
    ds_read_b64_tr_b16 a[166:167], v24 offset:55552
    v_mfma_f32_16x16x32_bf16 v[176:179], a[172:175], a[84:87], v[176:179]
    v_mfma_f32_16x16x32_bf16 v[176:179], a[168:171], a[80:83], v[176:179]
    s_waitcnt lgkmcnt(8)
    v_mfma_f32_16x16x32_bf16 v[192:195], a[176:179], a[80:83], v[192:195]
    ds_read_b64_tr_b16 a[168:169], v25 offset:53248
    v_mfma_f32_16x16x32_bf16 v[192:195], a[180:183], a[84:87], v[192:195]
    ds_read_b64_tr_b16 a[170:171], v25 offset:53504
    v_mfma_f32_16x16x32_bf16 v[196:199], a[180:183], a[92:95], v[196:199]
    v_mfma_f32_16x16x32_bf16 v[196:199], a[176:179], a[88:91], v[196:199]
    v_mfma_f32_16x16x32_bf16 v[200:203], a[176:179], a[96:99], v[200:203]
    ds_read_b64_tr_b16 a[172:173], v25 offset:55296
    v_mfma_f32_16x16x32_bf16 v[200:203], a[180:183], a[100:103], v[200:203]
    ds_read_b64_tr_b16 a[174:175], v25 offset:55552
    v_mfma_f32_16x16x32_bf16 v[204:207], a[180:183], a[108:111], v[204:207]
    v_mfma_f32_16x16x32_bf16 v[204:207], a[176:179], a[104:107], v[204:207]
    s_waitcnt lgkmcnt(8)
    v_mfma_f32_16x16x32_bf16 v[220:223], a[184:187], a[104:107], v[220:223]
    s_waitcnt vmcnt(21)
    s_barrier
    ds_read_b64_tr_b16 a[176:177], v2 offset:0
    v_mfma_f32_16x16x32_bf16 v[220:223], a[188:191], a[108:111], v[220:223]
    ds_read_b64_tr_b16 a[178:179], v2 offset:512
    v_mfma_f32_16x16x32_bf16 v[216:219], a[188:191], a[100:103], v[216:219]
    v_mfma_f32_16x16x32_bf16 v[216:219], a[184:187], a[96:99], v[216:219]
    v_mfma_f32_16x16x32_bf16 v[212:215], a[184:187], a[88:91], v[212:215]
    ds_read_b64_tr_b16 a[180:181], v2 offset:4096
    v_mfma_f32_16x16x32_bf16 v[212:215], a[188:191], a[92:95], v[212:215]
    ds_read_b64_tr_b16 a[182:183], v2 offset:4608
    v_mfma_f32_16x16x32_bf16 v[208:211], a[188:191], a[84:87], v[208:211]
    v_mfma_f32_16x16x32_bf16 v[208:211], a[184:187], a[80:83], v[208:211]
    s_waitcnt lgkmcnt(8)
    v_mfma_f32_16x16x32_bf16 v[224:227], a[160:163], a[80:83], v[224:227]
    ds_read_b64_tr_b16 a[184:185], v3 offset:0
    v_mfma_f32_16x16x32_bf16 v[224:227], a[164:167], a[84:87], v[224:227]
    ds_read_b64_tr_b16 a[186:187], v3 offset:512
    v_mfma_f32_16x16x32_bf16 v[228:231], a[164:167], a[92:95], v[228:231]
    v_mfma_f32_16x16x32_bf16 v[228:231], a[160:163], a[88:91], v[228:231]
    v_mfma_f32_16x16x32_bf16 v[232:235], a[160:163], a[96:99], v[232:235]
    ds_read_b64_tr_b16 a[188:189], v3 offset:4096
    v_mfma_f32_16x16x32_bf16 v[232:235], a[164:167], a[100:103], v[232:235]
    ds_read_b64_tr_b16 a[190:191], v3 offset:4608
    v_mfma_f32_16x16x32_bf16 v[236:239], a[164:167], a[108:111], v[236:239]
    v_mfma_f32_16x16x32_bf16 v[236:239], a[160:163], a[104:107], v[236:239]
    s_waitcnt lgkmcnt(8)
    v_mfma_f32_16x16x32_bf16 v[252:255], a[168:171], a[104:107], v[252:255]
    ds_read_b64_tr_b16 a[160:161], v4 offset:0
    v_mfma_f32_16x16x32_bf16 v[252:255], a[172:175], a[108:111], v[252:255]
    ds_read_b64_tr_b16 a[162:163], v4 offset:512
    v_mfma_f32_16x16x32_bf16 v[248:251], a[172:175], a[100:103], v[248:251]
    v_mfma_f32_16x16x32_bf16 v[248:251], a[168:171], a[96:99], v[248:251]
    v_mfma_f32_16x16x32_bf16 v[244:247], a[168:171], a[88:91], v[244:247]
    ds_read_b64_tr_b16 a[164:165], v4 offset:4096
    v_mfma_f32_16x16x32_bf16 v[244:247], a[172:175], a[92:95], v[244:247]
    ds_read_b64_tr_b16 a[166:167], v4 offset:4608
    v_mfma_f32_16x16x32_bf16 v[240:243], a[172:175], a[84:87], v[240:243]
    v_mfma_f32_16x16x32_bf16 v[240:243], a[168:171], a[80:83], v[240:243]
    s_waitcnt lgkmcnt(8)
    v_mfma_f32_16x16x32_bf16 v[32:35], a[176:179], a[120:123], v[32:35]
    ds_read_b64_tr_b16 a[168:169], v10 offset:0
    v_mfma_f32_16x16x32_bf16 v[32:35], a[180:183], a[124:127], v[32:35]
    ds_read_b64_tr_b16 a[170:171], v10 offset:512
    s_mov_b32 s24, 1310720
    v_mfma_f32_16x16x32_bf16 v[36:39], a[180:183], a[132:135], v[36:39]
    buffer_load_dwordx4 a[40:43], v8, s[8:11], s24 offen offset:0 sc1
    v_mfma_f32_16x16x32_bf16 v[36:39], a[176:179], a[128:131], v[36:39]
    v_mfma_f32_16x16x32_bf16 v[40:43], a[176:179], a[136:139], v[40:43]
    ds_read_b64_tr_b16 a[172:173], v10 offset:4096
    v_mfma_f32_16x16x32_bf16 v[40:43], a[180:183], a[140:143], v[40:43]
    ds_read_b64_tr_b16 a[174:175], v10 offset:4608
    v_mfma_f32_16x16x32_bf16 v[44:47], a[180:183], a[148:151], v[44:47]
    buffer_load_dwordx4 a[44:47], v8, s[8:11], s24 offen offset:1024 sc1
    v_mfma_f32_16x16x32_bf16 v[44:47], a[176:179], a[144:147], v[44:47]
    s_waitcnt lgkmcnt(8)
    v_mfma_f32_16x16x32_bf16 v[60:63], a[184:187], a[144:147], v[60:63]
    ds_read_b64_tr_b16 a[176:177], v2 offset:8192
    v_mfma_f32_16x16x32_bf16 v[60:63], a[188:191], a[148:151], v[60:63]
    ds_read_b64_tr_b16 a[178:179], v2 offset:8704
    v_mfma_f32_16x16x32_bf16 v[56:59], a[188:191], a[140:143], v[56:59]
    buffer_load_dwordx4 a[48:51], v8, s[8:11], s24 offen offset:2048 sc1
    v_mfma_f32_16x16x32_bf16 v[56:59], a[184:187], a[136:139], v[56:59]
    v_mfma_f32_16x16x32_bf16 v[52:55], a[184:187], a[128:131], v[52:55]
    ds_read_b64_tr_b16 a[180:181], v2 offset:12288
    v_mfma_f32_16x16x32_bf16 v[52:55], a[188:191], a[132:135], v[52:55]
    ds_read_b64_tr_b16 a[182:183], v2 offset:12800
    v_mfma_f32_16x16x32_bf16 v[48:51], a[188:191], a[124:127], v[48:51]
    buffer_load_dwordx4 a[52:55], v8, s[8:11], s24 offen offset:3072 sc1
    v_mfma_f32_16x16x32_bf16 v[48:51], a[184:187], a[120:123], v[48:51]
    s_waitcnt lgkmcnt(8)
    v_mfma_f32_16x16x32_bf16 v[64:67], a[160:163], a[120:123], v[64:67]
    ds_read_b64_tr_b16 a[184:185], v3 offset:8192
    v_mfma_f32_16x16x32_bf16 v[64:67], a[164:167], a[124:127], v[64:67]
    ds_read_b64_tr_b16 a[186:187], v3 offset:8704
    v_mfma_f32_16x16x32_bf16 v[68:71], a[164:167], a[132:135], v[68:71]
    buffer_load_dwordx4 a[56:59], v9, s[8:11], s24 offen offset:0 sc1
    v_mfma_f32_16x16x32_bf16 v[68:71], a[160:163], a[128:131], v[68:71]
    v_mfma_f32_16x16x32_bf16 v[72:75], a[160:163], a[136:139], v[72:75]
    ds_read_b64_tr_b16 a[188:189], v3 offset:12288
    v_mfma_f32_16x16x32_bf16 v[72:75], a[164:167], a[140:143], v[72:75]
    ds_read_b64_tr_b16 a[190:191], v3 offset:12800
    v_mfma_f32_16x16x32_bf16 v[76:79], a[164:167], a[148:151], v[76:79]
    buffer_load_dwordx4 a[60:63], v9, s[8:11], s24 offen offset:1024 sc1
    v_mfma_f32_16x16x32_bf16 v[76:79], a[160:163], a[144:147], v[76:79]
    s_waitcnt lgkmcnt(8)
    v_mfma_f32_16x16x32_bf16 v[92:95], a[168:171], a[144:147], v[92:95]
    ds_read_b64_tr_b16 a[160:161], v4 offset:8192
    v_mfma_f32_16x16x32_bf16 v[92:95], a[172:175], a[148:151], v[92:95]
    ds_read_b64_tr_b16 a[162:163], v4 offset:8704
    v_mfma_f32_16x16x32_bf16 v[88:91], a[172:175], a[140:143], v[88:91]
    buffer_load_dwordx4 a[64:67], v9, s[8:11], s24 offen offset:2048 sc1
    v_mfma_f32_16x16x32_bf16 v[88:91], a[168:171], a[136:139], v[88:91]
    v_mfma_f32_16x16x32_bf16 v[84:87], a[168:171], a[128:131], v[84:87]
    ds_read_b64_tr_b16 a[164:165], v4 offset:12288
    v_mfma_f32_16x16x32_bf16 v[84:87], a[172:175], a[132:135], v[84:87]
    ds_read_b64_tr_b16 a[166:167], v4 offset:12800
    v_mfma_f32_16x16x32_bf16 v[80:83], a[172:175], a[124:127], v[80:83]
    buffer_load_dwordx4 a[68:71], v9, s[8:11], s24 offen offset:3072 sc1
    v_mfma_f32_16x16x32_bf16 v[80:83], a[168:171], a[120:123], v[80:83]
    s_waitcnt lgkmcnt(8)
    v_mfma_f32_16x16x32_bf16 v[96:99], a[176:179], a[120:123], v[96:99]
    ds_read_b64_tr_b16 a[168:169], v10 offset:8192
    v_mfma_f32_16x16x32_bf16 v[96:99], a[180:183], a[124:127], v[96:99]
    ds_read_b64_tr_b16 a[170:171], v10 offset:8704
    s_add_u32 s25, s52, 2293760
    s_add_u32 s26, s53, 2293760
    s_add_u32 s27, s54, 2293760
    s_add_u32 s28, s55, 2293760
    s_add_u32 m0, s29, 0
    v_mfma_f32_16x16x32_bf16 v[100:103], a[180:183], a[132:135], v[100:103]
    buffer_load_dwordx4 v13, s[12:15], s25 offen  lds
    v_mfma_f32_16x16x32_bf16 v[100:103], a[176:179], a[128:131], v[100:103]
    v_mfma_f32_16x16x32_bf16 v[104:107], a[176:179], a[136:139], v[104:107]
    ds_read_b64_tr_b16 a[172:173], v10 offset:12288
    v_mfma_f32_16x16x32_bf16 v[104:107], a[180:183], a[140:143], v[104:107]
    ds_read_b64_tr_b16 a[174:175], v10 offset:12800
    s_add_u32 m0, s29, 1024
    v_mfma_f32_16x16x32_bf16 v[108:111], a[180:183], a[148:151], v[108:111]
    buffer_load_dwordx4 v14, s[12:15], s25 offen  lds
    v_mfma_f32_16x16x32_bf16 v[108:111], a[176:179], a[144:147], v[108:111]
    s_waitcnt lgkmcnt(8)
    v_mfma_f32_16x16x32_bf16 v[124:127], a[184:187], a[144:147], v[124:127]
    ds_read_b64_tr_b16 a[176:177], v2 offset:16384
    v_mfma_f32_16x16x32_bf16 v[124:127], a[188:191], a[148:151], v[124:127]
    ds_read_b64_tr_b16 a[178:179], v2 offset:16896
    s_add_u32 m0, s29, 8192
    v_mfma_f32_16x16x32_bf16 v[120:123], a[188:191], a[140:143], v[120:123]
    buffer_load_dwordx4 v13, s[12:15], s26 offen  lds
    v_mfma_f32_16x16x32_bf16 v[120:123], a[184:187], a[136:139], v[120:123]
    v_mfma_f32_16x16x32_bf16 v[116:119], a[184:187], a[128:131], v[116:119]
    ds_read_b64_tr_b16 a[180:181], v2 offset:20480
    v_mfma_f32_16x16x32_bf16 v[116:119], a[188:191], a[132:135], v[116:119]
    ds_read_b64_tr_b16 a[182:183], v2 offset:20992
    s_add_u32 m0, s29, 9216
    v_mfma_f32_16x16x32_bf16 v[112:115], a[188:191], a[124:127], v[112:115]
    buffer_load_dwordx4 v14, s[12:15], s26 offen  lds
    v_mfma_f32_16x16x32_bf16 v[112:115], a[184:187], a[120:123], v[112:115]
    s_waitcnt lgkmcnt(8)
    v_mfma_f32_16x16x32_bf16 v[128:131], a[160:163], a[120:123], v[128:131]
    ds_read_b64_tr_b16 a[184:185], v3 offset:16384
    v_mfma_f32_16x16x32_bf16 v[128:131], a[164:167], a[124:127], v[128:131]
    ds_read_b64_tr_b16 a[186:187], v3 offset:16896
    s_add_u32 m0, s29, 16384
    v_mfma_f32_16x16x32_bf16 v[132:135], a[164:167], a[132:135], v[132:135]
    buffer_load_dwordx4 v13, s[12:15], s27 offen  lds
    v_mfma_f32_16x16x32_bf16 v[132:135], a[160:163], a[128:131], v[132:135]
    v_mfma_f32_16x16x32_bf16 v[136:139], a[160:163], a[136:139], v[136:139]
    ds_read_b64_tr_b16 a[188:189], v3 offset:20480
    v_mfma_f32_16x16x32_bf16 v[136:139], a[164:167], a[140:143], v[136:139]
    ds_read_b64_tr_b16 a[190:191], v3 offset:20992
    s_add_u32 m0, s29, 17408
    v_mfma_f32_16x16x32_bf16 v[140:143], a[164:167], a[148:151], v[140:143]
    buffer_load_dwordx4 v14, s[12:15], s27 offen  lds
    v_mfma_f32_16x16x32_bf16 v[140:143], a[160:163], a[144:147], v[140:143]
    s_waitcnt lgkmcnt(8)
    v_mfma_f32_16x16x32_bf16 v[156:159], a[168:171], a[144:147], v[156:159]
    ds_read_b64_tr_b16 a[160:161], v4 offset:16384
    v_mfma_f32_16x16x32_bf16 v[156:159], a[172:175], a[148:151], v[156:159]
    ds_read_b64_tr_b16 a[162:163], v4 offset:16896
    s_add_u32 m0, s30, 0
    v_mfma_f32_16x16x32_bf16 v[152:155], a[172:175], a[140:143], v[152:155]
    buffer_load_dwordx4 v15, s[12:15], s28 offen  lds
    v_mfma_f32_16x16x32_bf16 v[152:155], a[168:171], a[136:139], v[152:155]
    v_mfma_f32_16x16x32_bf16 v[148:151], a[168:171], a[128:131], v[148:151]
    ds_read_b64_tr_b16 a[164:165], v4 offset:20480
    v_mfma_f32_16x16x32_bf16 v[148:151], a[172:175], a[132:135], v[148:151]
    ds_read_b64_tr_b16 a[166:167], v4 offset:20992
    s_add_u32 s33, s56, 3211264
    v_mfma_f32_16x16x32_bf16 v[144:147], a[172:175], a[124:127], v[144:147]
    buffer_load_dword a252, v11, s[12:15], s33 offen
    v_mfma_f32_16x16x32_bf16 v[144:147], a[168:171], a[120:123], v[144:147]
    s_waitcnt lgkmcnt(8)
    v_mfma_f32_16x16x32_bf16 v[160:163], a[176:179], a[120:123], v[160:163]
    ds_read_b64_tr_b16 a[168:169], v10 offset:16384
    v_mfma_f32_16x16x32_bf16 v[160:163], a[180:183], a[124:127], v[160:163]
    ds_read_b64_tr_b16 a[170:171], v10 offset:16896
    s_add_u32 s33, s68, 1572864
    v_mfma_f32_16x16x32_bf16 v[164:167], a[180:183], a[132:135], v[164:167]
    buffer_load_dword a253, v5, s[64:67], s33 offen
    v_mfma_f32_16x16x32_bf16 v[164:167], a[176:179], a[128:131], v[164:167]
    v_mfma_f32_16x16x32_bf16 v[168:171], a[176:179], a[136:139], v[168:171]
    ds_read_b64_tr_b16 a[172:173], v10 offset:20480
    v_mfma_f32_16x16x32_bf16 v[168:171], a[180:183], a[140:143], v[168:171]
    ds_read_b64_tr_b16 a[174:175], v10 offset:20992
    s_add_u32 s33, s68, 2097152
    v_mfma_f32_16x16x32_bf16 v[172:175], a[180:183], a[148:151], v[172:175]
    buffer_load_dword a253, v5, s[64:67], s33 offen
    v_mfma_f32_16x16x32_bf16 v[172:175], a[176:179], a[144:147], v[172:175]
    s_waitcnt lgkmcnt(8)
    v_mfma_f32_16x16x32_bf16 v[188:191], a[184:187], a[144:147], v[188:191]
    ds_read_b64_tr_b16 a[176:177], v6 offset:24576
    v_mfma_f32_16x16x32_bf16 v[188:191], a[188:191], a[148:151], v[188:191]
    ds_read_b64_tr_b16 a[178:179], v6 offset:24832
    v_mfma_f32_16x16x32_bf16 v[184:187], a[188:191], a[140:143], v[184:187]
    v_mfma_f32_16x16x32_bf16 v[184:187], a[184:187], a[136:139], v[184:187]
    v_mfma_f32_16x16x32_bf16 v[180:183], a[184:187], a[128:131], v[180:183]
    ds_read_b64_tr_b16 a[180:181], v6 offset:26624
    v_mfma_f32_16x16x32_bf16 v[180:183], a[188:191], a[132:135], v[180:183]
    ds_read_b64_tr_b16 a[182:183], v6 offset:26880
    v_mfma_f32_16x16x32_bf16 v[176:179], a[188:191], a[124:127], v[176:179]
    v_mfma_f32_16x16x32_bf16 v[176:179], a[184:187], a[120:123], v[176:179]
    s_waitcnt lgkmcnt(8)
    v_mfma_f32_16x16x32_bf16 v[192:195], a[160:163], a[120:123], v[192:195]
    ds_read_b64_tr_b16 a[184:185], v7 offset:24576
    v_mfma_f32_16x16x32_bf16 v[192:195], a[164:167], a[124:127], v[192:195]
    ds_read_b64_tr_b16 a[186:187], v7 offset:24832
    v_mfma_f32_16x16x32_bf16 v[196:199], a[164:167], a[132:135], v[196:199]
    v_mfma_f32_16x16x32_bf16 v[196:199], a[160:163], a[128:131], v[196:199]
    v_mfma_f32_16x16x32_bf16 v[200:203], a[160:163], a[136:139], v[200:203]
    ds_read_b64_tr_b16 a[188:189], v7 offset:26624
    v_mfma_f32_16x16x32_bf16 v[200:203], a[164:167], a[140:143], v[200:203]
    ds_read_b64_tr_b16 a[190:191], v7 offset:26880
    v_mfma_f32_16x16x32_bf16 v[204:207], a[164:167], a[148:151], v[204:207]
    v_mfma_f32_16x16x32_bf16 v[204:207], a[160:163], a[144:147], v[204:207]
    s_waitcnt lgkmcnt(8)
    v_mfma_f32_16x16x32_bf16 v[220:223], a[168:171], a[144:147], v[220:223]
    s_waitcnt vmcnt(21)
    s_barrier
    ds_read_b64_tr_b16 a[160:161], v20 offset:28672
    v_mfma_f32_16x16x32_bf16 v[220:223], a[172:175], a[148:151], v[220:223]
    ds_read_b64_tr_b16 a[162:163], v20 offset:29184
    v_mfma_f32_16x16x32_bf16 v[216:219], a[172:175], a[140:143], v[216:219]
    v_mfma_f32_16x16x32_bf16 v[216:219], a[168:171], a[136:139], v[216:219]
    v_mfma_f32_16x16x32_bf16 v[212:215], a[168:171], a[128:131], v[212:215]
    ds_read_b64_tr_b16 a[164:165], v20 offset:32768
    v_mfma_f32_16x16x32_bf16 v[212:215], a[172:175], a[132:135], v[212:215]
    ds_read_b64_tr_b16 a[166:167], v20 offset:33280
    v_mfma_f32_16x16x32_bf16 v[208:211], a[172:175], a[124:127], v[208:211]
    v_mfma_f32_16x16x32_bf16 v[208:211], a[168:171], a[120:123], v[208:211]
    s_waitcnt lgkmcnt(8)
    v_mfma_f32_16x16x32_bf16 v[224:227], a[176:179], a[120:123], v[224:227]
    ds_read_b64_tr_b16 a[168:169], v21 offset:28672
    v_mfma_f32_16x16x32_bf16 v[224:227], a[180:183], a[124:127], v[224:227]
    ds_read_b64_tr_b16 a[170:171], v21 offset:29184
    v_mfma_f32_16x16x32_bf16 v[228:231], a[180:183], a[132:135], v[228:231]
    v_mfma_f32_16x16x32_bf16 v[228:231], a[176:179], a[128:131], v[228:231]
    v_mfma_f32_16x16x32_bf16 v[232:235], a[176:179], a[136:139], v[232:235]
    ds_read_b64_tr_b16 a[172:173], v21 offset:32768
    v_mfma_f32_16x16x32_bf16 v[232:235], a[180:183], a[140:143], v[232:235]
    ds_read_b64_tr_b16 a[174:175], v21 offset:33280
    v_mfma_f32_16x16x32_bf16 v[236:239], a[180:183], a[148:151], v[236:239]
    v_mfma_f32_16x16x32_bf16 v[236:239], a[176:179], a[144:147], v[236:239]
    s_waitcnt lgkmcnt(8)
    v_mfma_f32_16x16x32_bf16 v[252:255], a[184:187], a[144:147], v[252:255]
    ds_read_b64_tr_b16 a[176:177], v22 offset:28672
    v_mfma_f32_16x16x32_bf16 v[252:255], a[188:191], a[148:151], v[252:255]
    ds_read_b64_tr_b16 a[178:179], v22 offset:29184
    v_mfma_f32_16x16x32_bf16 v[248:251], a[188:191], a[140:143], v[248:251]
    v_mfma_f32_16x16x32_bf16 v[248:251], a[184:187], a[136:139], v[248:251]
    v_mfma_f32_16x16x32_bf16 v[244:247], a[184:187], a[128:131], v[244:247]
    ds_read_b64_tr_b16 a[180:181], v22 offset:32768
    v_mfma_f32_16x16x32_bf16 v[244:247], a[188:191], a[132:135], v[244:247]
    ds_read_b64_tr_b16 a[182:183], v22 offset:33280
    v_mfma_f32_16x16x32_bf16 v[240:243], a[188:191], a[124:127], v[240:243]
    v_mfma_f32_16x16x32_bf16 v[240:243], a[184:187], a[120:123], v[240:243]
    s_waitcnt lgkmcnt(8)
    v_mfma_f32_16x16x32_bf16 v[32:35], a[160:163], a[0:3], v[32:35]
    ds_read_b64_tr_b16 a[184:185], v23 offset:28672
    v_mfma_f32_16x16x32_bf16 v[32:35], a[164:167], a[4:7], v[32:35]
    ds_read_b64_tr_b16 a[186:187], v23 offset:29184
    s_mov_b32 s24, 1572864
    v_mfma_f32_16x16x32_bf16 v[36:39], a[164:167], a[12:15], v[36:39]
    buffer_load_dwordx4 a[80:83], v8, s[8:11], s24 offen offset:0 sc1
    v_mfma_f32_16x16x32_bf16 v[36:39], a[160:163], a[8:11], v[36:39]
    v_mfma_f32_16x16x32_bf16 v[40:43], a[160:163], a[16:19], v[40:43]
    ds_read_b64_tr_b16 a[188:189], v23 offset:32768
    v_mfma_f32_16x16x32_bf16 v[40:43], a[164:167], a[20:23], v[40:43]
    ds_read_b64_tr_b16 a[190:191], v23 offset:33280
    v_mfma_f32_16x16x32_bf16 v[44:47], a[164:167], a[28:31], v[44:47]
    buffer_load_dwordx4 a[84:87], v8, s[8:11], s24 offen offset:1024 sc1
    v_mfma_f32_16x16x32_bf16 v[44:47], a[160:163], a[24:27], v[44:47]
    s_waitcnt lgkmcnt(8)
    v_mfma_f32_16x16x32_bf16 v[60:63], a[168:171], a[24:27], v[60:63]
    ds_read_b64_tr_b16 a[160:161], v20 offset:36864
    v_mfma_f32_16x16x32_bf16 v[60:63], a[172:175], a[28:31], v[60:63]
    ds_read_b64_tr_b16 a[162:163], v20 offset:37376
    v_mfma_f32_16x16x32_bf16 v[56:59], a[172:175], a[20:23], v[56:59]
    buffer_load_dwordx4 a[88:91], v8, s[8:11], s24 offen offset:2048 sc1
    v_mfma_f32_16x16x32_bf16 v[56:59], a[168:171], a[16:19], v[56:59]
    v_mfma_f32_16x16x32_bf16 v[52:55], a[168:171], a[8:11], v[52:55]
    ds_read_b64_tr_b16 a[164:165], v20 offset:40960
    v_mfma_f32_16x16x32_bf16 v[52:55], a[172:175], a[12:15], v[52:55]
    ds_read_b64_tr_b16 a[166:167], v20 offset:41472
    v_mfma_f32_16x16x32_bf16 v[48:51], a[172:175], a[4:7], v[48:51]
    buffer_load_dwordx4 a[92:95], v8, s[8:11], s24 offen offset:3072 sc1
    v_mfma_f32_16x16x32_bf16 v[48:51], a[168:171], a[0:3], v[48:51]
    s_waitcnt lgkmcnt(8)
    v_mfma_f32_16x16x32_bf16 v[64:67], a[176:179], a[0:3], v[64:67]
    ds_read_b64_tr_b16 a[168:169], v21 offset:36864
    v_mfma_f32_16x16x32_bf16 v[64:67], a[180:183], a[4:7], v[64:67]
    ds_read_b64_tr_b16 a[170:171], v21 offset:37376
    v_mfma_f32_16x16x32_bf16 v[68:71], a[180:183], a[12:15], v[68:71]
    buffer_load_dwordx4 a[96:99], v9, s[8:11], s24 offen offset:0 sc1
    v_mfma_f32_16x16x32_bf16 v[68:71], a[176:179], a[8:11], v[68:71]
    v_mfma_f32_16x16x32_bf16 v[72:75], a[176:179], a[16:19], v[72:75]
    ds_read_b64_tr_b16 a[172:173], v21 offset:40960
    v_mfma_f32_16x16x32_bf16 v[72:75], a[180:183], a[20:23], v[72:75]
    ds_read_b64_tr_b16 a[174:175], v21 offset:41472
    v_mfma_f32_16x16x32_bf16 v[76:79], a[180:183], a[28:31], v[76:79]
    buffer_load_dwordx4 a[100:103], v9, s[8:11], s24 offen offset:1024 sc1
    v_mfma_f32_16x16x32_bf16 v[76:79], a[176:179], a[24:27], v[76:79]
    s_waitcnt lgkmcnt(8)
    v_mfma_f32_16x16x32_bf16 v[92:95], a[184:187], a[24:27], v[92:95]
    ds_read_b64_tr_b16 a[176:177], v22 offset:36864
    v_mfma_f32_16x16x32_bf16 v[92:95], a[188:191], a[28:31], v[92:95]
    ds_read_b64_tr_b16 a[178:179], v22 offset:37376
    v_mfma_f32_16x16x32_bf16 v[88:91], a[188:191], a[20:23], v[88:91]
    buffer_load_dwordx4 a[104:107], v9, s[8:11], s24 offen offset:2048 sc1
    v_mfma_f32_16x16x32_bf16 v[88:91], a[184:187], a[16:19], v[88:91]
    v_mfma_f32_16x16x32_bf16 v[84:87], a[184:187], a[8:11], v[84:87]
    ds_read_b64_tr_b16 a[180:181], v22 offset:40960
    v_mfma_f32_16x16x32_bf16 v[84:87], a[188:191], a[12:15], v[84:87]
    ds_read_b64_tr_b16 a[182:183], v22 offset:41472
    v_mfma_f32_16x16x32_bf16 v[80:83], a[188:191], a[4:7], v[80:83]
    buffer_load_dwordx4 a[108:111], v9, s[8:11], s24 offen offset:3072 sc1
    v_mfma_f32_16x16x32_bf16 v[80:83], a[184:187], a[0:3], v[80:83]
    s_waitcnt lgkmcnt(8)
    v_mfma_f32_16x16x32_bf16 v[96:99], a[160:163], a[0:3], v[96:99]
    ds_read_b64_tr_b16 a[184:185], v23 offset:36864
    v_mfma_f32_16x16x32_bf16 v[96:99], a[164:167], a[4:7], v[96:99]
    ds_read_b64_tr_b16 a[186:187], v23 offset:37376
    s_add_u32 s25, s52, 2752512
    s_add_u32 s26, s53, 2752512
    s_add_u32 s27, s54, 2752512
    s_add_u32 s28, s55, 2752512
    s_add_u32 m0, s29, 28672
    v_mfma_f32_16x16x32_bf16 v[100:103], a[164:167], a[12:15], v[100:103]
    buffer_load_dwordx4 v13, s[12:15], s25 offen  lds
    v_mfma_f32_16x16x32_bf16 v[100:103], a[160:163], a[8:11], v[100:103]
    v_mfma_f32_16x16x32_bf16 v[104:107], a[160:163], a[16:19], v[104:107]
    ds_read_b64_tr_b16 a[188:189], v23 offset:40960
    v_mfma_f32_16x16x32_bf16 v[104:107], a[164:167], a[20:23], v[104:107]
    ds_read_b64_tr_b16 a[190:191], v23 offset:41472
    s_add_u32 m0, s29, 29696
    v_mfma_f32_16x16x32_bf16 v[108:111], a[164:167], a[28:31], v[108:111]
    buffer_load_dwordx4 v14, s[12:15], s25 offen  lds
    v_mfma_f32_16x16x32_bf16 v[108:111], a[160:163], a[24:27], v[108:111]
    s_waitcnt lgkmcnt(8)
    v_mfma_f32_16x16x32_bf16 v[124:127], a[168:171], a[24:27], v[124:127]
    ds_read_b64_tr_b16 a[160:161], v20 offset:45056
    v_mfma_f32_16x16x32_bf16 v[124:127], a[172:175], a[28:31], v[124:127]
    ds_read_b64_tr_b16 a[162:163], v20 offset:45568
    s_add_u32 m0, s29, 36864
    v_mfma_f32_16x16x32_bf16 v[120:123], a[172:175], a[20:23], v[120:123]
    buffer_load_dwordx4 v13, s[12:15], s26 offen  lds
    v_mfma_f32_16x16x32_bf16 v[120:123], a[168:171], a[16:19], v[120:123]
    v_mfma_f32_16x16x32_bf16 v[116:119], a[168:171], a[8:11], v[116:119]
    ds_read_b64_tr_b16 a[164:165], v20 offset:49152
    v_mfma_f32_16x16x32_bf16 v[116:119], a[172:175], a[12:15], v[116:119]
    ds_read_b64_tr_b16 a[166:167], v20 offset:49664
    s_add_u32 m0, s29, 37888
    v_mfma_f32_16x16x32_bf16 v[112:115], a[172:175], a[4:7], v[112:115]
    buffer_load_dwordx4 v14, s[12:15], s26 offen  lds
    v_mfma_f32_16x16x32_bf16 v[112:115], a[168:171], a[0:3], v[112:115]
    s_waitcnt lgkmcnt(8)
    v_mfma_f32_16x16x32_bf16 v[128:131], a[176:179], a[0:3], v[128:131]
    ds_read_b64_tr_b16 a[168:169], v21 offset:45056
    v_mfma_f32_16x16x32_bf16 v[128:131], a[180:183], a[4:7], v[128:131]
    ds_read_b64_tr_b16 a[170:171], v21 offset:45568
    s_add_u32 m0, s29, 45056
    v_mfma_f32_16x16x32_bf16 v[132:135], a[180:183], a[12:15], v[132:135]
    buffer_load_dwordx4 v13, s[12:15], s27 offen  lds
    v_mfma_f32_16x16x32_bf16 v[132:135], a[176:179], a[8:11], v[132:135]
    v_mfma_f32_16x16x32_bf16 v[136:139], a[176:179], a[16:19], v[136:139]
    ds_read_b64_tr_b16 a[172:173], v21 offset:49152
    v_mfma_f32_16x16x32_bf16 v[136:139], a[180:183], a[20:23], v[136:139]
    ds_read_b64_tr_b16 a[174:175], v21 offset:49664
    s_add_u32 m0, s29, 46080
    v_mfma_f32_16x16x32_bf16 v[140:143], a[180:183], a[28:31], v[140:143]
    buffer_load_dwordx4 v14, s[12:15], s27 offen  lds
    v_mfma_f32_16x16x32_bf16 v[140:143], a[176:179], a[24:27], v[140:143]
    s_waitcnt lgkmcnt(8)
    v_mfma_f32_16x16x32_bf16 v[156:159], a[184:187], a[24:27], v[156:159]
    ds_read_b64_tr_b16 a[176:177], v22 offset:45056
    v_mfma_f32_16x16x32_bf16 v[156:159], a[188:191], a[28:31], v[156:159]
    ds_read_b64_tr_b16 a[178:179], v22 offset:45568
    s_add_u32 m0, s30, 28672
    v_mfma_f32_16x16x32_bf16 v[152:155], a[188:191], a[20:23], v[152:155]
    buffer_load_dwordx4 v15, s[12:15], s28 offen  lds
    v_mfma_f32_16x16x32_bf16 v[152:155], a[184:187], a[16:19], v[152:155]
    v_mfma_f32_16x16x32_bf16 v[148:151], a[184:187], a[8:11], v[148:151]
    ds_read_b64_tr_b16 a[180:181], v22 offset:49152
    v_mfma_f32_16x16x32_bf16 v[148:151], a[188:191], a[12:15], v[148:151]
    ds_read_b64_tr_b16 a[182:183], v22 offset:49664
    s_add_u32 s33, s56, 3670016
    v_mfma_f32_16x16x32_bf16 v[144:147], a[188:191], a[4:7], v[144:147]
    buffer_load_dword a252, v11, s[12:15], s33 offen
    v_mfma_f32_16x16x32_bf16 v[144:147], a[184:187], a[0:3], v[144:147]
    s_waitcnt lgkmcnt(8)
    v_mfma_f32_16x16x32_bf16 v[160:163], a[160:163], a[0:3], v[160:163]
    ds_read_b64_tr_b16 a[184:185], v23 offset:45056
    v_mfma_f32_16x16x32_bf16 v[160:163], a[164:167], a[4:7], v[160:163]
    ds_read_b64_tr_b16 a[186:187], v23 offset:45568
    s_add_u32 s33, s68, 2621440
    v_mfma_f32_16x16x32_bf16 v[164:167], a[164:167], a[12:15], v[164:167]
    buffer_load_dword a253, v5, s[64:67], s33 offen
    v_mfma_f32_16x16x32_bf16 v[164:167], a[160:163], a[8:11], v[164:167]
    v_mfma_f32_16x16x32_bf16 v[168:171], a[160:163], a[16:19], v[168:171]
    ds_read_b64_tr_b16 a[188:189], v23 offset:49152
    v_mfma_f32_16x16x32_bf16 v[168:171], a[164:167], a[20:23], v[168:171]
    ds_read_b64_tr_b16 a[190:191], v23 offset:49664
    s_add_u32 s48, s75, 0
    v_mfma_f32_16x16x32_bf16 v[172:175], a[164:167], a[28:31], v[172:175]
    buffer_load_dwordx4 a[232:235], v30, s[40:43], s48 offen nt
    v_mfma_f32_16x16x32_bf16 v[172:175], a[160:163], a[24:27], v[172:175]
    s_waitcnt lgkmcnt(8)
    v_mfma_f32_16x16x32_bf16 v[188:191], a[168:171], a[24:27], v[188:191]
    ds_read_b64_tr_b16 a[160:161], v26 offset:53248
    v_mfma_f32_16x16x32_bf16 v[188:191], a[172:175], a[28:31], v[188:191]
    ds_read_b64_tr_b16 a[162:163], v26 offset:53504
    v_mfma_f32_16x16x32_bf16 v[184:187], a[172:175], a[20:23], v[184:187]
    v_mfma_f32_16x16x32_bf16 v[184:187], a[168:171], a[16:19], v[184:187]
    v_mfma_f32_16x16x32_bf16 v[180:183], a[168:171], a[8:11], v[180:183]
    ds_read_b64_tr_b16 a[164:165], v26 offset:55296
    v_mfma_f32_16x16x32_bf16 v[180:183], a[172:175], a[12:15], v[180:183]
    ds_read_b64_tr_b16 a[166:167], v26 offset:55552
    v_mfma_f32_16x16x32_bf16 v[176:179], a[172:175], a[4:7], v[176:179]
    v_mfma_f32_16x16x32_bf16 v[176:179], a[168:171], a[0:3], v[176:179]
    s_waitcnt lgkmcnt(8)
    v_mfma_f32_16x16x32_bf16 v[192:195], a[176:179], a[0:3], v[192:195]
    ds_read_b64_tr_b16 a[168:169], v27 offset:53248
    v_mfma_f32_16x16x32_bf16 v[192:195], a[180:183], a[4:7], v[192:195]
    ds_read_b64_tr_b16 a[170:171], v27 offset:53504
    v_mfma_f32_16x16x32_bf16 v[196:199], a[180:183], a[12:15], v[196:199]
    v_mfma_f32_16x16x32_bf16 v[196:199], a[176:179], a[8:11], v[196:199]
    v_mfma_f32_16x16x32_bf16 v[200:203], a[176:179], a[16:19], v[200:203]
    ds_read_b64_tr_b16 a[172:173], v27 offset:55296
    v_mfma_f32_16x16x32_bf16 v[200:203], a[180:183], a[20:23], v[200:203]
    ds_read_b64_tr_b16 a[174:175], v27 offset:55552
    v_mfma_f32_16x16x32_bf16 v[204:207], a[180:183], a[28:31], v[204:207]
    v_mfma_f32_16x16x32_bf16 v[204:207], a[176:179], a[24:27], v[204:207]
    s_waitcnt lgkmcnt(8)
    v_mfma_f32_16x16x32_bf16 v[220:223], a[184:187], a[24:27], v[220:223]
    s_waitcnt vmcnt(21)
    s_barrier
    ds_read_b64_tr_b16 a[176:177], v16 offset:0
    v_mfma_f32_16x16x32_bf16 v[220:223], a[188:191], a[28:31], v[220:223]
    ds_read_b64_tr_b16 a[178:179], v16 offset:512
    v_mfma_f32_16x16x32_bf16 v[216:219], a[188:191], a[20:23], v[216:219]
    v_mfma_f32_16x16x32_bf16 v[216:219], a[184:187], a[16:19], v[216:219]
    v_mfma_f32_16x16x32_bf16 v[212:215], a[184:187], a[8:11], v[212:215]
    ds_read_b64_tr_b16 a[180:181], v16 offset:4096
    v_mfma_f32_16x16x32_bf16 v[212:215], a[188:191], a[12:15], v[212:215]
    ds_read_b64_tr_b16 a[182:183], v16 offset:4608
    v_mfma_f32_16x16x32_bf16 v[208:211], a[188:191], a[4:7], v[208:211]
    v_mfma_f32_16x16x32_bf16 v[208:211], a[184:187], a[0:3], v[208:211]
    s_waitcnt lgkmcnt(8)
    v_mfma_f32_16x16x32_bf16 v[224:227], a[160:163], a[0:3], v[224:227]
    ds_read_b64_tr_b16 a[184:185], v17 offset:0
    v_mfma_f32_16x16x32_bf16 v[224:227], a[164:167], a[4:7], v[224:227]
    ds_read_b64_tr_b16 a[186:187], v17 offset:512
    v_mfma_f32_16x16x32_bf16 v[228:231], a[164:167], a[12:15], v[228:231]
    v_mfma_f32_16x16x32_bf16 v[228:231], a[160:163], a[8:11], v[228:231]
    v_mfma_f32_16x16x32_bf16 v[232:235], a[160:163], a[16:19], v[232:235]
    ds_read_b64_tr_b16 a[188:189], v17 offset:4096
    v_mfma_f32_16x16x32_bf16 v[232:235], a[164:167], a[20:23], v[232:235]
    ds_read_b64_tr_b16 a[190:191], v17 offset:4608
    v_mfma_f32_16x16x32_bf16 v[236:239], a[164:167], a[28:31], v[236:239]
    v_mfma_f32_16x16x32_bf16 v[236:239], a[160:163], a[24:27], v[236:239]
    s_waitcnt lgkmcnt(8)
    v_mfma_f32_16x16x32_bf16 v[252:255], a[168:171], a[24:27], v[252:255]
    ds_read_b64_tr_b16 a[160:161], v18 offset:0
    v_mfma_f32_16x16x32_bf16 v[252:255], a[172:175], a[28:31], v[252:255]
    ds_read_b64_tr_b16 a[162:163], v18 offset:512
    v_mfma_f32_16x16x32_bf16 v[248:251], a[172:175], a[20:23], v[248:251]
    v_mfma_f32_16x16x32_bf16 v[248:251], a[168:171], a[16:19], v[248:251]
    v_mfma_f32_16x16x32_bf16 v[244:247], a[168:171], a[8:11], v[244:247]
    ds_read_b64_tr_b16 a[164:165], v18 offset:4096
    v_mfma_f32_16x16x32_bf16 v[244:247], a[172:175], a[12:15], v[244:247]
    ds_read_b64_tr_b16 a[166:167], v18 offset:4608
    v_mfma_f32_16x16x32_bf16 v[240:243], a[172:175], a[4:7], v[240:243]
    v_mfma_f32_16x16x32_bf16 v[240:243], a[168:171], a[0:3], v[240:243]
    s_waitcnt lgkmcnt(8)
    v_mfma_f32_16x16x32_bf16 v[32:35], a[176:179], a[40:43], v[32:35]
    ds_read_b64_tr_b16 a[168:169], v19 offset:0
    v_mfma_f32_16x16x32_bf16 v[32:35], a[180:183], a[44:47], v[32:35]
    ds_read_b64_tr_b16 a[170:171], v19 offset:512
    s_mov_b32 s24, 1835008
    v_mfma_f32_16x16x32_bf16 v[36:39], a[180:183], a[52:55], v[36:39]
    buffer_load_dwordx4 a[120:123], v8, s[8:11], s24 offen offset:0 sc1
    v_mfma_f32_16x16x32_bf16 v[36:39], a[176:179], a[48:51], v[36:39]
    v_mfma_f32_16x16x32_bf16 v[40:43], a[176:179], a[56:59], v[40:43]
    ds_read_b64_tr_b16 a[172:173], v19 offset:4096
    v_mfma_f32_16x16x32_bf16 v[40:43], a[180:183], a[60:63], v[40:43]
    ds_read_b64_tr_b16 a[174:175], v19 offset:4608
    v_mfma_f32_16x16x32_bf16 v[44:47], a[180:183], a[68:71], v[44:47]
    buffer_load_dwordx4 a[124:127], v8, s[8:11], s24 offen offset:1024 sc1
    v_mfma_f32_16x16x32_bf16 v[44:47], a[176:179], a[64:67], v[44:47]
    s_waitcnt lgkmcnt(8)
    v_mfma_f32_16x16x32_bf16 v[60:63], a[184:187], a[64:67], v[60:63]
    ds_read_b64_tr_b16 a[176:177], v16 offset:8192
    v_mfma_f32_16x16x32_bf16 v[60:63], a[188:191], a[68:71], v[60:63]
    ds_read_b64_tr_b16 a[178:179], v16 offset:8704
    v_mfma_f32_16x16x32_bf16 v[56:59], a[188:191], a[60:63], v[56:59]
    buffer_load_dwordx4 a[128:131], v8, s[8:11], s24 offen offset:2048 sc1
    v_mfma_f32_16x16x32_bf16 v[56:59], a[184:187], a[56:59], v[56:59]
    v_mfma_f32_16x16x32_bf16 v[52:55], a[184:187], a[48:51], v[52:55]
    ds_read_b64_tr_b16 a[180:181], v16 offset:12288
    v_mfma_f32_16x16x32_bf16 v[52:55], a[188:191], a[52:55], v[52:55]
    ds_read_b64_tr_b16 a[182:183], v16 offset:12800
    v_mfma_f32_16x16x32_bf16 v[48:51], a[188:191], a[44:47], v[48:51]
    buffer_load_dwordx4 a[132:135], v8, s[8:11], s24 offen offset:3072 sc1
    v_mfma_f32_16x16x32_bf16 v[48:51], a[184:187], a[40:43], v[48:51]
    s_waitcnt lgkmcnt(8)
    v_mfma_f32_16x16x32_bf16 v[64:67], a[160:163], a[40:43], v[64:67]
    ds_read_b64_tr_b16 a[184:185], v17 offset:8192
    v_mfma_f32_16x16x32_bf16 v[64:67], a[164:167], a[44:47], v[64:67]
    ds_read_b64_tr_b16 a[186:187], v17 offset:8704
    v_mfma_f32_16x16x32_bf16 v[68:71], a[164:167], a[52:55], v[68:71]
    buffer_load_dwordx4 a[136:139], v9, s[8:11], s24 offen offset:0 sc1
    v_mfma_f32_16x16x32_bf16 v[68:71], a[160:163], a[48:51], v[68:71]
    v_mfma_f32_16x16x32_bf16 v[72:75], a[160:163], a[56:59], v[72:75]
    ds_read_b64_tr_b16 a[188:189], v17 offset:12288
    v_mfma_f32_16x16x32_bf16 v[72:75], a[164:167], a[60:63], v[72:75]
    ds_read_b64_tr_b16 a[190:191], v17 offset:12800
    v_mfma_f32_16x16x32_bf16 v[76:79], a[164:167], a[68:71], v[76:79]
    buffer_load_dwordx4 a[140:143], v9, s[8:11], s24 offen offset:1024 sc1
    v_mfma_f32_16x16x32_bf16 v[76:79], a[160:163], a[64:67], v[76:79]
    s_waitcnt lgkmcnt(8)
    v_mfma_f32_16x16x32_bf16 v[92:95], a[168:171], a[64:67], v[92:95]
    ds_read_b64_tr_b16 a[160:161], v18 offset:8192
    v_mfma_f32_16x16x32_bf16 v[92:95], a[172:175], a[68:71], v[92:95]
    ds_read_b64_tr_b16 a[162:163], v18 offset:8704
    v_mfma_f32_16x16x32_bf16 v[88:91], a[172:175], a[60:63], v[88:91]
    buffer_load_dwordx4 a[144:147], v9, s[8:11], s24 offen offset:2048 sc1
    v_mfma_f32_16x16x32_bf16 v[88:91], a[168:171], a[56:59], v[88:91]
    v_mfma_f32_16x16x32_bf16 v[84:87], a[168:171], a[48:51], v[84:87]
    ds_read_b64_tr_b16 a[164:165], v18 offset:12288
    v_mfma_f32_16x16x32_bf16 v[84:87], a[172:175], a[52:55], v[84:87]
    ds_read_b64_tr_b16 a[166:167], v18 offset:12800
    v_mfma_f32_16x16x32_bf16 v[80:83], a[172:175], a[44:47], v[80:83]
    buffer_load_dwordx4 a[148:151], v9, s[8:11], s24 offen offset:3072 sc1
    v_mfma_f32_16x16x32_bf16 v[80:83], a[168:171], a[40:43], v[80:83]
    s_waitcnt lgkmcnt(8)
    v_mfma_f32_16x16x32_bf16 v[96:99], a[176:179], a[40:43], v[96:99]
    ds_read_b64_tr_b16 a[168:169], v19 offset:8192
    v_mfma_f32_16x16x32_bf16 v[96:99], a[180:183], a[44:47], v[96:99]
    ds_read_b64_tr_b16 a[170:171], v19 offset:8704
    s_add_u32 s25, s52, 3211264
    s_add_u32 s26, s53, 3211264
    s_add_u32 s27, s54, 3211264
    s_add_u32 s28, s55, 3211264
    s_add_u32 m0, s29, 114688
    v_mfma_f32_16x16x32_bf16 v[100:103], a[180:183], a[52:55], v[100:103]
    buffer_load_dwordx4 v13, s[12:15], s25 offen  lds
    v_mfma_f32_16x16x32_bf16 v[100:103], a[176:179], a[48:51], v[100:103]
    v_mfma_f32_16x16x32_bf16 v[104:107], a[176:179], a[56:59], v[104:107]
    ds_read_b64_tr_b16 a[172:173], v19 offset:12288
    v_mfma_f32_16x16x32_bf16 v[104:107], a[180:183], a[60:63], v[104:107]
    ds_read_b64_tr_b16 a[174:175], v19 offset:12800
    s_add_u32 m0, s29, 115712
    v_mfma_f32_16x16x32_bf16 v[108:111], a[180:183], a[68:71], v[108:111]
    buffer_load_dwordx4 v14, s[12:15], s25 offen  lds
    v_mfma_f32_16x16x32_bf16 v[108:111], a[176:179], a[64:67], v[108:111]
    s_waitcnt lgkmcnt(8)
    v_mfma_f32_16x16x32_bf16 v[124:127], a[184:187], a[64:67], v[124:127]
    ds_read_b64_tr_b16 a[176:177], v16 offset:16384
    v_mfma_f32_16x16x32_bf16 v[124:127], a[188:191], a[68:71], v[124:127]
    ds_read_b64_tr_b16 a[178:179], v16 offset:16896
    s_add_u32 m0, s29, 122880
    v_mfma_f32_16x16x32_bf16 v[120:123], a[188:191], a[60:63], v[120:123]
    buffer_load_dwordx4 v13, s[12:15], s26 offen  lds
    v_mfma_f32_16x16x32_bf16 v[120:123], a[184:187], a[56:59], v[120:123]
    v_mfma_f32_16x16x32_bf16 v[116:119], a[184:187], a[48:51], v[116:119]
    ds_read_b64_tr_b16 a[180:181], v16 offset:20480
    v_mfma_f32_16x16x32_bf16 v[116:119], a[188:191], a[52:55], v[116:119]
    ds_read_b64_tr_b16 a[182:183], v16 offset:20992
    s_add_u32 m0, s29, 123904
    v_mfma_f32_16x16x32_bf16 v[112:115], a[188:191], a[44:47], v[112:115]
    buffer_load_dwordx4 v14, s[12:15], s26 offen  lds
    v_mfma_f32_16x16x32_bf16 v[112:115], a[184:187], a[40:43], v[112:115]
    s_waitcnt lgkmcnt(8)
    v_mfma_f32_16x16x32_bf16 v[128:131], a[160:163], a[40:43], v[128:131]
    ds_read_b64_tr_b16 a[184:185], v17 offset:16384
    v_mfma_f32_16x16x32_bf16 v[128:131], a[164:167], a[44:47], v[128:131]
    ds_read_b64_tr_b16 a[186:187], v17 offset:16896
    s_add_u32 m0, s29, 131072
    v_mfma_f32_16x16x32_bf16 v[132:135], a[164:167], a[52:55], v[132:135]
    buffer_load_dwordx4 v13, s[12:15], s27 offen  lds
    v_mfma_f32_16x16x32_bf16 v[132:135], a[160:163], a[48:51], v[132:135]
    v_mfma_f32_16x16x32_bf16 v[136:139], a[160:163], a[56:59], v[136:139]
    ds_read_b64_tr_b16 a[188:189], v17 offset:20480
    v_mfma_f32_16x16x32_bf16 v[136:139], a[164:167], a[60:63], v[136:139]
    ds_read_b64_tr_b16 a[190:191], v17 offset:20992
    s_add_u32 m0, s29, 132096
    v_mfma_f32_16x16x32_bf16 v[140:143], a[164:167], a[68:71], v[140:143]
    buffer_load_dwordx4 v14, s[12:15], s27 offen  lds
    v_mfma_f32_16x16x32_bf16 v[140:143], a[160:163], a[64:67], v[140:143]
    s_waitcnt lgkmcnt(8)
    v_mfma_f32_16x16x32_bf16 v[156:159], a[168:171], a[64:67], v[156:159]
    ds_read_b64_tr_b16 a[160:161], v18 offset:16384
    v_mfma_f32_16x16x32_bf16 v[156:159], a[172:175], a[68:71], v[156:159]
    ds_read_b64_tr_b16 a[162:163], v18 offset:16896
    s_add_u32 m0, s30, 114688
    v_mfma_f32_16x16x32_bf16 v[152:155], a[172:175], a[60:63], v[152:155]
    buffer_load_dwordx4 v15, s[12:15], s28 offen  lds
    v_mfma_f32_16x16x32_bf16 v[152:155], a[168:171], a[56:59], v[152:155]
    v_mfma_f32_16x16x32_bf16 v[148:151], a[168:171], a[48:51], v[148:151]
    ds_read_b64_tr_b16 a[164:165], v18 offset:20480
    v_mfma_f32_16x16x32_bf16 v[148:151], a[172:175], a[52:55], v[148:151]
    ds_read_b64_tr_b16 a[166:167], v18 offset:20992
    s_add_u32 s33, s56, 4128768
    v_mfma_f32_16x16x32_bf16 v[144:147], a[172:175], a[44:47], v[144:147]
    buffer_load_dword a252, v11, s[12:15], s33 offen
    v_mfma_f32_16x16x32_bf16 v[144:147], a[168:171], a[40:43], v[144:147]
    s_waitcnt lgkmcnt(8)
    v_mfma_f32_16x16x32_bf16 v[160:163], a[176:179], a[40:43], v[160:163]
    ds_read_b64_tr_b16 a[168:169], v19 offset:16384
    v_mfma_f32_16x16x32_bf16 v[160:163], a[180:183], a[44:47], v[160:163]
    ds_read_b64_tr_b16 a[170:171], v19 offset:16896
    s_add_u32 s33, s68, 3145728
    v_mfma_f32_16x16x32_bf16 v[164:167], a[180:183], a[52:55], v[164:167]
    buffer_load_dword a253, v5, s[64:67], s33 offen
    v_mfma_f32_16x16x32_bf16 v[164:167], a[176:179], a[48:51], v[164:167]
    v_mfma_f32_16x16x32_bf16 v[168:171], a[176:179], a[56:59], v[168:171]
    ds_read_b64_tr_b16 a[172:173], v19 offset:20480
    v_mfma_f32_16x16x32_bf16 v[168:171], a[180:183], a[60:63], v[168:171]
    ds_read_b64_tr_b16 a[174:175], v19 offset:20992
    s_add_u32 s48, s75, 32768
    v_mfma_f32_16x16x32_bf16 v[172:175], a[180:183], a[68:71], v[172:175]
    buffer_load_dwordx4 a[236:239], v30, s[40:43], s48 offen nt
    v_mfma_f32_16x16x32_bf16 v[172:175], a[176:179], a[64:67], v[172:175]
    s_waitcnt lgkmcnt(8)
    v_mfma_f32_16x16x32_bf16 v[188:191], a[184:187], a[64:67], v[188:191]
    ds_read_b64_tr_b16 a[176:177], v24 offset:24576
    v_mfma_f32_16x16x32_bf16 v[188:191], a[188:191], a[68:71], v[188:191]
    ds_read_b64_tr_b16 a[178:179], v24 offset:24832
    v_mfma_f32_16x16x32_bf16 v[184:187], a[188:191], a[60:63], v[184:187]
    v_mfma_f32_16x16x32_bf16 v[184:187], a[184:187], a[56:59], v[184:187]
    v_mfma_f32_16x16x32_bf16 v[180:183], a[184:187], a[48:51], v[180:183]
    ds_read_b64_tr_b16 a[180:181], v24 offset:26624
    v_mfma_f32_16x16x32_bf16 v[180:183], a[188:191], a[52:55], v[180:183]
    ds_read_b64_tr_b16 a[182:183], v24 offset:26880
    v_mfma_f32_16x16x32_bf16 v[176:179], a[188:191], a[44:47], v[176:179]
    v_mfma_f32_16x16x32_bf16 v[176:179], a[184:187], a[40:43], v[176:179]
    s_waitcnt lgkmcnt(8)
    v_mfma_f32_16x16x32_bf16 v[192:195], a[160:163], a[40:43], v[192:195]
    ds_read_b64_tr_b16 a[184:185], v25 offset:24576
    v_mfma_f32_16x16x32_bf16 v[192:195], a[164:167], a[44:47], v[192:195]
    ds_read_b64_tr_b16 a[186:187], v25 offset:24832
    v_mfma_f32_16x16x32_bf16 v[196:199], a[164:167], a[52:55], v[196:199]
    v_mfma_f32_16x16x32_bf16 v[196:199], a[160:163], a[48:51], v[196:199]
    v_mfma_f32_16x16x32_bf16 v[200:203], a[160:163], a[56:59], v[200:203]
    ds_read_b64_tr_b16 a[188:189], v25 offset:26624
    v_mfma_f32_16x16x32_bf16 v[200:203], a[164:167], a[60:63], v[200:203]
    ds_read_b64_tr_b16 a[190:191], v25 offset:26880
    v_mfma_f32_16x16x32_bf16 v[204:207], a[164:167], a[68:71], v[204:207]
    v_mfma_f32_16x16x32_bf16 v[204:207], a[160:163], a[64:67], v[204:207]
    s_waitcnt lgkmcnt(8)
    v_mfma_f32_16x16x32_bf16 v[220:223], a[168:171], a[64:67], v[220:223]
    s_waitcnt vmcnt(21)
    s_barrier
    ds_read_b64_tr_b16 a[160:161], v16 offset:28672
    v_mfma_f32_16x16x32_bf16 v[220:223], a[172:175], a[68:71], v[220:223]
    ds_read_b64_tr_b16 a[162:163], v16 offset:29184
    v_mfma_f32_16x16x32_bf16 v[216:219], a[172:175], a[60:63], v[216:219]
    v_mfma_f32_16x16x32_bf16 v[216:219], a[168:171], a[56:59], v[216:219]
    v_mfma_f32_16x16x32_bf16 v[212:215], a[168:171], a[48:51], v[212:215]
    ds_read_b64_tr_b16 a[164:165], v16 offset:32768
    v_mfma_f32_16x16x32_bf16 v[212:215], a[172:175], a[52:55], v[212:215]
    ds_read_b64_tr_b16 a[166:167], v16 offset:33280
    v_mfma_f32_16x16x32_bf16 v[208:211], a[172:175], a[44:47], v[208:211]
    v_mfma_f32_16x16x32_bf16 v[208:211], a[168:171], a[40:43], v[208:211]
    s_waitcnt lgkmcnt(8)
    v_mfma_f32_16x16x32_bf16 v[224:227], a[176:179], a[40:43], v[224:227]
    ds_read_b64_tr_b16 a[168:169], v17 offset:28672
    v_mfma_f32_16x16x32_bf16 v[224:227], a[180:183], a[44:47], v[224:227]
    ds_read_b64_tr_b16 a[170:171], v17 offset:29184
    v_mfma_f32_16x16x32_bf16 v[228:231], a[180:183], a[52:55], v[228:231]
    v_mfma_f32_16x16x32_bf16 v[228:231], a[176:179], a[48:51], v[228:231]
    v_mfma_f32_16x16x32_bf16 v[232:235], a[176:179], a[56:59], v[232:235]
    ds_read_b64_tr_b16 a[172:173], v17 offset:32768
    v_mfma_f32_16x16x32_bf16 v[232:235], a[180:183], a[60:63], v[232:235]
    ds_read_b64_tr_b16 a[174:175], v17 offset:33280
    v_mfma_f32_16x16x32_bf16 v[236:239], a[180:183], a[68:71], v[236:239]
    v_mfma_f32_16x16x32_bf16 v[236:239], a[176:179], a[64:67], v[236:239]
    s_waitcnt lgkmcnt(8)
    v_mfma_f32_16x16x32_bf16 v[252:255], a[184:187], a[64:67], v[252:255]
    ds_read_b64_tr_b16 a[176:177], v18 offset:28672
    v_mfma_f32_16x16x32_bf16 v[252:255], a[188:191], a[68:71], v[252:255]
    ds_read_b64_tr_b16 a[178:179], v18 offset:29184
    v_mfma_f32_16x16x32_bf16 v[248:251], a[188:191], a[60:63], v[248:251]
    v_mfma_f32_16x16x32_bf16 v[248:251], a[184:187], a[56:59], v[248:251]
    v_mfma_f32_16x16x32_bf16 v[244:247], a[184:187], a[48:51], v[244:247]
    ds_read_b64_tr_b16 a[180:181], v18 offset:32768
    v_mfma_f32_16x16x32_bf16 v[244:247], a[188:191], a[52:55], v[244:247]
    ds_read_b64_tr_b16 a[182:183], v18 offset:33280
    v_mfma_f32_16x16x32_bf16 v[240:243], a[188:191], a[44:47], v[240:243]
    v_mfma_f32_16x16x32_bf16 v[240:243], a[184:187], a[40:43], v[240:243]
    s_waitcnt lgkmcnt(8)
    v_mfma_f32_16x16x32_bf16 v[32:35], a[160:163], a[80:83], v[32:35]
    ds_read_b64_tr_b16 a[184:185], v19 offset:28672
    v_mfma_f32_16x16x32_bf16 v[32:35], a[164:167], a[84:87], v[32:35]
    ds_read_b64_tr_b16 a[186:187], v19 offset:29184
    s_mov_b32 s24, 2097152
    v_mfma_f32_16x16x32_bf16 v[36:39], a[164:167], a[92:95], v[36:39]
    buffer_load_dwordx4 a[0:3], v8, s[8:11], s24 offen offset:0 sc1
    v_mfma_f32_16x16x32_bf16 v[36:39], a[160:163], a[88:91], v[36:39]
    v_mfma_f32_16x16x32_bf16 v[40:43], a[160:163], a[96:99], v[40:43]
    ds_read_b64_tr_b16 a[188:189], v19 offset:32768
    v_mfma_f32_16x16x32_bf16 v[40:43], a[164:167], a[100:103], v[40:43]
    ds_read_b64_tr_b16 a[190:191], v19 offset:33280
    v_mfma_f32_16x16x32_bf16 v[44:47], a[164:167], a[108:111], v[44:47]
    buffer_load_dwordx4 a[4:7], v8, s[8:11], s24 offen offset:1024 sc1
    v_mfma_f32_16x16x32_bf16 v[44:47], a[160:163], a[104:107], v[44:47]
    s_waitcnt lgkmcnt(8)
    v_mfma_f32_16x16x32_bf16 v[60:63], a[168:171], a[104:107], v[60:63]
    ds_read_b64_tr_b16 a[160:161], v16 offset:36864
    v_mfma_f32_16x16x32_bf16 v[60:63], a[172:175], a[108:111], v[60:63]
    ds_read_b64_tr_b16 a[162:163], v16 offset:37376
    v_mfma_f32_16x16x32_bf16 v[56:59], a[172:175], a[100:103], v[56:59]
    buffer_load_dwordx4 a[8:11], v8, s[8:11], s24 offen offset:2048 sc1
    v_mfma_f32_16x16x32_bf16 v[56:59], a[168:171], a[96:99], v[56:59]
    v_mfma_f32_16x16x32_bf16 v[52:55], a[168:171], a[88:91], v[52:55]
    ds_read_b64_tr_b16 a[164:165], v16 offset:40960
    v_mfma_f32_16x16x32_bf16 v[52:55], a[172:175], a[92:95], v[52:55]
    ds_read_b64_tr_b16 a[166:167], v16 offset:41472
    v_mfma_f32_16x16x32_bf16 v[48:51], a[172:175], a[84:87], v[48:51]
    buffer_load_dwordx4 a[12:15], v8, s[8:11], s24 offen offset:3072 sc1
    v_mfma_f32_16x16x32_bf16 v[48:51], a[168:171], a[80:83], v[48:51]
    s_waitcnt lgkmcnt(8)
    v_mfma_f32_16x16x32_bf16 v[64:67], a[176:179], a[80:83], v[64:67]
    ds_read_b64_tr_b16 a[168:169], v17 offset:36864
    v_mfma_f32_16x16x32_bf16 v[64:67], a[180:183], a[84:87], v[64:67]
    ds_read_b64_tr_b16 a[170:171], v17 offset:37376
    v_mfma_f32_16x16x32_bf16 v[68:71], a[180:183], a[92:95], v[68:71]
    buffer_load_dwordx4 a[16:19], v9, s[8:11], s24 offen offset:0 sc1
    v_mfma_f32_16x16x32_bf16 v[68:71], a[176:179], a[88:91], v[68:71]
    v_mfma_f32_16x16x32_bf16 v[72:75], a[176:179], a[96:99], v[72:75]
    ds_read_b64_tr_b16 a[172:173], v17 offset:40960
    v_mfma_f32_16x16x32_bf16 v[72:75], a[180:183], a[100:103], v[72:75]
    ds_read_b64_tr_b16 a[174:175], v17 offset:41472
    v_mfma_f32_16x16x32_bf16 v[76:79], a[180:183], a[108:111], v[76:79]
    buffer_load_dwordx4 a[20:23], v9, s[8:11], s24 offen offset:1024 sc1
    v_mfma_f32_16x16x32_bf16 v[76:79], a[176:179], a[104:107], v[76:79]
    s_waitcnt lgkmcnt(8)
    v_mfma_f32_16x16x32_bf16 v[92:95], a[184:187], a[104:107], v[92:95]
    ds_read_b64_tr_b16 a[176:177], v18 offset:36864
    v_mfma_f32_16x16x32_bf16 v[92:95], a[188:191], a[108:111], v[92:95]
    ds_read_b64_tr_b16 a[178:179], v18 offset:37376
    v_mfma_f32_16x16x32_bf16 v[88:91], a[188:191], a[100:103], v[88:91]
    buffer_load_dwordx4 a[24:27], v9, s[8:11], s24 offen offset:2048 sc1
    v_mfma_f32_16x16x32_bf16 v[88:91], a[184:187], a[96:99], v[88:91]
    v_mfma_f32_16x16x32_bf16 v[84:87], a[184:187], a[88:91], v[84:87]
    ds_read_b64_tr_b16 a[180:181], v18 offset:40960
    v_mfma_f32_16x16x32_bf16 v[84:87], a[188:191], a[92:95], v[84:87]
    ds_read_b64_tr_b16 a[182:183], v18 offset:41472
    v_mfma_f32_16x16x32_bf16 v[80:83], a[188:191], a[84:87], v[80:83]
    buffer_load_dwordx4 a[28:31], v9, s[8:11], s24 offen offset:3072 sc1
    v_mfma_f32_16x16x32_bf16 v[80:83], a[184:187], a[80:83], v[80:83]
    s_waitcnt lgkmcnt(8)
    v_mfma_f32_16x16x32_bf16 v[96:99], a[160:163], a[80:83], v[96:99]
    ds_read_b64_tr_b16 a[184:185], v19 offset:36864
    v_mfma_f32_16x16x32_bf16 v[96:99], a[164:167], a[84:87], v[96:99]
    ds_read_b64_tr_b16 a[186:187], v19 offset:37376
    s_add_u32 s25, s52, 3670016
    s_add_u32 s26, s53, 3670016
    s_add_u32 s27, s54, 3670016
    s_add_u32 s28, s55, 3670016
    s_add_u32 m0, s29, 86016
    v_mfma_f32_16x16x32_bf16 v[100:103], a[164:167], a[92:95], v[100:103]
    buffer_load_dwordx4 v13, s[12:15], s25 offen  lds
    v_mfma_f32_16x16x32_bf16 v[100:103], a[160:163], a[88:91], v[100:103]
    v_mfma_f32_16x16x32_bf16 v[104:107], a[160:163], a[96:99], v[104:107]
    ds_read_b64_tr_b16 a[188:189], v19 offset:40960
    v_mfma_f32_16x16x32_bf16 v[104:107], a[164:167], a[100:103], v[104:107]
    ds_read_b64_tr_b16 a[190:191], v19 offset:41472
    s_add_u32 m0, s29, 87040
    v_mfma_f32_16x16x32_bf16 v[108:111], a[164:167], a[108:111], v[108:111]
    buffer_load_dwordx4 v14, s[12:15], s25 offen  lds
    v_mfma_f32_16x16x32_bf16 v[108:111], a[160:163], a[104:107], v[108:111]
    s_waitcnt lgkmcnt(8)
    v_mfma_f32_16x16x32_bf16 v[124:127], a[168:171], a[104:107], v[124:127]
    ds_read_b64_tr_b16 a[160:161], v16 offset:45056
    v_mfma_f32_16x16x32_bf16 v[124:127], a[172:175], a[108:111], v[124:127]
    ds_read_b64_tr_b16 a[162:163], v16 offset:45568
    s_add_u32 m0, s29, 94208
    v_mfma_f32_16x16x32_bf16 v[120:123], a[172:175], a[100:103], v[120:123]
    buffer_load_dwordx4 v13, s[12:15], s26 offen  lds
    v_mfma_f32_16x16x32_bf16 v[120:123], a[168:171], a[96:99], v[120:123]
    v_mfma_f32_16x16x32_bf16 v[116:119], a[168:171], a[88:91], v[116:119]
    ds_read_b64_tr_b16 a[164:165], v16 offset:49152
    v_mfma_f32_16x16x32_bf16 v[116:119], a[172:175], a[92:95], v[116:119]
    ds_read_b64_tr_b16 a[166:167], v16 offset:49664
    s_add_u32 m0, s29, 95232
    v_mfma_f32_16x16x32_bf16 v[112:115], a[172:175], a[84:87], v[112:115]
    buffer_load_dwordx4 v14, s[12:15], s26 offen  lds
    v_mfma_f32_16x16x32_bf16 v[112:115], a[168:171], a[80:83], v[112:115]
    s_waitcnt lgkmcnt(8)
    v_mfma_f32_16x16x32_bf16 v[128:131], a[176:179], a[80:83], v[128:131]
    ds_read_b64_tr_b16 a[168:169], v17 offset:45056
    v_mfma_f32_16x16x32_bf16 v[128:131], a[180:183], a[84:87], v[128:131]
    ds_read_b64_tr_b16 a[170:171], v17 offset:45568
    s_add_u32 m0, s29, 102400
    v_mfma_f32_16x16x32_bf16 v[132:135], a[180:183], a[92:95], v[132:135]
    buffer_load_dwordx4 v13, s[12:15], s27 offen  lds
    v_mfma_f32_16x16x32_bf16 v[132:135], a[176:179], a[88:91], v[132:135]
    v_mfma_f32_16x16x32_bf16 v[136:139], a[176:179], a[96:99], v[136:139]
    ds_read_b64_tr_b16 a[172:173], v17 offset:49152
    v_mfma_f32_16x16x32_bf16 v[136:139], a[180:183], a[100:103], v[136:139]
    ds_read_b64_tr_b16 a[174:175], v17 offset:49664
    s_add_u32 m0, s29, 103424
    v_mfma_f32_16x16x32_bf16 v[140:143], a[180:183], a[108:111], v[140:143]
    buffer_load_dwordx4 v14, s[12:15], s27 offen  lds
    v_mfma_f32_16x16x32_bf16 v[140:143], a[176:179], a[104:107], v[140:143]
    s_waitcnt lgkmcnt(8)
    v_mfma_f32_16x16x32_bf16 v[156:159], a[184:187], a[104:107], v[156:159]
    ds_read_b64_tr_b16 a[176:177], v18 offset:45056
    v_mfma_f32_16x16x32_bf16 v[156:159], a[188:191], a[108:111], v[156:159]
    ds_read_b64_tr_b16 a[178:179], v18 offset:45568
    s_add_u32 m0, s30, 86016
    v_mfma_f32_16x16x32_bf16 v[152:155], a[188:191], a[100:103], v[152:155]
    buffer_load_dwordx4 v15, s[12:15], s28 offen  lds
    v_mfma_f32_16x16x32_bf16 v[152:155], a[184:187], a[96:99], v[152:155]
    v_mfma_f32_16x16x32_bf16 v[148:151], a[184:187], a[88:91], v[148:151]
    ds_read_b64_tr_b16 a[180:181], v18 offset:49152
    v_mfma_f32_16x16x32_bf16 v[148:151], a[188:191], a[92:95], v[148:151]
    ds_read_b64_tr_b16 a[182:183], v18 offset:49664
    s_add_u32 s33, s56, 4587520
    v_mfma_f32_16x16x32_bf16 v[144:147], a[188:191], a[84:87], v[144:147]
    buffer_load_dword a252, v11, s[12:15], s33 offen
    v_mfma_f32_16x16x32_bf16 v[144:147], a[184:187], a[80:83], v[144:147]
    s_waitcnt lgkmcnt(8)
    v_mfma_f32_16x16x32_bf16 v[160:163], a[160:163], a[80:83], v[160:163]
    ds_read_b64_tr_b16 a[184:185], v19 offset:45056
    v_mfma_f32_16x16x32_bf16 v[160:163], a[164:167], a[84:87], v[160:163]
    ds_read_b64_tr_b16 a[186:187], v19 offset:45568
    s_add_u32 s33, s68, 3670016
    v_mfma_f32_16x16x32_bf16 v[164:167], a[164:167], a[92:95], v[164:167]
    buffer_load_dword a253, v5, s[64:67], s33 offen
    v_mfma_f32_16x16x32_bf16 v[164:167], a[160:163], a[88:91], v[164:167]
    v_mfma_f32_16x16x32_bf16 v[168:171], a[160:163], a[96:99], v[168:171]
    ds_read_b64_tr_b16 a[188:189], v19 offset:49152
    v_mfma_f32_16x16x32_bf16 v[168:171], a[164:167], a[100:103], v[168:171]
    ds_read_b64_tr_b16 a[190:191], v19 offset:49664
    s_add_u32 s33, s68, 4194304
    v_mfma_f32_16x16x32_bf16 v[172:175], a[164:167], a[108:111], v[172:175]
    buffer_load_dword a253, v5, s[64:67], s33 offen
    v_mfma_f32_16x16x32_bf16 v[172:175], a[160:163], a[104:107], v[172:175]
    s_waitcnt lgkmcnt(8)
    v_mfma_f32_16x16x32_bf16 v[188:191], a[168:171], a[104:107], v[188:191]
    ds_read_b64_tr_b16 a[160:161], v24 offset:53248
    v_mfma_f32_16x16x32_bf16 v[188:191], a[172:175], a[108:111], v[188:191]
    ds_read_b64_tr_b16 a[162:163], v24 offset:53504
    v_mfma_f32_16x16x32_bf16 v[184:187], a[172:175], a[100:103], v[184:187]
    v_mfma_f32_16x16x32_bf16 v[184:187], a[168:171], a[96:99], v[184:187]
    v_mfma_f32_16x16x32_bf16 v[180:183], a[168:171], a[88:91], v[180:183]
    ds_read_b64_tr_b16 a[164:165], v24 offset:55296
    v_mfma_f32_16x16x32_bf16 v[180:183], a[172:175], a[92:95], v[180:183]
    ds_read_b64_tr_b16 a[166:167], v24 offset:55552
    v_mfma_f32_16x16x32_bf16 v[176:179], a[172:175], a[84:87], v[176:179]
    v_mfma_f32_16x16x32_bf16 v[176:179], a[168:171], a[80:83], v[176:179]
    s_waitcnt lgkmcnt(8)
    v_mfma_f32_16x16x32_bf16 v[192:195], a[176:179], a[80:83], v[192:195]
    ds_read_b64_tr_b16 a[168:169], v25 offset:53248
    v_mfma_f32_16x16x32_bf16 v[192:195], a[180:183], a[84:87], v[192:195]
    ds_read_b64_tr_b16 a[170:171], v25 offset:53504
    v_mfma_f32_16x16x32_bf16 v[196:199], a[180:183], a[92:95], v[196:199]
    v_mfma_f32_16x16x32_bf16 v[196:199], a[176:179], a[88:91], v[196:199]
    v_mfma_f32_16x16x32_bf16 v[200:203], a[176:179], a[96:99], v[200:203]
    ds_read_b64_tr_b16 a[172:173], v25 offset:55296
    v_mfma_f32_16x16x32_bf16 v[200:203], a[180:183], a[100:103], v[200:203]
    ds_read_b64_tr_b16 a[174:175], v25 offset:55552
    v_mfma_f32_16x16x32_bf16 v[204:207], a[180:183], a[108:111], v[204:207]
    v_mfma_f32_16x16x32_bf16 v[204:207], a[176:179], a[104:107], v[204:207]
    s_waitcnt lgkmcnt(8)
    v_mfma_f32_16x16x32_bf16 v[220:223], a[184:187], a[104:107], v[220:223]
    s_waitcnt vmcnt(21)
    s_barrier
    ds_read_b64_tr_b16 a[176:177], v2 offset:0
    v_mfma_f32_16x16x32_bf16 v[220:223], a[188:191], a[108:111], v[220:223]
    ds_read_b64_tr_b16 a[178:179], v2 offset:512
    v_mfma_f32_16x16x32_bf16 v[216:219], a[188:191], a[100:103], v[216:219]
    v_mfma_f32_16x16x32_bf16 v[216:219], a[184:187], a[96:99], v[216:219]
    v_mfma_f32_16x16x32_bf16 v[212:215], a[184:187], a[88:91], v[212:215]
    ds_read_b64_tr_b16 a[180:181], v2 offset:4096
    v_mfma_f32_16x16x32_bf16 v[212:215], a[188:191], a[92:95], v[212:215]
    ds_read_b64_tr_b16 a[182:183], v2 offset:4608
    v_mfma_f32_16x16x32_bf16 v[208:211], a[188:191], a[84:87], v[208:211]
    v_mfma_f32_16x16x32_bf16 v[208:211], a[184:187], a[80:83], v[208:211]
    s_waitcnt lgkmcnt(8)
    v_mfma_f32_16x16x32_bf16 v[224:227], a[160:163], a[80:83], v[224:227]
    ds_read_b64_tr_b16 a[184:185], v3 offset:0
    v_mfma_f32_16x16x32_bf16 v[224:227], a[164:167], a[84:87], v[224:227]
    ds_read_b64_tr_b16 a[186:187], v3 offset:512
    v_mfma_f32_16x16x32_bf16 v[228:231], a[164:167], a[92:95], v[228:231]
    v_mfma_f32_16x16x32_bf16 v[228:231], a[160:163], a[88:91], v[228:231]
    v_mfma_f32_16x16x32_bf16 v[232:235], a[160:163], a[96:99], v[232:235]
    ds_read_b64_tr_b16 a[188:189], v3 offset:4096
    v_mfma_f32_16x16x32_bf16 v[232:235], a[164:167], a[100:103], v[232:235]
    ds_read_b64_tr_b16 a[190:191], v3 offset:4608
    v_mfma_f32_16x16x32_bf16 v[236:239], a[164:167], a[108:111], v[236:239]
    v_mfma_f32_16x16x32_bf16 v[236:239], a[160:163], a[104:107], v[236:239]
    s_waitcnt lgkmcnt(8)
    v_mfma_f32_16x16x32_bf16 v[252:255], a[168:171], a[104:107], v[252:255]
    ds_read_b64_tr_b16 a[160:161], v4 offset:0
    v_mfma_f32_16x16x32_bf16 v[252:255], a[172:175], a[108:111], v[252:255]
    ds_read_b64_tr_b16 a[162:163], v4 offset:512
    v_mfma_f32_16x16x32_bf16 v[248:251], a[172:175], a[100:103], v[248:251]
    v_mfma_f32_16x16x32_bf16 v[248:251], a[168:171], a[96:99], v[248:251]
    v_mfma_f32_16x16x32_bf16 v[244:247], a[168:171], a[88:91], v[244:247]
    ds_read_b64_tr_b16 a[164:165], v4 offset:4096
    v_mfma_f32_16x16x32_bf16 v[244:247], a[172:175], a[92:95], v[244:247]
    ds_read_b64_tr_b16 a[166:167], v4 offset:4608
    v_mfma_f32_16x16x32_bf16 v[240:243], a[172:175], a[84:87], v[240:243]
    v_mfma_f32_16x16x32_bf16 v[240:243], a[168:171], a[80:83], v[240:243]
    s_waitcnt lgkmcnt(8)
    v_mfma_f32_16x16x32_bf16 v[32:35], a[176:179], a[120:123], v[32:35]
    ds_read_b64_tr_b16 a[168:169], v10 offset:0
    v_mfma_f32_16x16x32_bf16 v[32:35], a[180:183], a[124:127], v[32:35]
    ds_read_b64_tr_b16 a[170:171], v10 offset:512
    s_mov_b32 s24, 2359296
    v_mfma_f32_16x16x32_bf16 v[36:39], a[180:183], a[132:135], v[36:39]
    buffer_load_dwordx4 a[40:43], v8, s[8:11], s24 offen offset:0 sc1
    v_mfma_f32_16x16x32_bf16 v[36:39], a[176:179], a[128:131], v[36:39]
    v_mfma_f32_16x16x32_bf16 v[40:43], a[176:179], a[136:139], v[40:43]
    ds_read_b64_tr_b16 a[172:173], v10 offset:4096
    v_mfma_f32_16x16x32_bf16 v[40:43], a[180:183], a[140:143], v[40:43]
    ds_read_b64_tr_b16 a[174:175], v10 offset:4608
    v_mfma_f32_16x16x32_bf16 v[44:47], a[180:183], a[148:151], v[44:47]
    buffer_load_dwordx4 a[44:47], v8, s[8:11], s24 offen offset:1024 sc1
    v_mfma_f32_16x16x32_bf16 v[44:47], a[176:179], a[144:147], v[44:47]
    s_waitcnt lgkmcnt(8)
    v_mfma_f32_16x16x32_bf16 v[60:63], a[184:187], a[144:147], v[60:63]
    ds_read_b64_tr_b16 a[176:177], v2 offset:8192
    v_mfma_f32_16x16x32_bf16 v[60:63], a[188:191], a[148:151], v[60:63]
    ds_read_b64_tr_b16 a[178:179], v2 offset:8704
    v_mfma_f32_16x16x32_bf16 v[56:59], a[188:191], a[140:143], v[56:59]
    buffer_load_dwordx4 a[48:51], v8, s[8:11], s24 offen offset:2048 sc1
    v_mfma_f32_16x16x32_bf16 v[56:59], a[184:187], a[136:139], v[56:59]
    v_mfma_f32_16x16x32_bf16 v[52:55], a[184:187], a[128:131], v[52:55]
    ds_read_b64_tr_b16 a[180:181], v2 offset:12288
    v_mfma_f32_16x16x32_bf16 v[52:55], a[188:191], a[132:135], v[52:55]
    ds_read_b64_tr_b16 a[182:183], v2 offset:12800
    v_mfma_f32_16x16x32_bf16 v[48:51], a[188:191], a[124:127], v[48:51]
    buffer_load_dwordx4 a[52:55], v8, s[8:11], s24 offen offset:3072 sc1
    v_mfma_f32_16x16x32_bf16 v[48:51], a[184:187], a[120:123], v[48:51]
    s_waitcnt lgkmcnt(8)
    v_mfma_f32_16x16x32_bf16 v[64:67], a[160:163], a[120:123], v[64:67]
    ds_read_b64_tr_b16 a[184:185], v3 offset:8192
    v_mfma_f32_16x16x32_bf16 v[64:67], a[164:167], a[124:127], v[64:67]
    ds_read_b64_tr_b16 a[186:187], v3 offset:8704
    v_mfma_f32_16x16x32_bf16 v[68:71], a[164:167], a[132:135], v[68:71]
    buffer_load_dwordx4 a[56:59], v9, s[8:11], s24 offen offset:0 sc1
    v_mfma_f32_16x16x32_bf16 v[68:71], a[160:163], a[128:131], v[68:71]
    v_mfma_f32_16x16x32_bf16 v[72:75], a[160:163], a[136:139], v[72:75]
    ds_read_b64_tr_b16 a[188:189], v3 offset:12288
    v_mfma_f32_16x16x32_bf16 v[72:75], a[164:167], a[140:143], v[72:75]
    ds_read_b64_tr_b16 a[190:191], v3 offset:12800
    v_mfma_f32_16x16x32_bf16 v[76:79], a[164:167], a[148:151], v[76:79]
    buffer_load_dwordx4 a[60:63], v9, s[8:11], s24 offen offset:1024 sc1
    v_mfma_f32_16x16x32_bf16 v[76:79], a[160:163], a[144:147], v[76:79]
    s_waitcnt lgkmcnt(8)
    v_mfma_f32_16x16x32_bf16 v[92:95], a[168:171], a[144:147], v[92:95]
    ds_read_b64_tr_b16 a[160:161], v4 offset:8192
    v_mfma_f32_16x16x32_bf16 v[92:95], a[172:175], a[148:151], v[92:95]
    ds_read_b64_tr_b16 a[162:163], v4 offset:8704
    v_mfma_f32_16x16x32_bf16 v[88:91], a[172:175], a[140:143], v[88:91]
    buffer_load_dwordx4 a[64:67], v9, s[8:11], s24 offen offset:2048 sc1
    v_mfma_f32_16x16x32_bf16 v[88:91], a[168:171], a[136:139], v[88:91]
    v_mfma_f32_16x16x32_bf16 v[84:87], a[168:171], a[128:131], v[84:87]
    ds_read_b64_tr_b16 a[164:165], v4 offset:12288
    v_mfma_f32_16x16x32_bf16 v[84:87], a[172:175], a[132:135], v[84:87]
    ds_read_b64_tr_b16 a[166:167], v4 offset:12800
    v_mfma_f32_16x16x32_bf16 v[80:83], a[172:175], a[124:127], v[80:83]
    buffer_load_dwordx4 a[68:71], v9, s[8:11], s24 offen offset:3072 sc1
    v_mfma_f32_16x16x32_bf16 v[80:83], a[168:171], a[120:123], v[80:83]
    s_waitcnt lgkmcnt(8)
    v_mfma_f32_16x16x32_bf16 v[96:99], a[176:179], a[120:123], v[96:99]
    ds_read_b64_tr_b16 a[168:169], v10 offset:8192
    v_mfma_f32_16x16x32_bf16 v[96:99], a[180:183], a[124:127], v[96:99]
    ds_read_b64_tr_b16 a[170:171], v10 offset:8704
    s_add_u32 s25, s52, 4128768
    s_add_u32 s26, s53, 4128768
    s_add_u32 s27, s54, 4128768
    s_add_u32 s28, s55, 4128768
    s_add_u32 m0, s29, 0
    v_mfma_f32_16x16x32_bf16 v[100:103], a[180:183], a[132:135], v[100:103]
    buffer_load_dwordx4 v13, s[12:15], s25 offen  lds
    v_mfma_f32_16x16x32_bf16 v[100:103], a[176:179], a[128:131], v[100:103]
    v_mfma_f32_16x16x32_bf16 v[104:107], a[176:179], a[136:139], v[104:107]
    ds_read_b64_tr_b16 a[172:173], v10 offset:12288
    v_mfma_f32_16x16x32_bf16 v[104:107], a[180:183], a[140:143], v[104:107]
    ds_read_b64_tr_b16 a[174:175], v10 offset:12800
    s_add_u32 m0, s29, 1024
    v_mfma_f32_16x16x32_bf16 v[108:111], a[180:183], a[148:151], v[108:111]
    buffer_load_dwordx4 v14, s[12:15], s25 offen  lds
    v_mfma_f32_16x16x32_bf16 v[108:111], a[176:179], a[144:147], v[108:111]
    s_waitcnt lgkmcnt(8)
    v_mfma_f32_16x16x32_bf16 v[124:127], a[184:187], a[144:147], v[124:127]
    ds_read_b64_tr_b16 a[176:177], v2 offset:16384
    v_mfma_f32_16x16x32_bf16 v[124:127], a[188:191], a[148:151], v[124:127]
    ds_read_b64_tr_b16 a[178:179], v2 offset:16896
    s_add_u32 m0, s29, 8192
    v_mfma_f32_16x16x32_bf16 v[120:123], a[188:191], a[140:143], v[120:123]
    buffer_load_dwordx4 v13, s[12:15], s26 offen  lds
    v_mfma_f32_16x16x32_bf16 v[120:123], a[184:187], a[136:139], v[120:123]
    v_mfma_f32_16x16x32_bf16 v[116:119], a[184:187], a[128:131], v[116:119]
    ds_read_b64_tr_b16 a[180:181], v2 offset:20480
    v_mfma_f32_16x16x32_bf16 v[116:119], a[188:191], a[132:135], v[116:119]
    ds_read_b64_tr_b16 a[182:183], v2 offset:20992
    s_add_u32 m0, s29, 9216
    v_mfma_f32_16x16x32_bf16 v[112:115], a[188:191], a[124:127], v[112:115]
    buffer_load_dwordx4 v14, s[12:15], s26 offen  lds
    v_mfma_f32_16x16x32_bf16 v[112:115], a[184:187], a[120:123], v[112:115]
    s_waitcnt lgkmcnt(8)
    v_mfma_f32_16x16x32_bf16 v[128:131], a[160:163], a[120:123], v[128:131]
    ds_read_b64_tr_b16 a[184:185], v3 offset:16384
    v_mfma_f32_16x16x32_bf16 v[128:131], a[164:167], a[124:127], v[128:131]
    ds_read_b64_tr_b16 a[186:187], v3 offset:16896
    s_add_u32 m0, s29, 16384
    v_mfma_f32_16x16x32_bf16 v[132:135], a[164:167], a[132:135], v[132:135]
    buffer_load_dwordx4 v13, s[12:15], s27 offen  lds
    v_mfma_f32_16x16x32_bf16 v[132:135], a[160:163], a[128:131], v[132:135]
    v_mfma_f32_16x16x32_bf16 v[136:139], a[160:163], a[136:139], v[136:139]
    ds_read_b64_tr_b16 a[188:189], v3 offset:20480
    v_mfma_f32_16x16x32_bf16 v[136:139], a[164:167], a[140:143], v[136:139]
    ds_read_b64_tr_b16 a[190:191], v3 offset:20992
    s_add_u32 m0, s29, 17408
    v_mfma_f32_16x16x32_bf16 v[140:143], a[164:167], a[148:151], v[140:143]
    buffer_load_dwordx4 v14, s[12:15], s27 offen  lds
    v_mfma_f32_16x16x32_bf16 v[140:143], a[160:163], a[144:147], v[140:143]
    s_waitcnt lgkmcnt(8)
    v_mfma_f32_16x16x32_bf16 v[156:159], a[168:171], a[144:147], v[156:159]
    ds_read_b64_tr_b16 a[160:161], v4 offset:16384
    v_mfma_f32_16x16x32_bf16 v[156:159], a[172:175], a[148:151], v[156:159]
    ds_read_b64_tr_b16 a[162:163], v4 offset:16896
    s_add_u32 m0, s30, 0
    v_mfma_f32_16x16x32_bf16 v[152:155], a[172:175], a[140:143], v[152:155]
    buffer_load_dwordx4 v15, s[12:15], s28 offen  lds
    v_mfma_f32_16x16x32_bf16 v[152:155], a[168:171], a[136:139], v[152:155]
    v_mfma_f32_16x16x32_bf16 v[148:151], a[168:171], a[128:131], v[148:151]
    ds_read_b64_tr_b16 a[164:165], v4 offset:20480
    v_mfma_f32_16x16x32_bf16 v[148:151], a[172:175], a[132:135], v[148:151]
    ds_read_b64_tr_b16 a[166:167], v4 offset:20992
    s_add_u32 s33, s56, 5046272
    v_mfma_f32_16x16x32_bf16 v[144:147], a[172:175], a[124:127], v[144:147]
    buffer_load_dword a252, v11, s[12:15], s33 offen
    v_mfma_f32_16x16x32_bf16 v[144:147], a[168:171], a[120:123], v[144:147]
    s_waitcnt lgkmcnt(8)
    v_mfma_f32_16x16x32_bf16 v[160:163], a[176:179], a[120:123], v[160:163]
    ds_read_b64_tr_b16 a[168:169], v10 offset:16384
    v_mfma_f32_16x16x32_bf16 v[160:163], a[180:183], a[124:127], v[160:163]
    ds_read_b64_tr_b16 a[170:171], v10 offset:16896
    s_add_u32 s33, s68, 4718592
    v_mfma_f32_16x16x32_bf16 v[164:167], a[180:183], a[132:135], v[164:167]
    buffer_load_dword a253, v5, s[64:67], s33 offen
    v_mfma_f32_16x16x32_bf16 v[164:167], a[176:179], a[128:131], v[164:167]
    v_mfma_f32_16x16x32_bf16 v[168:171], a[176:179], a[136:139], v[168:171]
    ds_read_b64_tr_b16 a[172:173], v10 offset:20480
    v_mfma_f32_16x16x32_bf16 v[168:171], a[180:183], a[140:143], v[168:171]
    ds_read_b64_tr_b16 a[174:175], v10 offset:20992
    s_add_u32 s48, s75, 65536
    v_mfma_f32_16x16x32_bf16 v[172:175], a[180:183], a[148:151], v[172:175]
    buffer_load_dwordx4 a[240:243], v30, s[40:43], s48 offen nt
    v_mfma_f32_16x16x32_bf16 v[172:175], a[176:179], a[144:147], v[172:175]
    s_waitcnt lgkmcnt(8)
    v_mfma_f32_16x16x32_bf16 v[188:191], a[184:187], a[144:147], v[188:191]
    ds_read_b64_tr_b16 a[176:177], v6 offset:24576
    v_mfma_f32_16x16x32_bf16 v[188:191], a[188:191], a[148:151], v[188:191]
    ds_read_b64_tr_b16 a[178:179], v6 offset:24832
    v_mfma_f32_16x16x32_bf16 v[184:187], a[188:191], a[140:143], v[184:187]
    v_mfma_f32_16x16x32_bf16 v[184:187], a[184:187], a[136:139], v[184:187]
    v_mfma_f32_16x16x32_bf16 v[180:183], a[184:187], a[128:131], v[180:183]
    ds_read_b64_tr_b16 a[180:181], v6 offset:26624
    v_mfma_f32_16x16x32_bf16 v[180:183], a[188:191], a[132:135], v[180:183]
    ds_read_b64_tr_b16 a[182:183], v6 offset:26880
    v_mfma_f32_16x16x32_bf16 v[176:179], a[188:191], a[124:127], v[176:179]
    v_mfma_f32_16x16x32_bf16 v[176:179], a[184:187], a[120:123], v[176:179]
    s_waitcnt lgkmcnt(8)
    v_mfma_f32_16x16x32_bf16 v[192:195], a[160:163], a[120:123], v[192:195]
    ds_read_b64_tr_b16 a[184:185], v7 offset:24576
    v_mfma_f32_16x16x32_bf16 v[192:195], a[164:167], a[124:127], v[192:195]
    ds_read_b64_tr_b16 a[186:187], v7 offset:24832
    v_mfma_f32_16x16x32_bf16 v[196:199], a[164:167], a[132:135], v[196:199]
    v_mfma_f32_16x16x32_bf16 v[196:199], a[160:163], a[128:131], v[196:199]
    v_mfma_f32_16x16x32_bf16 v[200:203], a[160:163], a[136:139], v[200:203]
    ds_read_b64_tr_b16 a[188:189], v7 offset:26624
    v_mfma_f32_16x16x32_bf16 v[200:203], a[164:167], a[140:143], v[200:203]
    ds_read_b64_tr_b16 a[190:191], v7 offset:26880
    v_mfma_f32_16x16x32_bf16 v[204:207], a[164:167], a[148:151], v[204:207]
    v_mfma_f32_16x16x32_bf16 v[204:207], a[160:163], a[144:147], v[204:207]
    s_waitcnt lgkmcnt(8)
    v_mfma_f32_16x16x32_bf16 v[220:223], a[168:171], a[144:147], v[220:223]
    s_waitcnt vmcnt(21)
    s_barrier
    ds_read_b64_tr_b16 a[160:161], v20 offset:28672
    v_mfma_f32_16x16x32_bf16 v[220:223], a[172:175], a[148:151], v[220:223]
    ds_read_b64_tr_b16 a[162:163], v20 offset:29184
    v_mfma_f32_16x16x32_bf16 v[216:219], a[172:175], a[140:143], v[216:219]
    v_mfma_f32_16x16x32_bf16 v[216:219], a[168:171], a[136:139], v[216:219]
    v_mfma_f32_16x16x32_bf16 v[212:215], a[168:171], a[128:131], v[212:215]
    ds_read_b64_tr_b16 a[164:165], v20 offset:32768
    v_mfma_f32_16x16x32_bf16 v[212:215], a[172:175], a[132:135], v[212:215]
    ds_read_b64_tr_b16 a[166:167], v20 offset:33280
    v_mfma_f32_16x16x32_bf16 v[208:211], a[172:175], a[124:127], v[208:211]
    v_mfma_f32_16x16x32_bf16 v[208:211], a[168:171], a[120:123], v[208:211]
    s_waitcnt lgkmcnt(8)
    v_mfma_f32_16x16x32_bf16 v[224:227], a[176:179], a[120:123], v[224:227]
    ds_read_b64_tr_b16 a[168:169], v21 offset:28672
    v_mfma_f32_16x16x32_bf16 v[224:227], a[180:183], a[124:127], v[224:227]
    ds_read_b64_tr_b16 a[170:171], v21 offset:29184
    v_mfma_f32_16x16x32_bf16 v[228:231], a[180:183], a[132:135], v[228:231]
    v_mfma_f32_16x16x32_bf16 v[228:231], a[176:179], a[128:131], v[228:231]
    v_mfma_f32_16x16x32_bf16 v[232:235], a[176:179], a[136:139], v[232:235]
    ds_read_b64_tr_b16 a[172:173], v21 offset:32768
    v_mfma_f32_16x16x32_bf16 v[232:235], a[180:183], a[140:143], v[232:235]
    ds_read_b64_tr_b16 a[174:175], v21 offset:33280
    v_mfma_f32_16x16x32_bf16 v[236:239], a[180:183], a[148:151], v[236:239]
    v_mfma_f32_16x16x32_bf16 v[236:239], a[176:179], a[144:147], v[236:239]
    s_waitcnt lgkmcnt(8)
    v_mfma_f32_16x16x32_bf16 v[252:255], a[184:187], a[144:147], v[252:255]
    ds_read_b64_tr_b16 a[176:177], v22 offset:28672
    v_mfma_f32_16x16x32_bf16 v[252:255], a[188:191], a[148:151], v[252:255]
    ds_read_b64_tr_b16 a[178:179], v22 offset:29184
    v_mfma_f32_16x16x32_bf16 v[248:251], a[188:191], a[140:143], v[248:251]
    v_mfma_f32_16x16x32_bf16 v[248:251], a[184:187], a[136:139], v[248:251]
    v_mfma_f32_16x16x32_bf16 v[244:247], a[184:187], a[128:131], v[244:247]
    ds_read_b64_tr_b16 a[180:181], v22 offset:32768
    v_mfma_f32_16x16x32_bf16 v[244:247], a[188:191], a[132:135], v[244:247]
    ds_read_b64_tr_b16 a[182:183], v22 offset:33280
    v_mfma_f32_16x16x32_bf16 v[240:243], a[188:191], a[124:127], v[240:243]
    v_mfma_f32_16x16x32_bf16 v[240:243], a[184:187], a[120:123], v[240:243]
    s_waitcnt lgkmcnt(8)
    v_mfma_f32_16x16x32_bf16 v[32:35], a[160:163], a[0:3], v[32:35]
    ds_read_b64_tr_b16 a[184:185], v23 offset:28672
    v_mfma_f32_16x16x32_bf16 v[32:35], a[164:167], a[4:7], v[32:35]
    ds_read_b64_tr_b16 a[186:187], v23 offset:29184
    s_mov_b32 s24, 2621440
    v_mfma_f32_16x16x32_bf16 v[36:39], a[164:167], a[12:15], v[36:39]
    buffer_load_dwordx4 a[80:83], v8, s[8:11], s24 offen offset:0 sc1
    v_mfma_f32_16x16x32_bf16 v[36:39], a[160:163], a[8:11], v[36:39]
    v_mfma_f32_16x16x32_bf16 v[40:43], a[160:163], a[16:19], v[40:43]
    ds_read_b64_tr_b16 a[188:189], v23 offset:32768
    v_mfma_f32_16x16x32_bf16 v[40:43], a[164:167], a[20:23], v[40:43]
    ds_read_b64_tr_b16 a[190:191], v23 offset:33280
    v_mfma_f32_16x16x32_bf16 v[44:47], a[164:167], a[28:31], v[44:47]
    buffer_load_dwordx4 a[84:87], v8, s[8:11], s24 offen offset:1024 sc1
    v_mfma_f32_16x16x32_bf16 v[44:47], a[160:163], a[24:27], v[44:47]
    s_waitcnt lgkmcnt(8)
    v_mfma_f32_16x16x32_bf16 v[60:63], a[168:171], a[24:27], v[60:63]
    ds_read_b64_tr_b16 a[160:161], v20 offset:36864
    v_mfma_f32_16x16x32_bf16 v[60:63], a[172:175], a[28:31], v[60:63]
    ds_read_b64_tr_b16 a[162:163], v20 offset:37376
    v_mfma_f32_16x16x32_bf16 v[56:59], a[172:175], a[20:23], v[56:59]
    buffer_load_dwordx4 a[88:91], v8, s[8:11], s24 offen offset:2048 sc1
    v_mfma_f32_16x16x32_bf16 v[56:59], a[168:171], a[16:19], v[56:59]
    v_mfma_f32_16x16x32_bf16 v[52:55], a[168:171], a[8:11], v[52:55]
    ds_read_b64_tr_b16 a[164:165], v20 offset:40960
    v_mfma_f32_16x16x32_bf16 v[52:55], a[172:175], a[12:15], v[52:55]
    ds_read_b64_tr_b16 a[166:167], v20 offset:41472
    v_mfma_f32_16x16x32_bf16 v[48:51], a[172:175], a[4:7], v[48:51]
    buffer_load_dwordx4 a[92:95], v8, s[8:11], s24 offen offset:3072 sc1
    v_mfma_f32_16x16x32_bf16 v[48:51], a[168:171], a[0:3], v[48:51]
    s_waitcnt lgkmcnt(8)
    v_mfma_f32_16x16x32_bf16 v[64:67], a[176:179], a[0:3], v[64:67]
    ds_read_b64_tr_b16 a[168:169], v21 offset:36864
    v_mfma_f32_16x16x32_bf16 v[64:67], a[180:183], a[4:7], v[64:67]
    ds_read_b64_tr_b16 a[170:171], v21 offset:37376
    v_mfma_f32_16x16x32_bf16 v[68:71], a[180:183], a[12:15], v[68:71]
    buffer_load_dwordx4 a[96:99], v9, s[8:11], s24 offen offset:0 sc1
    v_mfma_f32_16x16x32_bf16 v[68:71], a[176:179], a[8:11], v[68:71]
    v_mfma_f32_16x16x32_bf16 v[72:75], a[176:179], a[16:19], v[72:75]
    ds_read_b64_tr_b16 a[172:173], v21 offset:40960
    v_mfma_f32_16x16x32_bf16 v[72:75], a[180:183], a[20:23], v[72:75]
    ds_read_b64_tr_b16 a[174:175], v21 offset:41472
    v_mfma_f32_16x16x32_bf16 v[76:79], a[180:183], a[28:31], v[76:79]
    buffer_load_dwordx4 a[100:103], v9, s[8:11], s24 offen offset:1024 sc1
    v_mfma_f32_16x16x32_bf16 v[76:79], a[176:179], a[24:27], v[76:79]
    s_waitcnt lgkmcnt(8)
    v_mfma_f32_16x16x32_bf16 v[92:95], a[184:187], a[24:27], v[92:95]
    ds_read_b64_tr_b16 a[176:177], v22 offset:36864
    v_mfma_f32_16x16x32_bf16 v[92:95], a[188:191], a[28:31], v[92:95]
    ds_read_b64_tr_b16 a[178:179], v22 offset:37376
    v_mfma_f32_16x16x32_bf16 v[88:91], a[188:191], a[20:23], v[88:91]
    buffer_load_dwordx4 a[104:107], v9, s[8:11], s24 offen offset:2048 sc1
    v_mfma_f32_16x16x32_bf16 v[88:91], a[184:187], a[16:19], v[88:91]
    v_mfma_f32_16x16x32_bf16 v[84:87], a[184:187], a[8:11], v[84:87]
    ds_read_b64_tr_b16 a[180:181], v22 offset:40960
    v_mfma_f32_16x16x32_bf16 v[84:87], a[188:191], a[12:15], v[84:87]
    ds_read_b64_tr_b16 a[182:183], v22 offset:41472
    v_mfma_f32_16x16x32_bf16 v[80:83], a[188:191], a[4:7], v[80:83]
    buffer_load_dwordx4 a[108:111], v9, s[8:11], s24 offen offset:3072 sc1
    v_mfma_f32_16x16x32_bf16 v[80:83], a[184:187], a[0:3], v[80:83]
    s_waitcnt lgkmcnt(8)
    v_mfma_f32_16x16x32_bf16 v[96:99], a[160:163], a[0:3], v[96:99]
    ds_read_b64_tr_b16 a[184:185], v23 offset:36864
    v_mfma_f32_16x16x32_bf16 v[96:99], a[164:167], a[4:7], v[96:99]
    ds_read_b64_tr_b16 a[186:187], v23 offset:37376
    s_add_u32 s25, s52, 4587520
    s_add_u32 s26, s53, 4587520
    s_add_u32 s27, s54, 4587520
    s_add_u32 s28, s55, 4587520
    s_add_u32 m0, s29, 28672
    v_mfma_f32_16x16x32_bf16 v[100:103], a[164:167], a[12:15], v[100:103]
    buffer_load_dwordx4 v13, s[12:15], s25 offen  lds
    v_mfma_f32_16x16x32_bf16 v[100:103], a[160:163], a[8:11], v[100:103]
    v_mfma_f32_16x16x32_bf16 v[104:107], a[160:163], a[16:19], v[104:107]
    ds_read_b64_tr_b16 a[188:189], v23 offset:40960
    v_mfma_f32_16x16x32_bf16 v[104:107], a[164:167], a[20:23], v[104:107]
    ds_read_b64_tr_b16 a[190:191], v23 offset:41472
    s_add_u32 m0, s29, 29696
    v_mfma_f32_16x16x32_bf16 v[108:111], a[164:167], a[28:31], v[108:111]
    buffer_load_dwordx4 v14, s[12:15], s25 offen  lds
    v_mfma_f32_16x16x32_bf16 v[108:111], a[160:163], a[24:27], v[108:111]
    s_waitcnt lgkmcnt(8)
    v_mfma_f32_16x16x32_bf16 v[124:127], a[168:171], a[24:27], v[124:127]
    ds_read_b64_tr_b16 a[160:161], v20 offset:45056
    v_mfma_f32_16x16x32_bf16 v[124:127], a[172:175], a[28:31], v[124:127]
    ds_read_b64_tr_b16 a[162:163], v20 offset:45568
    s_add_u32 m0, s29, 36864
    v_mfma_f32_16x16x32_bf16 v[120:123], a[172:175], a[20:23], v[120:123]
    buffer_load_dwordx4 v13, s[12:15], s26 offen  lds
    v_mfma_f32_16x16x32_bf16 v[120:123], a[168:171], a[16:19], v[120:123]
    v_mfma_f32_16x16x32_bf16 v[116:119], a[168:171], a[8:11], v[116:119]
    ds_read_b64_tr_b16 a[164:165], v20 offset:49152
    v_mfma_f32_16x16x32_bf16 v[116:119], a[172:175], a[12:15], v[116:119]
    ds_read_b64_tr_b16 a[166:167], v20 offset:49664
    s_add_u32 m0, s29, 37888
    v_mfma_f32_16x16x32_bf16 v[112:115], a[172:175], a[4:7], v[112:115]
    buffer_load_dwordx4 v14, s[12:15], s26 offen  lds
    v_mfma_f32_16x16x32_bf16 v[112:115], a[168:171], a[0:3], v[112:115]
    s_waitcnt lgkmcnt(8)
    v_mfma_f32_16x16x32_bf16 v[128:131], a[176:179], a[0:3], v[128:131]
    ds_read_b64_tr_b16 a[168:169], v21 offset:45056
    v_mfma_f32_16x16x32_bf16 v[128:131], a[180:183], a[4:7], v[128:131]
    ds_read_b64_tr_b16 a[170:171], v21 offset:45568
    s_add_u32 m0, s29, 45056
    v_mfma_f32_16x16x32_bf16 v[132:135], a[180:183], a[12:15], v[132:135]
    buffer_load_dwordx4 v13, s[12:15], s27 offen  lds
    v_mfma_f32_16x16x32_bf16 v[132:135], a[176:179], a[8:11], v[132:135]
    v_mfma_f32_16x16x32_bf16 v[136:139], a[176:179], a[16:19], v[136:139]
    ds_read_b64_tr_b16 a[172:173], v21 offset:49152
    v_mfma_f32_16x16x32_bf16 v[136:139], a[180:183], a[20:23], v[136:139]
    ds_read_b64_tr_b16 a[174:175], v21 offset:49664
    s_add_u32 m0, s29, 46080
    v_mfma_f32_16x16x32_bf16 v[140:143], a[180:183], a[28:31], v[140:143]
    buffer_load_dwordx4 v14, s[12:15], s27 offen  lds
    v_mfma_f32_16x16x32_bf16 v[140:143], a[176:179], a[24:27], v[140:143]
    s_waitcnt lgkmcnt(8)
    v_mfma_f32_16x16x32_bf16 v[156:159], a[184:187], a[24:27], v[156:159]
    ds_read_b64_tr_b16 a[176:177], v22 offset:45056
    v_mfma_f32_16x16x32_bf16 v[156:159], a[188:191], a[28:31], v[156:159]
    ds_read_b64_tr_b16 a[178:179], v22 offset:45568
    s_add_u32 m0, s30, 28672
    v_mfma_f32_16x16x32_bf16 v[152:155], a[188:191], a[20:23], v[152:155]
    buffer_load_dwordx4 v15, s[12:15], s28 offen  lds
    v_mfma_f32_16x16x32_bf16 v[152:155], a[184:187], a[16:19], v[152:155]
    v_mfma_f32_16x16x32_bf16 v[148:151], a[184:187], a[8:11], v[148:151]
    ds_read_b64_tr_b16 a[180:181], v22 offset:49152
    v_mfma_f32_16x16x32_bf16 v[148:151], a[188:191], a[12:15], v[148:151]
    ds_read_b64_tr_b16 a[182:183], v22 offset:49664
    s_add_u32 s33, s56, 5505024
    v_mfma_f32_16x16x32_bf16 v[144:147], a[188:191], a[4:7], v[144:147]
    buffer_load_dword a252, v11, s[12:15], s33 offen
    v_mfma_f32_16x16x32_bf16 v[144:147], a[184:187], a[0:3], v[144:147]
    s_waitcnt lgkmcnt(8)
    v_mfma_f32_16x16x32_bf16 v[160:163], a[160:163], a[0:3], v[160:163]
    ds_read_b64_tr_b16 a[184:185], v23 offset:45056
    v_mfma_f32_16x16x32_bf16 v[160:163], a[164:167], a[4:7], v[160:163]
    ds_read_b64_tr_b16 a[186:187], v23 offset:45568
    s_add_u32 s33, s56, 6881280
    v_mfma_f32_16x16x32_bf16 v[164:167], a[164:167], a[12:15], v[164:167]
    buffer_load_dword a252, v11, s[12:15], s33 offen
    v_mfma_f32_16x16x32_bf16 v[164:167], a[160:163], a[8:11], v[164:167]
    v_mfma_f32_16x16x32_bf16 v[168:171], a[160:163], a[16:19], v[168:171]
    ds_read_b64_tr_b16 a[188:189], v23 offset:49152
    v_mfma_f32_16x16x32_bf16 v[168:171], a[164:167], a[20:23], v[168:171]
    ds_read_b64_tr_b16 a[190:191], v23 offset:49664
    s_add_u32 s33, s68, 5242880
    v_mfma_f32_16x16x32_bf16 v[172:175], a[164:167], a[28:31], v[172:175]
    buffer_load_dword a253, v5, s[64:67], s33 offen
    v_mfma_f32_16x16x32_bf16 v[172:175], a[160:163], a[24:27], v[172:175]
    s_waitcnt lgkmcnt(8)
    v_mfma_f32_16x16x32_bf16 v[188:191], a[168:171], a[24:27], v[188:191]
    ds_read_b64_tr_b16 a[160:161], v26 offset:53248
    v_mfma_f32_16x16x32_bf16 v[188:191], a[172:175], a[28:31], v[188:191]
    ds_read_b64_tr_b16 a[162:163], v26 offset:53504
    s_add_u32 s48, s75, 98304
    v_mfma_f32_16x16x32_bf16 v[184:187], a[172:175], a[20:23], v[184:187]
    buffer_load_dwordx4 a[244:247], v30, s[40:43], s48 offen nt
    v_mfma_f32_16x16x32_bf16 v[184:187], a[168:171], a[16:19], v[184:187]
    v_mfma_f32_16x16x32_bf16 v[180:183], a[168:171], a[8:11], v[180:183]
    ds_read_b64_tr_b16 a[164:165], v26 offset:55296
    v_mfma_f32_16x16x32_bf16 v[180:183], a[172:175], a[12:15], v[180:183]
    ds_read_b64_tr_b16 a[166:167], v26 offset:55552
    v_mfma_f32_16x16x32_bf16 v[176:179], a[172:175], a[4:7], v[176:179]
    global_load_dword a255, v[28:29], off
    v_mfma_f32_16x16x32_bf16 v[176:179], a[168:171], a[0:3], v[176:179]
    s_waitcnt lgkmcnt(8)
    v_mfma_f32_16x16x32_bf16 v[192:195], a[176:179], a[0:3], v[192:195]
    ds_read_b64_tr_b16 a[168:169], v27 offset:53248
    v_mfma_f32_16x16x32_bf16 v[192:195], a[180:183], a[4:7], v[192:195]
    ds_read_b64_tr_b16 a[170:171], v27 offset:53504
    v_mfma_f32_16x16x32_bf16 v[196:199], a[180:183], a[12:15], v[196:199]
    v_mfma_f32_16x16x32_bf16 v[196:199], a[176:179], a[8:11], v[196:199]
    v_mfma_f32_16x16x32_bf16 v[200:203], a[176:179], a[16:19], v[200:203]
    ds_read_b64_tr_b16 a[172:173], v27 offset:55296
    v_mfma_f32_16x16x32_bf16 v[200:203], a[180:183], a[20:23], v[200:203]
    ds_read_b64_tr_b16 a[174:175], v27 offset:55552
    v_mfma_f32_16x16x32_bf16 v[204:207], a[180:183], a[28:31], v[204:207]
    v_mfma_f32_16x16x32_bf16 v[204:207], a[176:179], a[24:27], v[204:207]
    s_waitcnt lgkmcnt(8)
    v_mfma_f32_16x16x32_bf16 v[220:223], a[184:187], a[24:27], v[220:223]
    s_waitcnt vmcnt(23)
    s_barrier
    ds_read_b64_tr_b16 a[176:177], v16 offset:0
    v_mfma_f32_16x16x32_bf16 v[220:223], a[188:191], a[28:31], v[220:223]
    ds_read_b64_tr_b16 a[178:179], v16 offset:512
    v_mfma_f32_16x16x32_bf16 v[216:219], a[188:191], a[20:23], v[216:219]
    v_mfma_f32_16x16x32_bf16 v[216:219], a[184:187], a[16:19], v[216:219]
    v_mfma_f32_16x16x32_bf16 v[212:215], a[184:187], a[8:11], v[212:215]
    ds_read_b64_tr_b16 a[180:181], v16 offset:4096
    v_mfma_f32_16x16x32_bf16 v[212:215], a[188:191], a[12:15], v[212:215]
    ds_read_b64_tr_b16 a[182:183], v16 offset:4608
    v_mfma_f32_16x16x32_bf16 v[208:211], a[188:191], a[4:7], v[208:211]
    v_mfma_f32_16x16x32_bf16 v[208:211], a[184:187], a[0:3], v[208:211]
    s_waitcnt lgkmcnt(8)
    v_mfma_f32_16x16x32_bf16 v[224:227], a[160:163], a[0:3], v[224:227]
    ds_read_b64_tr_b16 a[184:185], v17 offset:0
    v_mfma_f32_16x16x32_bf16 v[224:227], a[164:167], a[4:7], v[224:227]
    ds_read_b64_tr_b16 a[186:187], v17 offset:512
    v_mfma_f32_16x16x32_bf16 v[228:231], a[164:167], a[12:15], v[228:231]
    v_mfma_f32_16x16x32_bf16 v[228:231], a[160:163], a[8:11], v[228:231]
    v_mfma_f32_16x16x32_bf16 v[232:235], a[160:163], a[16:19], v[232:235]
    ds_read_b64_tr_b16 a[188:189], v17 offset:4096
    v_mfma_f32_16x16x32_bf16 v[232:235], a[164:167], a[20:23], v[232:235]
    ds_read_b64_tr_b16 a[190:191], v17 offset:4608
    v_mfma_f32_16x16x32_bf16 v[236:239], a[164:167], a[28:31], v[236:239]
    v_mfma_f32_16x16x32_bf16 v[236:239], a[160:163], a[24:27], v[236:239]
    s_waitcnt lgkmcnt(8)
    v_mfma_f32_16x16x32_bf16 v[252:255], a[168:171], a[24:27], v[252:255]
    ds_read_b64_tr_b16 a[160:161], v18 offset:0
    v_mfma_f32_16x16x32_bf16 v[252:255], a[172:175], a[28:31], v[252:255]
    ds_read_b64_tr_b16 a[162:163], v18 offset:512
    v_mfma_f32_16x16x32_bf16 v[248:251], a[172:175], a[20:23], v[248:251]
    v_mfma_f32_16x16x32_bf16 v[248:251], a[168:171], a[16:19], v[248:251]
    v_mfma_f32_16x16x32_bf16 v[244:247], a[168:171], a[8:11], v[244:247]
    ds_read_b64_tr_b16 a[164:165], v18 offset:4096
    v_mfma_f32_16x16x32_bf16 v[244:247], a[172:175], a[12:15], v[244:247]
    ds_read_b64_tr_b16 a[166:167], v18 offset:4608
    v_mfma_f32_16x16x32_bf16 v[240:243], a[172:175], a[4:7], v[240:243]
    v_mfma_f32_16x16x32_bf16 v[240:243], a[168:171], a[0:3], v[240:243]
    s_waitcnt lgkmcnt(8)
    v_mfma_f32_16x16x32_bf16 v[32:35], a[176:179], a[40:43], v[32:35]
    ds_read_b64_tr_b16 a[168:169], v19 offset:0
    v_mfma_f32_16x16x32_bf16 v[32:35], a[180:183], a[44:47], v[32:35]
    ds_read_b64_tr_b16 a[170:171], v19 offset:512
    s_mov_b32 s24, 2883584
    v_mfma_f32_16x16x32_bf16 v[36:39], a[180:183], a[52:55], v[36:39]
    buffer_load_dwordx4 a[120:123], v8, s[8:11], s24 offen offset:0 sc1
    v_mfma_f32_16x16x32_bf16 v[36:39], a[176:179], a[48:51], v[36:39]
    v_mfma_f32_16x16x32_bf16 v[40:43], a[176:179], a[56:59], v[40:43]
    ds_read_b64_tr_b16 a[172:173], v19 offset:4096
    v_mfma_f32_16x16x32_bf16 v[40:43], a[180:183], a[60:63], v[40:43]
    ds_read_b64_tr_b16 a[174:175], v19 offset:4608
    v_mfma_f32_16x16x32_bf16 v[44:47], a[180:183], a[68:71], v[44:47]
    buffer_load_dwordx4 a[124:127], v8, s[8:11], s24 offen offset:1024 sc1
    v_mfma_f32_16x16x32_bf16 v[44:47], a[176:179], a[64:67], v[44:47]
    s_waitcnt lgkmcnt(8)
    v_mfma_f32_16x16x32_bf16 v[60:63], a[184:187], a[64:67], v[60:63]
    ds_read_b64_tr_b16 a[176:177], v16 offset:8192
    v_mfma_f32_16x16x32_bf16 v[60:63], a[188:191], a[68:71], v[60:63]
    ds_read_b64_tr_b16 a[178:179], v16 offset:8704
    v_mfma_f32_16x16x32_bf16 v[56:59], a[188:191], a[60:63], v[56:59]
    buffer_load_dwordx4 a[128:131], v8, s[8:11], s24 offen offset:2048 sc1
    v_mfma_f32_16x16x32_bf16 v[56:59], a[184:187], a[56:59], v[56:59]
    v_mfma_f32_16x16x32_bf16 v[52:55], a[184:187], a[48:51], v[52:55]
    ds_read_b64_tr_b16 a[180:181], v16 offset:12288
    v_mfma_f32_16x16x32_bf16 v[52:55], a[188:191], a[52:55], v[52:55]
    ds_read_b64_tr_b16 a[182:183], v16 offset:12800
    v_mfma_f32_16x16x32_bf16 v[48:51], a[188:191], a[44:47], v[48:51]
    buffer_load_dwordx4 a[132:135], v8, s[8:11], s24 offen offset:3072 sc1
    v_mfma_f32_16x16x32_bf16 v[48:51], a[184:187], a[40:43], v[48:51]
    s_waitcnt lgkmcnt(8)
    v_mfma_f32_16x16x32_bf16 v[64:67], a[160:163], a[40:43], v[64:67]
    ds_read_b64_tr_b16 a[184:185], v17 offset:8192
    v_mfma_f32_16x16x32_bf16 v[64:67], a[164:167], a[44:47], v[64:67]
    ds_read_b64_tr_b16 a[186:187], v17 offset:8704
    v_mfma_f32_16x16x32_bf16 v[68:71], a[164:167], a[52:55], v[68:71]
    buffer_load_dwordx4 a[136:139], v9, s[8:11], s24 offen offset:0 sc1
    v_mfma_f32_16x16x32_bf16 v[68:71], a[160:163], a[48:51], v[68:71]
    v_mfma_f32_16x16x32_bf16 v[72:75], a[160:163], a[56:59], v[72:75]
    ds_read_b64_tr_b16 a[188:189], v17 offset:12288
    v_mfma_f32_16x16x32_bf16 v[72:75], a[164:167], a[60:63], v[72:75]
    ds_read_b64_tr_b16 a[190:191], v17 offset:12800
    v_mfma_f32_16x16x32_bf16 v[76:79], a[164:167], a[68:71], v[76:79]
    buffer_load_dwordx4 a[140:143], v9, s[8:11], s24 offen offset:1024 sc1
    v_mfma_f32_16x16x32_bf16 v[76:79], a[160:163], a[64:67], v[76:79]
    s_waitcnt lgkmcnt(8)
    v_mfma_f32_16x16x32_bf16 v[92:95], a[168:171], a[64:67], v[92:95]
    ds_read_b64_tr_b16 a[160:161], v18 offset:8192
    v_mfma_f32_16x16x32_bf16 v[92:95], a[172:175], a[68:71], v[92:95]
    ds_read_b64_tr_b16 a[162:163], v18 offset:8704
    v_mfma_f32_16x16x32_bf16 v[88:91], a[172:175], a[60:63], v[88:91]
    buffer_load_dwordx4 a[144:147], v9, s[8:11], s24 offen offset:2048 sc1
    v_mfma_f32_16x16x32_bf16 v[88:91], a[168:171], a[56:59], v[88:91]
    v_mfma_f32_16x16x32_bf16 v[84:87], a[168:171], a[48:51], v[84:87]
    ds_read_b64_tr_b16 a[164:165], v18 offset:12288
    v_mfma_f32_16x16x32_bf16 v[84:87], a[172:175], a[52:55], v[84:87]
    ds_read_b64_tr_b16 a[166:167], v18 offset:12800
    v_mfma_f32_16x16x32_bf16 v[80:83], a[172:175], a[44:47], v[80:83]
    buffer_load_dwordx4 a[148:151], v9, s[8:11], s24 offen offset:3072 sc1
    v_mfma_f32_16x16x32_bf16 v[80:83], a[168:171], a[40:43], v[80:83]
    s_waitcnt lgkmcnt(8)
    v_mfma_f32_16x16x32_bf16 v[96:99], a[176:179], a[40:43], v[96:99]
    ds_read_b64_tr_b16 a[168:169], v19 offset:8192
    v_mfma_f32_16x16x32_bf16 v[96:99], a[180:183], a[44:47], v[96:99]
    ds_read_b64_tr_b16 a[170:171], v19 offset:8704
    s_add_u32 s25, s52, 5046272
    s_add_u32 s26, s53, 5046272
    s_add_u32 s27, s54, 5046272
    s_add_u32 s28, s55, 5046272
    s_add_u32 m0, s29, 114688
    v_mfma_f32_16x16x32_bf16 v[100:103], a[180:183], a[52:55], v[100:103]
    buffer_load_dwordx4 v13, s[12:15], s25 offen  lds
    v_mfma_f32_16x16x32_bf16 v[100:103], a[176:179], a[48:51], v[100:103]
    v_mfma_f32_16x16x32_bf16 v[104:107], a[176:179], a[56:59], v[104:107]
    ds_read_b64_tr_b16 a[172:173], v19 offset:12288
    v_mfma_f32_16x16x32_bf16 v[104:107], a[180:183], a[60:63], v[104:107]
    ds_read_b64_tr_b16 a[174:175], v19 offset:12800
    s_add_u32 m0, s29, 115712
    v_mfma_f32_16x16x32_bf16 v[108:111], a[180:183], a[68:71], v[108:111]
    buffer_load_dwordx4 v14, s[12:15], s25 offen  lds
    v_mfma_f32_16x16x32_bf16 v[108:111], a[176:179], a[64:67], v[108:111]
    s_waitcnt lgkmcnt(8)
    v_mfma_f32_16x16x32_bf16 v[124:127], a[184:187], a[64:67], v[124:127]
    ds_read_b64_tr_b16 a[176:177], v16 offset:16384
    v_mfma_f32_16x16x32_bf16 v[124:127], a[188:191], a[68:71], v[124:127]
    ds_read_b64_tr_b16 a[178:179], v16 offset:16896
    s_add_u32 m0, s29, 122880
    v_mfma_f32_16x16x32_bf16 v[120:123], a[188:191], a[60:63], v[120:123]
    buffer_load_dwordx4 v13, s[12:15], s26 offen  lds
    v_mfma_f32_16x16x32_bf16 v[120:123], a[184:187], a[56:59], v[120:123]
    v_mfma_f32_16x16x32_bf16 v[116:119], a[184:187], a[48:51], v[116:119]
    ds_read_b64_tr_b16 a[180:181], v16 offset:20480
    v_mfma_f32_16x16x32_bf16 v[116:119], a[188:191], a[52:55], v[116:119]
    ds_read_b64_tr_b16 a[182:183], v16 offset:20992
    s_add_u32 m0, s29, 123904
    v_mfma_f32_16x16x32_bf16 v[112:115], a[188:191], a[44:47], v[112:115]
    buffer_load_dwordx4 v14, s[12:15], s26 offen  lds
    v_mfma_f32_16x16x32_bf16 v[112:115], a[184:187], a[40:43], v[112:115]
    s_waitcnt lgkmcnt(8)
    v_mfma_f32_16x16x32_bf16 v[128:131], a[160:163], a[40:43], v[128:131]
    ds_read_b64_tr_b16 a[184:185], v17 offset:16384
    v_mfma_f32_16x16x32_bf16 v[128:131], a[164:167], a[44:47], v[128:131]
    ds_read_b64_tr_b16 a[186:187], v17 offset:16896
    s_add_u32 m0, s29, 131072
    v_mfma_f32_16x16x32_bf16 v[132:135], a[164:167], a[52:55], v[132:135]
    buffer_load_dwordx4 v13, s[12:15], s27 offen  lds
    v_mfma_f32_16x16x32_bf16 v[132:135], a[160:163], a[48:51], v[132:135]
    v_mfma_f32_16x16x32_bf16 v[136:139], a[160:163], a[56:59], v[136:139]
    ds_read_b64_tr_b16 a[188:189], v17 offset:20480
    v_mfma_f32_16x16x32_bf16 v[136:139], a[164:167], a[60:63], v[136:139]
    ds_read_b64_tr_b16 a[190:191], v17 offset:20992
    s_add_u32 m0, s29, 132096
    v_mfma_f32_16x16x32_bf16 v[140:143], a[164:167], a[68:71], v[140:143]
    buffer_load_dwordx4 v14, s[12:15], s27 offen  lds
    v_mfma_f32_16x16x32_bf16 v[140:143], a[160:163], a[64:67], v[140:143]
    s_waitcnt lgkmcnt(8)
    v_mfma_f32_16x16x32_bf16 v[156:159], a[168:171], a[64:67], v[156:159]
    ds_read_b64_tr_b16 a[160:161], v18 offset:16384
    v_mfma_f32_16x16x32_bf16 v[156:159], a[172:175], a[68:71], v[156:159]
    ds_read_b64_tr_b16 a[162:163], v18 offset:16896
    s_add_u32 m0, s30, 114688
    v_mfma_f32_16x16x32_bf16 v[152:155], a[172:175], a[60:63], v[152:155]
    buffer_load_dwordx4 v15, s[12:15], s28 offen  lds
    v_mfma_f32_16x16x32_bf16 v[152:155], a[168:171], a[56:59], v[152:155]
    v_mfma_f32_16x16x32_bf16 v[148:151], a[168:171], a[48:51], v[148:151]
    ds_read_b64_tr_b16 a[164:165], v18 offset:20480
    v_mfma_f32_16x16x32_bf16 v[148:151], a[172:175], a[52:55], v[148:151]
    ds_read_b64_tr_b16 a[166:167], v18 offset:20992
    s_add_u32 s33, s56, 5963776
    v_mfma_f32_16x16x32_bf16 v[144:147], a[172:175], a[44:47], v[144:147]
    buffer_load_dword a252, v11, s[12:15], s33 offen
    v_mfma_f32_16x16x32_bf16 v[144:147], a[168:171], a[40:43], v[144:147]
    s_waitcnt lgkmcnt(8)
    v_mfma_f32_16x16x32_bf16 v[160:163], a[176:179], a[40:43], v[160:163]
    ds_read_b64_tr_b16 a[168:169], v19 offset:16384
    v_mfma_f32_16x16x32_bf16 v[160:163], a[180:183], a[44:47], v[160:163]
    ds_read_b64_tr_b16 a[170:171], v19 offset:16896
    s_add_u32 s33, s68, 5767168
    v_mfma_f32_16x16x32_bf16 v[164:167], a[180:183], a[52:55], v[164:167]
    buffer_load_dword a253, v5, s[64:67], s33 offen
    v_mfma_f32_16x16x32_bf16 v[164:167], a[176:179], a[48:51], v[164:167]
    v_mfma_f32_16x16x32_bf16 v[168:171], a[176:179], a[56:59], v[168:171]
    ds_read_b64_tr_b16 a[172:173], v19 offset:20480
    v_mfma_f32_16x16x32_bf16 v[168:171], a[180:183], a[60:63], v[168:171]
    ds_read_b64_tr_b16 a[174:175], v19 offset:20992
    s_add_u32 s33, s68, 6291456
    v_mfma_f32_16x16x32_bf16 v[172:175], a[180:183], a[68:71], v[172:175]
    buffer_load_dword a253, v5, s[64:67], s33 offen
    v_mfma_f32_16x16x32_bf16 v[172:175], a[176:179], a[64:67], v[172:175]
    s_waitcnt lgkmcnt(8)
    v_mfma_f32_16x16x32_bf16 v[188:191], a[184:187], a[64:67], v[188:191]
    ds_read_b64_tr_b16 a[176:177], v24 offset:24576
    v_mfma_f32_16x16x32_bf16 v[188:191], a[188:191], a[68:71], v[188:191]
    ds_read_b64_tr_b16 a[178:179], v24 offset:24832
    v_mfma_f32_16x16x32_bf16 v[184:187], a[188:191], a[60:63], v[184:187]
    v_mfma_f32_16x16x32_bf16 v[184:187], a[184:187], a[56:59], v[184:187]
    v_mfma_f32_16x16x32_bf16 v[180:183], a[184:187], a[48:51], v[180:183]
    ds_read_b64_tr_b16 a[180:181], v24 offset:26624
    v_mfma_f32_16x16x32_bf16 v[180:183], a[188:191], a[52:55], v[180:183]
    ds_read_b64_tr_b16 a[182:183], v24 offset:26880
    v_mfma_f32_16x16x32_bf16 v[176:179], a[188:191], a[44:47], v[176:179]
    v_mfma_f32_16x16x32_bf16 v[176:179], a[184:187], a[40:43], v[176:179]
    s_waitcnt lgkmcnt(8)
    v_mfma_f32_16x16x32_bf16 v[192:195], a[160:163], a[40:43], v[192:195]
    ds_read_b64_tr_b16 a[184:185], v25 offset:24576
    v_mfma_f32_16x16x32_bf16 v[192:195], a[164:167], a[44:47], v[192:195]
    ds_read_b64_tr_b16 a[186:187], v25 offset:24832
    v_mfma_f32_16x16x32_bf16 v[196:199], a[164:167], a[52:55], v[196:199]
    v_mfma_f32_16x16x32_bf16 v[196:199], a[160:163], a[48:51], v[196:199]
    v_mfma_f32_16x16x32_bf16 v[200:203], a[160:163], a[56:59], v[200:203]
    ds_read_b64_tr_b16 a[188:189], v25 offset:26624
    v_mfma_f32_16x16x32_bf16 v[200:203], a[164:167], a[60:63], v[200:203]
    ds_read_b64_tr_b16 a[190:191], v25 offset:26880
    v_mfma_f32_16x16x32_bf16 v[204:207], a[164:167], a[68:71], v[204:207]
    v_mfma_f32_16x16x32_bf16 v[204:207], a[160:163], a[64:67], v[204:207]
    s_waitcnt lgkmcnt(8)
    v_mfma_f32_16x16x32_bf16 v[220:223], a[168:171], a[64:67], v[220:223]
    s_waitcnt vmcnt(23)
    s_barrier
    ds_read_b64_tr_b16 a[160:161], v16 offset:28672
    v_mfma_f32_16x16x32_bf16 v[220:223], a[172:175], a[68:71], v[220:223]
    ds_read_b64_tr_b16 a[162:163], v16 offset:29184
    v_mfma_f32_16x16x32_bf16 v[216:219], a[172:175], a[60:63], v[216:219]
    v_mfma_f32_16x16x32_bf16 v[216:219], a[168:171], a[56:59], v[216:219]
    v_mfma_f32_16x16x32_bf16 v[212:215], a[168:171], a[48:51], v[212:215]
    ds_read_b64_tr_b16 a[164:165], v16 offset:32768
    v_mfma_f32_16x16x32_bf16 v[212:215], a[172:175], a[52:55], v[212:215]
    ds_read_b64_tr_b16 a[166:167], v16 offset:33280
    v_mfma_f32_16x16x32_bf16 v[208:211], a[172:175], a[44:47], v[208:211]
    v_mfma_f32_16x16x32_bf16 v[208:211], a[168:171], a[40:43], v[208:211]
    s_waitcnt lgkmcnt(8)
    v_mfma_f32_16x16x32_bf16 v[224:227], a[176:179], a[40:43], v[224:227]
    ds_read_b64_tr_b16 a[168:169], v17 offset:28672
    v_mfma_f32_16x16x32_bf16 v[224:227], a[180:183], a[44:47], v[224:227]
    ds_read_b64_tr_b16 a[170:171], v17 offset:29184
    v_mfma_f32_16x16x32_bf16 v[228:231], a[180:183], a[52:55], v[228:231]
    v_mfma_f32_16x16x32_bf16 v[228:231], a[176:179], a[48:51], v[228:231]
    v_mfma_f32_16x16x32_bf16 v[232:235], a[176:179], a[56:59], v[232:235]
    ds_read_b64_tr_b16 a[172:173], v17 offset:32768
    v_mfma_f32_16x16x32_bf16 v[232:235], a[180:183], a[60:63], v[232:235]
    ds_read_b64_tr_b16 a[174:175], v17 offset:33280
    v_mfma_f32_16x16x32_bf16 v[236:239], a[180:183], a[68:71], v[236:239]
    v_mfma_f32_16x16x32_bf16 v[236:239], a[176:179], a[64:67], v[236:239]
    s_waitcnt lgkmcnt(8)
    v_mfma_f32_16x16x32_bf16 v[252:255], a[184:187], a[64:67], v[252:255]
    ds_read_b64_tr_b16 a[176:177], v18 offset:28672
    v_mfma_f32_16x16x32_bf16 v[252:255], a[188:191], a[68:71], v[252:255]
    ds_read_b64_tr_b16 a[178:179], v18 offset:29184
    v_mfma_f32_16x16x32_bf16 v[248:251], a[188:191], a[60:63], v[248:251]
    v_mfma_f32_16x16x32_bf16 v[248:251], a[184:187], a[56:59], v[248:251]
    v_mfma_f32_16x16x32_bf16 v[244:247], a[184:187], a[48:51], v[244:247]
    ds_read_b64_tr_b16 a[180:181], v18 offset:32768
    v_mfma_f32_16x16x32_bf16 v[244:247], a[188:191], a[52:55], v[244:247]
    ds_read_b64_tr_b16 a[182:183], v18 offset:33280
    v_mfma_f32_16x16x32_bf16 v[240:243], a[188:191], a[44:47], v[240:243]
    v_mfma_f32_16x16x32_bf16 v[240:243], a[184:187], a[40:43], v[240:243]
    s_waitcnt lgkmcnt(8)
    v_mfma_f32_16x16x32_bf16 v[32:35], a[160:163], a[80:83], v[32:35]
    ds_read_b64_tr_b16 a[184:185], v19 offset:28672
    v_mfma_f32_16x16x32_bf16 v[32:35], a[164:167], a[84:87], v[32:35]
    ds_read_b64_tr_b16 a[186:187], v19 offset:29184
    s_mov_b32 s24, 3145728
    v_mfma_f32_16x16x32_bf16 v[36:39], a[164:167], a[92:95], v[36:39]
    buffer_load_dwordx4 a[0:3], v8, s[8:11], s24 offen offset:0 sc1
    v_mfma_f32_16x16x32_bf16 v[36:39], a[160:163], a[88:91], v[36:39]
    v_mfma_f32_16x16x32_bf16 v[40:43], a[160:163], a[96:99], v[40:43]
    ds_read_b64_tr_b16 a[188:189], v19 offset:32768
    v_mfma_f32_16x16x32_bf16 v[40:43], a[164:167], a[100:103], v[40:43]
    ds_read_b64_tr_b16 a[190:191], v19 offset:33280
    v_mfma_f32_16x16x32_bf16 v[44:47], a[164:167], a[108:111], v[44:47]
    buffer_load_dwordx4 a[4:7], v8, s[8:11], s24 offen offset:1024 sc1
    v_mfma_f32_16x16x32_bf16 v[44:47], a[160:163], a[104:107], v[44:47]
    s_waitcnt lgkmcnt(8)
    v_mfma_f32_16x16x32_bf16 v[60:63], a[168:171], a[104:107], v[60:63]
    ds_read_b64_tr_b16 a[160:161], v16 offset:36864
    v_mfma_f32_16x16x32_bf16 v[60:63], a[172:175], a[108:111], v[60:63]
    ds_read_b64_tr_b16 a[162:163], v16 offset:37376
    v_mfma_f32_16x16x32_bf16 v[56:59], a[172:175], a[100:103], v[56:59]
    buffer_load_dwordx4 a[8:11], v8, s[8:11], s24 offen offset:2048 sc1
    v_mfma_f32_16x16x32_bf16 v[56:59], a[168:171], a[96:99], v[56:59]
    v_mfma_f32_16x16x32_bf16 v[52:55], a[168:171], a[88:91], v[52:55]
    ds_read_b64_tr_b16 a[164:165], v16 offset:40960
    v_mfma_f32_16x16x32_bf16 v[52:55], a[172:175], a[92:95], v[52:55]
    ds_read_b64_tr_b16 a[166:167], v16 offset:41472
    v_mfma_f32_16x16x32_bf16 v[48:51], a[172:175], a[84:87], v[48:51]
    buffer_load_dwordx4 a[12:15], v8, s[8:11], s24 offen offset:3072 sc1
    v_mfma_f32_16x16x32_bf16 v[48:51], a[168:171], a[80:83], v[48:51]
    s_waitcnt lgkmcnt(8)
    v_mfma_f32_16x16x32_bf16 v[64:67], a[176:179], a[80:83], v[64:67]
    ds_read_b64_tr_b16 a[168:169], v17 offset:36864
    v_mfma_f32_16x16x32_bf16 v[64:67], a[180:183], a[84:87], v[64:67]
    ds_read_b64_tr_b16 a[170:171], v17 offset:37376
    v_mfma_f32_16x16x32_bf16 v[68:71], a[180:183], a[92:95], v[68:71]
    buffer_load_dwordx4 a[16:19], v9, s[8:11], s24 offen offset:0 sc1
    v_mfma_f32_16x16x32_bf16 v[68:71], a[176:179], a[88:91], v[68:71]
    v_mfma_f32_16x16x32_bf16 v[72:75], a[176:179], a[96:99], v[72:75]
    ds_read_b64_tr_b16 a[172:173], v17 offset:40960
    v_mfma_f32_16x16x32_bf16 v[72:75], a[180:183], a[100:103], v[72:75]
    ds_read_b64_tr_b16 a[174:175], v17 offset:41472
    v_mfma_f32_16x16x32_bf16 v[76:79], a[180:183], a[108:111], v[76:79]
    buffer_load_dwordx4 a[20:23], v9, s[8:11], s24 offen offset:1024 sc1
    v_mfma_f32_16x16x32_bf16 v[76:79], a[176:179], a[104:107], v[76:79]
    s_waitcnt lgkmcnt(8)
    v_mfma_f32_16x16x32_bf16 v[92:95], a[184:187], a[104:107], v[92:95]
    ds_read_b64_tr_b16 a[176:177], v18 offset:36864
    v_mfma_f32_16x16x32_bf16 v[92:95], a[188:191], a[108:111], v[92:95]
    ds_read_b64_tr_b16 a[178:179], v18 offset:37376
    v_mfma_f32_16x16x32_bf16 v[88:91], a[188:191], a[100:103], v[88:91]
    buffer_load_dwordx4 a[24:27], v9, s[8:11], s24 offen offset:2048 sc1
    v_mfma_f32_16x16x32_bf16 v[88:91], a[184:187], a[96:99], v[88:91]
    v_mfma_f32_16x16x32_bf16 v[84:87], a[184:187], a[88:91], v[84:87]
    ds_read_b64_tr_b16 a[180:181], v18 offset:40960
    v_mfma_f32_16x16x32_bf16 v[84:87], a[188:191], a[92:95], v[84:87]
    ds_read_b64_tr_b16 a[182:183], v18 offset:41472
    v_mfma_f32_16x16x32_bf16 v[80:83], a[188:191], a[84:87], v[80:83]
    buffer_load_dwordx4 a[28:31], v9, s[8:11], s24 offen offset:3072 sc1
    v_mfma_f32_16x16x32_bf16 v[80:83], a[184:187], a[80:83], v[80:83]
    s_waitcnt lgkmcnt(8)
    v_mfma_f32_16x16x32_bf16 v[96:99], a[160:163], a[80:83], v[96:99]
    ds_read_b64_tr_b16 a[184:185], v19 offset:36864
    v_mfma_f32_16x16x32_bf16 v[96:99], a[164:167], a[84:87], v[96:99]
    ds_read_b64_tr_b16 a[186:187], v19 offset:37376
    s_add_u32 s25, s52, 5505024
    s_add_u32 s26, s53, 5505024
    s_add_u32 s27, s54, 5505024
    s_add_u32 s28, s55, 5505024
    s_add_u32 m0, s29, 86016
    v_mfma_f32_16x16x32_bf16 v[100:103], a[164:167], a[92:95], v[100:103]
    buffer_load_dwordx4 v13, s[12:15], s25 offen  lds
    v_mfma_f32_16x16x32_bf16 v[100:103], a[160:163], a[88:91], v[100:103]
    v_mfma_f32_16x16x32_bf16 v[104:107], a[160:163], a[96:99], v[104:107]
    ds_read_b64_tr_b16 a[188:189], v19 offset:40960
    v_mfma_f32_16x16x32_bf16 v[104:107], a[164:167], a[100:103], v[104:107]
    ds_read_b64_tr_b16 a[190:191], v19 offset:41472
    s_add_u32 m0, s29, 87040
    v_mfma_f32_16x16x32_bf16 v[108:111], a[164:167], a[108:111], v[108:111]
    buffer_load_dwordx4 v14, s[12:15], s25 offen  lds
    v_mfma_f32_16x16x32_bf16 v[108:111], a[160:163], a[104:107], v[108:111]
    s_waitcnt lgkmcnt(8)
    v_mfma_f32_16x16x32_bf16 v[124:127], a[168:171], a[104:107], v[124:127]
    ds_read_b64_tr_b16 a[160:161], v16 offset:45056
    v_mfma_f32_16x16x32_bf16 v[124:127], a[172:175], a[108:111], v[124:127]
    ds_read_b64_tr_b16 a[162:163], v16 offset:45568
    s_add_u32 m0, s29, 94208
    v_mfma_f32_16x16x32_bf16 v[120:123], a[172:175], a[100:103], v[120:123]
    buffer_load_dwordx4 v13, s[12:15], s26 offen  lds
    v_mfma_f32_16x16x32_bf16 v[120:123], a[168:171], a[96:99], v[120:123]
    v_mfma_f32_16x16x32_bf16 v[116:119], a[168:171], a[88:91], v[116:119]
    ds_read_b64_tr_b16 a[164:165], v16 offset:49152
    v_mfma_f32_16x16x32_bf16 v[116:119], a[172:175], a[92:95], v[116:119]
    ds_read_b64_tr_b16 a[166:167], v16 offset:49664
    s_add_u32 m0, s29, 95232
    v_mfma_f32_16x16x32_bf16 v[112:115], a[172:175], a[84:87], v[112:115]
    buffer_load_dwordx4 v14, s[12:15], s26 offen  lds
    v_mfma_f32_16x16x32_bf16 v[112:115], a[168:171], a[80:83], v[112:115]
    s_waitcnt lgkmcnt(8)
    v_mfma_f32_16x16x32_bf16 v[128:131], a[176:179], a[80:83], v[128:131]
    ds_read_b64_tr_b16 a[168:169], v17 offset:45056
    v_mfma_f32_16x16x32_bf16 v[128:131], a[180:183], a[84:87], v[128:131]
    ds_read_b64_tr_b16 a[170:171], v17 offset:45568
    s_add_u32 m0, s29, 102400
    v_mfma_f32_16x16x32_bf16 v[132:135], a[180:183], a[92:95], v[132:135]
    buffer_load_dwordx4 v13, s[12:15], s27 offen  lds
    v_mfma_f32_16x16x32_bf16 v[132:135], a[176:179], a[88:91], v[132:135]
    v_mfma_f32_16x16x32_bf16 v[136:139], a[176:179], a[96:99], v[136:139]
    ds_read_b64_tr_b16 a[172:173], v17 offset:49152
    v_mfma_f32_16x16x32_bf16 v[136:139], a[180:183], a[100:103], v[136:139]
    ds_read_b64_tr_b16 a[174:175], v17 offset:49664
    s_add_u32 m0, s29, 103424
    v_mfma_f32_16x16x32_bf16 v[140:143], a[180:183], a[108:111], v[140:143]
    buffer_load_dwordx4 v14, s[12:15], s27 offen  lds
    v_mfma_f32_16x16x32_bf16 v[140:143], a[176:179], a[104:107], v[140:143]
    s_waitcnt lgkmcnt(8)
    v_mfma_f32_16x16x32_bf16 v[156:159], a[184:187], a[104:107], v[156:159]
    ds_read_b64_tr_b16 a[176:177], v18 offset:45056
    v_mfma_f32_16x16x32_bf16 v[156:159], a[188:191], a[108:111], v[156:159]
    ds_read_b64_tr_b16 a[178:179], v18 offset:45568
    s_add_u32 m0, s30, 86016
    v_mfma_f32_16x16x32_bf16 v[152:155], a[188:191], a[100:103], v[152:155]
    buffer_load_dwordx4 v15, s[12:15], s28 offen  lds
    v_mfma_f32_16x16x32_bf16 v[152:155], a[184:187], a[96:99], v[152:155]
    v_mfma_f32_16x16x32_bf16 v[148:151], a[184:187], a[88:91], v[148:151]
    ds_read_b64_tr_b16 a[180:181], v18 offset:49152
    v_mfma_f32_16x16x32_bf16 v[148:151], a[188:191], a[92:95], v[148:151]
    ds_read_b64_tr_b16 a[182:183], v18 offset:49664
    s_add_u32 s25, s52, 6881280
    s_add_u32 s26, s53, 6881280
    s_add_u32 s27, s54, 6881280
    s_add_u32 s28, s55, 6881280
    s_add_u32 m0, s29, 57344
    v_mfma_f32_16x16x32_bf16 v[144:147], a[188:191], a[84:87], v[144:147]
    buffer_load_dwordx4 v13, s[12:15], s25 offen  lds
    v_mfma_f32_16x16x32_bf16 v[144:147], a[184:187], a[80:83], v[144:147]
    s_waitcnt lgkmcnt(8)
    v_mfma_f32_16x16x32_bf16 v[160:163], a[160:163], a[80:83], v[160:163]
    ds_read_b64_tr_b16 a[184:185], v19 offset:45056
    v_mfma_f32_16x16x32_bf16 v[160:163], a[164:167], a[84:87], v[160:163]
    ds_read_b64_tr_b16 a[186:187], v19 offset:45568
    s_add_u32 m0, s29, 58368
    v_mfma_f32_16x16x32_bf16 v[164:167], a[164:167], a[92:95], v[164:167]
    buffer_load_dwordx4 v14, s[12:15], s25 offen  lds
    v_mfma_f32_16x16x32_bf16 v[164:167], a[160:163], a[88:91], v[164:167]
    v_mfma_f32_16x16x32_bf16 v[168:171], a[160:163], a[96:99], v[168:171]
    ds_read_b64_tr_b16 a[188:189], v19 offset:49152
    v_mfma_f32_16x16x32_bf16 v[168:171], a[164:167], a[100:103], v[168:171]
    ds_read_b64_tr_b16 a[190:191], v19 offset:49664
    s_add_u32 m0, s29, 65536
    v_mfma_f32_16x16x32_bf16 v[172:175], a[164:167], a[108:111], v[172:175]
    buffer_load_dwordx4 v13, s[12:15], s26 offen  lds
    v_mfma_f32_16x16x32_bf16 v[172:175], a[160:163], a[104:107], v[172:175]
    s_waitcnt lgkmcnt(8)
    v_mfma_f32_16x16x32_bf16 v[188:191], a[168:171], a[104:107], v[188:191]
    ds_read_b64_tr_b16 a[160:161], v24 offset:53248
    v_mfma_f32_16x16x32_bf16 v[188:191], a[172:175], a[108:111], v[188:191]
    ds_read_b64_tr_b16 a[162:163], v24 offset:53504
    s_add_u32 m0, s29, 66560
    v_mfma_f32_16x16x32_bf16 v[184:187], a[172:175], a[100:103], v[184:187]
    buffer_load_dwordx4 v14, s[12:15], s26 offen  lds
    v_mfma_f32_16x16x32_bf16 v[184:187], a[168:171], a[96:99], v[184:187]
    v_mfma_f32_16x16x32_bf16 v[180:183], a[168:171], a[88:91], v[180:183]
    ds_read_b64_tr_b16 a[164:165], v24 offset:55296
    v_mfma_f32_16x16x32_bf16 v[180:183], a[172:175], a[92:95], v[180:183]
    ds_read_b64_tr_b16 a[166:167], v24 offset:55552
    s_add_u32 m0, s29, 73728
    v_mfma_f32_16x16x32_bf16 v[176:179], a[172:175], a[84:87], v[176:179]
    buffer_load_dwordx4 v13, s[12:15], s27 offen  lds
    v_mfma_f32_16x16x32_bf16 v[176:179], a[168:171], a[80:83], v[176:179]
    s_waitcnt lgkmcnt(8)
    v_mfma_f32_16x16x32_bf16 v[192:195], a[176:179], a[80:83], v[192:195]
    ds_read_b64_tr_b16 a[168:169], v25 offset:53248
    v_mfma_f32_16x16x32_bf16 v[192:195], a[180:183], a[84:87], v[192:195]
    ds_read_b64_tr_b16 a[170:171], v25 offset:53504
    s_add_u32 m0, s29, 74752
    v_mfma_f32_16x16x32_bf16 v[196:199], a[180:183], a[92:95], v[196:199]
    buffer_load_dwordx4 v14, s[12:15], s27 offen  lds
    v_mfma_f32_16x16x32_bf16 v[196:199], a[176:179], a[88:91], v[196:199]
    v_mfma_f32_16x16x32_bf16 v[200:203], a[176:179], a[96:99], v[200:203]
    ds_read_b64_tr_b16 a[172:173], v25 offset:55296
    v_mfma_f32_16x16x32_bf16 v[200:203], a[180:183], a[100:103], v[200:203]
    ds_read_b64_tr_b16 a[174:175], v25 offset:55552
    s_add_u32 m0, s30, 57344
    v_mfma_f32_16x16x32_bf16 v[204:207], a[180:183], a[108:111], v[204:207]
    buffer_load_dwordx4 v15, s[12:15], s28 offen  lds
    v_mfma_f32_16x16x32_bf16 v[204:207], a[176:179], a[104:107], v[204:207]
    s_waitcnt lgkmcnt(8)
    v_mfma_f32_16x16x32_bf16 v[220:223], a[184:187], a[104:107], v[220:223]
    s_waitcnt vmcnt(25)
    s_barrier
    ds_read_b64_tr_b16 a[176:177], v2 offset:0
    v_mfma_f32_16x16x32_bf16 v[220:223], a[188:191], a[108:111], v[220:223]
    ds_read_b64_tr_b16 a[178:179], v2 offset:512
    s_add_u32 s33, s56, 6422528
    v_mfma_f32_16x16x32_bf16 v[216:219], a[188:191], a[100:103], v[216:219]
    buffer_load_dword a252, v11, s[12:15], s33 offen
    v_mfma_f32_16x16x32_bf16 v[216:219], a[184:187], a[96:99], v[216:219]
    v_mfma_f32_16x16x32_bf16 v[212:215], a[184:187], a[88:91], v[212:215]
    ds_read_b64_tr_b16 a[180:181], v2 offset:4096
    v_mfma_f32_16x16x32_bf16 v[212:215], a[188:191], a[92:95], v[212:215]
    ds_read_b64_tr_b16 a[182:183], v2 offset:4608
    s_add_u32 s33, s68, 6815744
    v_mfma_f32_16x16x32_bf16 v[208:211], a[188:191], a[84:87], v[208:211]
    buffer_load_dword a253, v5, s[64:67], s33 offen
    v_mfma_f32_16x16x32_bf16 v[208:211], a[184:187], a[80:83], v[208:211]
    s_waitcnt lgkmcnt(8)
    v_mfma_f32_16x16x32_bf16 v[224:227], a[160:163], a[80:83], v[224:227]
    ds_read_b64_tr_b16 a[184:185], v3 offset:0
    v_mfma_f32_16x16x32_bf16 v[224:227], a[164:167], a[84:87], v[224:227]
    ds_read_b64_tr_b16 a[186:187], v3 offset:512
    v_mfma_f32_16x16x32_bf16 v[228:231], a[164:167], a[92:95], v[228:231]
    v_mfma_f32_16x16x32_bf16 v[228:231], a[160:163], a[88:91], v[228:231]
    v_mfma_f32_16x16x32_bf16 v[232:235], a[160:163], a[96:99], v[232:235]
    ds_read_b64_tr_b16 a[188:189], v3 offset:4096
    v_mfma_f32_16x16x32_bf16 v[232:235], a[164:167], a[100:103], v[232:235]
    ds_read_b64_tr_b16 a[190:191], v3 offset:4608
    v_mfma_f32_16x16x32_bf16 v[236:239], a[164:167], a[108:111], v[236:239]
    v_mfma_f32_16x16x32_bf16 v[236:239], a[160:163], a[104:107], v[236:239]
    s_waitcnt lgkmcnt(8)
    v_mfma_f32_16x16x32_bf16 v[252:255], a[168:171], a[104:107], v[252:255]
    ds_read_b64_tr_b16 a[160:161], v4 offset:0
    v_mfma_f32_16x16x32_bf16 v[252:255], a[172:175], a[108:111], v[252:255]
    ds_read_b64_tr_b16 a[162:163], v4 offset:512
    v_mfma_f32_16x16x32_bf16 v[248:251], a[172:175], a[100:103], v[248:251]
    v_mfma_f32_16x16x32_bf16 v[248:251], a[168:171], a[96:99], v[248:251]
    v_mfma_f32_16x16x32_bf16 v[244:247], a[168:171], a[88:91], v[244:247]
    ds_read_b64_tr_b16 a[164:165], v4 offset:4096
    v_mfma_f32_16x16x32_bf16 v[244:247], a[172:175], a[92:95], v[244:247]
    ds_read_b64_tr_b16 a[166:167], v4 offset:4608
    v_mfma_f32_16x16x32_bf16 v[240:243], a[172:175], a[84:87], v[240:243]
    v_mfma_f32_16x16x32_bf16 v[240:243], a[168:171], a[80:83], v[240:243]
    s_waitcnt lgkmcnt(8)
    v_mfma_f32_16x16x32_bf16 v[32:35], a[176:179], a[120:123], v[32:35]
    ds_read_b64_tr_b16 a[168:169], v10 offset:0
    v_mfma_f32_16x16x32_bf16 v[32:35], a[180:183], a[124:127], v[32:35]
    ds_read_b64_tr_b16 a[170:171], v10 offset:512
    s_mov_b32 s24, 3407872
    v_mfma_f32_16x16x32_bf16 v[36:39], a[180:183], a[132:135], v[36:39]
    buffer_load_dwordx4 a[40:43], v8, s[8:11], s24 offen offset:0 sc1
    v_mfma_f32_16x16x32_bf16 v[36:39], a[176:179], a[128:131], v[36:39]
    v_mfma_f32_16x16x32_bf16 v[40:43], a[176:179], a[136:139], v[40:43]
    ds_read_b64_tr_b16 a[172:173], v10 offset:4096
    v_mfma_f32_16x16x32_bf16 v[40:43], a[180:183], a[140:143], v[40:43]
    ds_read_b64_tr_b16 a[174:175], v10 offset:4608
    v_mfma_f32_16x16x32_bf16 v[44:47], a[180:183], a[148:151], v[44:47]
    buffer_load_dwordx4 a[44:47], v8, s[8:11], s24 offen offset:1024 sc1
    v_mfma_f32_16x16x32_bf16 v[44:47], a[176:179], a[144:147], v[44:47]
    s_waitcnt lgkmcnt(8)
    v_mfma_f32_16x16x32_bf16 v[60:63], a[184:187], a[144:147], v[60:63]
    ds_read_b64_tr_b16 a[176:177], v2 offset:8192
    v_mfma_f32_16x16x32_bf16 v[60:63], a[188:191], a[148:151], v[60:63]
    ds_read_b64_tr_b16 a[178:179], v2 offset:8704
    v_mfma_f32_16x16x32_bf16 v[56:59], a[188:191], a[140:143], v[56:59]
    buffer_load_dwordx4 a[48:51], v8, s[8:11], s24 offen offset:2048 sc1
    v_mfma_f32_16x16x32_bf16 v[56:59], a[184:187], a[136:139], v[56:59]
    v_mfma_f32_16x16x32_bf16 v[52:55], a[184:187], a[128:131], v[52:55]
    ds_read_b64_tr_b16 a[180:181], v2 offset:12288
    v_mfma_f32_16x16x32_bf16 v[52:55], a[188:191], a[132:135], v[52:55]
    ds_read_b64_tr_b16 a[182:183], v2 offset:12800
    v_mfma_f32_16x16x32_bf16 v[48:51], a[188:191], a[124:127], v[48:51]
    buffer_load_dwordx4 a[52:55], v8, s[8:11], s24 offen offset:3072 sc1
    v_mfma_f32_16x16x32_bf16 v[48:51], a[184:187], a[120:123], v[48:51]
    s_waitcnt lgkmcnt(8)
    v_mfma_f32_16x16x32_bf16 v[64:67], a[160:163], a[120:123], v[64:67]
    ds_read_b64_tr_b16 a[184:185], v3 offset:8192
    v_mfma_f32_16x16x32_bf16 v[64:67], a[164:167], a[124:127], v[64:67]
    ds_read_b64_tr_b16 a[186:187], v3 offset:8704
    v_mfma_f32_16x16x32_bf16 v[68:71], a[164:167], a[132:135], v[68:71]
    buffer_load_dwordx4 a[56:59], v9, s[8:11], s24 offen offset:0 sc1
    v_mfma_f32_16x16x32_bf16 v[68:71], a[160:163], a[128:131], v[68:71]
    v_mfma_f32_16x16x32_bf16 v[72:75], a[160:163], a[136:139], v[72:75]
    ds_read_b64_tr_b16 a[188:189], v3 offset:12288
    v_mfma_f32_16x16x32_bf16 v[72:75], a[164:167], a[140:143], v[72:75]
    ds_read_b64_tr_b16 a[190:191], v3 offset:12800
    v_mfma_f32_16x16x32_bf16 v[76:79], a[164:167], a[148:151], v[76:79]
    buffer_load_dwordx4 a[60:63], v9, s[8:11], s24 offen offset:1024 sc1
    v_mfma_f32_16x16x32_bf16 v[76:79], a[160:163], a[144:147], v[76:79]
    s_waitcnt lgkmcnt(8)
    v_mfma_f32_16x16x32_bf16 v[92:95], a[168:171], a[144:147], v[92:95]
    ds_read_b64_tr_b16 a[160:161], v4 offset:8192
    v_mfma_f32_16x16x32_bf16 v[92:95], a[172:175], a[148:151], v[92:95]
    ds_read_b64_tr_b16 a[162:163], v4 offset:8704
    v_mfma_f32_16x16x32_bf16 v[88:91], a[172:175], a[140:143], v[88:91]
    buffer_load_dwordx4 a[64:67], v9, s[8:11], s24 offen offset:2048 sc1
    v_mfma_f32_16x16x32_bf16 v[88:91], a[168:171], a[136:139], v[88:91]
    v_mfma_f32_16x16x32_bf16 v[84:87], a[168:171], a[128:131], v[84:87]
    ds_read_b64_tr_b16 a[164:165], v4 offset:12288
    v_mfma_f32_16x16x32_bf16 v[84:87], a[172:175], a[132:135], v[84:87]
    ds_read_b64_tr_b16 a[166:167], v4 offset:12800
    v_mfma_f32_16x16x32_bf16 v[80:83], a[172:175], a[124:127], v[80:83]
    buffer_load_dwordx4 a[68:71], v9, s[8:11], s24 offen offset:3072 sc1
    v_mfma_f32_16x16x32_bf16 v[80:83], a[168:171], a[120:123], v[80:83]
    s_waitcnt lgkmcnt(8)
    v_mfma_f32_16x16x32_bf16 v[96:99], a[176:179], a[120:123], v[96:99]
    ds_read_b64_tr_b16 a[168:169], v10 offset:8192
    v_mfma_f32_16x16x32_bf16 v[96:99], a[180:183], a[124:127], v[96:99]
    ds_read_b64_tr_b16 a[170:171], v10 offset:8704
    s_add_u32 s25, s52, 5963776
    s_add_u32 s26, s53, 5963776
    s_add_u32 s27, s54, 5963776
    s_add_u32 s28, s55, 5963776
    s_add_u32 m0, s29, 0
    v_mfma_f32_16x16x32_bf16 v[100:103], a[180:183], a[132:135], v[100:103]
    buffer_load_dwordx4 v13, s[12:15], s25 offen  lds
    v_mfma_f32_16x16x32_bf16 v[100:103], a[176:179], a[128:131], v[100:103]
    v_mfma_f32_16x16x32_bf16 v[104:107], a[176:179], a[136:139], v[104:107]
    ds_read_b64_tr_b16 a[172:173], v10 offset:12288
    v_mfma_f32_16x16x32_bf16 v[104:107], a[180:183], a[140:143], v[104:107]
    ds_read_b64_tr_b16 a[174:175], v10 offset:12800
    s_add_u32 m0, s29, 1024
    v_mfma_f32_16x16x32_bf16 v[108:111], a[180:183], a[148:151], v[108:111]
    buffer_load_dwordx4 v14, s[12:15], s25 offen  lds
    v_mfma_f32_16x16x32_bf16 v[108:111], a[176:179], a[144:147], v[108:111]
    s_waitcnt lgkmcnt(8)
    v_mfma_f32_16x16x32_bf16 v[124:127], a[184:187], a[144:147], v[124:127]
    ds_read_b64_tr_b16 a[176:177], v2 offset:16384
    v_mfma_f32_16x16x32_bf16 v[124:127], a[188:191], a[148:151], v[124:127]
    ds_read_b64_tr_b16 a[178:179], v2 offset:16896
    s_add_u32 m0, s29, 8192
    v_mfma_f32_16x16x32_bf16 v[120:123], a[188:191], a[140:143], v[120:123]
    buffer_load_dwordx4 v13, s[12:15], s26 offen  lds
    v_mfma_f32_16x16x32_bf16 v[120:123], a[184:187], a[136:139], v[120:123]
    v_mfma_f32_16x16x32_bf16 v[116:119], a[184:187], a[128:131], v[116:119]
    ds_read_b64_tr_b16 a[180:181], v2 offset:20480
    v_mfma_f32_16x16x32_bf16 v[116:119], a[188:191], a[132:135], v[116:119]
    ds_read_b64_tr_b16 a[182:183], v2 offset:20992
    s_add_u32 m0, s29, 9216
    v_mfma_f32_16x16x32_bf16 v[112:115], a[188:191], a[124:127], v[112:115]
    buffer_load_dwordx4 v14, s[12:15], s26 offen  lds
    v_mfma_f32_16x16x32_bf16 v[112:115], a[184:187], a[120:123], v[112:115]
    s_waitcnt lgkmcnt(8)
    v_mfma_f32_16x16x32_bf16 v[128:131], a[160:163], a[120:123], v[128:131]
    ds_read_b64_tr_b16 a[184:185], v3 offset:16384
    v_mfma_f32_16x16x32_bf16 v[128:131], a[164:167], a[124:127], v[128:131]
    ds_read_b64_tr_b16 a[186:187], v3 offset:16896
    s_add_u32 m0, s29, 16384
    v_mfma_f32_16x16x32_bf16 v[132:135], a[164:167], a[132:135], v[132:135]
    buffer_load_dwordx4 v13, s[12:15], s27 offen  lds
    v_mfma_f32_16x16x32_bf16 v[132:135], a[160:163], a[128:131], v[132:135]
    v_mfma_f32_16x16x32_bf16 v[136:139], a[160:163], a[136:139], v[136:139]
    ds_read_b64_tr_b16 a[188:189], v3 offset:20480
    v_mfma_f32_16x16x32_bf16 v[136:139], a[164:167], a[140:143], v[136:139]
    ds_read_b64_tr_b16 a[190:191], v3 offset:20992
    s_add_u32 m0, s29, 17408
    v_mfma_f32_16x16x32_bf16 v[140:143], a[164:167], a[148:151], v[140:143]
    buffer_load_dwordx4 v14, s[12:15], s27 offen  lds
    v_mfma_f32_16x16x32_bf16 v[140:143], a[160:163], a[144:147], v[140:143]
    s_waitcnt lgkmcnt(8)
    v_mfma_f32_16x16x32_bf16 v[156:159], a[168:171], a[144:147], v[156:159]
    ds_read_b64_tr_b16 a[160:161], v4 offset:16384
    v_mfma_f32_16x16x32_bf16 v[156:159], a[172:175], a[148:151], v[156:159]
    ds_read_b64_tr_b16 a[162:163], v4 offset:16896
    s_add_u32 m0, s30, 0
    v_mfma_f32_16x16x32_bf16 v[152:155], a[172:175], a[140:143], v[152:155]
    buffer_load_dwordx4 v15, s[12:15], s28 offen  lds
    v_mfma_f32_16x16x32_bf16 v[152:155], a[168:171], a[136:139], v[152:155]
    v_mfma_f32_16x16x32_bf16 v[148:151], a[168:171], a[128:131], v[148:151]
    ds_read_b64_tr_b16 a[164:165], v4 offset:20480
    v_mfma_f32_16x16x32_bf16 v[148:151], a[172:175], a[132:135], v[148:151]
    ds_read_b64_tr_b16 a[166:167], v4 offset:20992
    s_mov_b32 s24, 3670016
    v_mfma_f32_16x16x32_bf16 v[144:147], a[172:175], a[124:127], v[144:147]
    buffer_load_dwordx4 a[80:83], v8, s[8:11], s24 offen offset:0 sc1
    v_mfma_f32_16x16x32_bf16 v[144:147], a[168:171], a[120:123], v[144:147]
    s_waitcnt lgkmcnt(8)
    v_mfma_f32_16x16x32_bf16 v[160:163], a[176:179], a[120:123], v[160:163]
    ds_read_b64_tr_b16 a[168:169], v10 offset:16384
    v_mfma_f32_16x16x32_bf16 v[160:163], a[180:183], a[124:127], v[160:163]
    ds_read_b64_tr_b16 a[170:171], v10 offset:16896
    v_mfma_f32_16x16x32_bf16 v[164:167], a[180:183], a[132:135], v[164:167]
    buffer_load_dwordx4 a[84:87], v8, s[8:11], s24 offen offset:1024 sc1
    v_mfma_f32_16x16x32_bf16 v[164:167], a[176:179], a[128:131], v[164:167]
    v_mfma_f32_16x16x32_bf16 v[168:171], a[176:179], a[136:139], v[168:171]
    ds_read_b64_tr_b16 a[172:173], v10 offset:20480
    v_mfma_f32_16x16x32_bf16 v[168:171], a[180:183], a[140:143], v[168:171]
    ds_read_b64_tr_b16 a[174:175], v10 offset:20992
    v_mfma_f32_16x16x32_bf16 v[172:175], a[180:183], a[148:151], v[172:175]
    buffer_load_dwordx4 a[88:91], v8, s[8:11], s24 offen offset:2048 sc1
    v_mfma_f32_16x16x32_bf16 v[172:175], a[176:179], a[144:147], v[172:175]
    s_waitcnt lgkmcnt(8)
    v_mfma_f32_16x16x32_bf16 v[188:191], a[184:187], a[144:147], v[188:191]
    ds_read_b64_tr_b16 a[176:177], v6 offset:24576
    v_mfma_f32_16x16x32_bf16 v[188:191], a[188:191], a[148:151], v[188:191]
    ds_read_b64_tr_b16 a[178:179], v6 offset:24832
    v_mfma_f32_16x16x32_bf16 v[184:187], a[188:191], a[140:143], v[184:187]
    buffer_load_dwordx4 a[92:95], v8, s[8:11], s24 offen offset:3072 sc1
    v_mfma_f32_16x16x32_bf16 v[184:187], a[184:187], a[136:139], v[184:187]
    v_mfma_f32_16x16x32_bf16 v[180:183], a[184:187], a[128:131], v[180:183]
    ds_read_b64_tr_b16 a[180:181], v6 offset:26624
    v_mfma_f32_16x16x32_bf16 v[180:183], a[188:191], a[132:135], v[180:183]
    ds_read_b64_tr_b16 a[182:183], v6 offset:26880
    v_mfma_f32_16x16x32_bf16 v[176:179], a[188:191], a[124:127], v[176:179]
    buffer_load_dwordx4 a[96:99], v9, s[8:11], s24 offen offset:0 sc1
    v_mfma_f32_16x16x32_bf16 v[176:179], a[184:187], a[120:123], v[176:179]
    s_waitcnt lgkmcnt(8)
    v_mfma_f32_16x16x32_bf16 v[192:195], a[160:163], a[120:123], v[192:195]
    ds_read_b64_tr_b16 a[184:185], v7 offset:24576
    v_mfma_f32_16x16x32_bf16 v[192:195], a[164:167], a[124:127], v[192:195]
    ds_read_b64_tr_b16 a[186:187], v7 offset:24832
    v_mfma_f32_16x16x32_bf16 v[196:199], a[164:167], a[132:135], v[196:199]
    buffer_load_dwordx4 a[100:103], v9, s[8:11], s24 offen offset:1024 sc1
    v_mfma_f32_16x16x32_bf16 v[196:199], a[160:163], a[128:131], v[196:199]
    v_mfma_f32_16x16x32_bf16 v[200:203], a[160:163], a[136:139], v[200:203]
    ds_read_b64_tr_b16 a[188:189], v7 offset:26624
    v_mfma_f32_16x16x32_bf16 v[200:203], a[164:167], a[140:143], v[200:203]
    ds_read_b64_tr_b16 a[190:191], v7 offset:26880
    v_mfma_f32_16x16x32_bf16 v[204:207], a[164:167], a[148:151], v[204:207]
    buffer_load_dwordx4 a[104:107], v9, s[8:11], s24 offen offset:2048 sc1
    v_mfma_f32_16x16x32_bf16 v[204:207], a[160:163], a[144:147], v[204:207]
    s_waitcnt lgkmcnt(8)
    v_mfma_f32_16x16x32_bf16 v[220:223], a[168:171], a[144:147], v[220:223]
    s_waitcnt vmcnt(31)
    s_barrier
    ds_read_b64_tr_b16 a[160:161], v20 offset:28672
    v_mfma_f32_16x16x32_bf16 v[220:223], a[172:175], a[148:151], v[220:223]
    ds_read_b64_tr_b16 a[162:163], v20 offset:29184
    v_mfma_f32_16x16x32_bf16 v[216:219], a[172:175], a[140:143], v[216:219]
    buffer_load_dwordx4 a[108:111], v9, s[8:11], s24 offen offset:3072 sc1
    v_mfma_f32_16x16x32_bf16 v[216:219], a[168:171], a[136:139], v[216:219]
    v_mfma_f32_16x16x32_bf16 v[212:215], a[168:171], a[128:131], v[212:215]
    ds_read_b64_tr_b16 a[164:165], v20 offset:32768
    v_mfma_f32_16x16x32_bf16 v[212:215], a[172:175], a[132:135], v[212:215]
    ds_read_b64_tr_b16 a[166:167], v20 offset:33280
    s_add_u32 s33, s68, 0
    v_mfma_f32_16x16x32_bf16 v[208:211], a[172:175], a[124:127], v[208:211]
    buffer_load_dword a253, v5, s[60:63], s33 offen
    v_mfma_f32_16x16x32_bf16 v[208:211], a[168:171], a[120:123], v[208:211]
    s_waitcnt lgkmcnt(8)
    v_mfma_f32_16x16x32_bf16 v[224:227], a[176:179], a[120:123], v[224:227]
    ds_read_b64_tr_b16 a[168:169], v21 offset:28672
    v_mfma_f32_16x16x32_bf16 v[224:227], a[180:183], a[124:127], v[224:227]
    ds_read_b64_tr_b16 a[170:171], v21 offset:29184
    v_mfma_f32_16x16x32_bf16 v[228:231], a[180:183], a[132:135], v[228:231]
    v_mfma_f32_16x16x32_bf16 v[228:231], a[176:179], a[128:131], v[228:231]
    v_mfma_f32_16x16x32_bf16 v[232:235], a[176:179], a[136:139], v[232:235]
    ds_read_b64_tr_b16 a[172:173], v21 offset:32768
    v_mfma_f32_16x16x32_bf16 v[232:235], a[180:183], a[140:143], v[232:235]
    ds_read_b64_tr_b16 a[174:175], v21 offset:33280
    v_mfma_f32_16x16x32_bf16 v[236:239], a[180:183], a[148:151], v[236:239]
    v_mfma_f32_16x16x32_bf16 v[236:239], a[176:179], a[144:147], v[236:239]
    s_waitcnt lgkmcnt(8)
    v_mfma_f32_16x16x32_bf16 v[252:255], a[184:187], a[144:147], v[252:255]
    ds_read_b64_tr_b16 a[176:177], v22 offset:28672
    v_mfma_f32_16x16x32_bf16 v[252:255], a[188:191], a[148:151], v[252:255]
    ds_read_b64_tr_b16 a[178:179], v22 offset:29184
    v_mfma_f32_16x16x32_bf16 v[248:251], a[188:191], a[140:143], v[248:251]
    v_mfma_f32_16x16x32_bf16 v[248:251], a[184:187], a[136:139], v[248:251]
    v_mfma_f32_16x16x32_bf16 v[244:247], a[184:187], a[128:131], v[244:247]
    ds_read_b64_tr_b16 a[180:181], v22 offset:32768
    v_mfma_f32_16x16x32_bf16 v[244:247], a[188:191], a[132:135], v[244:247]
    ds_read_b64_tr_b16 a[182:183], v22 offset:33280
    v_mfma_f32_16x16x32_bf16 v[240:243], a[188:191], a[124:127], v[240:243]
    v_mfma_f32_16x16x32_bf16 v[240:243], a[184:187], a[120:123], v[240:243]
    s_waitcnt lgkmcnt(8)
    v_mfma_f32_16x16x32_bf16 v[32:35], a[160:163], a[0:3], v[32:35]
    ds_read_b64_tr_b16 a[184:185], v23 offset:28672
    v_mfma_f32_16x16x32_bf16 v[32:35], a[164:167], a[4:7], v[32:35]
    ds_read_b64_tr_b16 a[186:187], v23 offset:29184
    s_add_u32 s25, s52, 6422528
    s_add_u32 s26, s53, 6422528
    s_add_u32 s27, s54, 6422528
    s_add_u32 s28, s55, 6422528
    s_add_u32 m0, s29, 28672
    v_mfma_f32_16x16x32_bf16 v[36:39], a[164:167], a[12:15], v[36:39]
    buffer_load_dwordx4 v13, s[12:15], s25 offen  lds
    v_mfma_f32_16x16x32_bf16 v[36:39], a[160:163], a[8:11], v[36:39]
    v_mfma_f32_16x16x32_bf16 v[40:43], a[160:163], a[16:19], v[40:43]
    ds_read_b64_tr_b16 a[188:189], v23 offset:32768
    v_mfma_f32_16x16x32_bf16 v[40:43], a[164:167], a[20:23], v[40:43]
    ds_read_b64_tr_b16 a[190:191], v23 offset:33280
    s_add_u32 m0, s29, 29696
    v_mfma_f32_16x16x32_bf16 v[44:47], a[164:167], a[28:31], v[44:47]
    buffer_load_dwordx4 v14, s[12:15], s25 offen  lds
    v_mfma_f32_16x16x32_bf16 v[44:47], a[160:163], a[24:27], v[44:47]
    s_waitcnt lgkmcnt(8)
    v_mfma_f32_16x16x32_bf16 v[60:63], a[168:171], a[24:27], v[60:63]
    ds_read_b64_tr_b16 a[160:161], v20 offset:36864
    v_mfma_f32_16x16x32_bf16 v[60:63], a[172:175], a[28:31], v[60:63]
    ds_read_b64_tr_b16 a[162:163], v20 offset:37376
    s_add_u32 m0, s29, 36864
    v_mfma_f32_16x16x32_bf16 v[56:59], a[172:175], a[20:23], v[56:59]
    buffer_load_dwordx4 v13, s[12:15], s26 offen  lds
    v_mfma_f32_16x16x32_bf16 v[56:59], a[168:171], a[16:19], v[56:59]
    v_mfma_f32_16x16x32_bf16 v[52:55], a[168:171], a[8:11], v[52:55]
    ds_read_b64_tr_b16 a[164:165], v20 offset:40960
    v_mfma_f32_16x16x32_bf16 v[52:55], a[172:175], a[12:15], v[52:55]
    ds_read_b64_tr_b16 a[166:167], v20 offset:41472
    s_add_u32 m0, s29, 37888
    v_mfma_f32_16x16x32_bf16 v[48:51], a[172:175], a[4:7], v[48:51]
    buffer_load_dwordx4 v14, s[12:15], s26 offen  lds
    v_mfma_f32_16x16x32_bf16 v[48:51], a[168:171], a[0:3], v[48:51]
    s_waitcnt lgkmcnt(8)
    v_mfma_f32_16x16x32_bf16 v[64:67], a[176:179], a[0:3], v[64:67]
    ds_read_b64_tr_b16 a[168:169], v21 offset:36864
    v_mfma_f32_16x16x32_bf16 v[64:67], a[180:183], a[4:7], v[64:67]
    ds_read_b64_tr_b16 a[170:171], v21 offset:37376
    s_add_u32 m0, s29, 45056
    v_mfma_f32_16x16x32_bf16 v[68:71], a[180:183], a[12:15], v[68:71]
    buffer_load_dwordx4 v13, s[12:15], s27 offen  lds
    v_mfma_f32_16x16x32_bf16 v[68:71], a[176:179], a[8:11], v[68:71]
    v_mfma_f32_16x16x32_bf16 v[72:75], a[176:179], a[16:19], v[72:75]
    ds_read_b64_tr_b16 a[172:173], v21 offset:40960
    v_mfma_f32_16x16x32_bf16 v[72:75], a[180:183], a[20:23], v[72:75]
    ds_read_b64_tr_b16 a[174:175], v21 offset:41472
    s_add_u32 m0, s29, 46080
    v_mfma_f32_16x16x32_bf16 v[76:79], a[180:183], a[28:31], v[76:79]
    buffer_load_dwordx4 v14, s[12:15], s27 offen  lds
    v_mfma_f32_16x16x32_bf16 v[76:79], a[176:179], a[24:27], v[76:79]
    s_waitcnt lgkmcnt(8)
    v_mfma_f32_16x16x32_bf16 v[92:95], a[184:187], a[24:27], v[92:95]
    ds_read_b64_tr_b16 a[176:177], v22 offset:36864
    v_mfma_f32_16x16x32_bf16 v[92:95], a[188:191], a[28:31], v[92:95]
    ds_read_b64_tr_b16 a[178:179], v22 offset:37376
    s_add_u32 m0, s30, 28672
    v_mfma_f32_16x16x32_bf16 v[88:91], a[188:191], a[20:23], v[88:91]
    buffer_load_dwordx4 v15, s[12:15], s28 offen  lds
    v_mfma_f32_16x16x32_bf16 v[88:91], a[184:187], a[16:19], v[88:91]
    v_mfma_f32_16x16x32_bf16 v[84:87], a[184:187], a[8:11], v[84:87]
    ds_read_b64_tr_b16 a[180:181], v22 offset:40960
    v_mfma_f32_16x16x32_bf16 v[84:87], a[188:191], a[12:15], v[84:87]
    ds_read_b64_tr_b16 a[182:183], v22 offset:41472
    s_mov_b32 s24, 3932160
    v_mfma_f32_16x16x32_bf16 v[80:83], a[188:191], a[4:7], v[80:83]
    buffer_load_dwordx4 a[120:123], v8, s[8:11], s24 offen offset:0 sc1
    v_mfma_f32_16x16x32_bf16 v[80:83], a[184:187], a[0:3], v[80:83]
    s_waitcnt lgkmcnt(8)
    v_mfma_f32_16x16x32_bf16 v[96:99], a[160:163], a[0:3], v[96:99]
    ds_read_b64_tr_b16 a[184:185], v23 offset:36864
    v_mfma_f32_16x16x32_bf16 v[96:99], a[164:167], a[4:7], v[96:99]
    ds_read_b64_tr_b16 a[186:187], v23 offset:37376
    v_mfma_f32_16x16x32_bf16 v[100:103], a[164:167], a[12:15], v[100:103]
    buffer_load_dwordx4 a[124:127], v8, s[8:11], s24 offen offset:1024 sc1
    v_mfma_f32_16x16x32_bf16 v[100:103], a[160:163], a[8:11], v[100:103]
    v_mfma_f32_16x16x32_bf16 v[104:107], a[160:163], a[16:19], v[104:107]
    ds_read_b64_tr_b16 a[188:189], v23 offset:40960
    v_mfma_f32_16x16x32_bf16 v[104:107], a[164:167], a[20:23], v[104:107]
    ds_read_b64_tr_b16 a[190:191], v23 offset:41472
    v_mfma_f32_16x16x32_bf16 v[108:111], a[164:167], a[28:31], v[108:111]
    buffer_load_dwordx4 a[128:131], v8, s[8:11], s24 offen offset:2048 sc1
    v_mfma_f32_16x16x32_bf16 v[108:111], a[160:163], a[24:27], v[108:111]
    s_waitcnt lgkmcnt(8)
    v_mfma_f32_16x16x32_bf16 v[124:127], a[168:171], a[24:27], v[124:127]
    ds_read_b64_tr_b16 a[160:161], v20 offset:45056
    v_mfma_f32_16x16x32_bf16 v[124:127], a[172:175], a[28:31], v[124:127]
    ds_read_b64_tr_b16 a[162:163], v20 offset:45568
    v_mfma_f32_16x16x32_bf16 v[120:123], a[172:175], a[20:23], v[120:123]
    buffer_load_dwordx4 a[132:135], v8, s[8:11], s24 offen offset:3072 sc1
    v_mfma_f32_16x16x32_bf16 v[120:123], a[168:171], a[16:19], v[120:123]
    v_mfma_f32_16x16x32_bf16 v[116:119], a[168:171], a[8:11], v[116:119]
    ds_read_b64_tr_b16 a[164:165], v20 offset:49152
    v_mfma_f32_16x16x32_bf16 v[116:119], a[172:175], a[12:15], v[116:119]
    ds_read_b64_tr_b16 a[166:167], v20 offset:49664
    v_mfma_f32_16x16x32_bf16 v[112:115], a[172:175], a[4:7], v[112:115]
    buffer_load_dwordx4 a[136:139], v9, s[8:11], s24 offen offset:0 sc1
    v_mfma_f32_16x16x32_bf16 v[112:115], a[168:171], a[0:3], v[112:115]
    s_waitcnt lgkmcnt(8)
    v_mfma_f32_16x16x32_bf16 v[128:131], a[176:179], a[0:3], v[128:131]
    ds_read_b64_tr_b16 a[168:169], v21 offset:45056
    v_mfma_f32_16x16x32_bf16 v[128:131], a[180:183], a[4:7], v[128:131]
    ds_read_b64_tr_b16 a[170:171], v21 offset:45568
    v_mfma_f32_16x16x32_bf16 v[132:135], a[180:183], a[12:15], v[132:135]
    buffer_load_dwordx4 a[140:143], v9, s[8:11], s24 offen offset:1024 sc1
    v_mfma_f32_16x16x32_bf16 v[132:135], a[176:179], a[8:11], v[132:135]
    v_mfma_f32_16x16x32_bf16 v[136:139], a[176:179], a[16:19], v[136:139]
    ds_read_b64_tr_b16 a[172:173], v21 offset:49152
    v_mfma_f32_16x16x32_bf16 v[136:139], a[180:183], a[20:23], v[136:139]
    ds_read_b64_tr_b16 a[174:175], v21 offset:49664
    v_mfma_f32_16x16x32_bf16 v[140:143], a[180:183], a[28:31], v[140:143]
    buffer_load_dwordx4 a[144:147], v9, s[8:11], s24 offen offset:2048 sc1
    v_mfma_f32_16x16x32_bf16 v[140:143], a[176:179], a[24:27], v[140:143]
    s_waitcnt lgkmcnt(8)
    v_mfma_f32_16x16x32_bf16 v[156:159], a[184:187], a[24:27], v[156:159]
    ds_read_b64_tr_b16 a[176:177], v22 offset:45056
    v_mfma_f32_16x16x32_bf16 v[156:159], a[188:191], a[28:31], v[156:159]
    ds_read_b64_tr_b16 a[178:179], v22 offset:45568
    v_mfma_f32_16x16x32_bf16 v[152:155], a[188:191], a[20:23], v[152:155]
    buffer_load_dwordx4 a[148:151], v9, s[8:11], s24 offen offset:3072 sc1
    v_mfma_f32_16x16x32_bf16 v[152:155], a[184:187], a[16:19], v[152:155]
    v_mfma_f32_16x16x32_bf16 v[148:151], a[184:187], a[8:11], v[148:151]
    ds_read_b64_tr_b16 a[180:181], v22 offset:49152
    v_mfma_f32_16x16x32_bf16 v[148:151], a[188:191], a[12:15], v[148:151]
    ds_read_b64_tr_b16 a[182:183], v22 offset:49664
    s_add_u32 s33, s68, 524288
    v_mfma_f32_16x16x32_bf16 v[144:147], a[188:191], a[4:7], v[144:147]
    buffer_load_dword a253, v5, s[60:63], s33 offen
    v_mfma_f32_16x16x32_bf16 v[144:147], a[184:187], a[0:3], v[144:147]
    s_waitcnt lgkmcnt(8)
    v_mfma_f32_16x16x32_bf16 v[160:163], a[160:163], a[0:3], v[160:163]
    ds_read_b64_tr_b16 a[184:185], v23 offset:45056
    v_mfma_f32_16x16x32_bf16 v[160:163], a[164:167], a[4:7], v[160:163]
    ds_read_b64_tr_b16 a[186:187], v23 offset:45568
    v_mfma_f32_16x16x32_bf16 v[164:167], a[164:167], a[12:15], v[164:167]
    v_mfma_f32_16x16x32_bf16 v[164:167], a[160:163], a[8:11], v[164:167]
    v_mfma_f32_16x16x32_bf16 v[168:171], a[160:163], a[16:19], v[168:171]
    ds_read_b64_tr_b16 a[188:189], v23 offset:49152
    v_mfma_f32_16x16x32_bf16 v[168:171], a[164:167], a[20:23], v[168:171]
    ds_read_b64_tr_b16 a[190:191], v23 offset:49664
    v_mfma_f32_16x16x32_bf16 v[172:175], a[164:167], a[28:31], v[172:175]
    v_mfma_f32_16x16x32_bf16 v[172:175], a[160:163], a[24:27], v[172:175]
    s_waitcnt lgkmcnt(8)
    v_mfma_f32_16x16x32_bf16 v[188:191], a[168:171], a[24:27], v[188:191]
    ds_read_b64_tr_b16 a[160:161], v26 offset:53248
    v_mfma_f32_16x16x32_bf16 v[188:191], a[172:175], a[28:31], v[188:191]
    ds_read_b64_tr_b16 a[162:163], v26 offset:53504
    v_mfma_f32_16x16x32_bf16 v[184:187], a[172:175], a[20:23], v[184:187]
    v_mfma_f32_16x16x32_bf16 v[184:187], a[168:171], a[16:19], v[184:187]
    v_mfma_f32_16x16x32_bf16 v[180:183], a[168:171], a[8:11], v[180:183]
    ds_read_b64_tr_b16 a[164:165], v26 offset:55296
    v_mfma_f32_16x16x32_bf16 v[180:183], a[172:175], a[12:15], v[180:183]
    ds_read_b64_tr_b16 a[166:167], v26 offset:55552
    v_mfma_f32_16x16x32_bf16 v[176:179], a[172:175], a[4:7], v[176:179]
    v_mfma_f32_16x16x32_bf16 v[176:179], a[168:171], a[0:3], v[176:179]
    s_waitcnt lgkmcnt(8)
    v_mfma_f32_16x16x32_bf16 v[192:195], a[176:179], a[0:3], v[192:195]
    ds_read_b64_tr_b16 a[168:169], v27 offset:53248
    v_mfma_f32_16x16x32_bf16 v[192:195], a[180:183], a[4:7], v[192:195]
    ds_read_b64_tr_b16 a[170:171], v27 offset:53504
    v_mfma_f32_16x16x32_bf16 v[196:199], a[180:183], a[12:15], v[196:199]
    v_mfma_f32_16x16x32_bf16 v[196:199], a[176:179], a[8:11], v[196:199]
    v_mfma_f32_16x16x32_bf16 v[200:203], a[176:179], a[16:19], v[200:203]
    ds_read_b64_tr_b16 a[172:173], v27 offset:55296
    v_mfma_f32_16x16x32_bf16 v[200:203], a[180:183], a[20:23], v[200:203]
    ds_read_b64_tr_b16 a[174:175], v27 offset:55552
    v_mfma_f32_16x16x32_bf16 v[204:207], a[180:183], a[28:31], v[204:207]
    v_mfma_f32_16x16x32_bf16 v[204:207], a[176:179], a[24:27], v[204:207]
    s_waitcnt lgkmcnt(8)
    v_mfma_f32_16x16x32_bf16 v[220:223], a[184:187], a[24:27], v[220:223]
    s_waitcnt vmcnt(1)
    s_barrier
    ds_read_b64_tr_b16 a[176:177], v16 offset:0
    v_mfma_f32_16x16x32_bf16 v[220:223], a[188:191], a[28:31], v[220:223]
    ds_read_b64_tr_b16 a[178:179], v16 offset:512
    v_mfma_f32_16x16x32_bf16 v[216:219], a[188:191], a[20:23], v[216:219]
    v_mfma_f32_16x16x32_bf16 v[216:219], a[184:187], a[16:19], v[216:219]
    v_mfma_f32_16x16x32_bf16 v[212:215], a[184:187], a[8:11], v[212:215]
    ds_read_b64_tr_b16 a[180:181], v16 offset:4096
    v_mfma_f32_16x16x32_bf16 v[212:215], a[188:191], a[12:15], v[212:215]
    ds_read_b64_tr_b16 a[182:183], v16 offset:4608
    v_mfma_f32_16x16x32_bf16 v[208:211], a[188:191], a[4:7], v[208:211]
    v_mfma_f32_16x16x32_bf16 v[208:211], a[184:187], a[0:3], v[208:211]
    s_waitcnt lgkmcnt(8)
    v_mfma_f32_16x16x32_bf16 v[224:227], a[160:163], a[0:3], v[224:227]
    ds_read_b64_tr_b16 a[184:185], v16 offset:28672
    v_mfma_f32_16x16x32_bf16 v[224:227], a[164:167], a[4:7], v[224:227]
    ds_read_b64_tr_b16 a[186:187], v16 offset:29184
    v_mfma_f32_16x16x32_bf16 v[228:231], a[164:167], a[12:15], v[228:231]
    v_mfma_f32_16x16x32_bf16 v[228:231], a[160:163], a[8:11], v[228:231]
    v_mfma_f32_16x16x32_bf16 v[232:235], a[160:163], a[16:19], v[232:235]
    ds_read_b64_tr_b16 a[188:189], v16 offset:32768
    v_mfma_f32_16x16x32_bf16 v[232:235], a[164:167], a[20:23], v[232:235]
    ds_read_b64_tr_b16 a[190:191], v16 offset:33280
    v_mfma_f32_16x16x32_bf16 v[236:239], a[164:167], a[28:31], v[236:239]
    v_mfma_f32_16x16x32_bf16 v[236:239], a[160:163], a[24:27], v[236:239]
    s_waitcnt lgkmcnt(8)
    v_mfma_f32_16x16x32_bf16 v[252:255], a[168:171], a[24:27], v[252:255]
    ds_read_b64_tr_b16 a[160:161], v20 offset:0
    v_mfma_f32_16x16x32_bf16 v[252:255], a[172:175], a[28:31], v[252:255]
    ds_read_b64_tr_b16 a[162:163], v20 offset:512
    v_mfma_f32_16x16x32_bf16 v[248:251], a[172:175], a[20:23], v[248:251]
    v_mfma_f32_16x16x32_bf16 v[248:251], a[168:171], a[16:19], v[248:251]
    v_mfma_f32_16x16x32_bf16 v[244:247], a[168:171], a[8:11], v[244:247]
    ds_read_b64_tr_b16 a[164:165], v20 offset:4096
    v_mfma_f32_16x16x32_bf16 v[244:247], a[172:175], a[12:15], v[244:247]
    ds_read_b64_tr_b16 a[166:167], v20 offset:4608
    v_mfma_f32_16x16x32_bf16 v[240:243], a[172:175], a[4:7], v[240:243]
    v_mfma_f32_16x16x32_bf16 v[240:243], a[168:171], a[0:3], v[240:243]
    s_waitcnt lgkmcnt(8)
    v_mov_b32 v28, s98
    v_mfma_f32_16x16x32_bf16 v[32:35], a[176:179], a[40:43], v[32:35]
    ds_read_b64_tr_b16 a[168:169], v17 offset:0
    v_mov_b32 v29, s99
    v_mfma_f32_16x16x32_bf16 v[32:35], a[180:183], a[44:47], v[32:35]
    ds_read_b64_tr_b16 a[170:171], v17 offset:512
    v_and_b32 v31, 15, v1
    v_mfma_f32_16x16x32_bf16 v[36:39], a[180:183], a[52:55], v[36:39]
    v_lshlrev_b32 v31, 3, v31
    s_lshl_b32 s44, s32, 7
    v_mfma_f32_16x16x32_bf16 v[36:39], a[176:179], a[48:51], v[36:39]
    s_add_u32 s44, s44, 32768
    s_mov_b32 s66, 7340032
    v_mfma_f32_16x16x32_bf16 v[40:43], a[176:179], a[56:59], v[40:43]
    ds_read_b64_tr_b16 a[172:173], v17 offset:4096
    s_bfe_u32 s26, s2, 0x20001
    v_mfma_f32_16x16x32_bf16 v[40:43], a[180:183], a[60:63], v[40:43]
    ds_read_b64_tr_b16 a[174:175], v17 offset:4608
    s_lshr_b32 s27, s5, 1
    v_mfma_f32_16x16x32_bf16 v[44:47], a[180:183], a[68:71], v[44:47]
    s_lshl_b32 s25, s26, 1
    s_add_u32 s25, s25, s27
    v_mfma_f32_16x16x32_bf16 v[44:47], a[176:179], a[64:67], v[44:47]
    s_waitcnt lgkmcnt(8)
    s_mul_i32 s25, s25, 14
    v_mfma_f32_16x16x32_bf16 v[44:47], a[184:187], a[104:107], v[44:47]
    ds_read_b64_tr_b16 a[176:177], v17 offset:28672
    s_lshl_b32 s25, s25, 16
    v_mfma_f32_16x16x32_bf16 v[44:47], a[188:191], a[108:111], v[44:47]
    ds_read_b64_tr_b16 a[178:179], v17 offset:29184
    s_add_u32 s25, s25, s59
    v_mfma_f32_16x16x32_bf16 v[40:43], a[188:191], a[100:103], v[40:43]
    s_add_u32 s28, s39, 5
    s_cmp_eq_u32 s39, 0
    v_mfma_f32_16x16x32_bf16 v[40:43], a[184:187], a[96:99], v[40:43]
    s_cselect_b32 s26, 6, 0
    s_cmp_eq_u32 s27, 0
    v_mfma_f32_16x16x32_bf16 v[36:39], a[184:187], a[88:91], v[36:39]
    ds_read_b64_tr_b16 a[180:181], v17 offset:32768
    s_cselect_b32 s28, s28, s26
    v_mfma_f32_16x16x32_bf16 v[36:39], a[188:191], a[92:95], v[36:39]
    ds_read_b64_tr_b16 a[182:183], v17 offset:33280
    s_mul_i32 s26, s4, 7
    v_mfma_f32_16x16x32_bf16 v[32:35], a[188:191], a[84:87], v[32:35]
    s_add_u32 s28, s28, s26
    s_lshl_b32 s28, s28, 16
    v_mfma_f32_16x16x32_bf16 v[32:35], a[184:187], a[80:83], v[32:35]
    s_waitcnt lgkmcnt(8)
    s_add_u32 s28, s28, s59
    v_mfma_f32_16x16x32_bf16 v[32:35], a[160:163], a[120:123], v[32:35]
    ds_read_b64_tr_b16 a[184:185], v21 offset:0
    v_and_b32 v13, 7, v1
    v_mfma_f32_16x16x32_bf16 v[32:35], a[164:167], a[124:127], v[32:35]
    ds_read_b64_tr_b16 a[186:187], v21 offset:512
    v_bfe_u32 v14, v1, 4, 2
    v_mfma_f32_16x16x32_bf16 v[36:39], a[164:167], a[132:135], v[36:39]
    v_lshlrev_b32 v14, 1, v14
    v_xor_b32 v14, v14, v13
    v_mfma_f32_16x16x32_bf16 v[36:39], a[160:163], a[128:131], v[36:39]
    v_lshrrev_b32 v15, 3, v1
    s_and_b32 s27, s5, 1
    v_mfma_f32_16x16x32_bf16 v[40:43], a[160:163], a[136:139], v[40:43]
    ds_read_b64_tr_b16 a[188:189], v21 offset:4096
    s_lshl_b32 s27, s27, 4
    v_mfma_f32_16x16x32_bf16 v[40:43], a[164:167], a[140:143], v[40:43]
    ds_read_b64_tr_b16 a[190:191], v21 offset:4608
    v_add_u32 v15, s27, v15
    v_mfma_f32_16x16x32_bf16 v[44:47], a[164:167], a[148:151], v[44:47]
    v_lshlrev_b32 v15, 11, v15
    v_lshl_add_u32 v13, v14, 4, v15
    v_mfma_f32_16x16x32_bf16 v[44:47], a[160:163], a[144:147], v[44:47]
    s_waitcnt lgkmcnt(8)
    v_add_u32 v14, 16384, v13
    v_mfma_f32_16x16x32_bf16 v[60:63], a[168:171], a[64:67], v[60:63]
    ds_read_b64_tr_b16 a[160:161], v18 offset:0
    s_add_u32 m0, s29, 114688
    v_mfma_f32_16x16x32_bf16 v[60:63], a[172:175], a[68:71], v[60:63]
    ds_read_b64_tr_b16 a[162:163], v18 offset:512
    buffer_load_dwordx4 v13, s[64:67], s28 offen offset:0 lds
    v_mfma_f32_16x16x32_bf16 v[56:59], a[172:175], a[60:63], v[56:59]
    s_add_u32 m0, s29, 122368
    s_nop 0
    buffer_load_dwordx4 v13, s[64:67], s28 offen offset:512 lds
    v_mfma_f32_16x16x32_bf16 v[56:59], a[168:171], a[56:59], v[56:59]
    s_add_u32 m0, s29, 115712
    s_nop 0
    buffer_load_dwordx4 v14, s[64:67], s28 offen offset:0 lds
    v_mfma_f32_16x16x32_bf16 v[52:55], a[168:171], a[48:51], v[52:55]
    ds_read_b64_tr_b16 a[164:165], v18 offset:4096
    s_add_u32 m0, s29, 123392
    v_mfma_f32_16x16x32_bf16 v[52:55], a[172:175], a[52:55], v[52:55]
    ds_read_b64_tr_b16 a[166:167], v18 offset:4608
    buffer_load_dwordx4 v14, s[64:67], s28 offen offset:512 lds
    v_mfma_f32_16x16x32_bf16 v[48:51], a[172:175], a[44:47], v[48:51]
    v_mfma_f32_16x16x32_bf16 v[48:51], a[168:171], a[40:43], v[48:51]
    s_waitcnt lgkmcnt(8)
    s_add_u32 s27, s25, 0
    v_mfma_f32_16x16x32_bf16 v[48:51], a[176:179], a[80:83], v[48:51]
    ds_read_b64_tr_b16 a[168:169], v18 offset:28672
    s_add_u32 m0, s29, 131072
    v_mfma_f32_16x16x32_bf16 v[48:51], a[180:183], a[84:87], v[48:51]
    ds_read_b64_tr_b16 a[170:171], v18 offset:29184
    buffer_load_dwordx4 v13, s[64:67], s27 offen offset:0 lds
    v_mfma_f32_16x16x32_bf16 v[52:55], a[180:183], a[92:95], v[52:55]
    s_add_u32 m0, s29, 138752
    s_nop 0
    buffer_load_dwordx4 v13, s[64:67], s27 offen offset:512 lds
    v_mfma_f32_16x16x32_bf16 v[52:55], a[176:179], a[88:91], v[52:55]
    s_add_u32 m0, s29, 132096
    s_nop 0
    buffer_load_dwordx4 v14, s[64:67], s27 offen offset:0 lds
    v_mfma_f32_16x16x32_bf16 v[56:59], a[176:179], a[96:99], v[56:59]
    ds_read_b64_tr_b16 a[172:173], v18 offset:32768
    s_add_u32 m0, s29, 139776
    v_mfma_f32_16x16x32_bf16 v[56:59], a[180:183], a[100:103], v[56:59]
    ds_read_b64_tr_b16 a[174:175], v18 offset:33280
    buffer_load_dwordx4 v14, s[64:67], s27 offen offset:512 lds
    v_mfma_f32_16x16x32_bf16 v[60:63], a[180:183], a[108:111], v[60:63]
    v_mfma_f32_16x16x32_bf16 v[60:63], a[176:179], a[104:107], v[60:63]
    s_waitcnt lgkmcnt(8)
    v_mfma_f32_16x16x32_bf16 v[60:63], a[184:187], a[144:147], v[60:63]
    ds_read_b64_tr_b16 a[176:177], v22 offset:0
    v_mfma_f32_16x16x32_bf16 v[60:63], a[188:191], a[148:151], v[60:63]
    ds_read_b64_tr_b16 a[178:179], v22 offset:512
    v_mfma_f32_16x16x32_bf16 v[56:59], a[188:191], a[140:143], v[56:59]
    v_mfma_f32_16x16x32_bf16 v[56:59], a[184:187], a[136:139], v[56:59]
    s_add_u32 s27, s25, 65536
    s_add_u32 m0, s29, 147456
    s_nop 0
    buffer_load_dwordx4 v13, s[64:67], s27 offen offset:0 lds
    s_add_u32 m0, s29, 155136
    s_nop 0
    buffer_load_dwordx4 v13, s[64:67], s27 offen offset:512 lds
    v_mfma_f32_16x16x32_bf16 v[52:55], a[184:187], a[128:131], v[52:55]
    ds_read_b64_tr_b16 a[180:181], v22 offset:4096
    s_add_u32 m0, s29, 148480
    v_mfma_f32_16x16x32_bf16 v[52:55], a[188:191], a[132:135], v[52:55]
    ds_read_b64_tr_b16 a[182:183], v22 offset:4608
    buffer_load_dwordx4 v14, s[64:67], s27 offen offset:0 lds
    s_add_u32 m0, s29, 156160
    v_mfma_f32_16x16x32_bf16 v[48:51], a[188:191], a[124:127], v[48:51]
    buffer_load_dwordx4 v14, s[64:67], s27 offen offset:512 lds
    v_mfma_f32_16x16x32_bf16 v[48:51], a[184:187], a[120:123], v[48:51]
    s_waitcnt lgkmcnt(8)
    v_mfma_f32_16x16x32_bf16 v[64:67], a[160:163], a[40:43], v[64:67]
    ds_read_b64_tr_b16 a[184:185], v19 offset:0
    v_mfma_f32_16x16x32_bf16 v[64:67], a[164:167], a[44:47], v[64:67]
    ds_read_b64_tr_b16 a[186:187], v19 offset:512
    v_mfma_f32_16x16x32_bf16 v[68:71], a[164:167], a[52:55], v[68:71]
    v_mfma_f32_16x16x32_bf16 v[68:71], a[160:163], a[48:51], v[68:71]
    v_mul_f32 v32, v32, abs(v32)
    v_mul_f32 v33, v33, abs(v33)
    v_mul_f32 v34, v34, abs(v34)
    v_mfma_f32_16x16x32_bf16 v[72:75], a[160:163], a[56:59], v[72:75]
    ds_read_b64_tr_b16 a[188:189], v19 offset:4096
    v_mul_f32 v35, v35, abs(v35)
    v_mul_f32 v48, v48, abs(v48)
    v_mfma_f32_16x16x32_bf16 v[72:75], a[164:167], a[60:63], v[72:75]
    ds_read_b64_tr_b16 a[190:191], v19 offset:4608
    v_mul_f32 v49, v49, abs(v49)
    v_mul_f32 v50, v50, abs(v50)
    v_mfma_f32_16x16x32_bf16 v[76:79], a[164:167], a[68:71], v[76:79]
    v_mul_f32 v51, v51, abs(v51)
    v_cvt_pk_bf16_f32 v32, v32, v33
    v_cvt_pk_bf16_f32 v33, v34, v35
    v_mfma_f32_16x16x32_bf16 v[76:79], a[160:163], a[64:67], v[76:79]
    s_waitcnt lgkmcnt(8)
    v_cvt_pk_bf16_f32 v34, v48, v49
    v_cvt_pk_bf16_f32 v35, v50, v51
    v_mfma_f32_16x16x32_bf16 v[76:79], a[168:171], a[104:107], v[76:79]
    ds_read_b64_tr_b16 a[160:161], v19 offset:28672
    v_pk_max_i16 v32, v32, 0
    v_pk_max_i16 v33, v33, 0
    v_mfma_f32_16x16x32_bf16 v[76:79], a[172:175], a[108:111], v[76:79]
    ds_read_b64_tr_b16 a[162:163], v19 offset:29184
    v_pk_max_i16 v34, v34, 0
    v_pk_max_i16 v35, v35, 0
    v_mfma_f32_16x16x32_bf16 v[72:75], a[172:175], a[100:103], v[72:75]
    buffer_store_dwordx4 v[32:35], v12, s[16:19], s38 offen offset:0 sc1
    v_mul_f32 v36, v36, abs(v36)
    v_mul_f32 v37, v37, abs(v37)
    v_mfma_f32_16x16x32_bf16 v[72:75], a[168:171], a[96:99], v[72:75]
    v_mul_f32 v38, v38, abs(v38)
    v_mul_f32 v39, v39, abs(v39)
    v_mul_f32 v52, v52, abs(v52)
    v_mfma_f32_16x16x32_bf16 v[68:71], a[168:171], a[88:91], v[68:71]
    ds_read_b64_tr_b16 a[164:165], v19 offset:32768
    v_mul_f32 v53, v53, abs(v53)
    v_mfma_f32_16x16x32_bf16 v[68:71], a[172:175], a[92:95], v[68:71]
    ds_read_b64_tr_b16 a[166:167], v19 offset:33280
    v_mul_f32 v54, v54, abs(v54)
    v_mul_f32 v55, v55, abs(v55)
    v_mfma_f32_16x16x32_bf16 v[64:67], a[172:175], a[84:87], v[64:67]
    v_cvt_pk_bf16_f32 v36, v36, v37
    v_cvt_pk_bf16_f32 v37, v38, v39
    v_mfma_f32_16x16x32_bf16 v[64:67], a[168:171], a[80:83], v[64:67]
    s_waitcnt lgkmcnt(8)
    v_cvt_pk_bf16_f32 v38, v52, v53
    v_mfma_f32_16x16x32_bf16 v[64:67], a[176:179], a[120:123], v[64:67]
    ds_read_b64_tr_b16 a[168:169], v23 offset:0
    v_cvt_pk_bf16_f32 v39, v54, v55
    v_mfma_f32_16x16x32_bf16 v[64:67], a[180:183], a[124:127], v[64:67]
    ds_read_b64_tr_b16 a[170:171], v23 offset:512
    v_pk_max_i16 v36, v36, 0
    v_mfma_f32_16x16x32_bf16 v[68:71], a[180:183], a[132:135], v[68:71]
    v_pk_max_i16 v37, v37, 0
    v_pk_max_i16 v38, v38, 0
    v_mfma_f32_16x16x32_bf16 v[68:71], a[176:179], a[128:131], v[68:71]
    v_pk_max_i16 v39, v39, 0
    buffer_store_dwordx4 v[36:39], v12, s[16:19], s38 offen offset:1024 sc1
    v_mfma_f32_16x16x32_bf16 v[72:75], a[176:179], a[136:139], v[72:75]
    ds_read_b64_tr_b16 a[172:173], v23 offset:4096
    v_mul_f32 v40, v40, abs(v40)
    v_mfma_f32_16x16x32_bf16 v[72:75], a[180:183], a[140:143], v[72:75]
    ds_read_b64_tr_b16 a[174:175], v23 offset:4608
    v_mul_f32 v41, v41, abs(v41)
    v_mfma_f32_16x16x32_bf16 v[76:79], a[180:183], a[148:151], v[76:79]
    v_mul_f32 v42, v42, abs(v42)
    v_mul_f32 v43, v43, abs(v43)
    v_mfma_f32_16x16x32_bf16 v[76:79], a[176:179], a[144:147], v[76:79]
    s_waitcnt lgkmcnt(8)
    v_mul_f32 v56, v56, abs(v56)
    v_mfma_f32_16x16x32_bf16 v[92:95], a[184:187], a[64:67], v[92:95]
    ds_read_b64_tr_b16 a[176:177], v16 offset:8192
    v_mul_f32 v57, v57, abs(v57)
    v_mfma_f32_16x16x32_bf16 v[92:95], a[188:191], a[68:71], v[92:95]
    ds_read_b64_tr_b16 a[178:179], v16 offset:8704
    v_mul_f32 v58, v58, abs(v58)
    v_mfma_f32_16x16x32_bf16 v[88:91], a[188:191], a[60:63], v[88:91]
    v_mul_f32 v59, v59, abs(v59)
    v_cvt_pk_bf16_f32 v40, v40, v41
    v_mfma_f32_16x16x32_bf16 v[88:91], a[184:187], a[56:59], v[88:91]
    v_cvt_pk_bf16_f32 v41, v42, v43
    v_cvt_pk_bf16_f32 v42, v56, v57
    v_mfma_f32_16x16x32_bf16 v[84:87], a[184:187], a[48:51], v[84:87]
    ds_read_b64_tr_b16 a[180:181], v16 offset:12288
    v_cvt_pk_bf16_f32 v43, v58, v59
    v_mfma_f32_16x16x32_bf16 v[84:87], a[188:191], a[52:55], v[84:87]
    ds_read_b64_tr_b16 a[182:183], v16 offset:12800
    v_pk_max_i16 v40, v40, 0
    v_mfma_f32_16x16x32_bf16 v[80:83], a[188:191], a[44:47], v[80:83]
    v_pk_max_i16 v41, v41, 0
    v_pk_max_i16 v42, v42, 0
    v_mfma_f32_16x16x32_bf16 v[80:83], a[184:187], a[40:43], v[80:83]
    s_waitcnt lgkmcnt(8)
    v_pk_max_i16 v43, v43, 0
    v_mfma_f32_16x16x32_bf16 v[80:83], a[160:163], a[80:83], v[80:83]
    ds_read_b64_tr_b16 a[184:185], v16 offset:36864
    buffer_store_dwordx4 v[40:43], v12, s[16:19], s38 offen offset:2048 sc1
    v_mfma_f32_16x16x32_bf16 v[80:83], a[164:167], a[84:87], v[80:83]
    ds_read_b64_tr_b16 a[186:187], v16 offset:37376
    v_mul_f32 v44, v44, abs(v44)
    v_mfma_f32_16x16x32_bf16 v[84:87], a[164:167], a[92:95], v[84:87]
    v_mul_f32 v45, v45, abs(v45)
    v_mul_f32 v46, v46, abs(v46)
    v_mfma_f32_16x16x32_bf16 v[84:87], a[160:163], a[88:91], v[84:87]
    v_mul_f32 v47, v47, abs(v47)
    v_mul_f32 v60, v60, abs(v60)
    v_mfma_f32_16x16x32_bf16 v[88:91], a[160:163], a[96:99], v[88:91]
    ds_read_b64_tr_b16 a[188:189], v16 offset:40960
    v_mul_f32 v61, v61, abs(v61)
    v_mfma_f32_16x16x32_bf16 v[88:91], a[164:167], a[100:103], v[88:91]
    ds_read_b64_tr_b16 a[190:191], v16 offset:41472
    v_mul_f32 v62, v62, abs(v62)
    v_mfma_f32_16x16x32_bf16 v[92:95], a[164:167], a[108:111], v[92:95]
    v_mul_f32 v63, v63, abs(v63)
    v_cvt_pk_bf16_f32 v44, v44, v45
    v_mfma_f32_16x16x32_bf16 v[92:95], a[160:163], a[104:107], v[92:95]
    s_waitcnt lgkmcnt(8)
    v_cvt_pk_bf16_f32 v45, v46, v47
    v_mfma_f32_16x16x32_bf16 v[92:95], a[168:171], a[144:147], v[92:95]
    ds_read_b64_tr_b16 a[160:161], v20 offset:8192
    v_cvt_pk_bf16_f32 v46, v60, v61
    v_mfma_f32_16x16x32_bf16 v[92:95], a[172:175], a[148:151], v[92:95]
    ds_read_b64_tr_b16 a[162:163], v20 offset:8704
    v_cvt_pk_bf16_f32 v47, v62, v63
    v_mfma_f32_16x16x32_bf16 v[88:91], a[172:175], a[140:143], v[88:91]
    v_pk_max_i16 v44, v44, 0
    v_pk_max_i16 v45, v45, 0
    v_mfma_f32_16x16x32_bf16 v[88:91], a[168:171], a[136:139], v[88:91]
    v_pk_max_i16 v46, v46, 0
    v_pk_max_i16 v47, v47, 0
    v_mfma_f32_16x16x32_bf16 v[84:87], a[168:171], a[128:131], v[84:87]
    ds_read_b64_tr_b16 a[164:165], v20 offset:12288
    buffer_store_dwordx4 v[44:47], v12, s[16:19], s38 offen offset:3072 sc1
    v_mfma_f32_16x16x32_bf16 v[84:87], a[172:175], a[132:135], v[84:87]
    ds_read_b64_tr_b16 a[166:167], v20 offset:12800
    s_add_u32 s38, s38, 131072
    v_mfma_f32_16x16x32_bf16 v[80:83], a[172:175], a[124:127], v[80:83]
    v_mfma_f32_16x16x32_bf16 v[80:83], a[168:171], a[120:123], v[80:83]
    s_waitcnt lgkmcnt(8)
    v_mfma_f32_16x16x32_bf16 v[96:99], a[176:179], a[40:43], v[96:99]
    ds_read_b64_tr_b16 a[168:169], v17 offset:8192
    v_mfma_f32_16x16x32_bf16 v[96:99], a[180:183], a[44:47], v[96:99]
    ds_read_b64_tr_b16 a[170:171], v17 offset:8704
    v_mfma_f32_16x16x32_bf16 v[100:103], a[180:183], a[52:55], v[100:103]
    v_mfma_f32_16x16x32_bf16 v[100:103], a[176:179], a[48:51], v[100:103]
    v_mul_f32 v64, v64, abs(v64)
    v_mul_f32 v65, v65, abs(v65)
    v_mul_f32 v66, v66, abs(v66)
    v_mfma_f32_16x16x32_bf16 v[104:107], a[176:179], a[56:59], v[104:107]
    ds_read_b64_tr_b16 a[172:173], v17 offset:12288
    v_mul_f32 v67, v67, abs(v67)
    v_mul_f32 v80, v80, abs(v80)
    v_mfma_f32_16x16x32_bf16 v[104:107], a[180:183], a[60:63], v[104:107]
    ds_read_b64_tr_b16 a[174:175], v17 offset:12800
    v_mul_f32 v81, v81, abs(v81)
    v_mul_f32 v82, v82, abs(v82)
    v_mfma_f32_16x16x32_bf16 v[108:111], a[180:183], a[68:71], v[108:111]
    v_mul_f32 v83, v83, abs(v83)
    v_cvt_pk_bf16_f32 v64, v64, v65
    v_cvt_pk_bf16_f32 v65, v66, v67
    v_mfma_f32_16x16x32_bf16 v[108:111], a[176:179], a[64:67], v[108:111]
    s_waitcnt lgkmcnt(8)
    v_cvt_pk_bf16_f32 v66, v80, v81
    v_cvt_pk_bf16_f32 v67, v82, v83
    v_mfma_f32_16x16x32_bf16 v[108:111], a[184:187], a[104:107], v[108:111]
    ds_read_b64_tr_b16 a[176:177], v17 offset:36864
    v_pk_max_i16 v64, v64, 0
    v_pk_max_i16 v65, v65, 0
    v_mfma_f32_16x16x32_bf16 v[108:111], a[188:191], a[108:111], v[108:111]
    ds_read_b64_tr_b16 a[178:179], v17 offset:37376
    v_pk_max_i16 v66, v66, 0
    v_pk_max_i16 v67, v67, 0
    v_mfma_f32_16x16x32_bf16 v[104:107], a[188:191], a[100:103], v[104:107]
    buffer_store_dwordx4 v[64:67], v12, s[16:19], s38 offen offset:0 sc1
    v_mul_f32 v68, v68, abs(v68)
    v_mul_f32 v69, v69, abs(v69)
    v_mfma_f32_16x16x32_bf16 v[104:107], a[184:187], a[96:99], v[104:107]
    v_mul_f32 v70, v70, abs(v70)
    v_mul_f32 v71, v71, abs(v71)
    v_mul_f32 v84, v84, abs(v84)
    v_mfma_f32_16x16x32_bf16 v[100:103], a[184:187], a[88:91], v[100:103]
    ds_read_b64_tr_b16 a[180:181], v17 offset:40960
    v_mul_f32 v85, v85, abs(v85)
    v_mfma_f32_16x16x32_bf16 v[100:103], a[188:191], a[92:95], v[100:103]
    ds_read_b64_tr_b16 a[182:183], v17 offset:41472
    v_mul_f32 v86, v86, abs(v86)
    v_mul_f32 v87, v87, abs(v87)
    v_mfma_f32_16x16x32_bf16 v[96:99], a[188:191], a[84:87], v[96:99]
    v_cvt_pk_bf16_f32 v68, v68, v69
    v_cvt_pk_bf16_f32 v69, v70, v71
    v_mfma_f32_16x16x32_bf16 v[96:99], a[184:187], a[80:83], v[96:99]
    s_waitcnt lgkmcnt(8)
    v_cvt_pk_bf16_f32 v70, v84, v85
    v_mfma_f32_16x16x32_bf16 v[96:99], a[160:163], a[120:123], v[96:99]
    ds_read_b64_tr_b16 a[184:185], v21 offset:8192
    v_cvt_pk_bf16_f32 v71, v86, v87
    v_mfma_f32_16x16x32_bf16 v[96:99], a[164:167], a[124:127], v[96:99]
    ds_read_b64_tr_b16 a[186:187], v21 offset:8704
    v_pk_max_i16 v68, v68, 0
    v_mfma_f32_16x16x32_bf16 v[100:103], a[164:167], a[132:135], v[100:103]
    v_pk_max_i16 v69, v69, 0
    v_pk_max_i16 v70, v70, 0
    v_mfma_f32_16x16x32_bf16 v[100:103], a[160:163], a[128:131], v[100:103]
    v_pk_max_i16 v71, v71, 0
    buffer_store_dwordx4 v[68:71], v12, s[16:19], s38 offen offset:1024 sc1
    v_mfma_f32_16x16x32_bf16 v[104:107], a[160:163], a[136:139], v[104:107]
    ds_read_b64_tr_b16 a[188:189], v21 offset:12288
    v_mul_f32 v72, v72, abs(v72)
    v_mfma_f32_16x16x32_bf16 v[104:107], a[164:167], a[140:143], v[104:107]
    ds_read_b64_tr_b16 a[190:191], v21 offset:12800
    v_mul_f32 v73, v73, abs(v73)
    v_mfma_f32_16x16x32_bf16 v[108:111], a[164:167], a[148:151], v[108:111]
    v_mul_f32 v74, v74, abs(v74)
    v_mul_f32 v75, v75, abs(v75)
    v_mfma_f32_16x16x32_bf16 v[108:111], a[160:163], a[144:147], v[108:111]
    s_waitcnt lgkmcnt(8)
    v_mul_f32 v88, v88, abs(v88)
    v_mfma_f32_16x16x32_bf16 v[124:127], a[168:171], a[64:67], v[124:127]
    ds_read_b64_tr_b16 a[160:161], v18 offset:8192
    v_mul_f32 v89, v89, abs(v89)
    v_mfma_f32_16x16x32_bf16 v[124:127], a[172:175], a[68:71], v[124:127]
    ds_read_b64_tr_b16 a[162:163], v18 offset:8704
    v_mul_f32 v90, v90, abs(v90)
    v_mfma_f32_16x16x32_bf16 v[120:123], a[172:175], a[60:63], v[120:123]
    v_mul_f32 v91, v91, abs(v91)
    v_cvt_pk_bf16_f32 v72, v72, v73
    v_mfma_f32_16x16x32_bf16 v[120:123], a[168:171], a[56:59], v[120:123]
    v_cvt_pk_bf16_f32 v73, v74, v75
    v_cvt_pk_bf16_f32 v74, v88, v89
    v_mfma_f32_16x16x32_bf16 v[116:119], a[168:171], a[48:51], v[116:119]
    ds_read_b64_tr_b16 a[164:165], v18 offset:12288
    v_cvt_pk_bf16_f32 v75, v90, v91
    v_mfma_f32_16x16x32_bf16 v[116:119], a[172:175], a[52:55], v[116:119]
    ds_read_b64_tr_b16 a[166:167], v18 offset:12800
    v_pk_max_i16 v72, v72, 0
    v_mfma_f32_16x16x32_bf16 v[112:115], a[172:175], a[44:47], v[112:115]
    v_pk_max_i16 v73, v73, 0
    v_pk_max_i16 v74, v74, 0
    v_mfma_f32_16x16x32_bf16 v[112:115], a[168:171], a[40:43], v[112:115]
    s_waitcnt lgkmcnt(8)
    v_pk_max_i16 v75, v75, 0
    v_mfma_f32_16x16x32_bf16 v[112:115], a[176:179], a[80:83], v[112:115]
    ds_read_b64_tr_b16 a[168:169], v18 offset:36864
    buffer_store_dwordx4 v[72:75], v12, s[16:19], s38 offen offset:2048 sc1
    v_mfma_f32_16x16x32_bf16 v[112:115], a[180:183], a[84:87], v[112:115]
    ds_read_b64_tr_b16 a[170:171], v18 offset:37376
    v_mul_f32 v76, v76, abs(v76)
    v_mfma_f32_16x16x32_bf16 v[116:119], a[180:183], a[92:95], v[116:119]
    v_mul_f32 v77, v77, abs(v77)
    v_mul_f32 v78, v78, abs(v78)
    v_mfma_f32_16x16x32_bf16 v[116:119], a[176:179], a[88:91], v[116:119]
    v_mul_f32 v79, v79, abs(v79)
    v_mul_f32 v92, v92, abs(v92)
    v_mfma_f32_16x16x32_bf16 v[120:123], a[176:179], a[96:99], v[120:123]
    ds_read_b64_tr_b16 a[172:173], v18 offset:40960
    v_mul_f32 v93, v93, abs(v93)
    v_mfma_f32_16x16x32_bf16 v[120:123], a[180:183], a[100:103], v[120:123]
    ds_read_b64_tr_b16 a[174:175], v18 offset:41472
    v_mul_f32 v94, v94, abs(v94)
    v_mfma_f32_16x16x32_bf16 v[124:127], a[180:183], a[108:111], v[124:127]
    v_mul_f32 v95, v95, abs(v95)
    v_cvt_pk_bf16_f32 v76, v76, v77
    v_mfma_f32_16x16x32_bf16 v[124:127], a[176:179], a[104:107], v[124:127]
    s_waitcnt lgkmcnt(8)
    v_cvt_pk_bf16_f32 v77, v78, v79
    v_mfma_f32_16x16x32_bf16 v[124:127], a[184:187], a[144:147], v[124:127]
    ds_read_b64_tr_b16 a[176:177], v22 offset:8192
    v_cvt_pk_bf16_f32 v78, v92, v93
    v_mfma_f32_16x16x32_bf16 v[124:127], a[188:191], a[148:151], v[124:127]
    ds_read_b64_tr_b16 a[178:179], v22 offset:8704
    v_cvt_pk_bf16_f32 v79, v94, v95
    v_mfma_f32_16x16x32_bf16 v[120:123], a[188:191], a[140:143], v[120:123]
    v_pk_max_i16 v76, v76, 0
    v_pk_max_i16 v77, v77, 0
    v_mfma_f32_16x16x32_bf16 v[120:123], a[184:187], a[136:139], v[120:123]
    v_pk_max_i16 v78, v78, 0
    v_pk_max_i16 v79, v79, 0
    v_mfma_f32_16x16x32_bf16 v[116:119], a[184:187], a[128:131], v[116:119]
    ds_read_b64_tr_b16 a[180:181], v22 offset:12288
    buffer_store_dwordx4 v[76:79], v12, s[16:19], s38 offen offset:3072 sc1
    v_mfma_f32_16x16x32_bf16 v[116:119], a[188:191], a[132:135], v[116:119]
    ds_read_b64_tr_b16 a[182:183], v22 offset:12800
    s_add_u32 s38, s38, 131072
    v_mfma_f32_16x16x32_bf16 v[112:115], a[188:191], a[124:127], v[112:115]
    v_mfma_f32_16x16x32_bf16 v[112:115], a[184:187], a[120:123], v[112:115]
    s_waitcnt lgkmcnt(8)
    v_mfma_f32_16x16x32_bf16 v[128:131], a[160:163], a[40:43], v[128:131]
    ds_read_b64_tr_b16 a[184:185], v19 offset:8192
    v_mfma_f32_16x16x32_bf16 v[128:131], a[164:167], a[44:47], v[128:131]
    ds_read_b64_tr_b16 a[186:187], v19 offset:8704
    v_mfma_f32_16x16x32_bf16 v[132:135], a[164:167], a[52:55], v[132:135]
    v_mfma_f32_16x16x32_bf16 v[132:135], a[160:163], a[48:51], v[132:135]
    v_mul_f32 v96, v96, abs(v96)
    v_mul_f32 v97, v97, abs(v97)
    v_mul_f32 v98, v98, abs(v98)
    v_mfma_f32_16x16x32_bf16 v[136:139], a[160:163], a[56:59], v[136:139]
    ds_read_b64_tr_b16 a[188:189], v19 offset:12288
    v_mul_f32 v99, v99, abs(v99)
    v_mul_f32 v112, v112, abs(v112)
    v_mfma_f32_16x16x32_bf16 v[136:139], a[164:167], a[60:63], v[136:139]
    ds_read_b64_tr_b16 a[190:191], v19 offset:12800
    v_mul_f32 v113, v113, abs(v113)
    v_mul_f32 v114, v114, abs(v114)
    v_mfma_f32_16x16x32_bf16 v[140:143], a[164:167], a[68:71], v[140:143]
    v_mul_f32 v115, v115, abs(v115)
    v_cvt_pk_bf16_f32 v96, v96, v97
    v_cvt_pk_bf16_f32 v97, v98, v99
    v_mfma_f32_16x16x32_bf16 v[140:143], a[160:163], a[64:67], v[140:143]
    s_waitcnt lgkmcnt(8)
    v_cvt_pk_bf16_f32 v98, v112, v113
    v_cvt_pk_bf16_f32 v99, v114, v115
    v_mfma_f32_16x16x32_bf16 v[140:143], a[168:171], a[104:107], v[140:143]
    ds_read_b64_tr_b16 a[160:161], v19 offset:36864
    v_pk_max_i16 v96, v96, 0
    v_pk_max_i16 v97, v97, 0
    v_mfma_f32_16x16x32_bf16 v[140:143], a[172:175], a[108:111], v[140:143]
    ds_read_b64_tr_b16 a[162:163], v19 offset:37376
    v_pk_max_i16 v98, v98, 0
    v_pk_max_i16 v99, v99, 0
    v_mfma_f32_16x16x32_bf16 v[136:139], a[172:175], a[100:103], v[136:139]
    buffer_store_dwordx4 v[96:99], v12, s[16:19], s38 offen offset:0 sc1
    v_mul_f32 v100, v100, abs(v100)
    v_mul_f32 v101, v101, abs(v101)
    v_mfma_f32_16x16x32_bf16 v[136:139], a[168:171], a[96:99], v[136:139]
    v_mul_f32 v102, v102, abs(v102)
    v_mul_f32 v103, v103, abs(v103)
    v_mul_f32 v116, v116, abs(v116)
    v_mfma_f32_16x16x32_bf16 v[132:135], a[168:171], a[88:91], v[132:135]
    ds_read_b64_tr_b16 a[164:165], v19 offset:40960
    v_mul_f32 v117, v117, abs(v117)
    v_mfma_f32_16x16x32_bf16 v[132:135], a[172:175], a[92:95], v[132:135]
    ds_read_b64_tr_b16 a[166:167], v19 offset:41472
    v_mul_f32 v118, v118, abs(v118)
    v_mul_f32 v119, v119, abs(v119)
    v_mfma_f32_16x16x32_bf16 v[128:131], a[172:175], a[84:87], v[128:131]
    v_cvt_pk_bf16_f32 v100, v100, v101
    v_cvt_pk_bf16_f32 v101, v102, v103
    v_mfma_f32_16x16x32_bf16 v[128:131], a[168:171], a[80:83], v[128:131]
    s_waitcnt lgkmcnt(8)
    v_cvt_pk_bf16_f32 v102, v116, v117
    v_mfma_f32_16x16x32_bf16 v[128:131], a[176:179], a[120:123], v[128:131]
    ds_read_b64_tr_b16 a[168:169], v23 offset:8192
    v_cvt_pk_bf16_f32 v103, v118, v119
    v_mfma_f32_16x16x32_bf16 v[128:131], a[180:183], a[124:127], v[128:131]
    ds_read_b64_tr_b16 a[170:171], v23 offset:8704
    v_pk_max_i16 v100, v100, 0
    v_mfma_f32_16x16x32_bf16 v[132:135], a[180:183], a[132:135], v[132:135]
    v_pk_max_i16 v101, v101, 0
    v_pk_max_i16 v102, v102, 0
    v_mfma_f32_16x16x32_bf16 v[132:135], a[176:179], a[128:131], v[132:135]
    v_pk_max_i16 v103, v103, 0
    buffer_store_dwordx4 v[100:103], v12, s[16:19], s38 offen offset:1024 sc1
    v_mfma_f32_16x16x32_bf16 v[136:139], a[176:179], a[136:139], v[136:139]
    ds_read_b64_tr_b16 a[172:173], v23 offset:12288
    v_mul_f32 v104, v104, abs(v104)
    v_mfma_f32_16x16x32_bf16 v[136:139], a[180:183], a[140:143], v[136:139]
    ds_read_b64_tr_b16 a[174:175], v23 offset:12800
    v_mul_f32 v105, v105, abs(v105)
    v_mfma_f32_16x16x32_bf16 v[140:143], a[180:183], a[148:151], v[140:143]
    v_mul_f32 v106, v106, abs(v106)
    v_mul_f32 v107, v107, abs(v107)
    v_mfma_f32_16x16x32_bf16 v[140:143], a[176:179], a[144:147], v[140:143]
    s_waitcnt lgkmcnt(8)
    v_mul_f32 v120, v120, abs(v120)
    v_mfma_f32_16x16x32_bf16 v[156:159], a[184:187], a[64:67], v[156:159]
    ds_read_b64_tr_b16 a[176:177], v16 offset:16384
    v_mul_f32 v121, v121, abs(v121)
    v_mfma_f32_16x16x32_bf16 v[156:159], a[188:191], a[68:71], v[156:159]
    ds_read_b64_tr_b16 a[178:179], v16 offset:16896
    v_mul_f32 v122, v122, abs(v122)
    v_mfma_f32_16x16x32_bf16 v[152:155], a[188:191], a[60:63], v[152:155]
    v_mul_f32 v123, v123, abs(v123)
    v_cvt_pk_bf16_f32 v104, v104, v105
    v_mfma_f32_16x16x32_bf16 v[152:155], a[184:187], a[56:59], v[152:155]
    v_cvt_pk_bf16_f32 v105, v106, v107
    v_cvt_pk_bf16_f32 v106, v120, v121
    v_mfma_f32_16x16x32_bf16 v[148:151], a[184:187], a[48:51], v[148:151]
    ds_read_b64_tr_b16 a[180:181], v16 offset:20480
    v_cvt_pk_bf16_f32 v107, v122, v123
    v_mfma_f32_16x16x32_bf16 v[148:151], a[188:191], a[52:55], v[148:151]
    ds_read_b64_tr_b16 a[182:183], v16 offset:20992
    v_pk_max_i16 v104, v104, 0
    v_mfma_f32_16x16x32_bf16 v[144:147], a[188:191], a[44:47], v[144:147]
    v_pk_max_i16 v105, v105, 0
    v_pk_max_i16 v106, v106, 0
    v_mfma_f32_16x16x32_bf16 v[144:147], a[184:187], a[40:43], v[144:147]
    s_waitcnt lgkmcnt(8)
    v_pk_max_i16 v107, v107, 0
    v_mfma_f32_16x16x32_bf16 v[144:147], a[160:163], a[80:83], v[144:147]
    ds_read_b64_tr_b16 a[184:185], v16 offset:45056
    buffer_store_dwordx4 v[104:107], v12, s[16:19], s38 offen offset:2048 sc1
    v_mfma_f32_16x16x32_bf16 v[144:147], a[164:167], a[84:87], v[144:147]
    ds_read_b64_tr_b16 a[186:187], v16 offset:45568
    v_mul_f32 v108, v108, abs(v108)
    v_mfma_f32_16x16x32_bf16 v[148:151], a[164:167], a[92:95], v[148:151]
    v_mul_f32 v109, v109, abs(v109)
    v_mul_f32 v110, v110, abs(v110)
    v_mfma_f32_16x16x32_bf16 v[148:151], a[160:163], a[88:91], v[148:151]
    v_mul_f32 v111, v111, abs(v111)
    v_mul_f32 v124, v124, abs(v124)
    v_mfma_f32_16x16x32_bf16 v[152:155], a[160:163], a[96:99], v[152:155]
    ds_read_b64_tr_b16 a[188:189], v16 offset:49152
    v_mul_f32 v125, v125, abs(v125)
    v_mfma_f32_16x16x32_bf16 v[152:155], a[164:167], a[100:103], v[152:155]
    ds_read_b64_tr_b16 a[190:191], v16 offset:49664
    v_mul_f32 v126, v126, abs(v126)
    v_mfma_f32_16x16x32_bf16 v[156:159], a[164:167], a[108:111], v[156:159]
    v_mul_f32 v127, v127, abs(v127)
    v_cvt_pk_bf16_f32 v108, v108, v109
    v_mfma_f32_16x16x32_bf16 v[156:159], a[160:163], a[104:107], v[156:159]
    s_waitcnt lgkmcnt(8)
    v_cvt_pk_bf16_f32 v109, v110, v111
    v_mfma_f32_16x16x32_bf16 v[156:159], a[168:171], a[144:147], v[156:159]
    ds_read_b64_tr_b16 a[160:161], v20 offset:16384
    v_cvt_pk_bf16_f32 v110, v124, v125
    v_mfma_f32_16x16x32_bf16 v[156:159], a[172:175], a[148:151], v[156:159]
    ds_read_b64_tr_b16 a[162:163], v20 offset:16896
    v_cvt_pk_bf16_f32 v111, v126, v127
    v_mfma_f32_16x16x32_bf16 v[152:155], a[172:175], a[140:143], v[152:155]
    v_pk_max_i16 v108, v108, 0
    v_pk_max_i16 v109, v109, 0
    v_mfma_f32_16x16x32_bf16 v[152:155], a[168:171], a[136:139], v[152:155]
    v_pk_max_i16 v110, v110, 0
    v_pk_max_i16 v111, v111, 0
    v_mfma_f32_16x16x32_bf16 v[148:151], a[168:171], a[128:131], v[148:151]
    ds_read_b64_tr_b16 a[164:165], v20 offset:20480
    buffer_store_dwordx4 v[108:111], v12, s[16:19], s38 offen offset:3072 sc1
    v_mfma_f32_16x16x32_bf16 v[148:151], a[172:175], a[132:135], v[148:151]
    ds_read_b64_tr_b16 a[166:167], v20 offset:20992
    s_add_u32 s38, s38, 131072
    v_mfma_f32_16x16x32_bf16 v[144:147], a[172:175], a[124:127], v[144:147]
    v_mfma_f32_16x16x32_bf16 v[144:147], a[168:171], a[120:123], v[144:147]
    s_waitcnt lgkmcnt(8)
    v_mfma_f32_16x16x32_bf16 v[160:163], a[176:179], a[40:43], v[160:163]
    ds_read_b64_tr_b16 a[168:169], v17 offset:16384
    v_mfma_f32_16x16x32_bf16 v[160:163], a[180:183], a[44:47], v[160:163]
    ds_read_b64_tr_b16 a[170:171], v17 offset:16896
    v_mfma_f32_16x16x32_bf16 v[164:167], a[180:183], a[52:55], v[164:167]
    v_mfma_f32_16x16x32_bf16 v[164:167], a[176:179], a[48:51], v[164:167]
    v_mul_f32 v128, v128, abs(v128)
    v_mul_f32 v129, v129, abs(v129)
    v_mul_f32 v130, v130, abs(v130)
    v_mfma_f32_16x16x32_bf16 v[168:171], a[176:179], a[56:59], v[168:171]
    ds_read_b64_tr_b16 a[172:173], v17 offset:20480
    v_mul_f32 v131, v131, abs(v131)
    v_mul_f32 v144, v144, abs(v144)
    v_mfma_f32_16x16x32_bf16 v[168:171], a[180:183], a[60:63], v[168:171]
    ds_read_b64_tr_b16 a[174:175], v17 offset:20992
    v_mul_f32 v145, v145, abs(v145)
    v_mul_f32 v146, v146, abs(v146)
    v_mfma_f32_16x16x32_bf16 v[172:175], a[180:183], a[68:71], v[172:175]
    v_mul_f32 v147, v147, abs(v147)
    v_cvt_pk_bf16_f32 v128, v128, v129
    v_cvt_pk_bf16_f32 v129, v130, v131
    v_mfma_f32_16x16x32_bf16 v[172:175], a[176:179], a[64:67], v[172:175]
    s_waitcnt lgkmcnt(8)
    v_cvt_pk_bf16_f32 v130, v144, v145
    v_cvt_pk_bf16_f32 v131, v146, v147
    v_mfma_f32_16x16x32_bf16 v[172:175], a[184:187], a[104:107], v[172:175]
    ds_read_b64_tr_b16 a[176:177], v17 offset:45056
    v_pk_max_i16 v128, v128, 0
    v_pk_max_i16 v129, v129, 0
    v_mfma_f32_16x16x32_bf16 v[172:175], a[188:191], a[108:111], v[172:175]
    ds_read_b64_tr_b16 a[178:179], v17 offset:45568
    v_pk_max_i16 v130, v130, 0
    v_pk_max_i16 v131, v131, 0
    v_mfma_f32_16x16x32_bf16 v[168:171], a[188:191], a[100:103], v[168:171]
    buffer_store_dwordx4 v[128:131], v12, s[16:19], s38 offen offset:0 sc1
    v_mul_f32 v132, v132, abs(v132)
    v_mul_f32 v133, v133, abs(v133)
    v_mfma_f32_16x16x32_bf16 v[168:171], a[184:187], a[96:99], v[168:171]
    v_mul_f32 v134, v134, abs(v134)
    v_mul_f32 v135, v135, abs(v135)
    v_mul_f32 v148, v148, abs(v148)
    v_mfma_f32_16x16x32_bf16 v[164:167], a[184:187], a[88:91], v[164:167]
    ds_read_b64_tr_b16 a[180:181], v17 offset:49152
    v_mul_f32 v149, v149, abs(v149)
    v_mfma_f32_16x16x32_bf16 v[164:167], a[188:191], a[92:95], v[164:167]
    ds_read_b64_tr_b16 a[182:183], v17 offset:49664
    v_mul_f32 v150, v150, abs(v150)
    v_mul_f32 v151, v151, abs(v151)
    v_mfma_f32_16x16x32_bf16 v[160:163], a[188:191], a[84:87], v[160:163]
    v_cvt_pk_bf16_f32 v132, v132, v133
    v_cvt_pk_bf16_f32 v133, v134, v135
    v_mfma_f32_16x16x32_bf16 v[160:163], a[184:187], a[80:83], v[160:163]
    s_waitcnt lgkmcnt(8)
    v_cvt_pk_bf16_f32 v134, v148, v149
    v_mfma_f32_16x16x32_bf16 v[160:163], a[160:163], a[120:123], v[160:163]
    ds_read_b64_tr_b16 a[184:185], v21 offset:16384
    v_cvt_pk_bf16_f32 v135, v150, v151
    v_mfma_f32_16x16x32_bf16 v[160:163], a[164:167], a[124:127], v[160:163]
    ds_read_b64_tr_b16 a[186:187], v21 offset:16896
    v_pk_max_i16 v132, v132, 0
    v_mfma_f32_16x16x32_bf16 v[164:167], a[164:167], a[132:135], v[164:167]
    v_pk_max_i16 v133, v133, 0
    v_pk_max_i16 v134, v134, 0
    v_mfma_f32_16x16x32_bf16 v[164:167], a[160:163], a[128:131], v[164:167]
    v_pk_max_i16 v135, v135, 0
    buffer_store_dwordx4 v[132:135], v12, s[16:19], s38 offen offset:1024 sc1
    v_mfma_f32_16x16x32_bf16 v[168:171], a[160:163], a[136:139], v[168:171]
    ds_read_b64_tr_b16 a[188:189], v21 offset:20480
    v_mul_f32 v136, v136, abs(v136)
    v_mfma_f32_16x16x32_bf16 v[168:171], a[164:167], a[140:143], v[168:171]
    ds_read_b64_tr_b16 a[190:191], v21 offset:20992
    v_mul_f32 v137, v137, abs(v137)
    v_mfma_f32_16x16x32_bf16 v[172:175], a[164:167], a[148:151], v[172:175]
    v_mul_f32 v138, v138, abs(v138)
    v_mul_f32 v139, v139, abs(v139)
    v_mfma_f32_16x16x32_bf16 v[172:175], a[160:163], a[144:147], v[172:175]
    s_waitcnt lgkmcnt(8)
    v_mul_f32 v152, v152, abs(v152)
    v_mfma_f32_16x16x32_bf16 v[188:191], a[168:171], a[64:67], v[188:191]
    ds_read_b64_tr_b16 a[160:161], v18 offset:16384
    v_mul_f32 v153, v153, abs(v153)
    v_mfma_f32_16x16x32_bf16 v[188:191], a[172:175], a[68:71], v[188:191]
    ds_read_b64_tr_b16 a[162:163], v18 offset:16896
    v_mul_f32 v154, v154, abs(v154)
    v_mfma_f32_16x16x32_bf16 v[184:187], a[172:175], a[60:63], v[184:187]
    v_mul_f32 v155, v155, abs(v155)
    v_cvt_pk_bf16_f32 v136, v136, v137
    v_mfma_f32_16x16x32_bf16 v[184:187], a[168:171], a[56:59], v[184:187]
    v_cvt_pk_bf16_f32 v137, v138, v139
    v_cvt_pk_bf16_f32 v138, v152, v153
    v_mfma_f32_16x16x32_bf16 v[180:183], a[168:171], a[48:51], v[180:183]
    ds_read_b64_tr_b16 a[164:165], v18 offset:20480
    v_cvt_pk_bf16_f32 v139, v154, v155
    v_mfma_f32_16x16x32_bf16 v[180:183], a[172:175], a[52:55], v[180:183]
    ds_read_b64_tr_b16 a[166:167], v18 offset:20992
    v_pk_max_i16 v136, v136, 0
    v_mfma_f32_16x16x32_bf16 v[176:179], a[172:175], a[44:47], v[176:179]
    v_pk_max_i16 v137, v137, 0
    v_pk_max_i16 v138, v138, 0
    v_mfma_f32_16x16x32_bf16 v[176:179], a[168:171], a[40:43], v[176:179]
    s_waitcnt lgkmcnt(8)
    v_pk_max_i16 v139, v139, 0
    v_mfma_f32_16x16x32_bf16 v[176:179], a[176:179], a[80:83], v[176:179]
    ds_read_b64_tr_b16 a[168:169], v18 offset:45056
    buffer_store_dwordx4 v[136:139], v12, s[16:19], s38 offen offset:2048 sc1
    v_mfma_f32_16x16x32_bf16 v[176:179], a[180:183], a[84:87], v[176:179]
    ds_read_b64_tr_b16 a[170:171], v18 offset:45568
    v_mul_f32 v140, v140, abs(v140)
    v_mfma_f32_16x16x32_bf16 v[180:183], a[180:183], a[92:95], v[180:183]
    v_mul_f32 v141, v141, abs(v141)
    v_mul_f32 v142, v142, abs(v142)
    v_mfma_f32_16x16x32_bf16 v[180:183], a[176:179], a[88:91], v[180:183]
    v_mul_f32 v143, v143, abs(v143)
    v_mul_f32 v156, v156, abs(v156)
    v_mfma_f32_16x16x32_bf16 v[184:187], a[176:179], a[96:99], v[184:187]
    ds_read_b64_tr_b16 a[172:173], v18 offset:49152
    v_mul_f32 v157, v157, abs(v157)
    v_mfma_f32_16x16x32_bf16 v[184:187], a[180:183], a[100:103], v[184:187]
    ds_read_b64_tr_b16 a[174:175], v18 offset:49664
    v_mul_f32 v158, v158, abs(v158)
    v_mfma_f32_16x16x32_bf16 v[188:191], a[180:183], a[108:111], v[188:191]
    v_mul_f32 v159, v159, abs(v159)
    v_cvt_pk_bf16_f32 v140, v140, v141
    v_mfma_f32_16x16x32_bf16 v[188:191], a[176:179], a[104:107], v[188:191]
    s_waitcnt lgkmcnt(8)
    v_cvt_pk_bf16_f32 v141, v142, v143
    v_mfma_f32_16x16x32_bf16 v[188:191], a[184:187], a[144:147], v[188:191]
    ds_read_b64_tr_b16 a[176:177], v22 offset:16384
    v_cvt_pk_bf16_f32 v142, v156, v157
    v_mfma_f32_16x16x32_bf16 v[188:191], a[188:191], a[148:151], v[188:191]
    ds_read_b64_tr_b16 a[178:179], v22 offset:16896
    v_cvt_pk_bf16_f32 v143, v158, v159
    v_mfma_f32_16x16x32_bf16 v[184:187], a[188:191], a[140:143], v[184:187]
    v_pk_max_i16 v140, v140, 0
    v_pk_max_i16 v141, v141, 0
    v_mfma_f32_16x16x32_bf16 v[184:187], a[184:187], a[136:139], v[184:187]
    v_pk_max_i16 v142, v142, 0
    v_pk_max_i16 v143, v143, 0
    v_mfma_f32_16x16x32_bf16 v[180:183], a[184:187], a[128:131], v[180:183]
    ds_read_b64_tr_b16 a[180:181], v22 offset:20480
    buffer_store_dwordx4 v[140:143], v12, s[16:19], s38 offen offset:3072 sc1
    v_mfma_f32_16x16x32_bf16 v[180:183], a[188:191], a[132:135], v[180:183]
    ds_read_b64_tr_b16 a[182:183], v22 offset:20992
    s_add_u32 s38, s38, 131072
    v_mfma_f32_16x16x32_bf16 v[176:179], a[188:191], a[124:127], v[176:179]
    v_mfma_f32_16x16x32_bf16 v[176:179], a[184:187], a[120:123], v[176:179]
    s_waitcnt lgkmcnt(8)
    v_mfma_f32_16x16x32_bf16 v[192:195], a[160:163], a[40:43], v[192:195]
    ds_read_b64_tr_b16 a[184:185], v19 offset:16384
    v_mfma_f32_16x16x32_bf16 v[192:195], a[164:167], a[44:47], v[192:195]
    ds_read_b64_tr_b16 a[186:187], v19 offset:16896
    v_mfma_f32_16x16x32_bf16 v[196:199], a[164:167], a[52:55], v[196:199]
    s_waitcnt vmcnt(4)
    s_barrier
    s_cmp_lg_u32 s5, 0
    s_cbranch_scc1 L_nost1
    buffer_store_dwordx2 v[28:29], v31, s[20:23], s44 offen sc1
L_nost1:
    v_mfma_f32_16x16x32_bf16 v[196:199], a[160:163], a[48:51], v[196:199]
    v_mul_f32 v160, v160, abs(v160)
    v_mul_f32 v161, v161, abs(v161)
    v_mul_f32 v162, v162, abs(v162)
    v_mfma_f32_16x16x32_bf16 v[200:203], a[160:163], a[56:59], v[200:203]
    ds_read_b64_tr_b16 a[188:189], v19 offset:20480
    v_mul_f32 v163, v163, abs(v163)
    v_mul_f32 v176, v176, abs(v176)
    v_mfma_f32_16x16x32_bf16 v[200:203], a[164:167], a[60:63], v[200:203]
    ds_read_b64_tr_b16 a[190:191], v19 offset:20992
    s_add_u32 s27, s25, 131072
    s_add_u32 m0, s29, 98304
    v_mfma_f32_16x16x32_bf16 v[204:207], a[164:167], a[68:71], v[204:207]
    buffer_load_dwordx4 v13, s[64:67], s27 offen offset:0 lds
    v_mul_f32 v177, v177, abs(v177)
    v_mul_f32 v178, v178, abs(v178)
    v_mfma_f32_16x16x32_bf16 v[204:207], a[160:163], a[64:67], v[204:207]
    s_waitcnt lgkmcnt(8)
    v_mul_f32 v179, v179, abs(v179)
    v_cvt_pk_bf16_f32 v160, v160, v161
    v_mfma_f32_16x16x32_bf16 v[204:207], a[168:171], a[104:107], v[204:207]
    ds_read_b64_tr_b16 a[160:161], v19 offset:45056
    v_cvt_pk_bf16_f32 v161, v162, v163
    v_cvt_pk_bf16_f32 v162, v176, v177
    v_mfma_f32_16x16x32_bf16 v[204:207], a[172:175], a[108:111], v[204:207]
    ds_read_b64_tr_b16 a[162:163], v19 offset:45568
    s_add_u32 m0, s29, 105984
    v_cvt_pk_bf16_f32 v163, v178, v179
    v_mfma_f32_16x16x32_bf16 v[200:203], a[172:175], a[100:103], v[200:203]
    buffer_load_dwordx4 v13, s[64:67], s27 offen offset:512 lds
    v_pk_max_i16 v160, v160, 0
    v_pk_max_i16 v161, v161, 0
    v_mfma_f32_16x16x32_bf16 v[200:203], a[168:171], a[96:99], v[200:203]
    v_pk_max_i16 v162, v162, 0
    v_pk_max_i16 v163, v163, 0
    buffer_store_dwordx4 v[160:163], v12, s[16:19], s38 offen offset:0 sc1
    v_mfma_f32_16x16x32_bf16 v[196:199], a[168:171], a[88:91], v[196:199]
    ds_read_b64_tr_b16 a[164:165], v19 offset:49152
    v_mul_f32 v164, v164, abs(v164)
    v_mul_f32 v165, v165, abs(v165)
    v_mfma_f32_16x16x32_bf16 v[196:199], a[172:175], a[92:95], v[196:199]
    ds_read_b64_tr_b16 a[166:167], v19 offset:49664
    s_add_u32 m0, s29, 99328
    v_mul_f32 v166, v166, abs(v166)
    v_mfma_f32_16x16x32_bf16 v[192:195], a[172:175], a[84:87], v[192:195]
    buffer_load_dwordx4 v14, s[64:67], s27 offen offset:0 lds
    v_mul_f32 v167, v167, abs(v167)
    v_mul_f32 v180, v180, abs(v180)
    v_mfma_f32_16x16x32_bf16 v[192:195], a[168:171], a[80:83], v[192:195]
    s_waitcnt lgkmcnt(8)
    v_mul_f32 v181, v181, abs(v181)
    v_mul_f32 v182, v182, abs(v182)
    v_mfma_f32_16x16x32_bf16 v[192:195], a[176:179], a[120:123], v[192:195]
    ds_read_b64_tr_b16 a[168:169], v23 offset:16384
    v_mul_f32 v183, v183, abs(v183)
    v_cvt_pk_bf16_f32 v164, v164, v165
    v_mfma_f32_16x16x32_bf16 v[192:195], a[180:183], a[124:127], v[192:195]
    ds_read_b64_tr_b16 a[170:171], v23 offset:16896
    s_add_u32 m0, s29, 107008
    v_cvt_pk_bf16_f32 v165, v166, v167
    v_mfma_f32_16x16x32_bf16 v[196:199], a[180:183], a[132:135], v[196:199]
    buffer_load_dwordx4 v14, s[64:67], s27 offen offset:512 lds
    v_cvt_pk_bf16_f32 v166, v180, v181
    v_cvt_pk_bf16_f32 v167, v182, v183
    v_mfma_f32_16x16x32_bf16 v[196:199], a[176:179], a[128:131], v[196:199]
    v_pk_max_i16 v164, v164, 0
    v_pk_max_i16 v165, v165, 0
    v_pk_max_i16 v166, v166, 0
    v_mfma_f32_16x16x32_bf16 v[200:203], a[176:179], a[136:139], v[200:203]
    ds_read_b64_tr_b16 a[172:173], v23 offset:20480
    v_pk_max_i16 v167, v167, 0
    buffer_store_dwordx4 v[164:167], v12, s[16:19], s38 offen offset:1024 sc1
    v_mfma_f32_16x16x32_bf16 v[200:203], a[180:183], a[140:143], v[200:203]
    ds_read_b64_tr_b16 a[174:175], v23 offset:20992
    s_add_u32 s27, s25, 524288
    s_add_u32 m0, s29, 28672
    v_mfma_f32_16x16x32_bf16 v[204:207], a[180:183], a[148:151], v[204:207]
    buffer_load_dwordx4 v13, s[64:67], s27 offen offset:0 lds
    v_mul_f32 v168, v168, abs(v168)
    v_mul_f32 v169, v169, abs(v169)
    v_mfma_f32_16x16x32_bf16 v[204:207], a[176:179], a[144:147], v[204:207]
    s_waitcnt lgkmcnt(8)
    v_mul_f32 v170, v170, abs(v170)
    v_mul_f32 v171, v171, abs(v171)
    v_mfma_f32_16x16x32_bf16 v[220:223], a[184:187], a[64:67], v[220:223]
    ds_read_b64_tr_b16 a[176:177], v24 offset:24576
    v_mul_f32 v184, v184, abs(v184)
    v_mfma_f32_16x16x32_bf16 v[220:223], a[188:191], a[68:71], v[220:223]
    ds_read_b64_tr_b16 a[178:179], v24 offset:24832
    s_add_u32 m0, s29, 36352
    v_mul_f32 v185, v185, abs(v185)
    v_mfma_f32_16x16x32_bf16 v[216:219], a[188:191], a[60:63], v[216:219]
    buffer_load_dwordx4 v13, s[64:67], s27 offen offset:512 lds
    v_mul_f32 v186, v186, abs(v186)
    v_mul_f32 v187, v187, abs(v187)
    v_mfma_f32_16x16x32_bf16 v[216:219], a[184:187], a[56:59], v[216:219]
    v_cvt_pk_bf16_f32 v168, v168, v169
    v_cvt_pk_bf16_f32 v169, v170, v171
    v_mfma_f32_16x16x32_bf16 v[212:215], a[184:187], a[48:51], v[212:215]
    ds_read_b64_tr_b16 a[180:181], v24 offset:26624
    v_cvt_pk_bf16_f32 v170, v184, v185
    v_mfma_f32_16x16x32_bf16 v[212:215], a[188:191], a[52:55], v[212:215]
    ds_read_b64_tr_b16 a[182:183], v24 offset:26880
    s_add_u32 m0, s29, 29696
    v_mfma_f32_16x16x32_bf16 v[208:211], a[188:191], a[44:47], v[208:211]
    buffer_load_dwordx4 v14, s[64:67], s27 offen offset:0 lds
    v_cvt_pk_bf16_f32 v171, v186, v187
    v_pk_max_i16 v168, v168, 0
    v_mfma_f32_16x16x32_bf16 v[208:211], a[184:187], a[40:43], v[208:211]
    s_waitcnt lgkmcnt(8)
    v_pk_max_i16 v169, v169, 0
    v_pk_max_i16 v170, v170, 0
    v_mfma_f32_16x16x32_bf16 v[208:211], a[160:163], a[80:83], v[208:211]
    ds_read_b64_tr_b16 a[184:185], v24 offset:53248
    v_pk_max_i16 v171, v171, 0
    v_mfma_f32_16x16x32_bf16 v[208:211], a[164:167], a[84:87], v[208:211]
    ds_read_b64_tr_b16 a[186:187], v24 offset:53504
    s_add_u32 m0, s29, 37376
    buffer_store_dwordx4 v[168:171], v12, s[16:19], s38 offen offset:2048 sc1
    v_mfma_f32_16x16x32_bf16 v[212:215], a[164:167], a[92:95], v[212:215]
    buffer_load_dwordx4 v14, s[64:67], s27 offen offset:512 lds
    v_mul_f32 v172, v172, abs(v172)
    v_mul_f32 v173, v173, abs(v173)
    v_mfma_f32_16x16x32_bf16 v[212:215], a[160:163], a[88:91], v[212:215]
    v_mul_f32 v174, v174, abs(v174)
    v_mul_f32 v175, v175, abs(v175)
    v_mfma_f32_16x16x32_bf16 v[216:219], a[160:163], a[96:99], v[216:219]
    ds_read_b64_tr_b16 a[188:189], v24 offset:55296
    v_mul_f32 v188, v188, abs(v188)
    v_mfma_f32_16x16x32_bf16 v[216:219], a[164:167], a[100:103], v[216:219]
    ds_read_b64_tr_b16 a[190:191], v24 offset:55552
    s_add_u32 s27, s25, 589824
    s_add_u32 m0, s29, 57344
    v_mfma_f32_16x16x32_bf16 v[220:223], a[164:167], a[108:111], v[220:223]
    buffer_load_dwordx4 v13, s[64:67], s27 offen offset:0 lds
    v_mul_f32 v189, v189, abs(v189)
    v_mul_f32 v190, v190, abs(v190)
    v_mfma_f32_16x16x32_bf16 v[220:223], a[160:163], a[104:107], v[220:223]
    s_waitcnt lgkmcnt(8)
    v_mul_f32 v191, v191, abs(v191)
    v_cvt_pk_bf16_f32 v172, v172, v173
    v_mfma_f32_16x16x32_bf16 v[220:223], a[168:171], a[144:147], v[220:223]
    ds_read_b64_tr_b16 a[160:161], v26 offset:24576
    v_cvt_pk_bf16_f32 v173, v174, v175
    v_mfma_f32_16x16x32_bf16 v[220:223], a[172:175], a[148:151], v[220:223]
    ds_read_b64_tr_b16 a[162:163], v26 offset:24832
    s_add_u32 m0, s29, 65024
    v_mfma_f32_16x16x32_bf16 v[216:219], a[172:175], a[140:143], v[216:219]
    buffer_load_dwordx4 v13, s[64:67], s27 offen offset:512 lds
    v_cvt_pk_bf16_f32 v174, v188, v189
    v_cvt_pk_bf16_f32 v175, v190, v191
    v_mfma_f32_16x16x32_bf16 v[216:219], a[168:171], a[136:139], v[216:219]
    v_pk_max_i16 v172, v172, 0
    v_pk_max_i16 v173, v173, 0
    v_pk_max_i16 v174, v174, 0
    v_mfma_f32_16x16x32_bf16 v[212:215], a[168:171], a[128:131], v[212:215]
    ds_read_b64_tr_b16 a[164:165], v26 offset:26624
    v_pk_max_i16 v175, v175, 0
    v_mfma_f32_16x16x32_bf16 v[212:215], a[172:175], a[132:135], v[212:215]
    ds_read_b64_tr_b16 a[166:167], v26 offset:26880
    s_add_u32 m0, s29, 58368
    v_mfma_f32_16x16x32_bf16 v[208:211], a[172:175], a[124:127], v[208:211]
    buffer_load_dwordx4 v14, s[64:67], s27 offen offset:0 lds
    buffer_store_dwordx4 v[172:175], v12, s[16:19], s38 offen offset:3072 sc1
    s_add_u32 s38, s38, 131072
    v_mfma_f32_16x16x32_bf16 v[208:211], a[168:171], a[120:123], v[208:211]
    s_waitcnt lgkmcnt(8)
    v_mfma_f32_16x16x32_bf16 v[224:227], a[176:179], a[40:43], v[224:227]
    ds_read_b64_tr_b16 a[168:169], v25 offset:24576
    v_mfma_f32_16x16x32_bf16 v[224:227], a[180:183], a[44:47], v[224:227]
    ds_read_b64_tr_b16 a[170:171], v25 offset:24832
    s_add_u32 m0, s29, 66048
    v_mfma_f32_16x16x32_bf16 v[228:231], a[180:183], a[52:55], v[228:231]
    buffer_load_dwordx4 v14, s[64:67], s27 offen offset:512 lds
    v_mfma_f32_16x16x32_bf16 v[228:231], a[176:179], a[48:51], v[228:231]
    v_mul_f32 v192, v192, abs(v192)
    v_mul_f32 v193, v193, abs(v193)
    v_mul_f32 v194, v194, abs(v194)
    v_mfma_f32_16x16x32_bf16 v[232:235], a[176:179], a[56:59], v[232:235]
    ds_read_b64_tr_b16 a[172:173], v25 offset:26624
    v_mul_f32 v195, v195, abs(v195)
    v_mul_f32 v208, v208, abs(v208)
    v_mfma_f32_16x16x32_bf16 v[232:235], a[180:183], a[60:63], v[232:235]
    ds_read_b64_tr_b16 a[174:175], v25 offset:26880
    s_add_u32 s27, s25, 655360
    s_add_u32 m0, s29, 0
    v_mfma_f32_16x16x32_bf16 v[236:239], a[180:183], a[68:71], v[236:239]
    buffer_load_dwordx4 v13, s[64:67], s27 offen offset:0 lds
    v_mul_f32 v209, v209, abs(v209)
    v_mul_f32 v210, v210, abs(v210)
    v_mfma_f32_16x16x32_bf16 v[236:239], a[176:179], a[64:67], v[236:239]
    s_waitcnt lgkmcnt(8)
    v_mul_f32 v211, v211, abs(v211)
    v_cvt_pk_bf16_f32 v192, v192, v193
    v_mfma_f32_16x16x32_bf16 v[236:239], a[184:187], a[104:107], v[236:239]
    ds_read_b64_tr_b16 a[176:177], v25 offset:53248
    v_cvt_pk_bf16_f32 v193, v194, v195
    v_cvt_pk_bf16_f32 v194, v208, v209
    v_mfma_f32_16x16x32_bf16 v[236:239], a[188:191], a[108:111], v[236:239]
    ds_read_b64_tr_b16 a[178:179], v25 offset:53504
    s_add_u32 m0, s29, 7680
    v_cvt_pk_bf16_f32 v195, v210, v211
    v_mfma_f32_16x16x32_bf16 v[232:235], a[188:191], a[100:103], v[232:235]
    buffer_load_dwordx4 v13, s[64:67], s27 offen offset:512 lds
    v_pk_max_i16 v192, v192, 0
    v_pk_max_i16 v193, v193, 0
    v_mfma_f32_16x16x32_bf16 v[232:235], a[184:187], a[96:99], v[232:235]
    v_pk_max_i16 v194, v194, 0
    v_pk_max_i16 v195, v195, 0
    v_mul_f32 v196, v196, abs(v196)
    v_mfma_f32_16x16x32_bf16 v[228:231], a[184:187], a[88:91], v[228:231]
    ds_read_b64_tr_b16 a[180:181], v25 offset:55296
    v_mul_f32 v197, v197, abs(v197)
    v_mul_f32 v198, v198, abs(v198)
    v_mfma_f32_16x16x32_bf16 v[228:231], a[188:191], a[92:95], v[228:231]
    ds_read_b64_tr_b16 a[182:183], v25 offset:55552
    s_add_u32 m0, s29, 1024
    v_mul_f32 v199, v199, abs(v199)
    v_mfma_f32_16x16x32_bf16 v[224:227], a[188:191], a[84:87], v[224:227]
    buffer_load_dwordx4 v14, s[64:67], s27 offen offset:0 lds
    v_mul_f32 v212, v212, abs(v212)
    v_mul_f32 v213, v213, abs(v213)
    v_mfma_f32_16x16x32_bf16 v[224:227], a[184:187], a[80:83], v[224:227]
    s_waitcnt lgkmcnt(8)
    v_mul_f32 v214, v214, abs(v214)
    v_mul_f32 v215, v215, abs(v215)
    v_mfma_f32_16x16x32_bf16 v[224:227], a[160:163], a[120:123], v[224:227]
    ds_read_b64_tr_b16 a[184:185], v27 offset:24576
    v_cvt_pk_bf16_f32 v196, v196, v197
    v_cvt_pk_bf16_f32 v197, v198, v199
    v_mfma_f32_16x16x32_bf16 v[224:227], a[164:167], a[124:127], v[224:227]
    ds_read_b64_tr_b16 a[186:187], v27 offset:24832
    s_add_u32 m0, s29, 8704
    v_cvt_pk_bf16_f32 v198, v212, v213
    v_mfma_f32_16x16x32_bf16 v[228:231], a[164:167], a[132:135], v[228:231]
    buffer_load_dwordx4 v14, s[64:67], s27 offen offset:512 lds
    v_cvt_pk_bf16_f32 v199, v214, v215
    v_pk_max_i16 v196, v196, 0
    v_mfma_f32_16x16x32_bf16 v[228:231], a[160:163], a[128:131], v[228:231]
    v_pk_max_i16 v197, v197, 0
    v_pk_max_i16 v198, v198, 0
    v_pk_max_i16 v199, v199, 0
    v_mfma_f32_16x16x32_bf16 v[232:235], a[160:163], a[136:139], v[232:235]
    ds_read_b64_tr_b16 a[188:189], v27 offset:26624
    v_mul_f32 v200, v200, abs(v200)
    v_mul_f32 v201, v201, abs(v201)
    v_mfma_f32_16x16x32_bf16 v[232:235], a[164:167], a[140:143], v[232:235]
    ds_read_b64_tr_b16 a[190:191], v27 offset:26880
    v_mul_f32 v202, v202, abs(v202)
    v_mul_f32 v203, v203, abs(v203)
    v_mfma_f32_16x16x32_bf16 v[236:239], a[164:167], a[148:151], v[236:239]
    v_mul_f32 v216, v216, abs(v216)
    v_mul_f32 v217, v217, abs(v217)
    v_mul_f32 v218, v218, abs(v218)
    v_mfma_f32_16x16x32_bf16 v[236:239], a[160:163], a[144:147], v[236:239]
    s_waitcnt lgkmcnt(8)
    v_mul_f32 v219, v219, abs(v219)
    v_cvt_pk_bf16_f32 v200, v200, v201
    v_mfma_f32_16x16x32_bf16 v[252:255], a[168:171], a[64:67], v[252:255]
    v_cvt_pk_bf16_f32 v201, v202, v203
    v_cvt_pk_bf16_f32 v202, v216, v217
    v_mfma_f32_16x16x32_bf16 v[252:255], a[172:175], a[68:71], v[252:255]
    v_cvt_pk_bf16_f32 v203, v218, v219
    v_pk_max_i16 v200, v200, 0
    v_mfma_f32_16x16x32_bf16 v[248:251], a[172:175], a[60:63], v[248:251]
    v_pk_max_i16 v201, v201, 0
    v_pk_max_i16 v202, v202, 0
    v_mfma_f32_16x16x32_bf16 v[248:251], a[168:171], a[56:59], v[248:251]
    v_pk_max_i16 v203, v203, 0
    v_mul_f32 v204, v204, abs(v204)
    v_mfma_f32_16x16x32_bf16 v[244:247], a[168:171], a[48:51], v[244:247]
    v_mul_f32 v205, v205, abs(v205)
    v_mul_f32 v206, v206, abs(v206)
    v_mfma_f32_16x16x32_bf16 v[244:247], a[172:175], a[52:55], v[244:247]
    v_mul_f32 v207, v207, abs(v207)
    v_mul_f32 v220, v220, abs(v220)
    v_mfma_f32_16x16x32_bf16 v[240:243], a[172:175], a[44:47], v[240:243]
    v_mul_f32 v221, v221, abs(v221)
    v_mul_f32 v222, v222, abs(v222)
    v_mfma_f32_16x16x32_bf16 v[240:243], a[168:171], a[40:43], v[240:243]
    s_waitcnt lgkmcnt(4)
    v_mul_f32 v223, v223, abs(v223)
    v_mfma_f32_16x16x32_bf16 v[240:243], a[176:179], a[80:83], v[240:243]
    v_cvt_pk_bf16_f32 v204, v204, v205
    v_cvt_pk_bf16_f32 v205, v206, v207
    v_mfma_f32_16x16x32_bf16 v[240:243], a[180:183], a[84:87], v[240:243]
    v_cvt_pk_bf16_f32 v206, v220, v221
    v_cvt_pk_bf16_f32 v207, v222, v223
    v_mfma_f32_16x16x32_bf16 v[244:247], a[180:183], a[92:95], v[244:247]
    v_pk_max_i16 v204, v204, 0
    v_pk_max_i16 v205, v205, 0
    v_mfma_f32_16x16x32_bf16 v[244:247], a[176:179], a[88:91], v[244:247]
    v_pk_max_i16 v206, v206, 0
    v_pk_max_i16 v207, v207, 0
    v_mfma_f32_16x16x32_bf16 v[248:251], a[176:179], a[96:99], v[248:251]
    s_lshl_b32 s49, s34, 3
    s_bfe_u32 s48, s2, 0x20001
    v_mfma_f32_16x16x32_bf16 v[248:251], a[180:183], a[100:103], v[248:251]
    s_add_u32 s49, s49, s48
    s_lshl_b32 s49, s49, 9
    v_mfma_f32_16x16x32_bf16 v[252:255], a[180:183], a[108:111], v[252:255]
    v_lshrrev_b32 v31, 4, v1
    v_lshlrev_b32 v31, 7, v31
    v_mfma_f32_16x16x32_bf16 v[252:255], a[176:179], a[104:107], v[252:255]
    s_waitcnt lgkmcnt(0)
    s_add_u32 s48, s49, 34816
    v_mfma_f32_16x16x32_bf16 v[252:255], a[184:187], a[144:147], v[252:255]
    buffer_load_dwordx2 v[28:29], v31, s[20:23], s48 offen sc1
    v_mfma_f32_16x16x32_bf16 v[252:255], a[188:191], a[148:151], v[252:255]
    v_mfma_f32_16x16x32_bf16 v[248:251], a[188:191], a[140:143], v[248:251]
    v_mfma_f32_16x16x32_bf16 v[248:251], a[184:187], a[136:139], v[248:251]
    v_mfma_f32_16x16x32_bf16 v[244:247], a[184:187], a[128:131], v[244:247]
    v_mfma_f32_16x16x32_bf16 v[244:247], a[188:191], a[132:135], v[244:247]
    v_mfma_f32_16x16x32_bf16 v[240:243], a[188:191], a[124:127], v[240:243]
    v_mfma_f32_16x16x32_bf16 v[240:243], a[184:187], a[120:123], v[240:243]
    v_mul_f32 v224, v224, abs(v224)
    v_mul_f32 v225, v225, abs(v225)
    v_mul_f32 v226, v226, abs(v226)
    v_mul_f32 v227, v227, abs(v227)
    s_nop 3
    v_mul_f32 v240, v240, abs(v240)
    v_mul_f32 v241, v241, abs(v241)
    v_mul_f32 v242, v242, abs(v242)
    v_mul_f32 v243, v243, abs(v243)
    v_cvt_pk_bf16_f32 v224, v224, v225
    v_cvt_pk_bf16_f32 v225, v226, v227
    v_cvt_pk_bf16_f32 v226, v240, v241
    v_cvt_pk_bf16_f32 v227, v242, v243
    v_pk_max_i16 v224, v224, 0
    v_pk_max_i16 v225, v225, 0
    v_pk_max_i16 v226, v226, 0
    v_pk_max_i16 v227, v227, 0
    v_mul_f32 v228, v228, abs(v228)
    v_mul_f32 v229, v229, abs(v229)
    v_mul_f32 v230, v230, abs(v230)
    v_mul_f32 v231, v231, abs(v231)
    v_mul_f32 v244, v244, abs(v244)
    v_mul_f32 v245, v245, abs(v245)
    v_mul_f32 v246, v246, abs(v246)
    v_mul_f32 v247, v247, abs(v247)
    v_cvt_pk_bf16_f32 v228, v228, v229
    v_cvt_pk_bf16_f32 v229, v230, v231
    v_cvt_pk_bf16_f32 v230, v244, v245
    v_cvt_pk_bf16_f32 v231, v246, v247
    v_pk_max_i16 v228, v228, 0
    v_pk_max_i16 v229, v229, 0
    v_pk_max_i16 v230, v230, 0
    v_pk_max_i16 v231, v231, 0
    v_mul_f32 v232, v232, abs(v232)
    v_mul_f32 v233, v233, abs(v233)
    v_mul_f32 v234, v234, abs(v234)
    v_mul_f32 v235, v235, abs(v235)
    v_mul_f32 v248, v248, abs(v248)
    v_mul_f32 v249, v249, abs(v249)
    v_mul_f32 v250, v250, abs(v250)
    v_mul_f32 v251, v251, abs(v251)
    v_cvt_pk_bf16_f32 v232, v232, v233
    v_cvt_pk_bf16_f32 v233, v234, v235
    v_cvt_pk_bf16_f32 v234, v248, v249
    v_cvt_pk_bf16_f32 v235, v250, v251
    v_pk_max_i16 v232, v232, 0
    v_pk_max_i16 v233, v233, 0
    v_pk_max_i16 v234, v234, 0
    v_pk_max_i16 v235, v235, 0
    v_mul_f32 v236, v236, abs(v236)
    v_mul_f32 v237, v237, abs(v237)
    v_mul_f32 v238, v238, abs(v238)
    v_mul_f32 v239, v239, abs(v239)
    v_mul_f32 v252, v252, abs(v252)
    v_mul_f32 v253, v253, abs(v253)
    v_mul_f32 v254, v254, abs(v254)
    v_mul_f32 v255, v255, abs(v255)
    v_cvt_pk_bf16_f32 v236, v236, v237
    v_cvt_pk_bf16_f32 v237, v238, v239
    v_cvt_pk_bf16_f32 v238, v252, v253
    v_cvt_pk_bf16_f32 v239, v254, v255
    v_pk_max_i16 v236, v236, 0
    v_pk_max_i16 v237, v237, 0
    v_pk_max_i16 v238, v238, 0
    v_pk_max_i16 v239, v239, 0
    s_mov_b32 s50, s38
    s_mov_b32 s51, s47
L_g2:
    s_nop 1
    s_bfe_u32 s6, s2, 0x20001
    s_mul_i32 s24, s6, 28
    s_add_u32 s24, s24, 32
    s_lshl_b32 s24, s24, 17
    s_lshr_b32 s36, s75, 17
    s_lshl_b32 s36, s36, 12
    s_add_u32 s24, s24, s36
    s_lshl_b32 s30, s6, 20
    s_add_u32 s30, s30, s36
    s_waitcnt vmcnt(0)
    v_cmp_ne_u64 vcc, s[98:99], v[28:29]
    s_nop 1
    s_cmp_lg_u64 vcc, 0
    s_cbranch_scc1 L_slow_c1
L_back_c1:
    s_add_u32 s37, s24, 0
    buffer_load_dwordx4 a[32:35], v12, s[16:19], s37 offen offset:0 sc1
    buffer_load_dwordx4 a[36:39], v12, s[16:19], s37 offen offset:1024 sc1
    buffer_load_dwordx4 a[40:43], v12, s[16:19], s37 offen offset:2048 sc1
    buffer_load_dwordx4 a[44:47], v12, s[16:19], s37 offen offset:3072 sc1
    v_accvgpr_read_b32 v16, a224
    v_accvgpr_read_b32 v17, a225
    v_accvgpr_read_b32 v18, a226
    v_accvgpr_read_b32 v19, a227
    v_accvgpr_read_b32 v20, a228
    v_accvgpr_read_b32 v21, a229
    v_accvgpr_read_b32 v22, a230
    v_accvgpr_read_b32 v23, a231
    s_waitcnt lgkmcnt(0)
    s_barrier
    ds_read_b64_tr_b16 a[192:193], v16 offset:49152
    ds_read_b64_tr_b16 a[194:195], v16 offset:51200
    ds_read_b64_tr_b16 a[196:197], v16 offset:53248
    ds_read_b64_tr_b16 a[198:199], v16 offset:55296
    ds_read_b64_tr_b16 a[200:201], v17 offset:49152
    ds_read_b64_tr_b16 a[202:203], v17 offset:51200
    ds_read_b64_tr_b16 a[204:205], v17 offset:53248
    ds_read_b64_tr_b16 a[206:207], v17 offset:55296
    ds_read_b64_tr_b16 a[208:209], v18 offset:49152
    ds_read_b64_tr_b16 a[210:211], v18 offset:51200
    ds_read_b64_tr_b16 a[212:213], v18 offset:53248
    ds_read_b64_tr_b16 a[214:215], v18 offset:55296
    v_mov_b32 v24, s98
    v_mov_b32 v25, s99
    s_lshl_b32 s40, s32, 7
    s_add_u32 s40, s40, 65536
    v_and_b32 v26, 15, v1
    v_lshlrev_b32 v26, 3, v26
    s_cmp_lg_u32 s5, 0
    s_cbranch_scc1 L_nofl2
    buffer_store_dwordx2 v[24:25], v26, s[20:23], s40 offen sc1
L_nofl2:
    s_waitcnt lgkmcnt(8)
    v_add_u32 v208, 0x10000, v16
    v_add_u32 v209, 0x10000, v17
    v_mfma_f32_16x16x32_bf16 v[32:35], a[192:195], v[192:195], 0
    ds_read_b64_tr_b16 a[216:217], v19 offset:49152
    v_add_u32 v210, 0x10000, v18
    v_add_u32 v211, 0x10000, v19
    v_mfma_f32_16x16x32_bf16 v[32:35], a[196:199], v[224:227], v[32:35]
    ds_read_b64_tr_b16 a[218:219], v19 offset:51200
    s_add_u32 s37, s24, 1835008
    v_add_u32 v212, 0x10000, v20
    v_mfma_f32_16x16x32_bf16 v[36:39], a[196:199], v[228:231], 0
    buffer_load_dwordx4 a[48:51], v12, s[16:19], s37 offen offset:0 sc1
    v_add_u32 v213, 0x10000, v21
    v_add_u32 v214, 0x10000, v22
    v_mfma_f32_16x16x32_bf16 v[36:39], a[192:195], v[196:199], v[36:39]
    v_add_u32 v215, 0x10000, v23
    v_subrev_u32 v2, 0x10000, v16
    v_subrev_u32 v3, 0x10000, v17
    v_mfma_f32_16x16x32_bf16 v[40:43], a[192:195], v[200:203], 0
    ds_read_b64_tr_b16 a[220:221], v19 offset:53248
    v_subrev_u32 v4, 0x10000, v18
    v_subrev_u32 v5, 0x10000, v19
    v_mfma_f32_16x16x32_bf16 v[40:43], a[196:199], v[232:235], v[40:43]
    ds_read_b64_tr_b16 a[222:223], v19 offset:55296
    v_subrev_u32 v6, 0x10000, v20
    v_subrev_u32 v7, 0x10000, v21
    v_mfma_f32_16x16x32_bf16 v[44:47], a[196:199], v[236:239], 0
    buffer_load_dwordx4 a[52:55], v12, s[16:19], s37 offen offset:1024 sc1
    v_subrev_u32 v8, 0x10000, v22
    v_subrev_u32 v9, 0x10000, v23
    v_mfma_f32_16x16x32_bf16 v[44:47], a[192:195], v[204:207], v[44:47]
    s_waitcnt lgkmcnt(8)
    v_bfe_u32 v27, v1, 3, 2
    v_lshlrev_b32 v27, 7, v27
    v_mfma_f32_16x16x32_bf16 v[60:63], a[200:203], v[204:207], 0
    ds_read_b64_tr_b16 a[192:193], v20 offset:49152
    v_lshrrev_b32 v11, 5, v1
    v_lshl_add_u32 v27, v11, 11, v27
    v_mfma_f32_16x16x32_bf16 v[60:63], a[204:207], v[236:239], v[60:63]
    ds_read_b64_tr_b16 a[194:195], v20 offset:51200
    s_mov_b32 s58, 0xffff0000
    s_lshl_b32 s39, s2, 2
    v_mfma_f32_16x16x32_bf16 v[56:59], a[204:207], v[232:235], 0
    buffer_load_dwordx4 a[56:59], v12, s[16:19], s37 offen offset:2048 sc1
    s_add_u32 s39, s39, s5
    s_mul_i32 s38, s39, 14336
    v_mfma_f32_16x16x32_bf16 v[56:59], a[200:203], v[200:203], v[56:59]
    s_mov_b32 s44, s92
    s_and_b32 s45, s93, 0xffff
    s_mov_b32 s46, 4194304
    v_mfma_f32_16x16x32_bf16 v[52:55], a[200:203], v[196:199], 0
    ds_read_b64_tr_b16 a[196:197], v20 offset:53248
    s_mov_b32 s47, 0x20000
    s_add_u32 s52, s96, 41943040
    s_addc_u32 s53, s97, 0
    s_and_b32 s53, s53, 0xffff
    s_mov_b32 s54, 18874368
    s_mov_b32 s55, 0x20000
    v_mfma_f32_16x16x32_bf16 v[52:55], a[204:207], v[228:231], v[52:55]
    ds_read_b64_tr_b16 a[198:199], v20 offset:55296
    s_lshr_b32 s7, s2, 5
    v_add_u32 v240, s7, v1
    v_mfma_f32_16x16x32_bf16 v[48:51], a[204:207], v[224:227], 0
    buffer_load_dwordx4 a[60:63], v12, s[16:19], s37 offen offset:3072 sc1
    v_and_b32 v241, 3, v240
    v_bfe_u32 v242, v240, 2, 1
    v_mfma_f32_16x16x32_bf16 v[48:51], a[200:203], v[192:195], v[48:51]
    s_waitcnt lgkmcnt(8)
    v_and_b32 v243, 1, v240
    v_mul_u32_u24 v244, 7, v241
    v_mfma_f32_16x16x32_bf16 v[64:67], a[208:211], v[192:195], 0
    ds_read_b64_tr_b16 a[200:201], v21 offset:49152
    v_add3_u32 v216, v244, v243, 5
    v_mul_u32_u24 v245, 6, v243
    v_mfma_f32_16x16x32_bf16 v[64:67], a[212:215], v[224:227], v[64:67]
    ds_read_b64_tr_b16 a[202:203], v21 offset:51200
    s_add_u32 s37, s24, 131072
    v_sub_u32 v245, 6, v245
    v_mfma_f32_16x16x32_bf16 v[68:71], a[212:215], v[228:231], 0
    buffer_load_dwordx4 a[64:67], v12, s[16:19], s37 offen offset:0 sc1
    v_add_u32 v217, v244, v245
    s_mul_i32 s7, s6, 28
    v_mfma_f32_16x16x32_bf16 v[68:71], a[208:211], v[196:199], v[68:71]
    v_add_u32 v216, s7, v216
    v_add_u32 v217, s7, v217
    s_lshl_b32 s7, s6, 3
    v_mfma_f32_16x16x32_bf16 v[72:75], a[208:211], v[200:203], 0
    ds_read_b64_tr_b16 a[204:205], v21 offset:53248
    v_lshl_add_u32 v244, v241, 1, s7
    v_add_u32 v245, 1, v244
    v_mfma_f32_16x16x32_bf16 v[72:75], a[212:215], v[232:235], v[72:75]
    ds_read_b64_tr_b16 a[206:207], v21 offset:55296
    v_cmp_eq_u32 s[70:71], 1, v242
    s_nop 1
    v_cndmask_b32 v216, v244, v216, s[70:71]
    v_mfma_f32_16x16x32_bf16 v[76:79], a[212:215], v[236:239], 0
    buffer_load_dwordx4 a[68:71], v12, s[16:19], s37 offen offset:1024 sc1
    v_cndmask_b32 v217, v245, v217, s[70:71]
    s_cmp_lt_u32 s5, 2
    s_cselect_b64 s[70:71], -1, 0
    v_mfma_f32_16x16x32_bf16 v[76:79], a[208:211], v[204:207], v[76:79]
    s_waitcnt lgkmcnt(8)
    v_cndmask_b32 v218, v217, v216, s[70:71]
    v_lshlrev_b32 v218, 16, v218
    v_mfma_f32_16x16x32_bf16 v[92:95], a[216:219], v[204:207], 0
    ds_read_b64_tr_b16 a[208:209], v22 offset:49152
    v_add3_u32 v218, v218, s59, v242
    v_lshl_add_u32 v216, v242, 5, v216
    v_mfma_f32_16x16x32_bf16 v[92:95], a[220:223], v[236:239], v[92:95]
    ds_read_b64_tr_b16 a[210:211], v22 offset:51200
    v_lshl_add_u32 v217, v242, 5, v217
    v_lshlrev_b32 v216, 17, v216
    v_mfma_f32_16x16x32_bf16 v[88:91], a[220:223], v[232:235], 0
    buffer_load_dwordx4 a[72:75], v12, s[16:19], s37 offen offset:2048 sc1
    v_lshlrev_b32 v217, 17, v217
    v_add_u32 v216, s36, v216
    v_mfma_f32_16x16x32_bf16 v[88:91], a[216:219], v[200:203], v[88:91]
    v_add_u32 v217, s36, v217
    v_mfma_f32_16x16x32_bf16 v[84:87], a[216:219], v[196:199], 0
    ds_read_b64_tr_b16 a[212:213], v22 offset:53248
    v_mfma_f32_16x16x32_bf16 v[84:87], a[220:223], v[228:231], v[84:87]
    ds_read_b64_tr_b16 a[214:215], v22 offset:55296
    v_mfma_f32_16x16x32_bf16 v[80:83], a[220:223], v[224:227], 0
    buffer_load_dwordx4 a[76:79], v12, s[16:19], s37 offen offset:3072 sc1
    v_mfma_f32_16x16x32_bf16 v[80:83], a[216:219], v[192:195], v[80:83]
    s_waitcnt lgkmcnt(8)
    v_mfma_f32_16x16x32_bf16 v[96:99], a[192:195], v[192:195], 0
    ds_read_b64_tr_b16 a[216:217], v23 offset:49152
    v_mfma_f32_16x16x32_bf16 v[96:99], a[196:199], v[224:227], v[96:99]
    ds_read_b64_tr_b16 a[218:219], v23 offset:51200
    v_mfma_f32_16x16x32_bf16 v[100:103], a[196:199], v[228:231], 0
    buffer_store_dwordx4 v[192:195], v12, s[16:19], s50 offen offset:0 sc1
    v_mfma_f32_16x16x32_bf16 v[100:103], a[192:195], v[196:199], v[100:103]
    v_mfma_f32_16x16x32_bf16 v[104:107], a[192:195], v[200:203], 0
    ds_read_b64_tr_b16 a[220:221], v23 offset:53248
    v_mfma_f32_16x16x32_bf16 v[104:107], a[196:199], v[232:235], v[104:107]
    ds_read_b64_tr_b16 a[222:223], v23 offset:55296
    s_add_u32 s37, s24, 1966080
    v_mfma_f32_16x16x32_bf16 v[108:111], a[196:199], v[236:239], 0
    buffer_load_dwordx4 a[80:83], v12, s[16:19], s37 offen offset:0 sc1
    v_mfma_f32_16x16x32_bf16 v[108:111], a[192:195], v[204:207], v[108:111]
    s_waitcnt lgkmcnt(8)
    v_mfma_f32_16x16x32_bf16 v[124:127], a[200:203], v[204:207], 0
    s_waitcnt vmcnt(6)
    s_barrier
    ds_read_b64_tr_b16 a[192:193], v208 offset:0
    v_mfma_f32_16x16x32_bf16 v[124:127], a[204:207], v[236:239], v[124:127]
    ds_read_b64_tr_b16 a[194:195], v208 offset:2048
    v_mfma_f32_16x16x32_bf16 v[120:123], a[204:207], v[232:235], 0
    buffer_load_dwordx4 a[84:87], v12, s[16:19], s37 offen offset:1024 sc1
    v_mfma_f32_16x16x32_bf16 v[120:123], a[200:203], v[200:203], v[120:123]
    v_mfma_f32_16x16x32_bf16 v[116:119], a[200:203], v[196:199], 0
    ds_read_b64_tr_b16 a[196:197], v208 offset:4096
    v_mfma_f32_16x16x32_bf16 v[116:119], a[204:207], v[228:231], v[116:119]
    ds_read_b64_tr_b16 a[198:199], v208 offset:6144
    v_mfma_f32_16x16x32_bf16 v[112:115], a[204:207], v[224:227], 0
    buffer_load_dwordx4 a[88:91], v12, s[16:19], s37 offen offset:2048 sc1
    v_mfma_f32_16x16x32_bf16 v[112:115], a[200:203], v[192:195], v[112:115]
    s_waitcnt lgkmcnt(8)
    v_mfma_f32_16x16x32_bf16 v[128:131], a[208:211], v[192:195], 0
    ds_read_b64_tr_b16 a[200:201], v209 offset:0
    v_mfma_f32_16x16x32_bf16 v[128:131], a[212:215], v[224:227], v[128:131]
    ds_read_b64_tr_b16 a[202:203], v209 offset:2048
    v_mfma_f32_16x16x32_bf16 v[132:135], a[212:215], v[228:231], 0
    buffer_store_dwordx4 v[196:199], v12, s[16:19], s50 offen offset:1024 sc1
    v_mfma_f32_16x16x32_bf16 v[132:135], a[208:211], v[196:199], v[132:135]
    v_mfma_f32_16x16x32_bf16 v[136:139], a[208:211], v[200:203], 0
    ds_read_b64_tr_b16 a[204:205], v209 offset:4096
    v_mfma_f32_16x16x32_bf16 v[136:139], a[212:215], v[232:235], v[136:139]
    ds_read_b64_tr_b16 a[206:207], v209 offset:6144
    v_mfma_f32_16x16x32_bf16 v[140:143], a[212:215], v[236:239], 0
    buffer_load_dwordx4 a[92:95], v12, s[16:19], s37 offen offset:3072 sc1
    v_mfma_f32_16x16x32_bf16 v[140:143], a[208:211], v[204:207], v[140:143]
    s_waitcnt lgkmcnt(8)
    v_mfma_f32_16x16x32_bf16 v[156:159], a[216:219], v[204:207], 0
    ds_read_b64_tr_b16 a[208:209], v210 offset:0
    v_mfma_f32_16x16x32_bf16 v[156:159], a[220:223], v[236:239], v[156:159]
    ds_read_b64_tr_b16 a[210:211], v210 offset:2048
    s_add_u32 s37, s24, 262144
    v_mfma_f32_16x16x32_bf16 v[152:155], a[220:223], v[232:235], 0
    buffer_load_dwordx4 a[96:99], v12, s[16:19], s37 offen offset:0 sc1
    v_mfma_f32_16x16x32_bf16 v[152:155], a[216:219], v[200:203], v[152:155]
    v_mfma_f32_16x16x32_bf16 v[148:151], a[216:219], v[196:199], 0
    ds_read_b64_tr_b16 a[212:213], v210 offset:4096
    v_mfma_f32_16x16x32_bf16 v[148:151], a[220:223], v[228:231], v[148:151]
    ds_read_b64_tr_b16 a[214:215], v210 offset:6144
    v_mfma_f32_16x16x32_bf16 v[144:147], a[220:223], v[224:227], 0
    buffer_load_dwordx4 a[100:103], v12, s[16:19], s37 offen offset:1024 sc1
    v_mfma_f32_16x16x32_bf16 v[144:147], a[216:219], v[192:195], v[144:147]
    s_waitcnt lgkmcnt(8)
    v_mfma_f32_16x16x32_bf16 v[32:35], a[192:195], a[32:35], v[32:35]
    ds_read_b64_tr_b16 a[216:217], v211 offset:0
    v_mfma_f32_16x16x32_bf16 v[32:35], a[196:199], a[48:51], v[32:35]
    ds_read_b64_tr_b16 a[218:219], v211 offset:2048
    v_mfma_f32_16x16x32_bf16 v[36:39], a[196:199], a[52:55], v[36:39]
    buffer_store_dwordx4 v[200:203], v12, s[16:19], s50 offen offset:2048 sc1
    v_mfma_f32_16x16x32_bf16 v[36:39], a[192:195], a[36:39], v[36:39]
    v_mfma_f32_16x16x32_bf16 v[40:43], a[192:195], a[40:43], v[40:43]
    ds_read_b64_tr_b16 a[220:221], v211 offset:4096
    v_mfma_f32_16x16x32_bf16 v[40:43], a[196:199], a[56:59], v[40:43]
    ds_read_b64_tr_b16 a[222:223], v211 offset:6144
    v_mfma_f32_16x16x32_bf16 v[44:47], a[196:199], a[60:63], v[44:47]
    buffer_load_dwordx4 a[104:107], v12, s[16:19], s37 offen offset:2048 sc1
    v_mfma_f32_16x16x32_bf16 v[44:47], a[192:195], a[44:47], v[44:47]
    s_waitcnt lgkmcnt(8)
    v_mfma_f32_16x16x32_bf16 v[60:63], a[200:203], a[44:47], v[60:63]
    ds_read_b64_tr_b16 a[192:193], v212 offset:0
    v_mfma_f32_16x16x32_bf16 v[60:63], a[204:207], a[60:63], v[60:63]
    ds_read_b64_tr_b16 a[194:195], v212 offset:2048
    v_mfma_f32_16x16x32_bf16 v[56:59], a[204:207], a[56:59], v[56:59]
    buffer_load_dwordx4 a[108:111], v12, s[16:19], s37 offen offset:3072 sc1
    v_mfma_f32_16x16x32_bf16 v[56:59], a[200:203], a[40:43], v[56:59]
    v_mfma_f32_16x16x32_bf16 v[52:55], a[200:203], a[36:39], v[52:55]
    ds_read_b64_tr_b16 a[196:197], v212 offset:4096
    v_mfma_f32_16x16x32_bf16 v[52:55], a[204:207], a[52:55], v[52:55]
    ds_read_b64_tr_b16 a[198:199], v212 offset:6144
    s_add_u32 s27, s25, 196608
    s_add_u32 m0, s29, 81920
    v_mfma_f32_16x16x32_bf16 v[48:51], a[204:207], a[48:51], v[48:51]
    buffer_load_dwordx4 v13, s[64:67], s27 offen offset:0 lds
    v_mfma_f32_16x16x32_bf16 v[48:51], a[200:203], a[32:35], v[48:51]
    s_waitcnt lgkmcnt(8)
    v_mfma_f32_16x16x32_bf16 v[64:67], a[208:211], a[32:35], v[64:67]
    ds_read_b64_tr_b16 a[200:201], v213 offset:0
    v_mfma_f32_16x16x32_bf16 v[64:67], a[212:215], a[48:51], v[64:67]
    ds_read_b64_tr_b16 a[202:203], v213 offset:2048
    s_add_u32 s37, s24, 2097152
    v_mfma_f32_16x16x32_bf16 v[68:71], a[212:215], a[52:55], v[68:71]
    buffer_load_dwordx4 a[112:115], v12, s[16:19], s37 offen offset:0 sc1
    v_mfma_f32_16x16x32_bf16 v[68:71], a[208:211], a[36:39], v[68:71]
    v_mfma_f32_16x16x32_bf16 v[72:75], a[208:211], a[40:43], v[72:75]
    ds_read_b64_tr_b16 a[204:205], v213 offset:4096
    v_mfma_f32_16x16x32_bf16 v[72:75], a[212:215], a[56:59], v[72:75]
    ds_read_b64_tr_b16 a[206:207], v213 offset:6144
    v_mfma_f32_16x16x32_bf16 v[76:79], a[212:215], a[60:63], v[76:79]
    buffer_store_dwordx4 v[204:207], v12, s[16:19], s50 offen offset:3072 sc1
    v_mfma_f32_16x16x32_bf16 v[76:79], a[208:211], a[44:47], v[76:79]
    s_waitcnt lgkmcnt(8)
    v_mfma_f32_16x16x32_bf16 v[92:95], a[216:219], a[44:47], v[92:95]
    ds_read_b64_tr_b16 a[208:209], v214 offset:0
    v_mfma_f32_16x16x32_bf16 v[92:95], a[220:223], a[60:63], v[92:95]
    ds_read_b64_tr_b16 a[210:211], v214 offset:2048
    v_mfma_f32_16x16x32_bf16 v[88:91], a[220:223], a[56:59], v[88:91]
    buffer_load_dwordx4 a[116:119], v12, s[16:19], s37 offen offset:1024 sc1
    v_mfma_f32_16x16x32_bf16 v[88:91], a[216:219], a[40:43], v[88:91]
    v_mfma_f32_16x16x32_bf16 v[84:87], a[216:219], a[36:39], v[84:87]
    ds_read_b64_tr_b16 a[212:213], v214 offset:4096
    v_mfma_f32_16x16x32_bf16 v[84:87], a[220:223], a[52:55], v[84:87]
    ds_read_b64_tr_b16 a[214:215], v214 offset:6144
    v_mfma_f32_16x16x32_bf16 v[80:83], a[220:223], a[48:51], v[80:83]
    buffer_load_dwordx4 a[120:123], v12, s[16:19], s37 offen offset:2048 sc1
    v_mfma_f32_16x16x32_bf16 v[80:83], a[216:219], a[32:35], v[80:83]
    s_waitcnt lgkmcnt(8)
    v_mfma_f32_16x16x32_bf16 v[96:99], a[192:195], a[32:35], v[96:99]
    ds_read_b64_tr_b16 a[216:217], v215 offset:0
    v_mfma_f32_16x16x32_bf16 v[96:99], a[196:199], a[48:51], v[96:99]
    ds_read_b64_tr_b16 a[218:219], v215 offset:2048
    v_mfma_f32_16x16x32_bf16 v[100:103], a[196:199], a[52:55], v[100:103]
    buffer_store_dwordx4 v[224:227], v12, s[16:19], s51 offen offset:0 sc1
    v_mfma_f32_16x16x32_bf16 v[100:103], a[192:195], a[36:39], v[100:103]
    v_mfma_f32_16x16x32_bf16 v[104:107], a[192:195], a[40:43], v[104:107]
    ds_read_b64_tr_b16 a[220:221], v215 offset:4096
    v_mfma_f32_16x16x32_bf16 v[104:107], a[196:199], a[56:59], v[104:107]
    ds_read_b64_tr_b16 a[222:223], v215 offset:6144
    s_add_u32 m0, s29, 89600
    v_mfma_f32_16x16x32_bf16 v[108:111], a[196:199], a[60:63], v[108:111]
    buffer_load_dwordx4 v13, s[64:67], s27 offen offset:512 lds
    v_mfma_f32_16x16x32_bf16 v[108:111], a[192:195], a[44:47], v[108:111]
    s_waitcnt lgkmcnt(8)
    v_mfma_f32_16x16x32_bf16 v[124:127], a[200:203], a[44:47], v[124:127]
    s_waitcnt vmcnt(12)
    s_barrier
    ds_read_b64_tr_b16 a[192:193], v208 offset:16384
    v_mfma_f32_16x16x32_bf16 v[124:127], a[204:207], a[60:63], v[124:127]
    ds_read_b64_tr_b16 a[194:195], v208 offset:18432
    v_mfma_f32_16x16x32_bf16 v[120:123], a[204:207], a[56:59], v[120:123]
    buffer_load_dwordx4 a[124:127], v12, s[16:19], s37 offen offset:3072 sc1
    v_mfma_f32_16x16x32_bf16 v[120:123], a[200:203], a[40:43], v[120:123]
    v_mfma_f32_16x16x32_bf16 v[116:119], a[200:203], a[36:39], v[116:119]
    ds_read_b64_tr_b16 a[196:197], v208 offset:20480
    v_mfma_f32_16x16x32_bf16 v[116:119], a[204:207], a[52:55], v[116:119]
    ds_read_b64_tr_b16 a[198:199], v208 offset:22528
    s_add_u32 s37, s24, 1048576
    v_mfma_f32_16x16x32_bf16 v[112:115], a[204:207], a[48:51], v[112:115]
    buffer_load_dwordx4 a[128:131], v12, s[16:19], s37 offen offset:0 sc1
    v_mfma_f32_16x16x32_bf16 v[112:115], a[200:203], a[32:35], v[112:115]
    s_waitcnt lgkmcnt(8)
    v_mfma_f32_16x16x32_bf16 v[128:131], a[208:211], a[32:35], v[128:131]
    ds_read_b64_tr_b16 a[200:201], v209 offset:16384
    v_mfma_f32_16x16x32_bf16 v[128:131], a[212:215], a[48:51], v[128:131]
    ds_read_b64_tr_b16 a[202:203], v209 offset:18432
    v_mfma_f32_16x16x32_bf16 v[132:135], a[212:215], a[52:55], v[132:135]
    buffer_store_dwordx4 v[228:231], v12, s[16:19], s51 offen offset:1024 sc1
    v_mfma_f32_16x16x32_bf16 v[132:135], a[208:211], a[36:39], v[132:135]
    v_mfma_f32_16x16x32_bf16 v[136:139], a[208:211], a[40:43], v[136:139]
    ds_read_b64_tr_b16 a[204:205], v209 offset:20480
    v_mfma_f32_16x16x32_bf16 v[136:139], a[212:215], a[56:59], v[136:139]
    ds_read_b64_tr_b16 a[206:207], v209 offset:22528
    v_mfma_f32_16x16x32_bf16 v[140:143], a[212:215], a[60:63], v[140:143]
    buffer_load_dwordx4 a[132:135], v12, s[16:19], s37 offen offset:1024 sc1
    v_mfma_f32_16x16x32_bf16 v[140:143], a[208:211], a[44:47], v[140:143]
    s_waitcnt lgkmcnt(8)
    v_mfma_f32_16x16x32_bf16 v[156:159], a[216:219], a[44:47], v[156:159]
    ds_read_b64_tr_b16 a[208:209], v210 offset:16384
    v_mfma_f32_16x16x32_bf16 v[156:159], a[220:223], a[60:63], v[156:159]
    ds_read_b64_tr_b16 a[210:211], v210 offset:18432
    s_add_u32 m0, s29, 82944
    v_mfma_f32_16x16x32_bf16 v[152:155], a[220:223], a[56:59], v[152:155]
    buffer_load_dwordx4 v14, s[64:67], s27 offen offset:0 lds
    v_mfma_f32_16x16x32_bf16 v[152:155], a[216:219], a[40:43], v[152:155]
    v_mfma_f32_16x16x32_bf16 v[148:151], a[216:219], a[36:39], v[148:151]
    ds_read_b64_tr_b16 a[212:213], v210 offset:20480
    v_mfma_f32_16x16x32_bf16 v[148:151], a[220:223], a[52:55], v[148:151]
    ds_read_b64_tr_b16 a[214:215], v210 offset:22528
    v_mfma_f32_16x16x32_bf16 v[144:147], a[220:223], a[48:51], v[144:147]
    buffer_load_dwordx4 a[136:139], v12, s[16:19], s37 offen offset:2048 sc1
    v_mfma_f32_16x16x32_bf16 v[144:147], a[216:219], a[32:35], v[144:147]
    s_waitcnt lgkmcnt(8)
    v_mfma_f32_16x16x32_bf16 v[32:35], a[192:195], a[64:67], v[32:35]
    ds_read_b64_tr_b16 a[216:217], v211 offset:16384
    v_mfma_f32_16x16x32_bf16 v[32:35], a[196:199], a[80:83], v[32:35]
    ds_read_b64_tr_b16 a[218:219], v211 offset:18432
    v_mfma_f32_16x16x32_bf16 v[36:39], a[196:199], a[84:87], v[36:39]
    buffer_store_dwordx4 v[232:235], v12, s[16:19], s51 offen offset:2048 sc1
    v_mfma_f32_16x16x32_bf16 v[36:39], a[192:195], a[68:71], v[36:39]
    v_mfma_f32_16x16x32_bf16 v[40:43], a[192:195], a[72:75], v[40:43]
    ds_read_b64_tr_b16 a[220:221], v211 offset:20480
    v_mfma_f32_16x16x32_bf16 v[40:43], a[196:199], a[88:91], v[40:43]
    ds_read_b64_tr_b16 a[222:223], v211 offset:22528
    v_mfma_f32_16x16x32_bf16 v[44:47], a[196:199], a[92:95], v[44:47]
    buffer_load_dwordx4 a[140:143], v12, s[16:19], s37 offen offset:3072 sc1
    v_mfma_f32_16x16x32_bf16 v[44:47], a[192:195], a[76:79], v[44:47]
    s_waitcnt lgkmcnt(8)
    v_mfma_f32_16x16x32_bf16 v[60:63], a[200:203], a[76:79], v[60:63]
    ds_read_b64_tr_b16 a[192:193], v212 offset:16384
    v_mfma_f32_16x16x32_bf16 v[60:63], a[204:207], a[92:95], v[60:63]
    ds_read_b64_tr_b16 a[194:195], v212 offset:18432
    s_add_u32 m0, s29, 90624
    v_mfma_f32_16x16x32_bf16 v[56:59], a[204:207], a[88:91], v[56:59]
    buffer_load_dwordx4 v14, s[64:67], s27 offen offset:512 lds
    v_mfma_f32_16x16x32_bf16 v[56:59], a[200:203], a[72:75], v[56:59]
    v_mfma_f32_16x16x32_bf16 v[52:55], a[200:203], a[68:71], v[52:55]
    ds_read_b64_tr_b16 a[196:197], v212 offset:20480
    v_mfma_f32_16x16x32_bf16 v[52:55], a[204:207], a[84:87], v[52:55]
    ds_read_b64_tr_b16 a[198:199], v212 offset:22528
    s_add_u32 s37, s24, 2883584
    v_mfma_f32_16x16x32_bf16 v[48:51], a[204:207], a[80:83], v[48:51]
    buffer_load_dwordx4 a[144:147], v12, s[16:19], s37 offen offset:0 sc1
    v_mfma_f32_16x16x32_bf16 v[48:51], a[200:203], a[64:67], v[48:51]
    s_waitcnt lgkmcnt(8)
    v_mfma_f32_16x16x32_bf16 v[64:67], a[208:211], a[64:67], v[64:67]
    ds_read_b64_tr_b16 a[200:201], v213 offset:16384
    v_mfma_f32_16x16x32_bf16 v[64:67], a[212:215], a[80:83], v[64:67]
    ds_read_b64_tr_b16 a[202:203], v213 offset:18432
    v_mfma_f32_16x16x32_bf16 v[68:71], a[212:215], a[84:87], v[68:71]
    buffer_store_dwordx4 v[236:239], v12, s[16:19], s51 offen offset:3072 sc1
    v_mfma_f32_16x16x32_bf16 v[68:71], a[208:211], a[68:71], v[68:71]
    v_mfma_f32_16x16x32_bf16 v[72:75], a[208:211], a[72:75], v[72:75]
    ds_read_b64_tr_b16 a[204:205], v213 offset:20480
    v_mfma_f32_16x16x32_bf16 v[72:75], a[212:215], a[88:91], v[72:75]
    ds_read_b64_tr_b16 a[206:207], v213 offset:22528
    v_mfma_f32_16x16x32_bf16 v[76:79], a[212:215], a[92:95], v[76:79]
    buffer_load_dwordx4 a[148:151], v12, s[16:19], s37 offen offset:1024 sc1
    v_mfma_f32_16x16x32_bf16 v[76:79], a[208:211], a[76:79], v[76:79]
    s_waitcnt lgkmcnt(8)
    v_mfma_f32_16x16x32_bf16 v[92:95], a[216:219], a[76:79], v[92:95]
    ds_read_b64_tr_b16 a[208:209], v214 offset:16384
    v_mfma_f32_16x16x32_bf16 v[92:95], a[220:223], a[92:95], v[92:95]
    ds_read_b64_tr_b16 a[210:211], v214 offset:18432
    v_mfma_f32_16x16x32_bf16 v[88:91], a[220:223], a[88:91], v[88:91]
    buffer_load_dwordx4 a[152:155], v12, s[16:19], s37 offen offset:2048 sc1
    v_mfma_f32_16x16x32_bf16 v[88:91], a[216:219], a[72:75], v[88:91]
    v_mfma_f32_16x16x32_bf16 v[84:87], a[216:219], a[68:71], v[84:87]
    ds_read_b64_tr_b16 a[212:213], v214 offset:20480
    v_mfma_f32_16x16x32_bf16 v[84:87], a[220:223], a[84:87], v[84:87]
    ds_read_b64_tr_b16 a[214:215], v214 offset:22528
    s_add_u32 s27, s25, 262144
    s_add_u32 m0, s29, 114688
    v_mfma_f32_16x16x32_bf16 v[80:83], a[220:223], a[80:83], v[80:83]
    buffer_load_dwordx4 v13, s[64:67], s27 offen offset:0 lds
    v_mfma_f32_16x16x32_bf16 v[80:83], a[216:219], a[64:67], v[80:83]
    s_waitcnt lgkmcnt(8)
    v_mfma_f32_16x16x32_bf16 v[96:99], a[192:195], a[64:67], v[96:99]
    ds_read_b64_tr_b16 a[216:217], v215 offset:16384
    v_mfma_f32_16x16x32_bf16 v[96:99], a[196:199], a[80:83], v[96:99]
    ds_read_b64_tr_b16 a[218:219], v215 offset:18432
    v_mfma_f32_16x16x32_bf16 v[100:103], a[196:199], a[84:87], v[100:103]
    buffer_load_dwordx4 a[156:159], v12, s[16:19], s37 offen offset:3072 sc1
    v_mfma_f32_16x16x32_bf16 v[100:103], a[192:195], a[68:71], v[100:103]
    v_mfma_f32_16x16x32_bf16 v[104:107], a[192:195], a[72:75], v[104:107]
    ds_read_b64_tr_b16 a[220:221], v215 offset:20480
    v_mfma_f32_16x16x32_bf16 v[104:107], a[196:199], a[88:91], v[104:107]
    ds_read_b64_tr_b16 a[222:223], v215 offset:22528
    s_add_u32 s37, s24, 1179648
    v_mfma_f32_16x16x32_bf16 v[108:111], a[196:199], a[92:95], v[108:111]
    buffer_load_dwordx4 a[160:163], v12, s[16:19], s37 offen offset:0 sc1
    v_mfma_f32_16x16x32_bf16 v[108:111], a[192:195], a[76:79], v[108:111]
    s_waitcnt lgkmcnt(8)
    v_mfma_f32_16x16x32_bf16 v[124:127], a[200:203], a[76:79], v[124:127]
    s_waitcnt vmcnt(15)
    s_barrier
    ds_read_b64_tr_b16 a[192:193], v16 offset:32768
    v_mfma_f32_16x16x32_bf16 v[124:127], a[204:207], a[92:95], v[124:127]
    ds_read_b64_tr_b16 a[194:195], v16 offset:34816
    v_mfma_f32_16x16x32_bf16 v[120:123], a[204:207], a[88:91], v[120:123]
    buffer_load_dwordx4 a[164:167], v12, s[16:19], s37 offen offset:1024 sc1
    v_mfma_f32_16x16x32_bf16 v[120:123], a[200:203], a[72:75], v[120:123]
    v_mfma_f32_16x16x32_bf16 v[116:119], a[200:203], a[68:71], v[116:119]
    ds_read_b64_tr_b16 a[196:197], v16 offset:36864
    v_mfma_f32_16x16x32_bf16 v[116:119], a[204:207], a[84:87], v[116:119]
    ds_read_b64_tr_b16 a[198:199], v16 offset:38912
    s_add_u32 m0, s29, 122368
    v_mfma_f32_16x16x32_bf16 v[112:115], a[204:207], a[80:83], v[112:115]
    buffer_load_dwordx4 v13, s[64:67], s27 offen offset:512 lds
    v_mfma_f32_16x16x32_bf16 v[112:115], a[200:203], a[64:67], v[112:115]
    s_waitcnt lgkmcnt(8)
    v_mfma_f32_16x16x32_bf16 v[128:131], a[208:211], a[64:67], v[128:131]
    ds_read_b64_tr_b16 a[200:201], v17 offset:32768
    v_mfma_f32_16x16x32_bf16 v[128:131], a[212:215], a[80:83], v[128:131]
    ds_read_b64_tr_b16 a[202:203], v17 offset:34816
    v_mfma_f32_16x16x32_bf16 v[132:135], a[212:215], a[84:87], v[132:135]
    buffer_load_dwordx4 a[168:171], v12, s[16:19], s37 offen offset:2048 sc1
    v_mfma_f32_16x16x32_bf16 v[132:135], a[208:211], a[68:71], v[132:135]
    v_mfma_f32_16x16x32_bf16 v[136:139], a[208:211], a[72:75], v[136:139]
    ds_read_b64_tr_b16 a[204:205], v17 offset:36864
    v_mfma_f32_16x16x32_bf16 v[136:139], a[212:215], a[88:91], v[136:139]
    ds_read_b64_tr_b16 a[206:207], v17 offset:38912
    v_mfma_f32_16x16x32_bf16 v[140:143], a[212:215], a[92:95], v[140:143]
    buffer_load_dwordx4 a[172:175], v12, s[16:19], s37 offen offset:3072 sc1
    v_mfma_f32_16x16x32_bf16 v[140:143], a[208:211], a[76:79], v[140:143]
    s_waitcnt lgkmcnt(8)
    v_mfma_f32_16x16x32_bf16 v[156:159], a[216:219], a[76:79], v[156:159]
    ds_read_b64_tr_b16 a[208:209], v18 offset:32768
    v_mfma_f32_16x16x32_bf16 v[156:159], a[220:223], a[92:95], v[156:159]
    ds_read_b64_tr_b16 a[210:211], v18 offset:34816
    s_add_u32 m0, s29, 115712
    v_mfma_f32_16x16x32_bf16 v[152:155], a[220:223], a[88:91], v[152:155]
    buffer_load_dwordx4 v14, s[64:67], s27 offen offset:0 lds
    v_mfma_f32_16x16x32_bf16 v[152:155], a[216:219], a[72:75], v[152:155]
    v_mfma_f32_16x16x32_bf16 v[148:151], a[216:219], a[68:71], v[148:151]
    ds_read_b64_tr_b16 a[212:213], v18 offset:36864
    v_mfma_f32_16x16x32_bf16 v[148:151], a[220:223], a[84:87], v[148:151]
    ds_read_b64_tr_b16 a[214:215], v18 offset:38912
    s_add_u32 s37, s24, 3014656
    v_mfma_f32_16x16x32_bf16 v[144:147], a[220:223], a[80:83], v[144:147]
    buffer_load_dwordx4 a[176:179], v12, s[16:19], s37 offen offset:0 sc1
    v_mfma_f32_16x16x32_bf16 v[144:147], a[216:219], a[64:67], v[144:147]
    s_waitcnt lgkmcnt(8)
    v_mfma_f32_16x16x32_bf16 v[32:35], a[192:195], a[96:99], v[32:35]
    ds_read_b64_tr_b16 a[216:217], v19 offset:32768
    v_mfma_f32_16x16x32_bf16 v[32:35], a[196:199], a[112:115], v[32:35]
    ds_read_b64_tr_b16 a[218:219], v19 offset:34816
    v_mfma_f32_16x16x32_bf16 v[36:39], a[196:199], a[116:119], v[36:39]
    buffer_load_dwordx4 a[180:183], v12, s[16:19], s37 offen offset:1024 sc1
    v_mfma_f32_16x16x32_bf16 v[36:39], a[192:195], a[100:103], v[36:39]
    v_mfma_f32_16x16x32_bf16 v[40:43], a[192:195], a[104:107], v[40:43]
    ds_read_b64_tr_b16 a[220:221], v19 offset:36864
    v_mfma_f32_16x16x32_bf16 v[40:43], a[196:199], a[120:123], v[40:43]
    ds_read_b64_tr_b16 a[222:223], v19 offset:38912
    v_mfma_f32_16x16x32_bf16 v[44:47], a[196:199], a[124:127], v[44:47]
    buffer_load_dwordx4 a[184:187], v12, s[16:19], s37 offen offset:2048 sc1
    v_mfma_f32_16x16x32_bf16 v[44:47], a[192:195], a[108:111], v[44:47]
    s_waitcnt lgkmcnt(8)
    v_mfma_f32_16x16x32_bf16 v[60:63], a[200:203], a[108:111], v[60:63]
    ds_read_b64_tr_b16 a[192:193], v20 offset:32768
    v_mfma_f32_16x16x32_bf16 v[60:63], a[204:207], a[124:127], v[60:63]
    ds_read_b64_tr_b16 a[194:195], v20 offset:34816
    s_add_u32 m0, s29, 123392
    v_mfma_f32_16x16x32_bf16 v[56:59], a[204:207], a[120:123], v[56:59]
    buffer_load_dwordx4 v14, s[64:67], s27 offen offset:512 lds
    v_mfma_f32_16x16x32_bf16 v[56:59], a[200:203], a[104:107], v[56:59]
    v_mfma_f32_16x16x32_bf16 v[52:55], a[200:203], a[100:103], v[52:55]
    ds_read_b64_tr_b16 a[196:197], v20 offset:36864
    v_mfma_f32_16x16x32_bf16 v[52:55], a[204:207], a[116:119], v[52:55]
    ds_read_b64_tr_b16 a[198:199], v20 offset:38912
    v_mfma_f32_16x16x32_bf16 v[48:51], a[204:207], a[112:115], v[48:51]
    buffer_load_dwordx4 a[188:191], v12, s[16:19], s37 offen offset:3072 sc1
    v_mfma_f32_16x16x32_bf16 v[48:51], a[200:203], a[96:99], v[48:51]
    s_waitcnt lgkmcnt(8)
    v_mfma_f32_16x16x32_bf16 v[64:67], a[208:211], a[96:99], v[64:67]
    ds_read_b64_tr_b16 a[200:201], v21 offset:32768
    v_mfma_f32_16x16x32_bf16 v[64:67], a[212:215], a[112:115], v[64:67]
    ds_read_b64_tr_b16 a[202:203], v21 offset:34816
    s_add_u32 s48, s49, 67584
    v_mfma_f32_16x16x32_bf16 v[68:71], a[212:215], a[116:119], v[68:71]
    buffer_load_dwordx2 v[28:29], v31, s[20:23], s48 offen sc1
    v_mfma_f32_16x16x32_bf16 v[68:71], a[208:211], a[100:103], v[68:71]
    v_mfma_f32_16x16x32_bf16 v[72:75], a[208:211], a[104:107], v[72:75]
    ds_read_b64_tr_b16 a[204:205], v21 offset:36864
    v_mfma_f32_16x16x32_bf16 v[72:75], a[212:215], a[120:123], v[72:75]
    ds_read_b64_tr_b16 a[206:207], v21 offset:38912
    s_add_u32 s37, s24, 1310720
    v_mfma_f32_16x16x32_bf16 v[76:79], a[212:215], a[124:127], v[76:79]
    buffer_load_dwordx4 a[0:3], v12, s[16:19], s37 offen offset:0 sc1
    v_mfma_f32_16x16x32_bf16 v[76:79], a[208:211], a[108:111], v[76:79]
    s_waitcnt lgkmcnt(8)
    v_mfma_f32_16x16x32_bf16 v[92:95], a[216:219], a[108:111], v[92:95]
    ds_read_b64_tr_b16 a[208:209], v22 offset:32768
    v_mfma_f32_16x16x32_bf16 v[92:95], a[220:223], a[124:127], v[92:95]
    ds_read_b64_tr_b16 a[210:211], v22 offset:34816
    v_mfma_f32_16x16x32_bf16 v[88:91], a[220:223], a[120:123], v[88:91]
    buffer_load_dwordx4 a[4:7], v12, s[16:19], s37 offen offset:1024 sc1
    v_mfma_f32_16x16x32_bf16 v[88:91], a[216:219], a[104:107], v[88:91]
    v_mfma_f32_16x16x32_bf16 v[84:87], a[216:219], a[100:103], v[84:87]
    ds_read_b64_tr_b16 a[212:213], v22 offset:36864
    v_mfma_f32_16x16x32_bf16 v[84:87], a[220:223], a[116:119], v[84:87]
    ds_read_b64_tr_b16 a[214:215], v22 offset:38912
    s_add_u32 s27, s25, 720896
    s_add_u32 m0, s29, 131072
    v_mfma_f32_16x16x32_bf16 v[80:83], a[220:223], a[112:115], v[80:83]
    buffer_load_dwordx4 v13, s[64:67], s27 offen offset:0 lds
    v_mfma_f32_16x16x32_bf16 v[80:83], a[216:219], a[96:99], v[80:83]
    s_waitcnt lgkmcnt(8)
    v_mfma_f32_16x16x32_bf16 v[96:99], a[192:195], a[96:99], v[96:99]
    ds_read_b64_tr_b16 a[216:217], v23 offset:32768
    v_mfma_f32_16x16x32_bf16 v[96:99], a[196:199], a[112:115], v[96:99]
    ds_read_b64_tr_b16 a[218:219], v23 offset:34816
    v_mfma_f32_16x16x32_bf16 v[100:103], a[196:199], a[116:119], v[100:103]
    buffer_load_dwordx4 a[8:11], v12, s[16:19], s37 offen offset:2048 sc1
    v_mfma_f32_16x16x32_bf16 v[100:103], a[192:195], a[100:103], v[100:103]
    v_mfma_f32_16x16x32_bf16 v[104:107], a[192:195], a[104:107], v[104:107]
    ds_read_b64_tr_b16 a[220:221], v23 offset:36864
    v_mfma_f32_16x16x32_bf16 v[104:107], a[196:199], a[120:123], v[104:107]
    ds_read_b64_tr_b16 a[222:223], v23 offset:38912
    v_mfma_f32_16x16x32_bf16 v[108:111], a[196:199], a[124:127], v[108:111]
    buffer_load_dwordx4 a[12:15], v12, s[16:19], s37 offen offset:3072 sc1
    v_mfma_f32_16x16x32_bf16 v[108:111], a[192:195], a[108:111], v[108:111]
    s_waitcnt lgkmcnt(8)
    v_mfma_f32_16x16x32_bf16 v[124:127], a[200:203], a[108:111], v[124:127]
    s_waitcnt vmcnt(17)
    s_barrier
    s_cmp_lg_u32 s5, 0
    s_cbranch_scc1 L_nofl3
    s_add_u32 s40, s40, 32768
    buffer_store_dwordx2 v[24:25], v26, s[20:23], s40 offen sc1
L_nofl3:
    ds_read_b64_tr_b16 a[192:193], v2 offset:28672
    v_mfma_f32_16x16x32_bf16 v[124:127], a[204:207], a[124:127], v[124:127]
    ds_read_b64_tr_b16 a[194:195], v2 offset:30720
    s_add_u32 m0, s29, 138752
    v_mfma_f32_16x16x32_bf16 v[120:123], a[204:207], a[120:123], v[120:123]
    buffer_load_dwordx4 v13, s[64:67], s27 offen offset:512 lds
    v_mfma_f32_16x16x32_bf16 v[120:123], a[200:203], a[104:107], v[120:123]
    v_mfma_f32_16x16x32_bf16 v[116:119], a[200:203], a[100:103], v[116:119]
    ds_read_b64_tr_b16 a[196:197], v2 offset:32768
    v_mfma_f32_16x16x32_bf16 v[116:119], a[204:207], a[116:119], v[116:119]
    ds_read_b64_tr_b16 a[198:199], v2 offset:34816
    s_add_u32 s37, s24, 3145728
    v_mfma_f32_16x16x32_bf16 v[112:115], a[204:207], a[112:115], v[112:115]
    buffer_load_dwordx4 a[16:19], v12, s[16:19], s37 offen offset:0 sc1
    v_mfma_f32_16x16x32_bf16 v[112:115], a[200:203], a[96:99], v[112:115]
    s_waitcnt lgkmcnt(8)
    v_mfma_f32_16x16x32_bf16 v[128:131], a[208:211], a[96:99], v[128:131]
    ds_read_b64_tr_b16 a[200:201], v3 offset:28672
    v_mfma_f32_16x16x32_bf16 v[128:131], a[212:215], a[112:115], v[128:131]
    ds_read_b64_tr_b16 a[202:203], v3 offset:30720
    v_mfma_f32_16x16x32_bf16 v[132:135], a[212:215], a[116:119], v[132:135]
    buffer_load_dwordx4 a[20:23], v12, s[16:19], s37 offen offset:1024 sc1
    v_mfma_f32_16x16x32_bf16 v[132:135], a[208:211], a[100:103], v[132:135]
    v_mfma_f32_16x16x32_bf16 v[136:139], a[208:211], a[104:107], v[136:139]
    ds_read_b64_tr_b16 a[204:205], v3 offset:32768
    v_mfma_f32_16x16x32_bf16 v[136:139], a[212:215], a[120:123], v[136:139]
    ds_read_b64_tr_b16 a[206:207], v3 offset:34816
    v_mfma_f32_16x16x32_bf16 v[140:143], a[212:215], a[124:127], v[140:143]
    buffer_load_dwordx4 a[24:27], v12, s[16:19], s37 offen offset:2048 sc1
    v_mfma_f32_16x16x32_bf16 v[140:143], a[208:211], a[108:111], v[140:143]
    s_waitcnt lgkmcnt(8)
    v_mfma_f32_16x16x32_bf16 v[156:159], a[216:219], a[108:111], v[156:159]
    ds_read_b64_tr_b16 a[208:209], v4 offset:28672
    v_mfma_f32_16x16x32_bf16 v[156:159], a[220:223], a[124:127], v[156:159]
    ds_read_b64_tr_b16 a[210:211], v4 offset:30720
    s_add_u32 m0, s29, 132096
    v_mfma_f32_16x16x32_bf16 v[152:155], a[220:223], a[120:123], v[152:155]
    buffer_load_dwordx4 v14, s[64:67], s27 offen offset:0 lds
    v_mfma_f32_16x16x32_bf16 v[152:155], a[216:219], a[104:107], v[152:155]
    v_mfma_f32_16x16x32_bf16 v[148:151], a[216:219], a[100:103], v[148:151]
    ds_read_b64_tr_b16 a[212:213], v4 offset:32768
    v_mfma_f32_16x16x32_bf16 v[148:151], a[220:223], a[116:119], v[148:151]
    ds_read_b64_tr_b16 a[214:215], v4 offset:34816
    v_mfma_f32_16x16x32_bf16 v[144:147], a[220:223], a[112:115], v[144:147]
    buffer_load_dwordx4 a[28:31], v12, s[16:19], s37 offen offset:3072 sc1
    v_mfma_f32_16x16x32_bf16 v[144:147], a[216:219], a[96:99], v[144:147]
    s_waitcnt lgkmcnt(8)
    v_mfma_f32_16x16x32_bf16 v[32:35], a[192:195], a[128:131], v[32:35]
    ds_read_b64_tr_b16 a[216:217], v5 offset:28672
    s_waitcnt vmcnt(11)
    v_cmp_ne_u64 vcc, s[98:99], v[28:29]
    s_nop 1
    s_cmp_lg_u64 vcc, 0
    s_cbranch_scc1 L_slow_c2
L_back_c2:
    v_mfma_f32_16x16x32_bf16 v[32:35], a[196:199], a[144:147], v[32:35]
    ds_read_b64_tr_b16 a[218:219], v5 offset:30720
    s_add_u32 s37, s24, 393216
    v_mfma_f32_16x16x32_bf16 v[36:39], a[196:199], a[148:151], v[36:39]
    buffer_load_dwordx4 a[32:35], v12, s[16:19], s37 offen offset:0 sc1
    v_mfma_f32_16x16x32_bf16 v[36:39], a[192:195], a[132:135], v[36:39]
    v_mfma_f32_16x16x32_bf16 v[40:43], a[192:195], a[136:139], v[40:43]
    ds_read_b64_tr_b16 a[220:221], v5 offset:32768
    v_mfma_f32_16x16x32_bf16 v[40:43], a[196:199], a[152:155], v[40:43]
    ds_read_b64_tr_b16 a[222:223], v5 offset:34816
    s_add_u32 m0, s29, 139776
    v_mfma_f32_16x16x32_bf16 v[44:47], a[196:199], a[156:159], v[44:47]
    buffer_load_dwordx4 v14, s[64:67], s27 offen offset:512 lds
    v_mfma_f32_16x16x32_bf16 v[44:47], a[192:195], a[140:143], v[44:47]
    s_waitcnt lgkmcnt(8)
    v_mfma_f32_16x16x32_bf16 v[60:63], a[200:203], a[140:143], v[60:63]
    ds_read_b64_tr_b16 a[192:193], v6 offset:28672
    v_mfma_f32_16x16x32_bf16 v[60:63], a[204:207], a[156:159], v[60:63]
    ds_read_b64_tr_b16 a[194:195], v6 offset:30720
    v_mfma_f32_16x16x32_bf16 v[56:59], a[204:207], a[152:155], v[56:59]
    buffer_load_dwordx4 a[36:39], v12, s[16:19], s37 offen offset:1024 sc1
    v_mfma_f32_16x16x32_bf16 v[56:59], a[200:203], a[136:139], v[56:59]
    v_mfma_f32_16x16x32_bf16 v[52:55], a[200:203], a[132:135], v[52:55]
    ds_read_b64_tr_b16 a[196:197], v6 offset:32768
    v_mfma_f32_16x16x32_bf16 v[52:55], a[204:207], a[148:151], v[52:55]
    ds_read_b64_tr_b16 a[198:199], v6 offset:34816
    v_mfma_f32_16x16x32_bf16 v[48:51], a[204:207], a[144:147], v[48:51]
    buffer_load_dwordx4 a[40:43], v12, s[16:19], s37 offen offset:2048 sc1
    v_mfma_f32_16x16x32_bf16 v[48:51], a[200:203], a[128:131], v[48:51]
    s_waitcnt lgkmcnt(8)
    v_mfma_f32_16x16x32_bf16 v[64:67], a[208:211], a[128:131], v[64:67]
    ds_read_b64_tr_b16 a[200:201], v7 offset:28672
    v_mfma_f32_16x16x32_bf16 v[64:67], a[212:215], a[144:147], v[64:67]
    ds_read_b64_tr_b16 a[202:203], v7 offset:30720
    v_mfma_f32_16x16x32_bf16 v[68:71], a[212:215], a[148:151], v[68:71]
    buffer_load_dwordx4 a[44:47], v12, s[16:19], s37 offen offset:3072 sc1
    v_mfma_f32_16x16x32_bf16 v[68:71], a[208:211], a[132:135], v[68:71]
    v_mfma_f32_16x16x32_bf16 v[72:75], a[208:211], a[136:139], v[72:75]
    ds_read_b64_tr_b16 a[204:205], v7 offset:32768
    v_mfma_f32_16x16x32_bf16 v[72:75], a[212:215], a[152:155], v[72:75]
    ds_read_b64_tr_b16 a[206:207], v7 offset:34816
    s_add_u32 s27, s25, 786432
    s_add_u32 m0, s29, 147456
    v_mfma_f32_16x16x32_bf16 v[76:79], a[212:215], a[156:159], v[76:79]
    buffer_load_dwordx4 v13, s[64:67], s27 offen offset:0 lds
    v_mfma_f32_16x16x32_bf16 v[76:79], a[208:211], a[140:143], v[76:79]
    s_waitcnt lgkmcnt(8)
    v_mfma_f32_16x16x32_bf16 v[92:95], a[216:219], a[140:143], v[92:95]
    ds_read_b64_tr_b16 a[208:209], v8 offset:28672
    v_mfma_f32_16x16x32_bf16 v[92:95], a[220:223], a[156:159], v[92:95]
    ds_read_b64_tr_b16 a[210:211], v8 offset:30720
    s_add_u32 s37, s24, 2228224
    v_mfma_f32_16x16x32_bf16 v[88:91], a[220:223], a[152:155], v[88:91]
    buffer_load_dwordx4 a[48:51], v12, s[16:19], s37 offen offset:0 sc1
    v_mfma_f32_16x16x32_bf16 v[88:91], a[216:219], a[136:139], v[88:91]
    v_mfma_f32_16x16x32_bf16 v[84:87], a[216:219], a[132:135], v[84:87]
    ds_read_b64_tr_b16 a[212:213], v8 offset:32768
    v_mfma_f32_16x16x32_bf16 v[84:87], a[220:223], a[148:151], v[84:87]
    ds_read_b64_tr_b16 a[214:215], v8 offset:34816
    v_mfma_f32_16x16x32_bf16 v[80:83], a[220:223], a[144:147], v[80:83]
    buffer_load_dwordx4 a[52:55], v12, s[16:19], s37 offen offset:1024 sc1
    v_mfma_f32_16x16x32_bf16 v[80:83], a[216:219], a[128:131], v[80:83]
    s_waitcnt lgkmcnt(8)
    v_mfma_f32_16x16x32_bf16 v[96:99], a[192:195], a[128:131], v[96:99]
    ds_read_b64_tr_b16 a[216:217], v9 offset:28672
    v_mfma_f32_16x16x32_bf16 v[96:99], a[196:199], a[144:147], v[96:99]
    ds_read_b64_tr_b16 a[218:219], v9 offset:30720
    v_mfma_f32_16x16x32_bf16 v[100:103], a[196:199], a[148:151], v[100:103]
    buffer_load_dwordx4 a[56:59], v12, s[16:19], s37 offen offset:2048 sc1
    v_mfma_f32_16x16x32_bf16 v[100:103], a[192:195], a[132:135], v[100:103]
    v_mfma_f32_16x16x32_bf16 v[104:107], a[192:195], a[136:139], v[104:107]
    ds_read_b64_tr_b16 a[220:221], v9 offset:32768
    v_mfma_f32_16x16x32_bf16 v[104:107], a[196:199], a[152:155], v[104:107]
    ds_read_b64_tr_b16 a[222:223], v9 offset:34816
    s_add_u32 m0, s29, 155136
    v_mfma_f32_16x16x32_bf16 v[108:111], a[196:199], a[156:159], v[108:111]
    buffer_load_dwordx4 v13, s[64:67], s27 offen offset:512 lds
    v_mfma_f32_16x16x32_bf16 v[108:111], a[192:195], a[140:143], v[108:111]
    s_waitcnt lgkmcnt(8)
    v_mfma_f32_16x16x32_bf16 v[124:127], a[200:203], a[140:143], v[124:127]
    s_waitcnt vmcnt(22)
    s_barrier
    ds_read_b64_tr_b16 a[192:193], v2 offset:57344
    v_mfma_f32_16x16x32_bf16 v[124:127], a[204:207], a[156:159], v[124:127]
    ds_read_b64_tr_b16 a[194:195], v2 offset:59392
    v_mfma_f32_16x16x32_bf16 v[120:123], a[204:207], a[152:155], v[120:123]
    buffer_load_dwordx4 a[60:63], v12, s[16:19], s37 offen offset:3072 sc1
    v_mfma_f32_16x16x32_bf16 v[120:123], a[200:203], a[136:139], v[120:123]
    v_mfma_f32_16x16x32_bf16 v[116:119], a[200:203], a[132:135], v[116:119]
    ds_read_b64_tr_b16 a[196:197], v2 offset:61440
    v_mfma_f32_16x16x32_bf16 v[116:119], a[204:207], a[148:151], v[116:119]
    ds_read_b64_tr_b16 a[198:199], v2 offset:63488
    s_add_u32 s37, s24, 524288
    v_mfma_f32_16x16x32_bf16 v[112:115], a[204:207], a[144:147], v[112:115]
    buffer_load_dwordx4 a[64:67], v12, s[16:19], s37 offen offset:0 sc1
    v_mfma_f32_16x16x32_bf16 v[112:115], a[200:203], a[128:131], v[112:115]
    s_waitcnt lgkmcnt(8)
    v_mfma_f32_16x16x32_bf16 v[128:131], a[208:211], a[128:131], v[128:131]
    ds_read_b64_tr_b16 a[200:201], v3 offset:57344
    v_mfma_f32_16x16x32_bf16 v[128:131], a[212:215], a[144:147], v[128:131]
    ds_read_b64_tr_b16 a[202:203], v3 offset:59392
    s_add_u32 m0, s29, 148480
    v_mfma_f32_16x16x32_bf16 v[132:135], a[212:215], a[148:151], v[132:135]
    buffer_load_dwordx4 v14, s[64:67], s27 offen offset:0 lds
    v_mfma_f32_16x16x32_bf16 v[132:135], a[208:211], a[132:135], v[132:135]
    v_mfma_f32_16x16x32_bf16 v[136:139], a[208:211], a[136:139], v[136:139]
    ds_read_b64_tr_b16 a[204:205], v3 offset:61440
    v_mfma_f32_16x16x32_bf16 v[136:139], a[212:215], a[152:155], v[136:139]
    ds_read_b64_tr_b16 a[206:207], v3 offset:63488
    v_mfma_f32_16x16x32_bf16 v[140:143], a[212:215], a[156:159], v[140:143]
    buffer_load_dwordx4 a[68:71], v12, s[16:19], s37 offen offset:1024 sc1
    v_mfma_f32_16x16x32_bf16 v[140:143], a[208:211], a[140:143], v[140:143]
    s_waitcnt lgkmcnt(8)
    v_mfma_f32_16x16x32_bf16 v[156:159], a[216:219], a[140:143], v[156:159]
    ds_read_b64_tr_b16 a[208:209], v4 offset:57344
    v_mfma_f32_16x16x32_bf16 v[156:159], a[220:223], a[156:159], v[156:159]
    ds_read_b64_tr_b16 a[210:211], v4 offset:59392
    v_mfma_f32_16x16x32_bf16 v[152:155], a[220:223], a[152:155], v[152:155]
    buffer_load_dwordx4 a[72:75], v12, s[16:19], s37 offen offset:2048 sc1
    v_mfma_f32_16x16x32_bf16 v[152:155], a[216:219], a[136:139], v[152:155]
    v_mfma_f32_16x16x32_bf16 v[148:151], a[216:219], a[132:135], v[148:151]
    ds_read_b64_tr_b16 a[212:213], v4 offset:61440
    v_mfma_f32_16x16x32_bf16 v[148:151], a[220:223], a[148:151], v[148:151]
    ds_read_b64_tr_b16 a[214:215], v4 offset:63488
    v_mfma_f32_16x16x32_bf16 v[144:147], a[220:223], a[144:147], v[144:147]
    buffer_load_dwordx4 a[76:79], v12, s[16:19], s37 offen offset:3072 sc1
    v_mfma_f32_16x16x32_bf16 v[144:147], a[216:219], a[128:131], v[144:147]
    s_waitcnt lgkmcnt(8)
    v_accvgpr_read_b32 v248, a248
    v_lshlrev_b32 v240, 16, v248
    v_mfma_f32_16x16x32_bf16 v[32:35], a[192:195], a[160:163], v[32:35]
    ds_read_b64_tr_b16 a[216:217], v5 offset:57344
    v_and_b32 v241, s58, v248
    v_accvgpr_read_b32 v248, a249
    v_mfma_f32_16x16x32_bf16 v[32:35], a[196:199], a[176:179], v[32:35]
    ds_read_b64_tr_b16 a[218:219], v5 offset:59392
    s_add_u32 m0, s29, 156160
    v_lshlrev_b32 v242, 16, v248
    v_mfma_f32_16x16x32_bf16 v[36:39], a[196:199], a[180:183], v[36:39]
    buffer_load_dwordx4 v14, s[64:67], s27 offen offset:512 lds
    v_and_b32 v243, s58, v248
    v_accvgpr_read_b32 v248, a250
    v_mfma_f32_16x16x32_bf16 v[36:39], a[192:195], a[164:167], v[36:39]
    v_lshlrev_b32 v244, 16, v248
    v_and_b32 v245, s58, v248
    v_accvgpr_read_b32 v248, a251
    v_mfma_f32_16x16x32_bf16 v[40:43], a[192:195], a[168:171], v[40:43]
    ds_read_b64_tr_b16 a[220:221], v5 offset:61440
    v_lshlrev_b32 v246, 16, v248
    v_and_b32 v247, s58, v248
    v_mfma_f32_16x16x32_bf16 v[40:43], a[196:199], a[184:187], v[40:43]
    ds_read_b64_tr_b16 a[222:223], v5 offset:63488
    s_add_u32 s37, s24, 2359296
    v_accvgpr_read_b32 v248, a232
    v_mfma_f32_16x16x32_bf16 v[44:47], a[196:199], a[188:191], v[44:47]
    buffer_load_dwordx4 a[80:83], v12, s[16:19], s37 offen offset:0 sc1
    v_lshlrev_b32 v160, 16, v248
    v_and_b32 v161, s58, v248
    v_mfma_f32_16x16x32_bf16 v[44:47], a[192:195], a[172:175], v[44:47]
    s_waitcnt lgkmcnt(8)
    v_add_f32 v160, v160, v240
    v_add_f32 v161, v161, v241
    v_mfma_f32_16x16x32_bf16 v[60:63], a[200:203], a[172:175], v[60:63]
    ds_read_b64_tr_b16 a[192:193], v6 offset:57344
    v_accvgpr_read_b32 v248, a233
    v_lshlrev_b32 v162, 16, v248
    v_mfma_f32_16x16x32_bf16 v[60:63], a[204:207], a[188:191], v[60:63]
    ds_read_b64_tr_b16 a[194:195], v6 offset:59392
    v_and_b32 v163, s58, v248
    v_add_f32 v162, v162, v242
    v_mfma_f32_16x16x32_bf16 v[56:59], a[204:207], a[184:187], v[56:59]
    buffer_load_dwordx4 a[84:87], v12, s[16:19], s37 offen offset:1024 sc1
    v_add_f32 v163, v163, v243
    v_accvgpr_read_b32 v248, a234
    v_mfma_f32_16x16x32_bf16 v[56:59], a[200:203], a[168:171], v[56:59]
    v_lshlrev_b32 v164, 16, v248
    v_and_b32 v165, s58, v248
    v_add_f32 v164, v164, v244
    v_mfma_f32_16x16x32_bf16 v[52:55], a[200:203], a[164:167], v[52:55]
    ds_read_b64_tr_b16 a[196:197], v6 offset:61440
    v_add_f32 v165, v165, v245
    v_accvgpr_read_b32 v248, a235
    v_mfma_f32_16x16x32_bf16 v[52:55], a[204:207], a[180:183], v[52:55]
    ds_read_b64_tr_b16 a[198:199], v6 offset:63488
    v_lshlrev_b32 v166, 16, v248
    v_and_b32 v167, s58, v248
    v_mfma_f32_16x16x32_bf16 v[48:51], a[204:207], a[176:179], v[48:51]
    buffer_load_dwordx4 a[88:91], v12, s[16:19], s37 offen offset:2048 sc1
    v_add_f32 v166, v166, v246
    v_add_f32 v167, v167, v247
    v_mfma_f32_16x16x32_bf16 v[48:51], a[200:203], a[160:163], v[48:51]
    s_waitcnt lgkmcnt(8)
    v_accvgpr_read_b32 v248, a236
    v_lshlrev_b32 v168, 16, v248
    v_mfma_f32_16x16x32_bf16 v[64:67], a[208:211], a[160:163], v[64:67]
    ds_read_b64_tr_b16 a[200:201], v7 offset:57344
    v_and_b32 v169, s58, v248
    v_add_f32 v168, v168, v240
    v_mfma_f32_16x16x32_bf16 v[64:67], a[212:215], a[176:179], v[64:67]
    ds_read_b64_tr_b16 a[202:203], v7 offset:59392
    v_readlane_b32 s27, v218, 1
    s_nop 0
    s_bitcmp1_b32 s27, 0
    s_cselect_b32 s12, s64, s60
    s_cselect_b32 s13, s65, s61
    s_cselect_b32 s14, s66, s62
    s_andn2_b32 s27, s27, 1
    s_add_u32 m0, s29, 98304
    v_mfma_f32_16x16x32_bf16 v[68:71], a[212:215], a[180:183], v[68:71]
    buffer_load_dwordx4 v13, s[12:15], s27 offen offset:0 lds
    v_add_f32 v169, v169, v241
    v_accvgpr_read_b32 v248, a237
    v_mfma_f32_16x16x32_bf16 v[68:71], a[208:211], a[164:167], v[68:71]
    v_lshlrev_b32 v170, 16, v248
    v_and_b32 v171, s58, v248
    v_add_f32 v170, v170, v242
    v_mfma_f32_16x16x32_bf16 v[72:75], a[208:211], a[168:171], v[72:75]
    ds_read_b64_tr_b16 a[204:205], v7 offset:61440
    v_add_f32 v171, v171, v243
    v_accvgpr_read_b32 v248, a238
    v_mfma_f32_16x16x32_bf16 v[72:75], a[212:215], a[184:187], v[72:75]
    ds_read_b64_tr_b16 a[206:207], v7 offset:63488
    v_lshlrev_b32 v172, 16, v248
    v_and_b32 v173, s58, v248
    v_mfma_f32_16x16x32_bf16 v[76:79], a[212:215], a[188:191], v[76:79]
    buffer_load_dwordx4 a[92:95], v12, s[16:19], s37 offen offset:3072 sc1
    v_add_f32 v172, v172, v244
    v_add_f32 v173, v173, v245
    v_mfma_f32_16x16x32_bf16 v[76:79], a[208:211], a[172:175], v[76:79]
    s_waitcnt lgkmcnt(8)
    v_accvgpr_read_b32 v248, a239
    v_lshlrev_b32 v174, 16, v248
    v_mfma_f32_16x16x32_bf16 v[92:95], a[216:219], a[172:175], v[92:95]
    ds_read_b64_tr_b16 a[208:209], v8 offset:57344
    v_and_b32 v175, s58, v248
    v_add_f32 v174, v174, v246
    v_mfma_f32_16x16x32_bf16 v[92:95], a[220:223], a[188:191], v[92:95]
    ds_read_b64_tr_b16 a[210:211], v8 offset:59392
    s_add_u32 s37, s24, 1441792
    v_add_f32 v175, v175, v247
    v_mfma_f32_16x16x32_bf16 v[88:91], a[220:223], a[184:187], v[88:91]
    buffer_load_dwordx4 a[96:99], v12, s[16:19], s37 offen offset:0 sc1
    v_accvgpr_read_b32 v248, a240
    v_lshlrev_b32 v176, 16, v248
    v_mfma_f32_16x16x32_bf16 v[88:91], a[216:219], a[168:171], v[88:91]
    v_and_b32 v177, s58, v248
    v_add_f32 v176, v176, v240
    v_add_f32 v177, v177, v241
    v_mfma_f32_16x16x32_bf16 v[84:87], a[216:219], a[164:167], v[84:87]
    ds_read_b64_tr_b16 a[212:213], v8 offset:61440
    v_accvgpr_read_b32 v248, a241
    v_lshlrev_b32 v178, 16, v248
    v_mfma_f32_16x16x32_bf16 v[84:87], a[220:223], a[180:183], v[84:87]
    ds_read_b64_tr_b16 a[214:215], v8 offset:63488
    v_and_b32 v179, s58, v248
    v_add_f32 v178, v178, v242
    v_mfma_f32_16x16x32_bf16 v[80:83], a[220:223], a[176:179], v[80:83]
    v_add_f32 v179, v179, v243
    v_accvgpr_read_b32 v248, a242
    v_lshlrev_b32 v180, 16, v248
    v_mfma_f32_16x16x32_bf16 v[80:83], a[216:219], a[160:163], v[80:83]
    s_waitcnt lgkmcnt(8)
    v_and_b32 v181, s58, v248
    v_add_f32 v180, v180, v244
    v_mfma_f32_16x16x32_bf16 v[96:99], a[192:195], a[160:163], v[96:99]
    ds_read_b64_tr_b16 a[216:217], v9 offset:57344
    v_add_f32 v181, v181, v245
    v_accvgpr_read_b32 v248, a243
    v_mfma_f32_16x16x32_bf16 v[96:99], a[196:199], a[176:179], v[96:99]
    ds_read_b64_tr_b16 a[218:219], v9 offset:59392
    s_add_u32 m0, s29, 105984
    v_lshlrev_b32 v182, 16, v248
    v_mfma_f32_16x16x32_bf16 v[100:103], a[196:199], a[180:183], v[100:103]
    buffer_load_dwordx4 v13, s[12:15], s27 offen offset:512 lds
    v_and_b32 v183, s58, v248
    v_add_f32 v182, v182, v246
    v_mfma_f32_16x16x32_bf16 v[100:103], a[192:195], a[164:167], v[100:103]
    v_add_f32 v183, v183, v247
    v_accvgpr_read_b32 v248, a244
    v_lshlrev_b32 v184, 16, v248
    v_mfma_f32_16x16x32_bf16 v[104:107], a[192:195], a[168:171], v[104:107]
    ds_read_b64_tr_b16 a[220:221], v9 offset:61440
    v_and_b32 v185, s58, v248
    v_add_f32 v184, v184, v240
    v_mfma_f32_16x16x32_bf16 v[104:107], a[196:199], a[184:187], v[104:107]
    ds_read_b64_tr_b16 a[222:223], v9 offset:63488
    v_add_f32 v185, v185, v241
    v_accvgpr_read_b32 v248, a245
    v_mfma_f32_16x16x32_bf16 v[108:111], a[196:199], a[188:191], v[108:111]
    buffer_load_dwordx4 a[100:103], v12, s[16:19], s37 offen offset:1024 sc1
    v_lshlrev_b32 v186, 16, v248
    v_and_b32 v187, s58, v248
    v_mfma_f32_16x16x32_bf16 v[108:111], a[192:195], a[172:175], v[108:111]
    s_waitcnt lgkmcnt(8)
    v_add_f32 v186, v186, v242
    v_add_f32 v187, v187, v243
    v_mfma_f32_16x16x32_bf16 v[124:127], a[200:203], a[172:175], v[124:127]
    s_waitcnt vmcnt(25)
    s_barrier
    ds_read_b64_tr_b16 a[192:193], v2 offset:0
    v_mfma_f32_16x16x32_bf16 v[124:127], a[204:207], a[188:191], v[124:127]
    ds_read_b64_tr_b16 a[194:195], v2 offset:2048
    v_accvgpr_read_b32 v248, a246
    v_lshlrev_b32 v188, 16, v248
    v_mfma_f32_16x16x32_bf16 v[120:123], a[204:207], a[184:187], v[120:123]
    buffer_load_dwordx4 a[104:107], v12, s[16:19], s37 offen offset:2048 sc1
    v_and_b32 v189, s58, v248
    v_add_f32 v188, v188, v244
    v_mfma_f32_16x16x32_bf16 v[120:123], a[200:203], a[168:171], v[120:123]
    v_add_f32 v189, v189, v245
    v_accvgpr_read_b32 v248, a247
    v_lshlrev_b32 v190, 16, v248
    v_mfma_f32_16x16x32_bf16 v[116:119], a[200:203], a[164:167], v[116:119]
    ds_read_b64_tr_b16 a[196:197], v2 offset:4096
    v_and_b32 v191, s58, v248
    v_add_f32 v190, v190, v246
    v_mfma_f32_16x16x32_bf16 v[116:119], a[204:207], a[180:183], v[116:119]
    ds_read_b64_tr_b16 a[198:199], v2 offset:6144
    v_add_f32 v191, v191, v247
    v_lshrrev_b32 v11, 5, v1
    v_mfma_f32_16x16x32_bf16 v[112:115], a[204:207], a[176:179], v[112:115]
    buffer_load_dwordx4 a[108:111], v12, s[16:19], s37 offen offset:3072 sc1
    v_lshlrev_b32 v11, 7, v11
    s_mov_b32 s68, 0
    v_mfma_f32_16x16x32_bf16 v[112:115], a[200:203], a[160:163], v[112:115]
    s_waitcnt lgkmcnt(8)
    s_mov_b32 s69, 0
    v_mfma_f32_16x16x32_bf16 v[128:131], a[208:211], a[160:163], v[128:131]
    ds_read_b64_tr_b16 a[200:201], v3 offset:0
    v_mfma_f32_16x16x32_bf16 v[128:131], a[212:215], a[176:179], v[128:131]
    ds_read_b64_tr_b16 a[202:203], v3 offset:2048
    s_add_u32 m0, s29, 99328
    v_mfma_f32_16x16x32_bf16 v[132:135], a[212:215], a[180:183], v[132:135]
    buffer_load_dwordx4 v14, s[12:15], s27 offen offset:0 lds
    v_mfma_f32_16x16x32_bf16 v[132:135], a[208:211], a[164:167], v[132:135]
    v_mfma_f32_16x16x32_bf16 v[136:139], a[208:211], a[168:171], v[136:139]
    ds_read_b64_tr_b16 a[204:205], v3 offset:4096
    v_mfma_f32_16x16x32_bf16 v[136:139], a[212:215], a[184:187], v[136:139]
    ds_read_b64_tr_b16 a[206:207], v3 offset:6144
    s_add_u32 s37, s24, 3276800
    v_mfma_f32_16x16x32_bf16 v[140:143], a[212:215], a[188:191], v[140:143]
    buffer_load_dwordx4 a[112:115], v12, s[16:19], s37 offen offset:0 sc1
    v_mfma_f32_16x16x32_bf16 v[140:143], a[208:211], a[172:175], v[140:143]
    s_waitcnt lgkmcnt(8)
    v_mfma_f32_16x16x32_bf16 v[156:159], a[216:219], a[172:175], v[156:159]
    ds_read_b64_tr_b16 a[208:209], v4 offset:0
    v_mfma_f32_16x16x32_bf16 v[156:159], a[220:223], a[188:191], v[156:159]
    ds_read_b64_tr_b16 a[210:211], v4 offset:2048
    v_mfma_f32_16x16x32_bf16 v[152:155], a[220:223], a[184:187], v[152:155]
    buffer_load_dwordx4 a[116:119], v12, s[16:19], s37 offen offset:1024 sc1
    v_mfma_f32_16x16x32_bf16 v[152:155], a[216:219], a[168:171], v[152:155]
    v_mfma_f32_16x16x32_bf16 v[148:151], a[216:219], a[164:167], v[148:151]
    ds_read_b64_tr_b16 a[212:213], v4 offset:4096
    v_mfma_f32_16x16x32_bf16 v[148:151], a[220:223], a[180:183], v[148:151]
    ds_read_b64_tr_b16 a[214:215], v4 offset:6144
    v_mfma_f32_16x16x32_bf16 v[144:147], a[220:223], a[176:179], v[144:147]
    v_mfma_f32_16x16x32_bf16 v[144:147], a[216:219], a[160:163], v[144:147]
    s_waitcnt lgkmcnt(8)
    v_mfma_f32_16x16x32_bf16 v[32:35], a[192:195], a[0:3], v[32:35]
    ds_read_b64_tr_b16 a[216:217], v5 offset:0
    v_mfma_f32_16x16x32_bf16 v[32:35], a[196:199], a[16:19], v[32:35]
    ds_read_b64_tr_b16 a[218:219], v5 offset:2048
    v_mfma_f32_16x16x32_bf16 v[36:39], a[196:199], a[20:23], v[36:39]
    buffer_load_dwordx4 a[120:123], v12, s[16:19], s37 offen offset:2048 sc1
    v_mfma_f32_16x16x32_bf16 v[36:39], a[192:195], a[4:7], v[36:39]
    v_mfma_f32_16x16x32_bf16 v[40:43], a[192:195], a[8:11], v[40:43]
    ds_read_b64_tr_b16 a[220:221], v5 offset:4096
    v_mfma_f32_16x16x32_bf16 v[40:43], a[196:199], a[24:27], v[40:43]
    ds_read_b64_tr_b16 a[222:223], v5 offset:6144
    s_add_u32 m0, s29, 107008
    v_mfma_f32_16x16x32_bf16 v[44:47], a[196:199], a[28:31], v[44:47]
    buffer_load_dwordx4 v14, s[12:15], s27 offen offset:512 lds
    v_mfma_f32_16x16x32_bf16 v[44:47], a[192:195], a[12:15], v[44:47]
    s_waitcnt lgkmcnt(8)
    v_mfma_f32_16x16x32_bf16 v[60:63], a[200:203], a[12:15], v[60:63]
    ds_read_b64_tr_b16 a[192:193], v6 offset:0
    v_mfma_f32_16x16x32_bf16 v[60:63], a[204:207], a[28:31], v[60:63]
    ds_read_b64_tr_b16 a[194:195], v6 offset:2048
    v_mfma_f32_16x16x32_bf16 v[56:59], a[204:207], a[24:27], v[56:59]
    buffer_load_dwordx4 a[124:127], v12, s[16:19], s37 offen offset:3072 sc1
    v_mfma_f32_16x16x32_bf16 v[56:59], a[200:203], a[8:11], v[56:59]
    v_mfma_f32_16x16x32_bf16 v[52:55], a[200:203], a[4:7], v[52:55]
    ds_read_b64_tr_b16 a[196:197], v6 offset:4096
    v_mfma_f32_16x16x32_bf16 v[52:55], a[204:207], a[20:23], v[52:55]
    ds_read_b64_tr_b16 a[198:199], v6 offset:6144
    s_add_u32 s48, s49, 98304
    v_mfma_f32_16x16x32_bf16 v[48:51], a[204:207], a[16:19], v[48:51]
    buffer_load_dwordx2 v[28:29], v27, s[20:23], s48 offen sc1
    v_mfma_f32_16x16x32_bf16 v[48:51], a[200:203], a[0:3], v[48:51]
    s_waitcnt lgkmcnt(8)
    v_mfma_f32_16x16x32_bf16 v[64:67], a[208:211], a[0:3], v[64:67]
    ds_read_b64_tr_b16 a[200:201], v7 offset:0
    v_mfma_f32_16x16x32_bf16 v[64:67], a[212:215], a[16:19], v[64:67]
    ds_read_b64_tr_b16 a[202:203], v7 offset:2048
    s_add_u32 s37, s24, 1572864
    v_mfma_f32_16x16x32_bf16 v[68:71], a[212:215], a[20:23], v[68:71]
    buffer_load_dwordx4 a[128:131], v12, s[16:19], s37 offen offset:0 sc1
    v_mfma_f32_16x16x32_bf16 v[68:71], a[208:211], a[4:7], v[68:71]
    v_mfma_f32_16x16x32_bf16 v[72:75], a[208:211], a[8:11], v[72:75]
    ds_read_b64_tr_b16 a[204:205], v7 offset:4096
    v_mfma_f32_16x16x32_bf16 v[72:75], a[212:215], a[24:27], v[72:75]
    ds_read_b64_tr_b16 a[206:207], v7 offset:6144
    v_readlane_b32 s27, v218, 2
    s_nop 0
    s_bitcmp1_b32 s27, 0
    s_cselect_b32 s12, s64, s60
    s_cselect_b32 s13, s65, s61
    s_cselect_b32 s14, s66, s62
    s_andn2_b32 s27, s27, 1
    s_add_u32 m0, s29, 28672
    v_mfma_f32_16x16x32_bf16 v[76:79], a[212:215], a[28:31], v[76:79]
    buffer_load_dwordx4 v13, s[12:15], s27 offen offset:0 lds
    v_mfma_f32_16x16x32_bf16 v[76:79], a[208:211], a[12:15], v[76:79]
    s_waitcnt lgkmcnt(8)
    v_mfma_f32_16x16x32_bf16 v[92:95], a[216:219], a[12:15], v[92:95]
    ds_read_b64_tr_b16 a[208:209], v8 offset:0
    v_mfma_f32_16x16x32_bf16 v[92:95], a[220:223], a[28:31], v[92:95]
    ds_read_b64_tr_b16 a[210:211], v8 offset:2048
    v_mfma_f32_16x16x32_bf16 v[88:91], a[220:223], a[24:27], v[88:91]
    buffer_load_dwordx4 a[132:135], v12, s[16:19], s37 offen offset:1024 sc1
    v_mfma_f32_16x16x32_bf16 v[88:91], a[216:219], a[8:11], v[88:91]
    v_mfma_f32_16x16x32_bf16 v[84:87], a[216:219], a[4:7], v[84:87]
    ds_read_b64_tr_b16 a[212:213], v8 offset:4096
    v_mfma_f32_16x16x32_bf16 v[84:87], a[220:223], a[20:23], v[84:87]
    ds_read_b64_tr_b16 a[214:215], v8 offset:6144
    v_mfma_f32_16x16x32_bf16 v[80:83], a[220:223], a[16:19], v[80:83]
    buffer_load_dwordx4 a[136:139], v12, s[16:19], s37 offen offset:2048 sc1
    v_mfma_f32_16x16x32_bf16 v[80:83], a[216:219], a[0:3], v[80:83]
    s_waitcnt lgkmcnt(8)
    v_mfma_f32_16x16x32_bf16 v[96:99], a[192:195], a[0:3], v[96:99]
    ds_read_b64_tr_b16 a[216:217], v9 offset:0
    v_mfma_f32_16x16x32_bf16 v[96:99], a[196:199], a[16:19], v[96:99]
    ds_read_b64_tr_b16 a[218:219], v9 offset:2048
    v_mfma_f32_16x16x32_bf16 v[100:103], a[196:199], a[20:23], v[100:103]
    buffer_load_dwordx4 a[140:143], v12, s[16:19], s37 offen offset:3072 sc1
    v_mfma_f32_16x16x32_bf16 v[100:103], a[192:195], a[4:7], v[100:103]
    v_mfma_f32_16x16x32_bf16 v[104:107], a[192:195], a[8:11], v[104:107]
    ds_read_b64_tr_b16 a[220:221], v9 offset:4096
    v_mfma_f32_16x16x32_bf16 v[104:107], a[196:199], a[24:27], v[104:107]
    ds_read_b64_tr_b16 a[222:223], v9 offset:6144
    s_add_u32 m0, s29, 36352
    v_mfma_f32_16x16x32_bf16 v[108:111], a[196:199], a[28:31], v[108:111]
    buffer_load_dwordx4 v13, s[12:15], s27 offen offset:512 lds
    v_mfma_f32_16x16x32_bf16 v[108:111], a[192:195], a[12:15], v[108:111]
    s_waitcnt lgkmcnt(8)
    v_mfma_f32_16x16x32_bf16 v[124:127], a[200:203], a[12:15], v[124:127]
    s_waitcnt vmcnt(29)
    s_barrier
    ds_read_b64_tr_b16 a[192:193], v16 offset:16384
    v_mfma_f32_16x16x32_bf16 v[124:127], a[204:207], a[28:31], v[124:127]
    ds_read_b64_tr_b16 a[194:195], v16 offset:18432
    s_add_u32 s37, s24, 3407872
    v_mfma_f32_16x16x32_bf16 v[120:123], a[204:207], a[24:27], v[120:123]
    buffer_load_dwordx4 a[144:147], v12, s[16:19], s37 offen offset:0 sc1
    v_mfma_f32_16x16x32_bf16 v[120:123], a[200:203], a[8:11], v[120:123]
    v_mfma_f32_16x16x32_bf16 v[116:119], a[200:203], a[4:7], v[116:119]
    ds_read_b64_tr_b16 a[196:197], v16 offset:20480
    v_mfma_f32_16x16x32_bf16 v[116:119], a[204:207], a[20:23], v[116:119]
    ds_read_b64_tr_b16 a[198:199], v16 offset:22528
    v_mfma_f32_16x16x32_bf16 v[112:115], a[204:207], a[16:19], v[112:115]
    buffer_load_dwordx4 a[148:151], v12, s[16:19], s37 offen offset:1024 sc1
    v_mfma_f32_16x16x32_bf16 v[112:115], a[200:203], a[0:3], v[112:115]
    s_waitcnt lgkmcnt(8)
    v_mfma_f32_16x16x32_bf16 v[128:131], a[208:211], a[0:3], v[128:131]
    ds_read_b64_tr_b16 a[200:201], v17 offset:16384
    v_mfma_f32_16x16x32_bf16 v[128:131], a[212:215], a[16:19], v[128:131]
    ds_read_b64_tr_b16 a[202:203], v17 offset:18432
    s_add_u32 m0, s29, 29696
    v_mfma_f32_16x16x32_bf16 v[132:135], a[212:215], a[20:23], v[132:135]
    buffer_load_dwordx4 v14, s[12:15], s27 offen offset:0 lds
    v_mfma_f32_16x16x32_bf16 v[132:135], a[208:211], a[4:7], v[132:135]
    v_mfma_f32_16x16x32_bf16 v[136:139], a[208:211], a[8:11], v[136:139]
    ds_read_b64_tr_b16 a[204:205], v17 offset:20480
    v_mfma_f32_16x16x32_bf16 v[136:139], a[212:215], a[24:27], v[136:139]
    ds_read_b64_tr_b16 a[206:207], v17 offset:22528
    v_mfma_f32_16x16x32_bf16 v[140:143], a[212:215], a[28:31], v[140:143]
    buffer_load_dwordx4 a[152:155], v12, s[16:19], s37 offen offset:2048 sc1
    v_mfma_f32_16x16x32_bf16 v[140:143], a[208:211], a[12:15], v[140:143]
    s_waitcnt lgkmcnt(8)
    v_mfma_f32_16x16x32_bf16 v[156:159], a[216:219], a[12:15], v[156:159]
    ds_read_b64_tr_b16 a[208:209], v18 offset:16384
    v_mfma_f32_16x16x32_bf16 v[156:159], a[220:223], a[28:31], v[156:159]
    ds_read_b64_tr_b16 a[210:211], v18 offset:18432
    v_mfma_f32_16x16x32_bf16 v[152:155], a[220:223], a[24:27], v[152:155]
    buffer_load_dwordx4 a[156:159], v12, s[16:19], s37 offen offset:3072 sc1
    v_mfma_f32_16x16x32_bf16 v[152:155], a[216:219], a[8:11], v[152:155]
    v_mfma_f32_16x16x32_bf16 v[148:151], a[216:219], a[4:7], v[148:151]
    ds_read_b64_tr_b16 a[212:213], v18 offset:20480
    s_waitcnt vmcnt(11)
    v_cmp_ne_u64 vcc, s[98:99], v[28:29]
    s_nop 1
    s_cmp_lg_u64 vcc, 0
    s_cbranch_scc1 L_slow_c3
L_back_c3:
    v_mfma_f32_16x16x32_bf16 v[148:151], a[220:223], a[20:23], v[148:151]
    ds_read_b64_tr_b16 a[214:215], v18 offset:22528
    v_mfma_f32_16x16x32_bf16 v[144:147], a[220:223], a[16:19], v[144:147]
    v_mfma_f32_16x16x32_bf16 v[144:147], a[216:219], a[0:3], v[144:147]
    s_waitcnt lgkmcnt(8)
    v_mfma_f32_16x16x32_bf16 v[32:35], a[192:195], a[32:35], v[32:35]
    ds_read_b64_tr_b16 a[216:217], v19 offset:16384
    v_mfma_f32_16x16x32_bf16 v[32:35], a[196:199], a[48:51], v[32:35]
    ds_read_b64_tr_b16 a[218:219], v19 offset:18432
    v_readlane_b32 s37, v216, 1
    v_mfma_f32_16x16x32_bf16 v[36:39], a[196:199], a[52:55], v[36:39]
    s_nop 3
    buffer_load_dwordx4 a[160:163], v12, s[16:19], s37 offen offset:0 sc1
    v_mfma_f32_16x16x32_bf16 v[36:39], a[192:195], a[36:39], v[36:39]
    v_mfma_f32_16x16x32_bf16 v[40:43], a[192:195], a[40:43], v[40:43]
    ds_read_b64_tr_b16 a[220:221], v19 offset:20480
    v_mfma_f32_16x16x32_bf16 v[40:43], a[196:199], a[56:59], v[40:43]
    ds_read_b64_tr_b16 a[222:223], v19 offset:22528
    s_add_u32 m0, s29, 37376
    v_mfma_f32_16x16x32_bf16 v[44:47], a[196:199], a[60:63], v[44:47]
    buffer_load_dwordx4 v14, s[12:15], s27 offen offset:512 lds
    v_mfma_f32_16x16x32_bf16 v[44:47], a[192:195], a[44:47], v[44:47]
    s_waitcnt lgkmcnt(8)
    v_mfma_f32_16x16x32_bf16 v[60:63], a[200:203], a[44:47], v[60:63]
    ds_read_b64_tr_b16 a[192:193], v20 offset:16384
    v_mfma_f32_16x16x32_bf16 v[60:63], a[204:207], a[60:63], v[60:63]
    ds_read_b64_tr_b16 a[194:195], v20 offset:18432
    v_mfma_f32_16x16x32_bf16 v[56:59], a[204:207], a[56:59], v[56:59]
    buffer_load_dwordx4 a[164:167], v12, s[16:19], s37 offen offset:1024 sc1
    v_mfma_f32_16x16x32_bf16 v[56:59], a[200:203], a[40:43], v[56:59]
    v_mfma_f32_16x16x32_bf16 v[52:55], a[200:203], a[36:39], v[52:55]
    ds_read_b64_tr_b16 a[196:197], v20 offset:20480
    v_mfma_f32_16x16x32_bf16 v[52:55], a[204:207], a[52:55], v[52:55]
    ds_read_b64_tr_b16 a[198:199], v20 offset:22528
    v_mfma_f32_16x16x32_bf16 v[48:51], a[204:207], a[48:51], v[48:51]
    buffer_load_dwordx4 a[168:171], v12, s[16:19], s37 offen offset:2048 sc1
    v_mfma_f32_16x16x32_bf16 v[48:51], a[200:203], a[32:35], v[48:51]
    s_waitcnt lgkmcnt(8)
    v_mfma_f32_16x16x32_bf16 v[64:67], a[208:211], a[32:35], v[64:67]
    ds_read_b64_tr_b16 a[200:201], v21 offset:16384
    v_mfma_f32_16x16x32_bf16 v[64:67], a[212:215], a[48:51], v[64:67]
    ds_read_b64_tr_b16 a[202:203], v21 offset:18432
    v_mfma_f32_16x16x32_bf16 v[68:71], a[212:215], a[52:55], v[68:71]
    buffer_load_dwordx4 a[172:175], v12, s[16:19], s37 offen offset:3072 sc1
    v_mfma_f32_16x16x32_bf16 v[68:71], a[208:211], a[36:39], v[68:71]
    v_mfma_f32_16x16x32_bf16 v[72:75], a[208:211], a[40:43], v[72:75]
    ds_read_b64_tr_b16 a[204:205], v21 offset:20480
    v_mfma_f32_16x16x32_bf16 v[72:75], a[212:215], a[56:59], v[72:75]
    ds_read_b64_tr_b16 a[206:207], v21 offset:22528
    v_readlane_b32 s27, v218, 3
    s_nop 0
    s_bitcmp1_b32 s27, 0
    s_cselect_b32 s12, s64, s60
    s_cselect_b32 s13, s65, s61
    s_cselect_b32 s14, s66, s62
    s_andn2_b32 s27, s27, 1
    s_add_u32 m0, s29, 57344
    v_mfma_f32_16x16x32_bf16 v[76:79], a[212:215], a[60:63], v[76:79]
    buffer_load_dwordx4 v13, s[12:15], s27 offen offset:0 lds
    v_mfma_f32_16x16x32_bf16 v[76:79], a[208:211], a[44:47], v[76:79]
    s_waitcnt lgkmcnt(8)
    v_mfma_f32_16x16x32_bf16 v[92:95], a[216:219], a[44:47], v[92:95]
    ds_read_b64_tr_b16 a[208:209], v22 offset:16384
    v_mfma_f32_16x16x32_bf16 v[92:95], a[220:223], a[60:63], v[92:95]
    ds_read_b64_tr_b16 a[210:211], v22 offset:18432
    v_readlane_b32 s37, v217, 1
    v_mfma_f32_16x16x32_bf16 v[88:91], a[220:223], a[56:59], v[88:91]
    s_nop 3
    buffer_load_dwordx4 a[176:179], v12, s[16:19], s37 offen offset:0 sc1
    v_mfma_f32_16x16x32_bf16 v[88:91], a[216:219], a[40:43], v[88:91]
    v_mfma_f32_16x16x32_bf16 v[84:87], a[216:219], a[36:39], v[84:87]
    ds_read_b64_tr_b16 a[212:213], v22 offset:20480
    v_mfma_f32_16x16x32_bf16 v[84:87], a[220:223], a[52:55], v[84:87]
    ds_read_b64_tr_b16 a[214:215], v22 offset:22528
    v_mfma_f32_16x16x32_bf16 v[80:83], a[220:223], a[48:51], v[80:83]
    v_mfma_f32_16x16x32_bf16 v[80:83], a[216:219], a[32:35], v[80:83]
    s_waitcnt lgkmcnt(8)
    v_mfma_f32_16x16x32_bf16 v[96:99], a[192:195], a[32:35], v[96:99]
    ds_read_b64_tr_b16 a[216:217], v23 offset:16384
    v_mfma_f32_16x16x32_bf16 v[96:99], a[196:199], a[48:51], v[96:99]
    ds_read_b64_tr_b16 a[218:219], v23 offset:18432
    v_mfma_f32_16x16x32_bf16 v[100:103], a[196:199], a[52:55], v[100:103]
    buffer_load_dwordx4 a[180:183], v12, s[16:19], s37 offen offset:1024 sc1
    v_mfma_f32_16x16x32_bf16 v[100:103], a[192:195], a[36:39], v[100:103]
    v_mfma_f32_16x16x32_bf16 v[104:107], a[192:195], a[40:43], v[104:107]
    ds_read_b64_tr_b16 a[220:221], v23 offset:20480
    v_mfma_f32_16x16x32_bf16 v[104:107], a[196:199], a[56:59], v[104:107]
    ds_read_b64_tr_b16 a[222:223], v23 offset:22528
    s_add_u32 m0, s29, 65024
    v_mfma_f32_16x16x32_bf16 v[108:111], a[196:199], a[60:63], v[108:111]
    buffer_load_dwordx4 v13, s[12:15], s27 offen offset:512 lds
    v_mfma_f32_16x16x32_bf16 v[108:111], a[192:195], a[44:47], v[108:111]
    s_waitcnt lgkmcnt(8)
    v_mfma_f32_16x16x32_bf16 v[124:127], a[200:203], a[44:47], v[124:127]
    s_waitcnt vmcnt(32)
    s_barrier
    ds_read_b64_tr_b16 a[192:193], v16 offset:49152
    v_mfma_f32_16x16x32_bf16 v[124:127], a[204:207], a[60:63], v[124:127]
    ds_read_b64_tr_b16 a[194:195], v16 offset:51200
    v_mfma_f32_16x16x32_bf16 v[120:123], a[204:207], a[56:59], v[120:123]
    buffer_load_dwordx4 a[184:187], v12, s[16:19], s37 offen offset:2048 sc1
    v_mfma_f32_16x16x32_bf16 v[120:123], a[200:203], a[40:43], v[120:123]
    v_mfma_f32_16x16x32_bf16 v[116:119], a[200:203], a[36:39], v[116:119]
    ds_read_b64_tr_b16 a[196:197], v16 offset:53248
    v_mfma_f32_16x16x32_bf16 v[116:119], a[204:207], a[52:55], v[116:119]
    ds_read_b64_tr_b16 a[198:199], v16 offset:55296
    v_mfma_f32_16x16x32_bf16 v[112:115], a[204:207], a[48:51], v[112:115]
    buffer_load_dwordx4 a[188:191], v12, s[16:19], s37 offen offset:3072 sc1
    v_mfma_f32_16x16x32_bf16 v[112:115], a[200:203], a[32:35], v[112:115]
    s_waitcnt lgkmcnt(8)
    v_mfma_f32_16x16x32_bf16 v[128:131], a[208:211], a[32:35], v[128:131]
    ds_read_b64_tr_b16 a[200:201], v17 offset:49152
    v_mfma_f32_16x16x32_bf16 v[128:131], a[212:215], a[48:51], v[128:131]
    ds_read_b64_tr_b16 a[202:203], v17 offset:51200
    v_readlane_b32 s37, v216, 2
    v_mfma_f32_16x16x32_bf16 v[132:135], a[212:215], a[52:55], v[132:135]
    s_nop 3
    buffer_load_dwordx4 a[0:3], v12, s[16:19], s37 offen offset:0 sc1
    v_mfma_f32_16x16x32_bf16 v[132:135], a[208:211], a[36:39], v[132:135]
    v_mfma_f32_16x16x32_bf16 v[136:139], a[208:211], a[40:43], v[136:139]
    ds_read_b64_tr_b16 a[204:205], v17 offset:53248
    v_mfma_f32_16x16x32_bf16 v[136:139], a[212:215], a[56:59], v[136:139]
    ds_read_b64_tr_b16 a[206:207], v17 offset:55296
    s_add_u32 m0, s29, 58368
    v_mfma_f32_16x16x32_bf16 v[140:143], a[212:215], a[60:63], v[140:143]
    buffer_load_dwordx4 v14, s[12:15], s27 offen offset:0 lds
    v_mfma_f32_16x16x32_bf16 v[140:143], a[208:211], a[44:47], v[140:143]
    s_waitcnt lgkmcnt(8)
    v_mfma_f32_16x16x32_bf16 v[156:159], a[216:219], a[44:47], v[156:159]
    ds_read_b64_tr_b16 a[208:209], v18 offset:49152
    v_mfma_f32_16x16x32_bf16 v[156:159], a[220:223], a[60:63], v[156:159]
    ds_read_b64_tr_b16 a[210:211], v18 offset:51200
    v_mfma_f32_16x16x32_bf16 v[152:155], a[220:223], a[56:59], v[152:155]
    buffer_load_dwordx4 a[4:7], v12, s[16:19], s37 offen offset:1024 sc1
    v_mfma_f32_16x16x32_bf16 v[152:155], a[216:219], a[40:43], v[152:155]
    v_mfma_f32_16x16x32_bf16 v[148:151], a[216:219], a[36:39], v[148:151]
    ds_read_b64_tr_b16 a[212:213], v18 offset:53248
    v_mfma_f32_16x16x32_bf16 v[148:151], a[220:223], a[52:55], v[148:151]
    ds_read_b64_tr_b16 a[214:215], v18 offset:55296
    v_mfma_f32_16x16x32_bf16 v[144:147], a[220:223], a[48:51], v[144:147]
    v_mfma_f32_16x16x32_bf16 v[144:147], a[216:219], a[32:35], v[144:147]
    s_waitcnt lgkmcnt(8)
    v_mfma_f32_16x16x32_bf16 v[32:35], a[192:195], a[64:67], v[32:35]
    ds_read_b64_tr_b16 a[216:217], v19 offset:49152
    v_mfma_f32_16x16x32_bf16 v[32:35], a[196:199], a[80:83], v[32:35]
    ds_read_b64_tr_b16 a[218:219], v19 offset:51200
    v_mfma_f32_16x16x32_bf16 v[36:39], a[196:199], a[84:87], v[36:39]
    buffer_load_dwordx4 a[8:11], v12, s[16:19], s37 offen offset:2048 sc1
    v_mfma_f32_16x16x32_bf16 v[36:39], a[192:195], a[68:71], v[36:39]
    v_mfma_f32_16x16x32_bf16 v[40:43], a[192:195], a[72:75], v[40:43]
    ds_read_b64_tr_b16 a[220:221], v19 offset:53248
    v_mfma_f32_16x16x32_bf16 v[40:43], a[196:199], a[88:91], v[40:43]
    ds_read_b64_tr_b16 a[222:223], v19 offset:55296
    v_mfma_f32_16x16x32_bf16 v[44:47], a[196:199], a[92:95], v[44:47]
    buffer_load_dwordx4 a[12:15], v12, s[16:19], s37 offen offset:3072 sc1
    v_mfma_f32_16x16x32_bf16 v[44:47], a[192:195], a[76:79], v[44:47]
    s_waitcnt lgkmcnt(8)
    v_mfma_f32_16x16x32_bf16 v[60:63], a[200:203], a[76:79], v[60:63]
    ds_read_b64_tr_b16 a[192:193], v20 offset:49152
    v_mfma_f32_16x16x32_bf16 v[60:63], a[204:207], a[92:95], v[60:63]
    ds_read_b64_tr_b16 a[194:195], v20 offset:51200
    s_add_u32 m0, s29, 66048
    v_mfma_f32_16x16x32_bf16 v[56:59], a[204:207], a[88:91], v[56:59]
    buffer_load_dwordx4 v14, s[12:15], s27 offen offset:512 lds
    v_mfma_f32_16x16x32_bf16 v[56:59], a[200:203], a[72:75], v[56:59]
    v_mfma_f32_16x16x32_bf16 v[52:55], a[200:203], a[68:71], v[52:55]
    ds_read_b64_tr_b16 a[196:197], v20 offset:53248
    v_mfma_f32_16x16x32_bf16 v[52:55], a[204:207], a[84:87], v[52:55]
    ds_read_b64_tr_b16 a[198:199], v20 offset:55296
    v_readlane_b32 s37, v217, 2
    v_mfma_f32_16x16x32_bf16 v[48:51], a[204:207], a[80:83], v[48:51]
    s_nop 3
    buffer_load_dwordx4 a[16:19], v12, s[16:19], s37 offen offset:0 sc1
    v_mfma_f32_16x16x32_bf16 v[48:51], a[200:203], a[64:67], v[48:51]
    s_waitcnt lgkmcnt(8)
    v_mfma_f32_16x16x32_bf16 v[64:67], a[208:211], a[64:67], v[64:67]
    ds_read_b64_tr_b16 a[200:201], v21 offset:49152
    v_mfma_f32_16x16x32_bf16 v[64:67], a[212:215], a[80:83], v[64:67]
    ds_read_b64_tr_b16 a[202:203], v21 offset:51200
    v_mfma_f32_16x16x32_bf16 v[68:71], a[212:215], a[84:87], v[68:71]
    buffer_load_dwordx4 a[20:23], v12, s[16:19], s37 offen offset:1024 sc1
    v_mfma_f32_16x16x32_bf16 v[68:71], a[208:211], a[68:71], v[68:71]
    v_mfma_f32_16x16x32_bf16 v[72:75], a[208:211], a[72:75], v[72:75]
    ds_read_b64_tr_b16 a[204:205], v21 offset:53248
    v_mfma_f32_16x16x32_bf16 v[72:75], a[212:215], a[88:91], v[72:75]
    ds_read_b64_tr_b16 a[206:207], v21 offset:55296
    v_mfma_f32_16x16x32_bf16 v[76:79], a[212:215], a[92:95], v[76:79]
    v_mfma_f32_16x16x32_bf16 v[76:79], a[208:211], a[76:79], v[76:79]
    s_waitcnt lgkmcnt(8)
    v_mfma_f32_16x16x32_bf16 v[92:95], a[216:219], a[76:79], v[92:95]
    ds_read_b64_tr_b16 a[208:209], v22 offset:49152
    v_mfma_f32_16x16x32_bf16 v[92:95], a[220:223], a[92:95], v[92:95]
    ds_read_b64_tr_b16 a[210:211], v22 offset:51200
    v_readlane_b32 s27, v218, 4
    s_nop 0
    s_bitcmp1_b32 s27, 0
    s_cselect_b32 s12, s64, s60
    s_cselect_b32 s13, s65, s61
    s_cselect_b32 s14, s66, s62
    s_andn2_b32 s27, s27, 1
    s_add_u32 m0, s29, 0
    v_mfma_f32_16x16x32_bf16 v[88:91], a[220:223], a[88:91], v[88:91]
    buffer_load_dwordx4 v13, s[12:15], s27 offen offset:0 lds
    v_mfma_f32_16x16x32_bf16 v[88:91], a[216:219], a[72:75], v[88:91]
    v_mfma_f32_16x16x32_bf16 v[84:87], a[216:219], a[68:71], v[84:87]
    ds_read_b64_tr_b16 a[212:213], v22 offset:53248
    v_mfma_f32_16x16x32_bf16 v[84:87], a[220:223], a[84:87], v[84:87]
    ds_read_b64_tr_b16 a[214:215], v22 offset:55296
    v_mfma_f32_16x16x32_bf16 v[80:83], a[220:223], a[80:83], v[80:83]
    buffer_load_dwordx4 a[24:27], v12, s[16:19], s37 offen offset:2048 sc1
    v_mfma_f32_16x16x32_bf16 v[80:83], a[216:219], a[64:67], v[80:83]
    s_waitcnt lgkmcnt(8)
    v_mfma_f32_16x16x32_bf16 v[96:99], a[192:195], a[64:67], v[96:99]
    ds_read_b64_tr_b16 a[216:217], v23 offset:49152
    v_mfma_f32_16x16x32_bf16 v[96:99], a[196:199], a[80:83], v[96:99]
    ds_read_b64_tr_b16 a[218:219], v23 offset:51200
    v_mfma_f32_16x16x32_bf16 v[100:103], a[196:199], a[84:87], v[100:103]
    buffer_load_dwordx4 a[28:31], v12, s[16:19], s37 offen offset:3072 sc1
    v_mfma_f32_16x16x32_bf16 v[100:103], a[192:195], a[68:71], v[100:103]
    v_mfma_f32_16x16x32_bf16 v[104:107], a[192:195], a[72:75], v[104:107]
    ds_read_b64_tr_b16 a[220:221], v23 offset:53248
    v_mfma_f32_16x16x32_bf16 v[104:107], a[196:199], a[88:91], v[104:107]
    ds_read_b64_tr_b16 a[222:223], v23 offset:55296
    v_readlane_b32 s37, v216, 3
    v_mfma_f32_16x16x32_bf16 v[108:111], a[196:199], a[92:95], v[108:111]
    s_nop 3
    buffer_load_dwordx4 a[32:35], v12, s[16:19], s37 offen offset:0 sc1
    v_mfma_f32_16x16x32_bf16 v[108:111], a[192:195], a[76:79], v[108:111]
    s_waitcnt lgkmcnt(8)
    v_mfma_f32_16x16x32_bf16 v[124:127], a[200:203], a[76:79], v[124:127]
    s_waitcnt vmcnt(35)
    s_barrier
    ds_read_b64_tr_b16 a[192:193], v208 offset:0
    v_mfma_f32_16x16x32_bf16 v[124:127], a[204:207], a[92:95], v[124:127]
    ds_read_b64_tr_b16 a[194:195], v208 offset:2048
    s_add_u32 m0, s29, 7680
    v_mfma_f32_16x16x32_bf16 v[120:123], a[204:207], a[88:91], v[120:123]
    buffer_load_dwordx4 v13, s[12:15], s27 offen offset:512 lds
    v_mfma_f32_16x16x32_bf16 v[120:123], a[200:203], a[72:75], v[120:123]
    v_mfma_f32_16x16x32_bf16 v[116:119], a[200:203], a[68:71], v[116:119]
    ds_read_b64_tr_b16 a[196:197], v208 offset:4096
    v_mfma_f32_16x16x32_bf16 v[116:119], a[204:207], a[84:87], v[116:119]
    ds_read_b64_tr_b16 a[198:199], v208 offset:6144
    v_mfma_f32_16x16x32_bf16 v[112:115], a[204:207], a[80:83], v[112:115]
    buffer_load_dwordx4 a[36:39], v12, s[16:19], s37 offen offset:1024 sc1
    v_mfma_f32_16x16x32_bf16 v[112:115], a[200:203], a[64:67], v[112:115]
    s_waitcnt lgkmcnt(8)
    v_mfma_f32_16x16x32_bf16 v[128:131], a[208:211], a[64:67], v[128:131]
    ds_read_b64_tr_b16 a[200:201], v209 offset:0
    v_mfma_f32_16x16x32_bf16 v[128:131], a[212:215], a[80:83], v[128:131]
    ds_read_b64_tr_b16 a[202:203], v209 offset:2048
    v_mfma_f32_16x16x32_bf16 v[132:135], a[212:215], a[84:87], v[132:135]
    buffer_load_dwordx4 a[40:43], v12, s[16:19], s37 offen offset:2048 sc1
    v_mfma_f32_16x16x32_bf16 v[132:135], a[208:211], a[68:71], v[132:135]
    v_mfma_f32_16x16x32_bf16 v[136:139], a[208:211], a[72:75], v[136:139]
    ds_read_b64_tr_b16 a[204:205], v209 offset:4096
    v_mfma_f32_16x16x32_bf16 v[136:139], a[212:215], a[88:91], v[136:139]
    ds_read_b64_tr_b16 a[206:207], v209 offset:6144
    v_mfma_f32_16x16x32_bf16 v[140:143], a[212:215], a[92:95], v[140:143]
    v_mfma_f32_16x16x32_bf16 v[140:143], a[208:211], a[76:79], v[140:143]
    s_waitcnt lgkmcnt(8)
    v_mfma_f32_16x16x32_bf16 v[156:159], a[216:219], a[76:79], v[156:159]
    ds_read_b64_tr_b16 a[208:209], v210 offset:0
    v_mfma_f32_16x16x32_bf16 v[156:159], a[220:223], a[92:95], v[156:159]
    ds_read_b64_tr_b16 a[210:211], v210 offset:2048
    v_mfma_f32_16x16x32_bf16 v[152:155], a[220:223], a[88:91], v[152:155]
    buffer_load_dwordx4 a[44:47], v12, s[16:19], s37 offen offset:3072 sc1
    v_mfma_f32_16x16x32_bf16 v[152:155], a[216:219], a[72:75], v[152:155]
    v_mfma_f32_16x16x32_bf16 v[148:151], a[216:219], a[68:71], v[148:151]
    ds_read_b64_tr_b16 a[212:213], v210 offset:4096
    v_mfma_f32_16x16x32_bf16 v[148:151], a[220:223], a[84:87], v[148:151]
    ds_read_b64_tr_b16 a[214:215], v210 offset:6144
    s_add_u32 m0, s29, 1024
    v_mfma_f32_16x16x32_bf16 v[144:147], a[220:223], a[80:83], v[144:147]
    buffer_load_dwordx4 v14, s[12:15], s27 offen offset:0 lds
    v_mfma_f32_16x16x32_bf16 v[144:147], a[216:219], a[64:67], v[144:147]
    s_waitcnt lgkmcnt(8)
    v_mfma_f32_16x16x32_bf16 v[32:35], a[192:195], a[96:99], v[32:35]
    ds_read_b64_tr_b16 a[216:217], v211 offset:0
    v_mfma_f32_16x16x32_bf16 v[32:35], a[196:199], a[112:115], v[32:35]
    ds_read_b64_tr_b16 a[218:219], v211 offset:2048
    v_readlane_b32 s37, v217, 3
    v_mfma_f32_16x16x32_bf16 v[36:39], a[196:199], a[116:119], v[36:39]
    s_nop 3
    buffer_load_dwordx4 a[48:51], v12, s[16:19], s37 offen offset:0 sc1
    v_mfma_f32_16x16x32_bf16 v[36:39], a[192:195], a[100:103], v[36:39]
    v_mfma_f32_16x16x32_bf16 v[40:43], a[192:195], a[104:107], v[40:43]
    ds_read_b64_tr_b16 a[220:221], v211 offset:4096
    v_mfma_f32_16x16x32_bf16 v[40:43], a[196:199], a[120:123], v[40:43]
    ds_read_b64_tr_b16 a[222:223], v211 offset:6144
    v_mfma_f32_16x16x32_bf16 v[44:47], a[196:199], a[124:127], v[44:47]
    buffer_load_dwordx4 a[52:55], v12, s[16:19], s37 offen offset:1024 sc1
    v_mfma_f32_16x16x32_bf16 v[44:47], a[192:195], a[108:111], v[44:47]
    s_waitcnt lgkmcnt(8)
    v_mfma_f32_16x16x32_bf16 v[60:63], a[200:203], a[108:111], v[60:63]
    ds_read_b64_tr_b16 a[192:193], v212 offset:0
    v_mfma_f32_16x16x32_bf16 v[60:63], a[204:207], a[124:127], v[60:63]
    ds_read_b64_tr_b16 a[194:195], v212 offset:2048
    s_add_u32 m0, s29, 8704
    v_mfma_f32_16x16x32_bf16 v[56:59], a[204:207], a[120:123], v[56:59]
    buffer_load_dwordx4 v14, s[12:15], s27 offen offset:512 lds
    v_mfma_f32_16x16x32_bf16 v[56:59], a[200:203], a[104:107], v[56:59]
    v_mfma_f32_16x16x32_bf16 v[52:55], a[200:203], a[100:103], v[52:55]
    ds_read_b64_tr_b16 a[196:197], v212 offset:4096
    v_mfma_f32_16x16x32_bf16 v[52:55], a[204:207], a[116:119], v[52:55]
    ds_read_b64_tr_b16 a[198:199], v212 offset:6144
    v_mfma_f32_16x16x32_bf16 v[48:51], a[204:207], a[112:115], v[48:51]
    buffer_load_dwordx4 a[56:59], v12, s[16:19], s37 offen offset:2048 sc1
    v_mfma_f32_16x16x32_bf16 v[48:51], a[200:203], a[96:99], v[48:51]
    s_waitcnt lgkmcnt(8)
    v_mfma_f32_16x16x32_bf16 v[64:67], a[208:211], a[96:99], v[64:67]
    ds_read_b64_tr_b16 a[200:201], v213 offset:0
    v_mfma_f32_16x16x32_bf16 v[64:67], a[212:215], a[112:115], v[64:67]
    ds_read_b64_tr_b16 a[202:203], v213 offset:2048
    v_mfma_f32_16x16x32_bf16 v[68:71], a[212:215], a[116:119], v[68:71]
    buffer_load_dwordx4 a[60:63], v12, s[16:19], s37 offen offset:3072 sc1
    v_mfma_f32_16x16x32_bf16 v[68:71], a[208:211], a[100:103], v[68:71]
    v_mfma_f32_16x16x32_bf16 v[72:75], a[208:211], a[104:107], v[72:75]
    ds_read_b64_tr_b16 a[204:205], v213 offset:4096
    v_mfma_f32_16x16x32_bf16 v[72:75], a[212:215], a[120:123], v[72:75]
    ds_read_b64_tr_b16 a[206:207], v213 offset:6144
    v_mfma_f32_16x16x32_bf16 v[76:79], a[212:215], a[124:127], v[76:79]
    v_mfma_f32_16x16x32_bf16 v[76:79], a[208:211], a[108:111], v[76:79]
    s_waitcnt lgkmcnt(8)
    v_mfma_f32_16x16x32_bf16 v[92:95], a[216:219], a[108:111], v[92:95]
    ds_read_b64_tr_b16 a[208:209], v214 offset:0
    v_mfma_f32_16x16x32_bf16 v[92:95], a[220:223], a[124:127], v[92:95]
    ds_read_b64_tr_b16 a[210:211], v214 offset:2048
    v_readlane_b32 s37, v216, 4
    v_mfma_f32_16x16x32_bf16 v[88:91], a[220:223], a[120:123], v[88:91]
    s_nop 3
    buffer_load_dwordx4 a[64:67], v12, s[16:19], s37 offen offset:0 sc1
    v_mfma_f32_16x16x32_bf16 v[88:91], a[216:219], a[104:107], v[88:91]
    v_mfma_f32_16x16x32_bf16 v[84:87], a[216:219], a[100:103], v[84:87]
    ds_read_b64_tr_b16 a[212:213], v214 offset:4096
    v_mfma_f32_16x16x32_bf16 v[84:87], a[220:223], a[116:119], v[84:87]
    ds_read_b64_tr_b16 a[214:215], v214 offset:6144
    v_readlane_b32 s27, v218, 5
    s_nop 0
    s_bitcmp1_b32 s27, 0
    s_cselect_b32 s12, s64, s60
    s_cselect_b32 s13, s65, s61
    s_cselect_b32 s14, s66, s62
    s_andn2_b32 s27, s27, 1
    s_add_u32 m0, s29, 81920
    v_mfma_f32_16x16x32_bf16 v[80:83], a[220:223], a[112:115], v[80:83]
    buffer_load_dwordx4 v13, s[12:15], s27 offen offset:0 lds
    v_mfma_f32_16x16x32_bf16 v[80:83], a[216:219], a[96:99], v[80:83]
    s_waitcnt lgkmcnt(8)
    v_mfma_f32_16x16x32_bf16 v[96:99], a[192:195], a[96:99], v[96:99]
    ds_read_b64_tr_b16 a[216:217], v215 offset:0
    v_mfma_f32_16x16x32_bf16 v[96:99], a[196:199], a[112:115], v[96:99]
    ds_read_b64_tr_b16 a[218:219], v215 offset:2048
    v_mfma_f32_16x16x32_bf16 v[100:103], a[196:199], a[116:119], v[100:103]
    buffer_load_dwordx4 a[68:71], v12, s[16:19], s37 offen offset:1024 sc1
    v_mfma_f32_16x16x32_bf16 v[100:103], a[192:195], a[100:103], v[100:103]
    v_mfma_f32_16x16x32_bf16 v[104:107], a[192:195], a[104:107], v[104:107]
    ds_read_b64_tr_b16 a[220:221], v215 offset:4096
    v_mfma_f32_16x16x32_bf16 v[104:107], a[196:199], a[120:123], v[104:107]
    ds_read_b64_tr_b16 a[222:223], v215 offset:6144
    v_mfma_f32_16x16x32_bf16 v[108:111], a[196:199], a[124:127], v[108:111]
    buffer_load_dwordx4 a[72:75], v12, s[16:19], s37 offen offset:2048 sc1
    v_mfma_f32_16x16x32_bf16 v[108:111], a[192:195], a[108:111], v[108:111]
    s_waitcnt lgkmcnt(8)
    v_mfma_f32_16x16x32_bf16 v[124:127], a[200:203], a[108:111], v[124:127]
    s_waitcnt vmcnt(37)
    s_barrier
    ds_read_b64_tr_b16 a[192:193], v208 offset:16384
    v_mfma_f32_16x16x32_bf16 v[124:127], a[204:207], a[124:127], v[124:127]
    ds_read_b64_tr_b16 a[194:195], v208 offset:18432
    s_add_u32 m0, s29, 89600
    v_mfma_f32_16x16x32_bf16 v[120:123], a[204:207], a[120:123], v[120:123]
    buffer_load_dwordx4 v13, s[12:15], s27 offen offset:512 lds
    v_mfma_f32_16x16x32_bf16 v[120:123], a[200:203], a[104:107], v[120:123]
    v_mfma_f32_16x16x32_bf16 v[116:119], a[200:203], a[100:103], v[116:119]
    ds_read_b64_tr_b16 a[196:197], v208 offset:20480
    v_mfma_f32_16x16x32_bf16 v[116:119], a[204:207], a[116:119], v[116:119]
    ds_read_b64_tr_b16 a[198:199], v208 offset:22528
    v_mfma_f32_16x16x32_bf16 v[112:115], a[204:207], a[112:115], v[112:115]
    buffer_load_dwordx4 a[76:79], v12, s[16:19], s37 offen offset:3072 sc1
    v_mfma_f32_16x16x32_bf16 v[112:115], a[200:203], a[96:99], v[112:115]
    s_waitcnt lgkmcnt(8)
    v_mfma_f32_16x16x32_bf16 v[128:131], a[208:211], a[96:99], v[128:131]
    ds_read_b64_tr_b16 a[200:201], v209 offset:16384
    v_mfma_f32_16x16x32_bf16 v[128:131], a[212:215], a[112:115], v[128:131]
    ds_read_b64_tr_b16 a[202:203], v209 offset:18432
    v_readlane_b32 s37, v217, 4
    v_mfma_f32_16x16x32_bf16 v[132:135], a[212:215], a[116:119], v[132:135]
    s_nop 3
    buffer_load_dwordx4 a[80:83], v12, s[16:19], s37 offen offset:0 sc1
    v_mfma_f32_16x16x32_bf16 v[132:135], a[208:211], a[100:103], v[132:135]
    v_mfma_f32_16x16x32_bf16 v[136:139], a[208:211], a[104:107], v[136:139]
    ds_read_b64_tr_b16 a[204:205], v209 offset:20480
    v_mfma_f32_16x16x32_bf16 v[136:139], a[212:215], a[120:123], v[136:139]
    ds_read_b64_tr_b16 a[206:207], v209 offset:22528
    v_mfma_f32_16x16x32_bf16 v[140:143], a[212:215], a[124:127], v[140:143]
    v_mfma_f32_16x16x32_bf16 v[140:143], a[208:211], a[108:111], v[140:143]
    s_waitcnt lgkmcnt(8)
    v_mfma_f32_16x16x32_bf16 v[156:159], a[216:219], a[108:111], v[156:159]
    ds_read_b64_tr_b16 a[208:209], v210 offset:16384
    v_mfma_f32_16x16x32_bf16 v[156:159], a[220:223], a[124:127], v[156:159]
    ds_read_b64_tr_b16 a[210:211], v210 offset:18432
    v_mfma_f32_16x16x32_bf16 v[152:155], a[220:223], a[120:123], v[152:155]
    buffer_load_dwordx4 a[84:87], v12, s[16:19], s37 offen offset:1024 sc1
    v_mfma_f32_16x16x32_bf16 v[152:155], a[216:219], a[104:107], v[152:155]
    v_mfma_f32_16x16x32_bf16 v[148:151], a[216:219], a[100:103], v[148:151]
    ds_read_b64_tr_b16 a[212:213], v210 offset:20480
    v_mfma_f32_16x16x32_bf16 v[148:151], a[220:223], a[116:119], v[148:151]
    ds_read_b64_tr_b16 a[214:215], v210 offset:22528
    s_add_u32 m0, s29, 82944
    v_mfma_f32_16x16x32_bf16 v[144:147], a[220:223], a[112:115], v[144:147]
    buffer_load_dwordx4 v14, s[12:15], s27 offen offset:0 lds
    v_mfma_f32_16x16x32_bf16 v[144:147], a[216:219], a[96:99], v[144:147]
    s_waitcnt lgkmcnt(8)
    v_mfma_f32_16x16x32_bf16 v[32:35], a[192:195], a[128:131], v[32:35]
    ds_read_b64_tr_b16 a[216:217], v211 offset:16384
    v_mfma_f32_16x16x32_bf16 v[32:35], a[196:199], a[144:147], v[32:35]
    ds_read_b64_tr_b16 a[218:219], v211 offset:18432
    v_mfma_f32_16x16x32_bf16 v[36:39], a[196:199], a[148:151], v[36:39]
    buffer_load_dwordx4 a[88:91], v12, s[16:19], s37 offen offset:2048 sc1
    v_mfma_f32_16x16x32_bf16 v[36:39], a[192:195], a[132:135], v[36:39]
    v_mfma_f32_16x16x32_bf16 v[40:43], a[192:195], a[136:139], v[40:43]
    ds_read_b64_tr_b16 a[220:221], v211 offset:20480
    v_mfma_f32_16x16x32_bf16 v[40:43], a[196:199], a[152:155], v[40:43]
    ds_read_b64_tr_b16 a[222:223], v211 offset:22528
    v_mfma_f32_16x16x32_bf16 v[44:47], a[196:199], a[156:159], v[44:47]
    buffer_load_dwordx4 a[92:95], v12, s[16:19], s37 offen offset:3072 sc1
    v_mfma_f32_16x16x32_bf16 v[44:47], a[192:195], a[140:143], v[44:47]
    s_waitcnt lgkmcnt(8)
    v_mfma_f32_16x16x32_bf16 v[60:63], a[200:203], a[140:143], v[60:63]
    ds_read_b64_tr_b16 a[192:193], v212 offset:16384
    v_mfma_f32_16x16x32_bf16 v[60:63], a[204:207], a[156:159], v[60:63]
    ds_read_b64_tr_b16 a[194:195], v212 offset:18432
    v_readlane_b32 s37, v216, 5
    v_mfma_f32_16x16x32_bf16 v[56:59], a[204:207], a[152:155], v[56:59]
    s_nop 3
    buffer_load_dwordx4 a[96:99], v12, s[16:19], s37 offen offset:0 sc1
    v_mfma_f32_16x16x32_bf16 v[56:59], a[200:203], a[136:139], v[56:59]
    v_mfma_f32_16x16x32_bf16 v[52:55], a[200:203], a[132:135], v[52:55]
    ds_read_b64_tr_b16 a[196:197], v212 offset:20480
    v_mfma_f32_16x16x32_bf16 v[52:55], a[204:207], a[148:151], v[52:55]
    ds_read_b64_tr_b16 a[198:199], v212 offset:22528
    s_add_u32 m0, s29, 90624
    v_mfma_f32_16x16x32_bf16 v[48:51], a[204:207], a[144:147], v[48:51]
    buffer_load_dwordx4 v14, s[12:15], s27 offen offset:512 lds
    v_mfma_f32_16x16x32_bf16 v[48:51], a[200:203], a[128:131], v[48:51]
    s_waitcnt lgkmcnt(8)
    v_mfma_f32_16x16x32_bf16 v[64:67], a[208:211], a[128:131], v[64:67]
    ds_read_b64_tr_b16 a[200:201], v213 offset:16384
    v_mfma_f32_16x16x32_bf16 v[64:67], a[212:215], a[144:147], v[64:67]
    ds_read_b64_tr_b16 a[202:203], v213 offset:18432
    v_mfma_f32_16x16x32_bf16 v[68:71], a[212:215], a[148:151], v[68:71]
    buffer_load_dwordx4 a[100:103], v12, s[16:19], s37 offen offset:1024 sc1
    v_mfma_f32_16x16x32_bf16 v[68:71], a[208:211], a[132:135], v[68:71]
    v_mfma_f32_16x16x32_bf16 v[72:75], a[208:211], a[136:139], v[72:75]
    ds_read_b64_tr_b16 a[204:205], v213 offset:20480
    v_mfma_f32_16x16x32_bf16 v[72:75], a[212:215], a[152:155], v[72:75]
    ds_read_b64_tr_b16 a[206:207], v213 offset:22528
    v_mfma_f32_16x16x32_bf16 v[76:79], a[212:215], a[156:159], v[76:79]
    v_mfma_f32_16x16x32_bf16 v[76:79], a[208:211], a[140:143], v[76:79]
    s_waitcnt lgkmcnt(8)
    s_lshl_b32 s48, s39, 9
    s_add_u32 s48, s48, 131072
    v_mfma_f32_16x16x32_bf16 v[92:95], a[216:219], a[140:143], v[92:95]
    ds_read_b64_tr_b16 a[208:209], v214 offset:16384
    buffer_load_dwordx2 v[28:29], v26, s[20:23], s48 offen sc1
    v_mfma_f32_16x16x32_bf16 v[92:95], a[220:223], a[156:159], v[92:95]
    ds_read_b64_tr_b16 a[210:211], v214 offset:18432
    v_mfma_f32_16x16x32_bf16 v[88:91], a[220:223], a[152:155], v[88:91]
    buffer_load_dwordx4 a[104:107], v12, s[16:19], s37 offen offset:2048 sc1
    v_mfma_f32_16x16x32_bf16 v[88:91], a[216:219], a[136:139], v[88:91]
    v_mfma_f32_16x16x32_bf16 v[84:87], a[216:219], a[132:135], v[84:87]
    ds_read_b64_tr_b16 a[212:213], v214 offset:20480
    v_mfma_f32_16x16x32_bf16 v[84:87], a[220:223], a[148:151], v[84:87]
    ds_read_b64_tr_b16 a[214:215], v214 offset:22528
    v_readlane_b32 s27, v218, 6
    s_nop 0
    s_bitcmp1_b32 s27, 0
    s_cselect_b32 s12, s64, s60
    s_cselect_b32 s13, s65, s61
    s_cselect_b32 s14, s66, s62
    s_andn2_b32 s27, s27, 1
    s_add_u32 m0, s29, 114688
    v_mfma_f32_16x16x32_bf16 v[80:83], a[220:223], a[144:147], v[80:83]
    buffer_load_dwordx4 v13, s[12:15], s27 offen offset:0 lds
    v_mfma_f32_16x16x32_bf16 v[80:83], a[216:219], a[128:131], v[80:83]
    s_waitcnt lgkmcnt(8)
    v_mfma_f32_16x16x32_bf16 v[96:99], a[192:195], a[128:131], v[96:99]
    ds_read_b64_tr_b16 a[216:217], v215 offset:16384
    v_mfma_f32_16x16x32_bf16 v[96:99], a[196:199], a[144:147], v[96:99]
    ds_read_b64_tr_b16 a[218:219], v215 offset:18432
    v_mfma_f32_16x16x32_bf16 v[100:103], a[196:199], a[148:151], v[100:103]
    buffer_load_dwordx4 a[108:111], v12, s[16:19], s37 offen offset:3072 sc1
    v_mfma_f32_16x16x32_bf16 v[100:103], a[192:195], a[132:135], v[100:103]
    v_mfma_f32_16x16x32_bf16 v[104:107], a[192:195], a[136:139], v[104:107]
    ds_read_b64_tr_b16 a[220:221], v215 offset:20480
    v_mfma_f32_16x16x32_bf16 v[104:107], a[196:199], a[152:155], v[104:107]
    ds_read_b64_tr_b16 a[222:223], v215 offset:22528
    v_readlane_b32 s37, v217, 5
    v_mfma_f32_16x16x32_bf16 v[108:111], a[196:199], a[156:159], v[108:111]
    s_nop 3
    buffer_load_dwordx4 a[112:115], v12, s[16:19], s37 offen offset:0 sc1
    v_mfma_f32_16x16x32_bf16 v[108:111], a[192:195], a[140:143], v[108:111]
    s_waitcnt lgkmcnt(8)
    v_mfma_f32_16x16x32_bf16 v[124:127], a[200:203], a[140:143], v[124:127]
    s_waitcnt vmcnt(41)
    s_barrier
    ds_read_b64_tr_b16 a[192:193], v16 offset:32768
    v_mfma_f32_16x16x32_bf16 v[124:127], a[204:207], a[156:159], v[124:127]
    ds_read_b64_tr_b16 a[194:195], v16 offset:34816
    v_mfma_f32_16x16x32_bf16 v[120:123], a[204:207], a[152:155], v[120:123]
    buffer_load_dwordx4 a[116:119], v12, s[16:19], s37 offen offset:1024 sc1
    v_mfma_f32_16x16x32_bf16 v[120:123], a[200:203], a[136:139], v[120:123]
    v_mfma_f32_16x16x32_bf16 v[116:119], a[200:203], a[132:135], v[116:119]
    ds_read_b64_tr_b16 a[196:197], v16 offset:36864
    v_mfma_f32_16x16x32_bf16 v[116:119], a[204:207], a[148:151], v[116:119]
    ds_read_b64_tr_b16 a[198:199], v16 offset:38912
    s_add_u32 m0, s29, 122368
    v_mfma_f32_16x16x32_bf16 v[112:115], a[204:207], a[144:147], v[112:115]
    buffer_load_dwordx4 v13, s[12:15], s27 offen offset:512 lds
    v_mfma_f32_16x16x32_bf16 v[112:115], a[200:203], a[128:131], v[112:115]
    s_waitcnt lgkmcnt(8)
    v_mfma_f32_16x16x32_bf16 v[128:131], a[208:211], a[128:131], v[128:131]
    ds_read_b64_tr_b16 a[200:201], v17 offset:32768
    v_mfma_f32_16x16x32_bf16 v[128:131], a[212:215], a[144:147], v[128:131]
    ds_read_b64_tr_b16 a[202:203], v17 offset:34816
    v_mfma_f32_16x16x32_bf16 v[132:135], a[212:215], a[148:151], v[132:135]
    buffer_load_dwordx4 a[120:123], v12, s[16:19], s37 offen offset:2048 sc1
    v_mfma_f32_16x16x32_bf16 v[132:135], a[208:211], a[132:135], v[132:135]
    v_mfma_f32_16x16x32_bf16 v[136:139], a[208:211], a[136:139], v[136:139]
    ds_read_b64_tr_b16 a[204:205], v17 offset:36864
    v_mfma_f32_16x16x32_bf16 v[136:139], a[212:215], a[152:155], v[136:139]
    ds_read_b64_tr_b16 a[206:207], v17 offset:38912
    v_mfma_f32_16x16x32_bf16 v[140:143], a[212:215], a[156:159], v[140:143]
    v_mfma_f32_16x16x32_bf16 v[140:143], a[208:211], a[140:143], v[140:143]
    s_waitcnt lgkmcnt(8)
    v_mfma_f32_16x16x32_bf16 v[156:159], a[216:219], a[140:143], v[156:159]
    ds_read_b64_tr_b16 a[208:209], v18 offset:32768
    v_mfma_f32_16x16x32_bf16 v[156:159], a[220:223], a[156:159], v[156:159]
    ds_read_b64_tr_b16 a[210:211], v18 offset:34816
    v_mfma_f32_16x16x32_bf16 v[152:155], a[220:223], a[152:155], v[152:155]
    buffer_load_dwordx4 a[124:127], v12, s[16:19], s37 offen offset:3072 sc1
    v_mfma_f32_16x16x32_bf16 v[152:155], a[216:219], a[136:139], v[152:155]
    v_mfma_f32_16x16x32_bf16 v[148:151], a[216:219], a[132:135], v[148:151]
    ds_read_b64_tr_b16 a[212:213], v18 offset:36864
    v_mfma_f32_16x16x32_bf16 v[148:151], a[220:223], a[148:151], v[148:151]
    ds_read_b64_tr_b16 a[214:215], v18 offset:38912
    v_mfma_f32_16x16x32_bf16 v[144:147], a[220:223], a[144:147], v[144:147]
    v_mfma_f32_16x16x32_bf16 v[144:147], a[216:219], a[128:131], v[144:147]
    s_waitcnt lgkmcnt(8)
    v_mfma_f32_16x16x32_bf16 v[32:35], a[192:195], a[160:163], v[32:35]
    ds_read_b64_tr_b16 a[216:217], v19 offset:32768
    v_mfma_f32_16x16x32_bf16 v[32:35], a[196:199], a[176:179], v[32:35]
    ds_read_b64_tr_b16 a[218:219], v19 offset:34816
    v_readlane_b32 s37, v216, 6
    v_mfma_f32_16x16x32_bf16 v[36:39], a[196:199], a[180:183], v[36:39]
    s_nop 3
    buffer_load_dwordx4 a[128:131], v12, s[16:19], s37 offen offset:0 sc1
    v_mfma_f32_16x16x32_bf16 v[36:39], a[192:195], a[164:167], v[36:39]
    v_mfma_f32_16x16x32_bf16 v[40:43], a[192:195], a[168:171], v[40:43]
    ds_read_b64_tr_b16 a[220:221], v19 offset:36864
    v_mfma_f32_16x16x32_bf16 v[40:43], a[196:199], a[184:187], v[40:43]
    ds_read_b64_tr_b16 a[222:223], v19 offset:38912
    s_add_u32 m0, s29, 115712
    v_mfma_f32_16x16x32_bf16 v[44:47], a[196:199], a[188:191], v[44:47]
    buffer_load_dwordx4 v14, s[12:15], s27 offen offset:0 lds
    v_mfma_f32_16x16x32_bf16 v[44:47], a[192:195], a[172:175], v[44:47]
    s_waitcnt lgkmcnt(8)
    v_mfma_f32_16x16x32_bf16 v[60:63], a[200:203], a[172:175], v[60:63]
    ds_read_b64_tr_b16 a[192:193], v20 offset:32768
    v_mfma_f32_16x16x32_bf16 v[60:63], a[204:207], a[188:191], v[60:63]
    ds_read_b64_tr_b16 a[194:195], v20 offset:34816
    v_mfma_f32_16x16x32_bf16 v[56:59], a[204:207], a[184:187], v[56:59]
    buffer_load_dwordx4 a[132:135], v12, s[16:19], s37 offen offset:1024 sc1
    v_mfma_f32_16x16x32_bf16 v[56:59], a[200:203], a[168:171], v[56:59]
    v_mfma_f32_16x16x32_bf16 v[52:55], a[200:203], a[164:167], v[52:55]
    ds_read_b64_tr_b16 a[196:197], v20 offset:36864
    v_mfma_f32_16x16x32_bf16 v[52:55], a[204:207], a[180:183], v[52:55]
    ds_read_b64_tr_b16 a[198:199], v20 offset:38912
    v_mfma_f32_16x16x32_bf16 v[48:51], a[204:207], a[176:179], v[48:51]
    buffer_load_dwordx4 a[136:139], v12, s[16:19], s37 offen offset:2048 sc1
    v_mfma_f32_16x16x32_bf16 v[48:51], a[200:203], a[160:163], v[48:51]
    s_waitcnt lgkmcnt(8)
    v_mfma_f32_16x16x32_bf16 v[64:67], a[208:211], a[160:163], v[64:67]
    ds_read_b64_tr_b16 a[200:201], v21 offset:32768
    v_mfma_f32_16x16x32_bf16 v[64:67], a[212:215], a[176:179], v[64:67]
    ds_read_b64_tr_b16 a[202:203], v21 offset:34816
    s_add_u32 m0, s29, 123392
    v_mfma_f32_16x16x32_bf16 v[68:71], a[212:215], a[180:183], v[68:71]
    buffer_load_dwordx4 v14, s[12:15], s27 offen offset:512 lds
    v_mfma_f32_16x16x32_bf16 v[68:71], a[208:211], a[164:167], v[68:71]
    v_mfma_f32_16x16x32_bf16 v[72:75], a[208:211], a[168:171], v[72:75]
    ds_read_b64_tr_b16 a[204:205], v21 offset:36864
    v_mfma_f32_16x16x32_bf16 v[72:75], a[212:215], a[184:187], v[72:75]
    ds_read_b64_tr_b16 a[206:207], v21 offset:38912
    v_mfma_f32_16x16x32_bf16 v[76:79], a[212:215], a[188:191], v[76:79]
    buffer_load_dwordx4 a[140:143], v12, s[16:19], s37 offen offset:3072 sc1
    v_mfma_f32_16x16x32_bf16 v[76:79], a[208:211], a[172:175], v[76:79]
    s_waitcnt lgkmcnt(8)
    v_mfma_f32_16x16x32_bf16 v[92:95], a[216:219], a[172:175], v[92:95]
    ds_read_b64_tr_b16 a[208:209], v22 offset:32768
    v_mfma_f32_16x16x32_bf16 v[92:95], a[220:223], a[188:191], v[92:95]
    ds_read_b64_tr_b16 a[210:211], v22 offset:34816
    v_readlane_b32 s37, v217, 6
    v_mfma_f32_16x16x32_bf16 v[88:91], a[220:223], a[184:187], v[88:91]
    s_nop 3
    buffer_load_dwordx4 a[144:147], v12, s[16:19], s37 offen offset:0 sc1
    v_mfma_f32_16x16x32_bf16 v[88:91], a[216:219], a[168:171], v[88:91]
    v_mfma_f32_16x16x32_bf16 v[84:87], a[216:219], a[164:167], v[84:87]
    ds_read_b64_tr_b16 a[212:213], v22 offset:36864
    v_mfma_f32_16x16x32_bf16 v[84:87], a[220:223], a[180:183], v[84:87]
    ds_read_b64_tr_b16 a[214:215], v22 offset:38912
    v_mfma_f32_16x16x32_bf16 v[80:83], a[220:223], a[176:179], v[80:83]
    buffer_load_dwordx4 a[148:151], v12, s[16:19], s37 offen offset:1024 sc1
    v_mfma_f32_16x16x32_bf16 v[80:83], a[216:219], a[160:163], v[80:83]
    s_waitcnt lgkmcnt(8)
    v_mfma_f32_16x16x32_bf16 v[96:99], a[192:195], a[160:163], v[96:99]
    ds_read_b64_tr_b16 a[216:217], v23 offset:32768
    v_mfma_f32_16x16x32_bf16 v[96:99], a[196:199], a[176:179], v[96:99]
    ds_read_b64_tr_b16 a[218:219], v23 offset:34816
    v_readlane_b32 s27, v218, 7
    s_nop 0
    s_bitcmp1_b32 s27, 0
    s_cselect_b32 s12, s64, s60
    s_cselect_b32 s13, s65, s61
    s_cselect_b32 s14, s66, s62
    s_andn2_b32 s27, s27, 1
    s_add_u32 m0, s29, 131072
    v_mfma_f32_16x16x32_bf16 v[100:103], a[196:199], a[180:183], v[100:103]
    buffer_load_dwordx4 v13, s[12:15], s27 offen offset:0 lds
    v_mfma_f32_16x16x32_bf16 v[100:103], a[192:195], a[164:167], v[100:103]
    v_mfma_f32_16x16x32_bf16 v[104:107], a[192:195], a[168:171], v[104:107]
    ds_read_b64_tr_b16 a[220:221], v23 offset:36864
    v_mfma_f32_16x16x32_bf16 v[104:107], a[196:199], a[184:187], v[104:107]
    ds_read_b64_tr_b16 a[222:223], v23 offset:38912
    v_mfma_f32_16x16x32_bf16 v[108:111], a[196:199], a[188:191], v[108:111]
    buffer_load_dwordx4 a[152:155], v12, s[16:19], s37 offen offset:2048 sc1
    v_mfma_f32_16x16x32_bf16 v[108:111], a[192:195], a[172:175], v[108:111]
    s_waitcnt lgkmcnt(8)
    v_mfma_f32_16x16x32_bf16 v[124:127], a[200:203], a[172:175], v[124:127]
    s_waitcnt vmcnt(44)
    s_barrier
    ds_read_b64_tr_b16 a[192:193], v4 offset:28672
    v_mfma_f32_16x16x32_bf16 v[124:127], a[204:207], a[188:191], v[124:127]
    ds_read_b64_tr_b16 a[194:195], v4 offset:30720
    v_mfma_f32_16x16x32_bf16 v[120:123], a[204:207], a[184:187], v[120:123]
    buffer_load_dwordx4 a[156:159], v12, s[16:19], s37 offen offset:3072 sc1
    v_mfma_f32_16x16x32_bf16 v[120:123], a[200:203], a[168:171], v[120:123]
    v_mfma_f32_16x16x32_bf16 v[116:119], a[200:203], a[164:167], v[116:119]
    ds_read_b64_tr_b16 a[196:197], v4 offset:32768
    v_mfma_f32_16x16x32_bf16 v[116:119], a[204:207], a[180:183], v[116:119]
    ds_read_b64_tr_b16 a[198:199], v4 offset:34816
    v_mfma_f32_16x16x32_bf16 v[112:115], a[204:207], a[176:179], v[112:115]
    v_mfma_f32_16x16x32_bf16 v[112:115], a[200:203], a[160:163], v[112:115]
    s_waitcnt lgkmcnt(8)
    v_mfma_f32_16x16x32_bf16 v[128:131], a[208:211], a[160:163], v[128:131]
    ds_read_b64_tr_b16 a[200:201], v5 offset:28672
    v_mfma_f32_16x16x32_bf16 v[128:131], a[212:215], a[176:179], v[128:131]
    ds_read_b64_tr_b16 a[202:203], v5 offset:30720
    v_mfma_f32_16x16x32_bf16 v[132:135], a[212:215], a[180:183], v[132:135]
    v_mfma_f32_16x16x32_bf16 v[132:135], a[208:211], a[164:167], v[132:135]
    v_mfma_f32_16x16x32_bf16 v[136:139], a[208:211], a[168:171], v[136:139]
    ds_read_b64_tr_b16 a[204:205], v5 offset:32768
    v_mfma_f32_16x16x32_bf16 v[136:139], a[212:215], a[184:187], v[136:139]
    ds_read_b64_tr_b16 a[206:207], v5 offset:34816
    v_mfma_f32_16x16x32_bf16 v[140:143], a[212:215], a[188:191], v[140:143]
    v_mfma_f32_16x16x32_bf16 v[140:143], a[208:211], a[172:175], v[140:143]
    s_waitcnt lgkmcnt(8)
    v_mfma_f32_16x16x32_bf16 v[156:159], a[216:219], a[172:175], v[156:159]
    s_waitcnt vmcnt(34)
    s_barrier
    ds_read_b64_tr_b16 a[208:209], v4 offset:57344
    v_mfma_f32_16x16x32_bf16 v[156:159], a[220:223], a[188:191], v[156:159]
    ds_read_b64_tr_b16 a[210:211], v4 offset:59392
    v_mfma_f32_16x16x32_bf16 v[152:155], a[220:223], a[184:187], v[152:155]
    v_mfma_f32_16x16x32_bf16 v[152:155], a[216:219], a[168:171], v[152:155]
    v_mfma_f32_16x16x32_bf16 v[148:151], a[216:219], a[164:167], v[148:151]
    ds_read_b64_tr_b16 a[212:213], v4 offset:61440
    v_mfma_f32_16x16x32_bf16 v[148:151], a[220:223], a[180:183], v[148:151]
    ds_read_b64_tr_b16 a[214:215], v4 offset:63488
    v_mfma_f32_16x16x32_bf16 v[144:147], a[220:223], a[176:179], v[144:147]
    v_mfma_f32_16x16x32_bf16 v[144:147], a[216:219], a[160:163], v[144:147]
    s_waitcnt lgkmcnt(8)
    v_mfma_f32_16x16x32_bf16 v[64:67], a[192:195], a[0:3], v[64:67]
    ds_read_b64_tr_b16 a[216:217], v5 offset:57344
    v_mfma_f32_16x16x32_bf16 v[64:67], a[196:199], a[16:19], v[64:67]
    ds_read_b64_tr_b16 a[218:219], v5 offset:59392
    v_readlane_b32 s37, v216, 7
    v_mfma_f32_16x16x32_bf16 v[68:71], a[196:199], a[20:23], v[68:71]
    s_nop 3
    buffer_load_dwordx4 a[160:163], v12, s[16:19], s37 offen offset:0 sc1
    v_mfma_f32_16x16x32_bf16 v[68:71], a[192:195], a[4:7], v[68:71]
    v_mfma_f32_16x16x32_bf16 v[72:75], a[192:195], a[8:11], v[72:75]
    ds_read_b64_tr_b16 a[220:221], v5 offset:61440
    v_mfma_f32_16x16x32_bf16 v[72:75], a[196:199], a[24:27], v[72:75]
    ds_read_b64_tr_b16 a[222:223], v5 offset:63488
    s_add_u32 m0, s29, 138752
    v_mfma_f32_16x16x32_bf16 v[76:79], a[196:199], a[28:31], v[76:79]
    buffer_load_dwordx4 v13, s[12:15], s27 offen offset:512 lds
    v_mfma_f32_16x16x32_bf16 v[76:79], a[192:195], a[12:15], v[76:79]
    s_waitcnt lgkmcnt(8)
    v_mfma_f32_16x16x32_bf16 v[92:95], a[200:203], a[12:15], v[92:95]
    s_waitcnt vmcnt(25)
    s_barrier
    ds_read_b64_tr_b16 a[192:193], v4 offset:0
    v_mfma_f32_16x16x32_bf16 v[92:95], a[204:207], a[28:31], v[92:95]
    ds_read_b64_tr_b16 a[194:195], v4 offset:2048
    v_mfma_f32_16x16x32_bf16 v[88:91], a[204:207], a[24:27], v[88:91]
    buffer_load_dwordx4 a[164:167], v12, s[16:19], s37 offen offset:1024 sc1
    v_mfma_f32_16x16x32_bf16 v[88:91], a[200:203], a[8:11], v[88:91]
    v_mfma_f32_16x16x32_bf16 v[84:87], a[200:203], a[4:7], v[84:87]
    ds_read_b64_tr_b16 a[196:197], v4 offset:4096
    v_mfma_f32_16x16x32_bf16 v[84:87], a[204:207], a[20:23], v[84:87]
    ds_read_b64_tr_b16 a[198:199], v4 offset:6144
    v_mfma_f32_16x16x32_bf16 v[80:83], a[204:207], a[16:19], v[80:83]
    buffer_load_dwordx4 a[168:171], v12, s[16:19], s37 offen offset:2048 sc1
    v_mfma_f32_16x16x32_bf16 v[80:83], a[200:203], a[0:3], v[80:83]
    s_waitcnt lgkmcnt(8)
    v_mfma_f32_16x16x32_bf16 v[64:67], a[208:211], a[32:35], v[64:67]
    ds_read_b64_tr_b16 a[200:201], v5 offset:0
    v_mfma_f32_16x16x32_bf16 v[64:67], a[212:215], a[48:51], v[64:67]
    ds_read_b64_tr_b16 a[202:203], v5 offset:2048
    s_add_u32 m0, s29, 132096
    v_mfma_f32_16x16x32_bf16 v[68:71], a[212:215], a[52:55], v[68:71]
    buffer_load_dwordx4 v14, s[12:15], s27 offen offset:0 lds
    v_mfma_f32_16x16x32_bf16 v[68:71], a[208:211], a[36:39], v[68:71]
    v_mfma_f32_16x16x32_bf16 v[72:75], a[208:211], a[40:43], v[72:75]
    ds_read_b64_tr_b16 a[204:205], v5 offset:4096
    v_mfma_f32_16x16x32_bf16 v[72:75], a[212:215], a[56:59], v[72:75]
    ds_read_b64_tr_b16 a[206:207], v5 offset:6144
    v_mfma_f32_16x16x32_bf16 v[76:79], a[212:215], a[60:63], v[76:79]
    buffer_load_dwordx4 a[172:175], v12, s[16:19], s37 offen offset:3072 sc1
    v_mfma_f32_16x16x32_bf16 v[76:79], a[208:211], a[44:47], v[76:79]
    s_waitcnt lgkmcnt(8)
    v_mfma_f32_16x16x32_bf16 v[92:95], a[216:219], a[44:47], v[92:95]
    s_waitcnt vmcnt(17)
    s_barrier
    ds_read_b64_tr_b16 a[208:209], v18 offset:16384
    v_mfma_f32_16x16x32_bf16 v[92:95], a[220:223], a[60:63], v[92:95]
    ds_read_b64_tr_b16 a[210:211], v18 offset:18432
    v_readlane_b32 s37, v217, 7
    v_mfma_f32_16x16x32_bf16 v[88:91], a[220:223], a[56:59], v[88:91]
    s_nop 3
    buffer_load_dwordx4 a[176:179], v12, s[16:19], s37 offen offset:0 sc1
    v_mfma_f32_16x16x32_bf16 v[88:91], a[216:219], a[40:43], v[88:91]
    v_mfma_f32_16x16x32_bf16 v[84:87], a[216:219], a[36:39], v[84:87]
    ds_read_b64_tr_b16 a[212:213], v18 offset:20480
    v_mfma_f32_16x16x32_bf16 v[84:87], a[220:223], a[52:55], v[84:87]
    ds_read_b64_tr_b16 a[214:215], v18 offset:22528
    v_mfma_f32_16x16x32_bf16 v[80:83], a[220:223], a[48:51], v[80:83]
    buffer_load_dwordx4 a[180:183], v12, s[16:19], s37 offen offset:1024 sc1
    v_mfma_f32_16x16x32_bf16 v[80:83], a[216:219], a[32:35], v[80:83]
    s_waitcnt lgkmcnt(8)
    v_mfma_f32_16x16x32_bf16 v[64:67], a[192:195], a[64:67], v[64:67]
    ds_read_b64_tr_b16 a[216:217], v19 offset:16384
    v_mfma_f32_16x16x32_bf16 v[64:67], a[196:199], a[80:83], v[64:67]
    ds_read_b64_tr_b16 a[218:219], v19 offset:18432
    s_add_u32 m0, s29, 139776
    v_mfma_f32_16x16x32_bf16 v[68:71], a[196:199], a[84:87], v[68:71]
    buffer_load_dwordx4 v14, s[12:15], s27 offen offset:512 lds
    v_mfma_f32_16x16x32_bf16 v[68:71], a[192:195], a[68:71], v[68:71]
    v_mfma_f32_16x16x32_bf16 v[72:75], a[192:195], a[72:75], v[72:75]
    ds_read_b64_tr_b16 a[220:221], v19 offset:20480
    v_mfma_f32_16x16x32_bf16 v[72:75], a[196:199], a[88:91], v[72:75]
    ds_read_b64_tr_b16 a[222:223], v19 offset:22528
    v_mfma_f32_16x16x32_bf16 v[76:79], a[196:199], a[92:95], v[76:79]
    buffer_load_dwordx4 a[184:187], v12, s[16:19], s37 offen offset:2048 sc1
    v_mfma_f32_16x16x32_bf16 v[76:79], a[192:195], a[76:79], v[76:79]
    s_waitcnt lgkmcnt(8)
    v_mfma_f32_16x16x32_bf16 v[92:95], a[200:203], a[76:79], v[92:95]
    s_waitcnt vmcnt(10)
    s_barrier
    ds_read_b64_tr_b16 a[192:193], v18 offset:49152
    v_mfma_f32_16x16x32_bf16 v[92:95], a[204:207], a[92:95], v[92:95]
    ds_read_b64_tr_b16 a[194:195], v18 offset:51200
    v_mfma_f32_16x16x32_bf16 v[88:91], a[204:207], a[88:91], v[88:91]
    buffer_load_dwordx4 a[188:191], v12, s[16:19], s37 offen offset:3072 sc1
    v_mfma_f32_16x16x32_bf16 v[88:91], a[200:203], a[72:75], v[88:91]
    v_mfma_f32_16x16x32_bf16 v[84:87], a[200:203], a[68:71], v[84:87]
    ds_read_b64_tr_b16 a[196:197], v18 offset:53248
    v_mfma_f32_16x16x32_bf16 v[84:87], a[204:207], a[84:87], v[84:87]
    ds_read_b64_tr_b16 a[198:199], v18 offset:55296
    v_mfma_f32_16x16x32_bf16 v[80:83], a[204:207], a[80:83], v[80:83]
    v_mfma_f32_16x16x32_bf16 v[80:83], a[200:203], a[64:67], v[80:83]
    s_waitcnt lgkmcnt(8)
    v_mfma_f32_16x16x32_bf16 v[64:67], a[208:211], a[96:99], v[64:67]
    ds_read_b64_tr_b16 a[200:201], v19 offset:49152
    v_mfma_f32_16x16x32_bf16 v[64:67], a[212:215], a[112:115], v[64:67]
    ds_read_b64_tr_b16 a[202:203], v19 offset:51200
    v_mfma_f32_16x16x32_bf16 v[68:71], a[212:215], a[116:119], v[68:71]
    v_mfma_f32_16x16x32_bf16 v[68:71], a[208:211], a[100:103], v[68:71]
    v_mfma_f32_16x16x32_bf16 v[72:75], a[208:211], a[104:107], v[72:75]
    ds_read_b64_tr_b16 a[204:205], v19 offset:53248
    v_mfma_f32_16x16x32_bf16 v[72:75], a[212:215], a[120:123], v[72:75]
    ds_read_b64_tr_b16 a[206:207], v19 offset:55296
    v_mfma_f32_16x16x32_bf16 v[76:79], a[212:215], a[124:127], v[76:79]
    v_mfma_f32_16x16x32_bf16 v[76:79], a[208:211], a[108:111], v[76:79]
    s_waitcnt lgkmcnt(8)
    v_mfma_f32_16x16x32_bf16 v[92:95], a[216:219], a[108:111], v[92:95]
    s_waitcnt vmcnt(0)
    s_barrier
    ds_read_b64_tr_b16 a[208:209], v210 offset:0
    v_mfma_f32_16x16x32_bf16 v[92:95], a[220:223], a[124:127], v[92:95]
    ds_read_b64_tr_b16 a[210:211], v210 offset:2048
    v_mfma_f32_16x16x32_bf16 v[88:91], a[220:223], a[120:123], v[88:91]
    v_mfma_f32_16x16x32_bf16 v[88:91], a[216:219], a[104:107], v[88:91]
    v_mfma_f32_16x16x32_bf16 v[84:87], a[216:219], a[100:103], v[84:87]
    ds_read_b64_tr_b16 a[212:213], v210 offset:4096
    v_mfma_f32_16x16x32_bf16 v[84:87], a[220:223], a[116:119], v[84:87]
    ds_read_b64_tr_b16 a[214:215], v210 offset:6144
    v_mfma_f32_16x16x32_bf16 v[80:83], a[220:223], a[112:115], v[80:83]
    v_mfma_f32_16x16x32_bf16 v[80:83], a[216:219], a[96:99], v[80:83]
    s_waitcnt lgkmcnt(8)
    v_mfma_f32_16x16x32_bf16 v[64:67], a[192:195], a[128:131], v[64:67]
    ds_read_b64_tr_b16 a[216:217], v211 offset:0
    v_mfma_f32_16x16x32_bf16 v[64:67], a[196:199], a[144:147], v[64:67]
    ds_read_b64_tr_b16 a[218:219], v211 offset:2048
    v_mfma_f32_16x16x32_bf16 v[68:71], a[196:199], a[148:151], v[68:71]
    v_mfma_f32_16x16x32_bf16 v[68:71], a[192:195], a[132:135], v[68:71]
    v_mfma_f32_16x16x32_bf16 v[72:75], a[192:195], a[136:139], v[72:75]
    ds_read_b64_tr_b16 a[220:221], v211 offset:4096
    v_mfma_f32_16x16x32_bf16 v[72:75], a[196:199], a[152:155], v[72:75]
    ds_read_b64_tr_b16 a[222:223], v211 offset:6144
    v_mfma_f32_16x16x32_bf16 v[76:79], a[196:199], a[156:159], v[76:79]
    v_mfma_f32_16x16x32_bf16 v[76:79], a[192:195], a[140:143], v[76:79]
    s_waitcnt lgkmcnt(8)
    v_mfma_f32_16x16x32_bf16 v[92:95], a[200:203], a[140:143], v[92:95]
    ds_read_b64_tr_b16 a[192:193], v6 offset:28672
    v_mfma_f32_16x16x32_bf16 v[92:95], a[204:207], a[156:159], v[92:95]
    ds_read_b64_tr_b16 a[194:195], v6 offset:30720
    v_mfma_f32_16x16x32_bf16 v[88:91], a[204:207], a[152:155], v[88:91]
    v_mfma_f32_16x16x32_bf16 v[88:91], a[200:203], a[136:139], v[88:91]
    v_mfma_f32_16x16x32_bf16 v[84:87], a[200:203], a[132:135], v[84:87]
    ds_read_b64_tr_b16 a[196:197], v6 offset:32768
    v_mfma_f32_16x16x32_bf16 v[84:87], a[204:207], a[148:151], v[84:87]
    ds_read_b64_tr_b16 a[198:199], v6 offset:34816
    v_mfma_f32_16x16x32_bf16 v[80:83], a[204:207], a[144:147], v[80:83]
    v_mfma_f32_16x16x32_bf16 v[80:83], a[200:203], a[128:131], v[80:83]
    s_waitcnt lgkmcnt(8)
    v_mfma_f32_16x16x32_bf16 v[64:67], a[208:211], a[160:163], v[64:67]
    ds_read_b64_tr_b16 a[200:201], v6 offset:57344
    v_mfma_f32_16x16x32_bf16 v[64:67], a[212:215], a[176:179], v[64:67]
    ds_read_b64_tr_b16 a[202:203], v6 offset:59392
    v_mfma_f32_16x16x32_bf16 v[68:71], a[212:215], a[180:183], v[68:71]
    v_mfma_f32_16x16x32_bf16 v[68:71], a[208:211], a[164:167], v[68:71]
    v_mfma_f32_16x16x32_bf16 v[72:75], a[208:211], a[168:171], v[72:75]
    ds_read_b64_tr_b16 a[204:205], v6 offset:61440
    v_mfma_f32_16x16x32_bf16 v[72:75], a[212:215], a[184:187], v[72:75]
    ds_read_b64_tr_b16 a[206:207], v6 offset:63488
    v_mfma_f32_16x16x32_bf16 v[76:79], a[212:215], a[188:191], v[76:79]
    v_mfma_f32_16x16x32_bf16 v[76:79], a[208:211], a[172:175], v[76:79]
    s_waitcnt lgkmcnt(8)
    v_mfma_f32_16x16x32_bf16 v[92:95], a[216:219], a[172:175], v[92:95]
    ds_read_b64_tr_b16 a[208:209], v6 offset:0
    v_mfma_f32_16x16x32_bf16 v[92:95], a[220:223], a[188:191], v[92:95]
    ds_read_b64_tr_b16 a[210:211], v6 offset:2048
    v_mfma_f32_16x16x32_bf16 v[88:91], a[220:223], a[184:187], v[88:91]
    v_mfma_f32_16x16x32_bf16 v[88:91], a[216:219], a[168:171], v[88:91]
    v_mfma_f32_16x16x32_bf16 v[84:87], a[216:219], a[164:167], v[84:87]
    ds_read_b64_tr_b16 a[212:213], v6 offset:4096
    v_mfma_f32_16x16x32_bf16 v[84:87], a[220:223], a[180:183], v[84:87]
    ds_read_b64_tr_b16 a[214:215], v6 offset:6144
    v_mfma_f32_16x16x32_bf16 v[80:83], a[220:223], a[176:179], v[80:83]
    v_mfma_f32_16x16x32_bf16 v[80:83], a[216:219], a[160:163], v[80:83]
    s_waitcnt lgkmcnt(8)
    v_mfma_f32_16x16x32_bf16 v[96:99], a[192:195], a[0:3], v[96:99]
    ds_read_b64_tr_b16 a[216:217], v20 offset:16384
    v_mfma_f32_16x16x32_bf16 v[96:99], a[196:199], a[16:19], v[96:99]
    ds_read_b64_tr_b16 a[218:219], v20 offset:18432
    v_mfma_f32_16x16x32_bf16 v[100:103], a[196:199], a[20:23], v[100:103]
    v_mfma_f32_16x16x32_bf16 v[100:103], a[192:195], a[4:7], v[100:103]
    s_xor_b32 s56, s39, 8
    s_mul_i32 s56, s56, 14336
    s_add_u32 s56, s56, 0
    v_mfma_f32_16x16x32_bf16 v[104:107], a[192:195], a[8:11], v[104:107]
    ds_read_b64_tr_b16 a[220:221], v20 offset:20480
    v_cvt_pk_bf16_f32 v64, v64, v65
    v_cvt_pk_bf16_f32 v65, v66, v67
    v_mfma_f32_16x16x32_bf16 v[104:107], a[196:199], a[24:27], v[104:107]
    ds_read_b64_tr_b16 a[222:223], v20 offset:22528
    v_cvt_pk_bf16_f32 v66, v80, v81
    v_cvt_pk_bf16_f32 v67, v82, v83
    v_mfma_f32_16x16x32_bf16 v[108:111], a[196:199], a[28:31], v[108:111]
    v_cvt_pk_bf16_f32 v68, v68, v69
    v_cvt_pk_bf16_f32 v69, v70, v71
    v_cvt_pk_bf16_f32 v70, v84, v85
    v_mfma_f32_16x16x32_bf16 v[108:111], a[192:195], a[12:15], v[108:111]
    s_waitcnt lgkmcnt(8)
    v_cvt_pk_bf16_f32 v71, v86, v87
    v_permlane16_swap_b32 v64, v66
    v_mfma_f32_16x16x32_bf16 v[108:111], a[200:203], a[44:47], v[108:111]
    ds_read_b64_tr_b16 a[192:193], v20 offset:49152
    v_permlane16_swap_b32 v65, v67
    buffer_store_dwordx4 v[64:67], v12, s[52:55], s56 offen offset:0 sc1
    v_mfma_f32_16x16x32_bf16 v[108:111], a[204:207], a[60:63], v[108:111]
    ds_read_b64_tr_b16 a[194:195], v20 offset:51200
    v_cvt_pk_bf16_f32 v72, v72, v73
    v_cvt_pk_bf16_f32 v73, v74, v75
    v_mfma_f32_16x16x32_bf16 v[104:107], a[204:207], a[56:59], v[104:107]
    v_cvt_pk_bf16_f32 v74, v88, v89
    v_cvt_pk_bf16_f32 v75, v90, v91
    v_permlane16_swap_b32 v68, v70
    v_mfma_f32_16x16x32_bf16 v[104:107], a[200:203], a[40:43], v[104:107]
    v_permlane16_swap_b32 v69, v71
    buffer_store_dwordx4 v[68:71], v12, s[52:55], s56 offen offset:1024 sc1
    v_cvt_pk_bf16_f32 v76, v76, v77
    v_mfma_f32_16x16x32_bf16 v[100:103], a[200:203], a[36:39], v[100:103]
    ds_read_b64_tr_b16 a[196:197], v20 offset:53248
    v_cvt_pk_bf16_f32 v77, v78, v79
    v_cvt_pk_bf16_f32 v78, v92, v93
    v_mfma_f32_16x16x32_bf16 v[100:103], a[204:207], a[52:55], v[100:103]
    ds_read_b64_tr_b16 a[198:199], v20 offset:55296
    v_cvt_pk_bf16_f32 v79, v94, v95
    v_permlane16_swap_b32 v72, v74
    v_mfma_f32_16x16x32_bf16 v[96:99], a[204:207], a[48:51], v[96:99]
    v_permlane16_swap_b32 v73, v75
    buffer_store_dwordx4 v[72:75], v12, s[52:55], s56 offen offset:2048 sc1
    v_mfma_f32_16x16x32_bf16 v[96:99], a[200:203], a[32:35], v[96:99]
    s_waitcnt lgkmcnt(8)
    v_permlane16_swap_b32 v76, v78
    v_permlane16_swap_b32 v77, v79
    v_mfma_f32_16x16x32_bf16 v[96:99], a[208:211], a[64:67], v[96:99]
    ds_read_b64_tr_b16 a[200:201], v212 offset:0
    buffer_store_dwordx4 v[76:79], v12, s[52:55], s56 offen offset:3072 sc1
    v_mfma_f32_16x16x32_bf16 v[96:99], a[212:215], a[80:83], v[96:99]
    ds_read_b64_tr_b16 a[202:203], v212 offset:2048
    v_mfma_f32_16x16x32_bf16 v[100:103], a[212:215], a[84:87], v[100:103]
    v_mfma_f32_16x16x32_bf16 v[100:103], a[208:211], a[68:71], v[100:103]
    v_mfma_f32_16x16x32_bf16 v[104:107], a[208:211], a[72:75], v[104:107]
    ds_read_b64_tr_b16 a[204:205], v212 offset:4096
    v_mfma_f32_16x16x32_bf16 v[104:107], a[212:215], a[88:91], v[104:107]
    ds_read_b64_tr_b16 a[206:207], v212 offset:6144
    v_mfma_f32_16x16x32_bf16 v[108:111], a[212:215], a[92:95], v[108:111]
    v_mfma_f32_16x16x32_bf16 v[108:111], a[208:211], a[76:79], v[108:111]
    s_waitcnt lgkmcnt(8)
    v_mfma_f32_16x16x32_bf16 v[108:111], a[216:219], a[108:111], v[108:111]
    ds_read_b64_tr_b16 a[208:209], v7 offset:28672
    v_mfma_f32_16x16x32_bf16 v[108:111], a[220:223], a[124:127], v[108:111]
    ds_read_b64_tr_b16 a[210:211], v7 offset:30720
    v_mfma_f32_16x16x32_bf16 v[104:107], a[220:223], a[120:123], v[104:107]
    v_mfma_f32_16x16x32_bf16 v[104:107], a[216:219], a[104:107], v[104:107]
    v_mfma_f32_16x16x32_bf16 v[100:103], a[216:219], a[100:103], v[100:103]
    ds_read_b64_tr_b16 a[212:213], v7 offset:32768
    v_mfma_f32_16x16x32_bf16 v[100:103], a[220:223], a[116:119], v[100:103]
    ds_read_b64_tr_b16 a[214:215], v7 offset:34816
    v_mfma_f32_16x16x32_bf16 v[96:99], a[220:223], a[112:115], v[96:99]
    v_mfma_f32_16x16x32_bf16 v[96:99], a[216:219], a[96:99], v[96:99]
    s_waitcnt lgkmcnt(8)
    v_mfma_f32_16x16x32_bf16 v[96:99], a[192:195], a[128:131], v[96:99]
    ds_read_b64_tr_b16 a[216:217], v7 offset:57344
    v_mfma_f32_16x16x32_bf16 v[96:99], a[196:199], a[144:147], v[96:99]
    ds_read_b64_tr_b16 a[218:219], v7 offset:59392
    v_mfma_f32_16x16x32_bf16 v[100:103], a[196:199], a[148:151], v[100:103]
    v_mfma_f32_16x16x32_bf16 v[100:103], a[192:195], a[132:135], v[100:103]
    v_mfma_f32_16x16x32_bf16 v[104:107], a[192:195], a[136:139], v[104:107]
    ds_read_b64_tr_b16 a[220:221], v7 offset:61440
    v_mfma_f32_16x16x32_bf16 v[104:107], a[196:199], a[152:155], v[104:107]
    ds_read_b64_tr_b16 a[222:223], v7 offset:63488
    v_mfma_f32_16x16x32_bf16 v[108:111], a[196:199], a[156:159], v[108:111]
    v_mfma_f32_16x16x32_bf16 v[108:111], a[192:195], a[140:143], v[108:111]
    s_waitcnt lgkmcnt(8)
    v_mfma_f32_16x16x32_bf16 v[108:111], a[200:203], a[172:175], v[108:111]
    ds_read_b64_tr_b16 a[192:193], v7 offset:0
    v_mfma_f32_16x16x32_bf16 v[108:111], a[204:207], a[188:191], v[108:111]
    ds_read_b64_tr_b16 a[194:195], v7 offset:2048
    v_mfma_f32_16x16x32_bf16 v[104:107], a[204:207], a[184:187], v[104:107]
    v_mfma_f32_16x16x32_bf16 v[104:107], a[200:203], a[168:171], v[104:107]
    v_mfma_f32_16x16x32_bf16 v[100:103], a[200:203], a[164:167], v[100:103]
    ds_read_b64_tr_b16 a[196:197], v7 offset:4096
    v_mfma_f32_16x16x32_bf16 v[100:103], a[204:207], a[180:183], v[100:103]
    ds_read_b64_tr_b16 a[198:199], v7 offset:6144
    v_mfma_f32_16x16x32_bf16 v[96:99], a[204:207], a[176:179], v[96:99]
    v_mfma_f32_16x16x32_bf16 v[96:99], a[200:203], a[160:163], v[96:99]
    s_waitcnt lgkmcnt(8)
    v_mfma_f32_16x16x32_bf16 v[112:115], a[208:211], a[0:3], v[112:115]
    ds_read_b64_tr_b16 a[200:201], v21 offset:16384
    v_mfma_f32_16x16x32_bf16 v[112:115], a[212:215], a[16:19], v[112:115]
    ds_read_b64_tr_b16 a[202:203], v21 offset:18432
    v_mfma_f32_16x16x32_bf16 v[116:119], a[212:215], a[20:23], v[116:119]
    v_mfma_f32_16x16x32_bf16 v[116:119], a[208:211], a[4:7], v[116:119]
    v_mfma_f32_16x16x32_bf16 v[120:123], a[208:211], a[8:11], v[120:123]
    ds_read_b64_tr_b16 a[204:205], v21 offset:20480
    v_mfma_f32_16x16x32_bf16 v[120:123], a[212:215], a[24:27], v[120:123]
    ds_read_b64_tr_b16 a[206:207], v21 offset:22528
    v_mfma_f32_16x16x32_bf16 v[124:127], a[212:215], a[28:31], v[124:127]
    v_mfma_f32_16x16x32_bf16 v[124:127], a[208:211], a[12:15], v[124:127]
    s_waitcnt lgkmcnt(8)
    v_mfma_f32_16x16x32_bf16 v[124:127], a[216:219], a[44:47], v[124:127]
    ds_read_b64_tr_b16 a[208:209], v21 offset:49152
    v_mfma_f32_16x16x32_bf16 v[124:127], a[220:223], a[60:63], v[124:127]
    ds_read_b64_tr_b16 a[210:211], v21 offset:51200
    v_mfma_f32_16x16x32_bf16 v[120:123], a[220:223], a[56:59], v[120:123]
    v_mfma_f32_16x16x32_bf16 v[120:123], a[216:219], a[40:43], v[120:123]
    v_mfma_f32_16x16x32_bf16 v[116:119], a[216:219], a[36:39], v[116:119]
    ds_read_b64_tr_b16 a[212:213], v21 offset:53248
    v_mfma_f32_16x16x32_bf16 v[116:119], a[220:223], a[52:55], v[116:119]
    ds_read_b64_tr_b16 a[214:215], v21 offset:55296
    v_mfma_f32_16x16x32_bf16 v[112:115], a[220:223], a[48:51], v[112:115]
    v_mfma_f32_16x16x32_bf16 v[112:115], a[216:219], a[32:35], v[112:115]
    s_waitcnt lgkmcnt(8)
    s_xor_b32 s57, s39, 8
    s_lshl_b32 s57, s57, 9
    v_mfma_f32_16x16x32_bf16 v[112:115], a[192:195], a[64:67], v[112:115]
    ds_read_b64_tr_b16 a[216:217], v213 offset:0
    s_add_u32 s57, s57, 131072
    s_waitcnt vmcnt(0)
    v_mfma_f32_16x16x32_bf16 v[112:115], a[196:199], a[80:83], v[112:115]
    ds_read_b64_tr_b16 a[218:219], v213 offset:2048
    buffer_store_dwordx2 v[24:25], v26, s[20:23], s57 offen sc1
    v_mfma_f32_16x16x32_bf16 v[116:119], a[196:199], a[84:87], v[116:119]
    v_mfma_f32_16x16x32_bf16 v[116:119], a[192:195], a[68:71], v[116:119]
    v_mfma_f32_16x16x32_bf16 v[120:123], a[192:195], a[72:75], v[120:123]
    ds_read_b64_tr_b16 a[220:221], v213 offset:4096
    v_mfma_f32_16x16x32_bf16 v[120:123], a[196:199], a[88:91], v[120:123]
    ds_read_b64_tr_b16 a[222:223], v213 offset:6144
    v_mfma_f32_16x16x32_bf16 v[124:127], a[196:199], a[92:95], v[124:127]
    v_mfma_f32_16x16x32_bf16 v[124:127], a[192:195], a[76:79], v[124:127]
    s_waitcnt lgkmcnt(8)
    v_mfma_f32_16x16x32_bf16 v[124:127], a[200:203], a[108:111], v[124:127]
    ds_read_b64_tr_b16 a[192:193], v8 offset:28672
    v_mfma_f32_16x16x32_bf16 v[124:127], a[204:207], a[124:127], v[124:127]
    ds_read_b64_tr_b16 a[194:195], v8 offset:30720
    v_mfma_f32_16x16x32_bf16 v[120:123], a[204:207], a[120:123], v[120:123]
    v_mfma_f32_16x16x32_bf16 v[120:123], a[200:203], a[104:107], v[120:123]
    v_mfma_f32_16x16x32_bf16 v[116:119], a[200:203], a[100:103], v[116:119]
    ds_read_b64_tr_b16 a[196:197], v8 offset:32768
    v_mfma_f32_16x16x32_bf16 v[116:119], a[204:207], a[116:119], v[116:119]
    ds_read_b64_tr_b16 a[198:199], v8 offset:34816
    v_mfma_f32_16x16x32_bf16 v[112:115], a[204:207], a[112:115], v[112:115]
    v_mfma_f32_16x16x32_bf16 v[112:115], a[200:203], a[96:99], v[112:115]
    s_waitcnt lgkmcnt(8)
    v_mfma_f32_16x16x32_bf16 v[112:115], a[208:211], a[128:131], v[112:115]
    ds_read_b64_tr_b16 a[200:201], v8 offset:57344
    v_mfma_f32_16x16x32_bf16 v[112:115], a[212:215], a[144:147], v[112:115]
    ds_read_b64_tr_b16 a[202:203], v8 offset:59392
    v_mfma_f32_16x16x32_bf16 v[116:119], a[212:215], a[148:151], v[116:119]
    v_mfma_f32_16x16x32_bf16 v[116:119], a[208:211], a[132:135], v[116:119]
    v_mfma_f32_16x16x32_bf16 v[120:123], a[208:211], a[136:139], v[120:123]
    ds_read_b64_tr_b16 a[204:205], v8 offset:61440
    v_mfma_f32_16x16x32_bf16 v[120:123], a[212:215], a[152:155], v[120:123]
    ds_read_b64_tr_b16 a[206:207], v8 offset:63488
    v_mfma_f32_16x16x32_bf16 v[124:127], a[212:215], a[156:159], v[124:127]
    v_mfma_f32_16x16x32_bf16 v[124:127], a[208:211], a[140:143], v[124:127]
    s_waitcnt lgkmcnt(8)
    v_mfma_f32_16x16x32_bf16 v[124:127], a[216:219], a[172:175], v[124:127]
    ds_read_b64_tr_b16 a[208:209], v8 offset:0
    v_mfma_f32_16x16x32_bf16 v[124:127], a[220:223], a[188:191], v[124:127]
    ds_read_b64_tr_b16 a[210:211], v8 offset:2048
    v_mfma_f32_16x16x32_bf16 v[120:123], a[220:223], a[184:187], v[120:123]
    v_mfma_f32_16x16x32_bf16 v[120:123], a[216:219], a[168:171], v[120:123]
    v_mfma_f32_16x16x32_bf16 v[116:119], a[216:219], a[164:167], v[116:119]
    ds_read_b64_tr_b16 a[212:213], v8 offset:4096
    v_mfma_f32_16x16x32_bf16 v[116:119], a[220:223], a[180:183], v[116:119]
    ds_read_b64_tr_b16 a[214:215], v8 offset:6144
    v_mfma_f32_16x16x32_bf16 v[112:115], a[220:223], a[176:179], v[112:115]
    v_mfma_f32_16x16x32_bf16 v[112:115], a[216:219], a[160:163], v[112:115]
    s_waitcnt lgkmcnt(8)
    v_mfma_f32_16x16x32_bf16 v[128:131], a[192:195], a[0:3], v[128:131]
    ds_read_b64_tr_b16 a[216:217], v22 offset:16384
    v_mfma_f32_16x16x32_bf16 v[128:131], a[196:199], a[16:19], v[128:131]
    ds_read_b64_tr_b16 a[218:219], v22 offset:18432
    v_mfma_f32_16x16x32_bf16 v[132:135], a[196:199], a[20:23], v[132:135]
    v_mfma_f32_16x16x32_bf16 v[132:135], a[192:195], a[4:7], v[132:135]
    s_xor_b32 s56, s39, 16
    s_mul_i32 s56, s56, 14336
    s_add_u32 s56, s56, 4096
    v_mfma_f32_16x16x32_bf16 v[136:139], a[192:195], a[8:11], v[136:139]
    ds_read_b64_tr_b16 a[220:221], v22 offset:20480
    v_cvt_pk_bf16_f32 v96, v96, v97
    v_cvt_pk_bf16_f32 v97, v98, v99
    v_mfma_f32_16x16x32_bf16 v[136:139], a[196:199], a[24:27], v[136:139]
    ds_read_b64_tr_b16 a[222:223], v22 offset:22528
    v_cvt_pk_bf16_f32 v98, v112, v113
    v_cvt_pk_bf16_f32 v99, v114, v115
    v_mfma_f32_16x16x32_bf16 v[140:143], a[196:199], a[28:31], v[140:143]
    v_cvt_pk_bf16_f32 v100, v100, v101
    v_cvt_pk_bf16_f32 v101, v102, v103
    v_cvt_pk_bf16_f32 v102, v116, v117
    v_mfma_f32_16x16x32_bf16 v[140:143], a[192:195], a[12:15], v[140:143]
    s_waitcnt lgkmcnt(8)
    v_cvt_pk_bf16_f32 v103, v118, v119
    v_permlane16_swap_b32 v96, v98
    v_mfma_f32_16x16x32_bf16 v[140:143], a[200:203], a[44:47], v[140:143]
    ds_read_b64_tr_b16 a[192:193], v22 offset:49152
    v_permlane16_swap_b32 v97, v99
    v_cvt_pk_bf16_f32 v104, v104, v105
    v_mfma_f32_16x16x32_bf16 v[140:143], a[204:207], a[60:63], v[140:143]
    ds_read_b64_tr_b16 a[194:195], v22 offset:51200
    v_cvt_pk_bf16_f32 v105, v106, v107
    v_cvt_pk_bf16_f32 v106, v120, v121
    v_mfma_f32_16x16x32_bf16 v[136:139], a[204:207], a[56:59], v[136:139]
    v_cvt_pk_bf16_f32 v107, v122, v123
    v_permlane16_swap_b32 v100, v102
    v_permlane16_swap_b32 v101, v103
    v_mfma_f32_16x16x32_bf16 v[136:139], a[200:203], a[40:43], v[136:139]
    v_cvt_pk_bf16_f32 v108, v108, v109
    v_cvt_pk_bf16_f32 v109, v110, v111
    v_cvt_pk_bf16_f32 v110, v124, v125
    v_mfma_f32_16x16x32_bf16 v[132:135], a[200:203], a[36:39], v[132:135]
    ds_read_b64_tr_b16 a[196:197], v22 offset:53248
    v_cvt_pk_bf16_f32 v111, v126, v127
    v_permlane16_swap_b32 v104, v106
    v_mfma_f32_16x16x32_bf16 v[132:135], a[204:207], a[52:55], v[132:135]
    ds_read_b64_tr_b16 a[198:199], v22 offset:55296
    v_permlane16_swap_b32 v105, v107
    v_mfma_f32_16x16x32_bf16 v[128:131], a[204:207], a[48:51], v[128:131]
    v_permlane16_swap_b32 v108, v110
    v_permlane16_swap_b32 v109, v111
    v_mfma_f32_16x16x32_bf16 v[128:131], a[200:203], a[32:35], v[128:131]
    s_waitcnt lgkmcnt(8)
    v_mfma_f32_16x16x32_bf16 v[128:131], a[208:211], a[64:67], v[128:131]
    ds_read_b64_tr_b16 a[200:201], v214 offset:0
    v_mfma_f32_16x16x32_bf16 v[128:131], a[212:215], a[80:83], v[128:131]
    ds_read_b64_tr_b16 a[202:203], v214 offset:2048
    v_mfma_f32_16x16x32_bf16 v[132:135], a[212:215], a[84:87], v[132:135]
    v_mfma_f32_16x16x32_bf16 v[132:135], a[208:211], a[68:71], v[132:135]
    v_mfma_f32_16x16x32_bf16 v[136:139], a[208:211], a[72:75], v[136:139]
    ds_read_b64_tr_b16 a[204:205], v214 offset:4096
    v_mfma_f32_16x16x32_bf16 v[136:139], a[212:215], a[88:91], v[136:139]
    ds_read_b64_tr_b16 a[206:207], v214 offset:6144
    v_mfma_f32_16x16x32_bf16 v[140:143], a[212:215], a[92:95], v[140:143]
    v_mfma_f32_16x16x32_bf16 v[140:143], a[208:211], a[76:79], v[140:143]
    s_waitcnt lgkmcnt(8)
    v_mfma_f32_16x16x32_bf16 v[140:143], a[216:219], a[108:111], v[140:143]
    ds_read_b64_tr_b16 a[208:209], v9 offset:28672
    v_mfma_f32_16x16x32_bf16 v[140:143], a[220:223], a[124:127], v[140:143]
    ds_read_b64_tr_b16 a[210:211], v9 offset:30720
    v_mfma_f32_16x16x32_bf16 v[136:139], a[220:223], a[120:123], v[136:139]
    v_mfma_f32_16x16x32_bf16 v[136:139], a[216:219], a[104:107], v[136:139]
    s_lshl_b32 s48, s39, 9
    s_add_u32 s48, s48, 131072
    v_mfma_f32_16x16x32_bf16 v[132:135], a[216:219], a[100:103], v[132:135]
    ds_read_b64_tr_b16 a[212:213], v9 offset:32768
    buffer_load_dwordx2 v[28:29], v26, s[20:23], s48 offen sc1
    buffer_store_dwordx4 v[96:99], v12, s[52:55], s56 offen offset:0 sc1
    v_mfma_f32_16x16x32_bf16 v[132:135], a[220:223], a[116:119], v[132:135]
    ds_read_b64_tr_b16 a[214:215], v9 offset:34816
    buffer_store_dwordx4 v[100:103], v12, s[52:55], s56 offen offset:1024 sc1
    buffer_store_dwordx4 v[104:107], v12, s[52:55], s56 offen offset:2048 sc1
    v_mfma_f32_16x16x32_bf16 v[128:131], a[220:223], a[112:115], v[128:131]
    buffer_store_dwordx4 v[108:111], v12, s[52:55], s56 offen offset:3072 sc1
    v_mfma_f32_16x16x32_bf16 v[128:131], a[216:219], a[96:99], v[128:131]
    s_waitcnt lgkmcnt(8)
    v_mfma_f32_16x16x32_bf16 v[128:131], a[192:195], a[128:131], v[128:131]
    ds_read_b64_tr_b16 a[216:217], v9 offset:57344
    v_mfma_f32_16x16x32_bf16 v[128:131], a[196:199], a[144:147], v[128:131]
    ds_read_b64_tr_b16 a[218:219], v9 offset:59392
    v_mfma_f32_16x16x32_bf16 v[132:135], a[196:199], a[148:151], v[132:135]
    v_mfma_f32_16x16x32_bf16 v[132:135], a[192:195], a[132:135], v[132:135]
    v_mfma_f32_16x16x32_bf16 v[136:139], a[192:195], a[136:139], v[136:139]
    ds_read_b64_tr_b16 a[220:221], v9 offset:61440
    v_mfma_f32_16x16x32_bf16 v[136:139], a[196:199], a[152:155], v[136:139]
    ds_read_b64_tr_b16 a[222:223], v9 offset:63488
    v_mfma_f32_16x16x32_bf16 v[140:143], a[196:199], a[156:159], v[140:143]
    v_mfma_f32_16x16x32_bf16 v[140:143], a[192:195], a[140:143], v[140:143]
    s_waitcnt lgkmcnt(8)
    v_mfma_f32_16x16x32_bf16 v[140:143], a[200:203], a[172:175], v[140:143]
    ds_read_b64_tr_b16 a[192:193], v9 offset:0
    v_mfma_f32_16x16x32_bf16 v[140:143], a[204:207], a[188:191], v[140:143]
    ds_read_b64_tr_b16 a[194:195], v9 offset:2048
    v_mfma_f32_16x16x32_bf16 v[136:139], a[204:207], a[184:187], v[136:139]
    v_mfma_f32_16x16x32_bf16 v[136:139], a[200:203], a[168:171], v[136:139]
    v_mfma_f32_16x16x32_bf16 v[132:135], a[200:203], a[164:167], v[132:135]
    ds_read_b64_tr_b16 a[196:197], v9 offset:4096
    v_mfma_f32_16x16x32_bf16 v[132:135], a[204:207], a[180:183], v[132:135]
    ds_read_b64_tr_b16 a[198:199], v9 offset:6144
    v_mfma_f32_16x16x32_bf16 v[128:131], a[204:207], a[176:179], v[128:131]
    v_mfma_f32_16x16x32_bf16 v[128:131], a[200:203], a[160:163], v[128:131]
    s_waitcnt lgkmcnt(8)
    v_mfma_f32_16x16x32_bf16 v[144:147], a[208:211], a[0:3], v[144:147]
    ds_read_b64_tr_b16 a[200:201], v23 offset:16384
    v_mfma_f32_16x16x32_bf16 v[144:147], a[212:215], a[16:19], v[144:147]
    ds_read_b64_tr_b16 a[202:203], v23 offset:18432
    v_mfma_f32_16x16x32_bf16 v[148:151], a[212:215], a[20:23], v[148:151]
    v_mfma_f32_16x16x32_bf16 v[148:151], a[208:211], a[4:7], v[148:151]
    v_mfma_f32_16x16x32_bf16 v[152:155], a[208:211], a[8:11], v[152:155]
    ds_read_b64_tr_b16 a[204:205], v23 offset:20480
    v_mfma_f32_16x16x32_bf16 v[152:155], a[212:215], a[24:27], v[152:155]
    ds_read_b64_tr_b16 a[206:207], v23 offset:22528
    v_mfma_f32_16x16x32_bf16 v[156:159], a[212:215], a[28:31], v[156:159]
    v_mfma_f32_16x16x32_bf16 v[156:159], a[208:211], a[12:15], v[156:159]
    s_waitcnt lgkmcnt(8)
    v_mfma_f32_16x16x32_bf16 v[156:159], a[216:219], a[44:47], v[156:159]
    ds_read_b64_tr_b16 a[208:209], v23 offset:49152
    v_mfma_f32_16x16x32_bf16 v[156:159], a[220:223], a[60:63], v[156:159]
    ds_read_b64_tr_b16 a[210:211], v23 offset:51200
    v_mfma_f32_16x16x32_bf16 v[152:155], a[220:223], a[56:59], v[152:155]
    v_mfma_f32_16x16x32_bf16 v[152:155], a[216:219], a[40:43], v[152:155]
    v_mfma_f32_16x16x32_bf16 v[148:151], a[216:219], a[36:39], v[148:151]
    ds_read_b64_tr_b16 a[212:213], v23 offset:53248
    v_mfma_f32_16x16x32_bf16 v[148:151], a[220:223], a[52:55], v[148:151]
    ds_read_b64_tr_b16 a[214:215], v23 offset:55296
    v_mfma_f32_16x16x32_bf16 v[144:147], a[220:223], a[48:51], v[144:147]
    v_mfma_f32_16x16x32_bf16 v[144:147], a[216:219], a[32:35], v[144:147]
    s_waitcnt lgkmcnt(8)
    v_mfma_f32_16x16x32_bf16 v[144:147], a[192:195], a[64:67], v[144:147]
    ds_read_b64_tr_b16 a[216:217], v215 offset:0
    v_mfma_f32_16x16x32_bf16 v[144:147], a[196:199], a[80:83], v[144:147]
    ds_read_b64_tr_b16 a[218:219], v215 offset:2048
    v_mfma_f32_16x16x32_bf16 v[148:151], a[196:199], a[84:87], v[148:151]
    v_mfma_f32_16x16x32_bf16 v[148:151], a[192:195], a[68:71], v[148:151]
    v_mfma_f32_16x16x32_bf16 v[152:155], a[192:195], a[72:75], v[152:155]
    ds_read_b64_tr_b16 a[220:221], v215 offset:4096
    v_mfma_f32_16x16x32_bf16 v[152:155], a[196:199], a[88:91], v[152:155]
    ds_read_b64_tr_b16 a[222:223], v215 offset:6144
    v_mfma_f32_16x16x32_bf16 v[156:159], a[196:199], a[92:95], v[156:159]
    v_mfma_f32_16x16x32_bf16 v[156:159], a[192:195], a[76:79], v[156:159]
    s_waitcnt lgkmcnt(8)
    s_waitcnt vmcnt(4)
    v_cmp_ne_u64 vcc, s[98:99], v[28:29]
    s_nop 1
    s_cmp_lg_u64 vcc, 0
    s_cbranch_scc1 L_try1
    s_add_u32 s57, s38, 0
    buffer_load_dwordx4 v[80:83], v12, s[52:55], s57 offen offset:0 sc1
    buffer_load_dwordx4 v[84:87], v12, s[52:55], s57 offen offset:1024 sc1
    buffer_load_dwordx4 v[88:91], v12, s[52:55], s57 offen offset:2048 sc1
    buffer_load_dwordx4 v[92:95], v12, s[52:55], s57 offen offset:3072 sc1
    s_mov_b32 s68, 1
L_try1:
    v_mfma_f32_16x16x32_bf16 v[156:159], a[200:203], a[108:111], v[156:159]
    ds_read_b64_tr_b16 a[192:193], v2 offset:28672
    v_mfma_f32_16x16x32_bf16 v[156:159], a[204:207], a[124:127], v[156:159]
    ds_read_b64_tr_b16 a[194:195], v2 offset:30720
    v_mfma_f32_16x16x32_bf16 v[152:155], a[204:207], a[120:123], v[152:155]
    v_mfma_f32_16x16x32_bf16 v[152:155], a[200:203], a[104:107], v[152:155]
    v_mfma_f32_16x16x32_bf16 v[148:151], a[200:203], a[100:103], v[148:151]
    ds_read_b64_tr_b16 a[196:197], v2 offset:32768
    v_mfma_f32_16x16x32_bf16 v[148:151], a[204:207], a[116:119], v[148:151]
    ds_read_b64_tr_b16 a[198:199], v2 offset:34816
    v_mfma_f32_16x16x32_bf16 v[144:147], a[204:207], a[112:115], v[144:147]
    v_mfma_f32_16x16x32_bf16 v[144:147], a[200:203], a[96:99], v[144:147]
    s_waitcnt lgkmcnt(8)
    v_mfma_f32_16x16x32_bf16 v[144:147], a[208:211], a[128:131], v[144:147]
    ds_read_b64_tr_b16 a[200:201], v2 offset:57344
    v_mfma_f32_16x16x32_bf16 v[144:147], a[212:215], a[144:147], v[144:147]
    ds_read_b64_tr_b16 a[202:203], v2 offset:59392
    v_mfma_f32_16x16x32_bf16 v[148:151], a[212:215], a[148:151], v[148:151]
    v_mfma_f32_16x16x32_bf16 v[148:151], a[208:211], a[132:135], v[148:151]
    v_mfma_f32_16x16x32_bf16 v[152:155], a[208:211], a[136:139], v[152:155]
    ds_read_b64_tr_b16 a[204:205], v2 offset:61440
    v_mfma_f32_16x16x32_bf16 v[152:155], a[212:215], a[152:155], v[152:155]
    ds_read_b64_tr_b16 a[206:207], v2 offset:63488
    v_mfma_f32_16x16x32_bf16 v[156:159], a[212:215], a[156:159], v[156:159]
    v_mfma_f32_16x16x32_bf16 v[156:159], a[208:211], a[140:143], v[156:159]
    s_waitcnt lgkmcnt(8)
    v_mfma_f32_16x16x32_bf16 v[156:159], a[216:219], a[172:175], v[156:159]
    ds_read_b64_tr_b16 a[208:209], v2 offset:0
    v_mfma_f32_16x16x32_bf16 v[156:159], a[220:223], a[188:191], v[156:159]
    ds_read_b64_tr_b16 a[210:211], v2 offset:2048
    v_mfma_f32_16x16x32_bf16 v[152:155], a[220:223], a[184:187], v[152:155]
    v_mfma_f32_16x16x32_bf16 v[152:155], a[216:219], a[168:171], v[152:155]
    s_xor_b32 s57, s39, 16
    s_lshl_b32 s57, s57, 9
    s_add_u32 s57, s57, 131200
    v_mfma_f32_16x16x32_bf16 v[148:151], a[216:219], a[164:167], v[148:151]
    ds_read_b64_tr_b16 a[212:213], v2 offset:4096
    s_waitcnt vmcnt(0)
    buffer_store_dwordx2 v[24:25], v26, s[20:23], s57 offen sc1
    v_mfma_f32_16x16x32_bf16 v[148:151], a[220:223], a[180:183], v[148:151]
    ds_read_b64_tr_b16 a[214:215], v2 offset:6144
    v_mfma_f32_16x16x32_bf16 v[144:147], a[220:223], a[176:179], v[144:147]
    v_mfma_f32_16x16x32_bf16 v[144:147], a[216:219], a[160:163], v[144:147]
    s_waitcnt lgkmcnt(8)
    v_mfma_f32_16x16x32_bf16 v[32:35], a[192:195], a[0:3], v[32:35]
    ds_read_b64_tr_b16 a[216:217], v16 offset:16384
    v_mfma_f32_16x16x32_bf16 v[32:35], a[196:199], a[16:19], v[32:35]
    ds_read_b64_tr_b16 a[218:219], v16 offset:18432
    v_mfma_f32_16x16x32_bf16 v[36:39], a[196:199], a[20:23], v[36:39]
    v_mfma_f32_16x16x32_bf16 v[36:39], a[192:195], a[4:7], v[36:39]
    s_xor_b32 s56, s39, 24
    s_mul_i32 s56, s56, 14336
    s_add_u32 s56, s56, 8192
    v_mfma_f32_16x16x32_bf16 v[40:43], a[192:195], a[8:11], v[40:43]
    ds_read_b64_tr_b16 a[220:221], v16 offset:20480
    v_cvt_pk_bf16_f32 v128, v128, v129
    v_cvt_pk_bf16_f32 v129, v130, v131
    v_mfma_f32_16x16x32_bf16 v[40:43], a[196:199], a[24:27], v[40:43]
    ds_read_b64_tr_b16 a[222:223], v16 offset:22528
    v_cvt_pk_bf16_f32 v130, v144, v145
    v_cvt_pk_bf16_f32 v131, v146, v147
    v_mfma_f32_16x16x32_bf16 v[44:47], a[196:199], a[28:31], v[44:47]
    v_cvt_pk_bf16_f32 v132, v132, v133
    v_cvt_pk_bf16_f32 v133, v134, v135
    v_cvt_pk_bf16_f32 v134, v148, v149
    v_mfma_f32_16x16x32_bf16 v[44:47], a[192:195], a[12:15], v[44:47]
    s_waitcnt lgkmcnt(8)
    v_cvt_pk_bf16_f32 v135, v150, v151
    v_permlane16_swap_b32 v128, v130
    v_mfma_f32_16x16x32_bf16 v[44:47], a[200:203], a[44:47], v[44:47]
    ds_read_b64_tr_b16 a[192:193], v16 offset:49152
    v_permlane16_swap_b32 v129, v131
    buffer_store_dwordx4 v[128:131], v12, s[52:55], s56 offen offset:0 sc1
    v_mfma_f32_16x16x32_bf16 v[44:47], a[204:207], a[60:63], v[44:47]
    ds_read_b64_tr_b16 a[194:195], v16 offset:51200
    v_cvt_pk_bf16_f32 v136, v136, v137
    v_cvt_pk_bf16_f32 v137, v138, v139
    v_mfma_f32_16x16x32_bf16 v[40:43], a[204:207], a[56:59], v[40:43]
    v_cvt_pk_bf16_f32 v138, v152, v153
    v_cvt_pk_bf16_f32 v139, v154, v155
    v_permlane16_swap_b32 v132, v134
    v_mfma_f32_16x16x32_bf16 v[40:43], a[200:203], a[40:43], v[40:43]
    v_permlane16_swap_b32 v133, v135
    buffer_store_dwordx4 v[132:135], v12, s[52:55], s56 offen offset:1024 sc1
    v_cvt_pk_bf16_f32 v140, v140, v141
    v_mfma_f32_16x16x32_bf16 v[36:39], a[200:203], a[36:39], v[36:39]
    ds_read_b64_tr_b16 a[196:197], v16 offset:53248
    v_cvt_pk_bf16_f32 v141, v142, v143
    v_cvt_pk_bf16_f32 v142, v156, v157
    v_mfma_f32_16x16x32_bf16 v[36:39], a[204:207], a[52:55], v[36:39]
    ds_read_b64_tr_b16 a[198:199], v16 offset:55296
    v_cvt_pk_bf16_f32 v143, v158, v159
    v_permlane16_swap_b32 v136, v138
    v_mfma_f32_16x16x32_bf16 v[32:35], a[204:207], a[48:51], v[32:35]
    v_permlane16_swap_b32 v137, v139
    buffer_store_dwordx4 v[136:139], v12, s[52:55], s56 offen offset:2048 sc1
    v_mfma_f32_16x16x32_bf16 v[32:35], a[200:203], a[32:35], v[32:35]
    s_waitcnt lgkmcnt(8)
    v_permlane16_swap_b32 v140, v142
    v_permlane16_swap_b32 v141, v143
    v_mfma_f32_16x16x32_bf16 v[32:35], a[208:211], a[64:67], v[32:35]
    ds_read_b64_tr_b16 a[200:201], v208 offset:0
    buffer_store_dwordx4 v[140:143], v12, s[52:55], s56 offen offset:3072 sc1
    v_mfma_f32_16x16x32_bf16 v[32:35], a[212:215], a[80:83], v[32:35]
    ds_read_b64_tr_b16 a[202:203], v208 offset:2048
    v_mfma_f32_16x16x32_bf16 v[36:39], a[212:215], a[84:87], v[36:39]
    v_mfma_f32_16x16x32_bf16 v[36:39], a[208:211], a[68:71], v[36:39]
    v_mfma_f32_16x16x32_bf16 v[40:43], a[208:211], a[72:75], v[40:43]
    ds_read_b64_tr_b16 a[204:205], v208 offset:4096
    v_mfma_f32_16x16x32_bf16 v[40:43], a[212:215], a[88:91], v[40:43]
    ds_read_b64_tr_b16 a[206:207], v208 offset:6144
    v_mfma_f32_16x16x32_bf16 v[44:47], a[212:215], a[92:95], v[44:47]
    v_mfma_f32_16x16x32_bf16 v[44:47], a[208:211], a[76:79], v[44:47]
    s_waitcnt lgkmcnt(8)
    v_mfma_f32_16x16x32_bf16 v[44:47], a[216:219], a[108:111], v[44:47]
    ds_read_b64_tr_b16 a[208:209], v3 offset:28672
    v_mfma_f32_16x16x32_bf16 v[44:47], a[220:223], a[124:127], v[44:47]
    ds_read_b64_tr_b16 a[210:211], v3 offset:30720
    v_mfma_f32_16x16x32_bf16 v[40:43], a[220:223], a[120:123], v[40:43]
    v_mfma_f32_16x16x32_bf16 v[40:43], a[216:219], a[104:107], v[40:43]
    v_mfma_f32_16x16x32_bf16 v[36:39], a[216:219], a[100:103], v[36:39]
    ds_read_b64_tr_b16 a[212:213], v3 offset:32768
    v_mfma_f32_16x16x32_bf16 v[36:39], a[220:223], a[116:119], v[36:39]
    ds_read_b64_tr_b16 a[214:215], v3 offset:34816
    v_mfma_f32_16x16x32_bf16 v[32:35], a[220:223], a[112:115], v[32:35]
    v_mfma_f32_16x16x32_bf16 v[32:35], a[216:219], a[96:99], v[32:35]
    s_waitcnt lgkmcnt(8)
    v_mfma_f32_16x16x32_bf16 v[32:35], a[192:195], a[128:131], v[32:35]
    ds_read_b64_tr_b16 a[216:217], v3 offset:57344
    v_mfma_f32_16x16x32_bf16 v[32:35], a[196:199], a[144:147], v[32:35]
    ds_read_b64_tr_b16 a[218:219], v3 offset:59392
    v_mfma_f32_16x16x32_bf16 v[36:39], a[196:199], a[148:151], v[36:39]
    v_mfma_f32_16x16x32_bf16 v[36:39], a[192:195], a[132:135], v[36:39]
    v_mfma_f32_16x16x32_bf16 v[40:43], a[192:195], a[136:139], v[40:43]
    ds_read_b64_tr_b16 a[220:221], v3 offset:61440
    v_mfma_f32_16x16x32_bf16 v[40:43], a[196:199], a[152:155], v[40:43]
    ds_read_b64_tr_b16 a[222:223], v3 offset:63488
    v_mfma_f32_16x16x32_bf16 v[44:47], a[196:199], a[156:159], v[44:47]
    v_mfma_f32_16x16x32_bf16 v[44:47], a[192:195], a[140:143], v[44:47]
    s_waitcnt lgkmcnt(8)
    v_mfma_f32_16x16x32_bf16 v[44:47], a[200:203], a[172:175], v[44:47]
    ds_read_b64_tr_b16 a[192:193], v3 offset:0
    v_mfma_f32_16x16x32_bf16 v[44:47], a[204:207], a[188:191], v[44:47]
    ds_read_b64_tr_b16 a[194:195], v3 offset:2048
    v_mfma_f32_16x16x32_bf16 v[40:43], a[204:207], a[184:187], v[40:43]
    v_mfma_f32_16x16x32_bf16 v[40:43], a[200:203], a[168:171], v[40:43]
    v_mfma_f32_16x16x32_bf16 v[36:39], a[200:203], a[164:167], v[36:39]
    ds_read_b64_tr_b16 a[196:197], v3 offset:4096
    v_mfma_f32_16x16x32_bf16 v[36:39], a[204:207], a[180:183], v[36:39]
    ds_read_b64_tr_b16 a[198:199], v3 offset:6144
    v_mfma_f32_16x16x32_bf16 v[32:35], a[204:207], a[176:179], v[32:35]
    v_mfma_f32_16x16x32_bf16 v[32:35], a[200:203], a[160:163], v[32:35]
    s_waitcnt lgkmcnt(8)
    s_lshl_b32 s48, s39, 9
    s_add_u32 s48, s48, 131200
    v_mfma_f32_16x16x32_bf16 v[48:51], a[208:211], a[0:3], v[48:51]
    ds_read_b64_tr_b16 a[200:201], v17 offset:16384
    buffer_load_dwordx2 v[28:29], v26, s[20:23], s48 offen sc1
    v_mfma_f32_16x16x32_bf16 v[48:51], a[212:215], a[16:19], v[48:51]
    ds_read_b64_tr_b16 a[202:203], v17 offset:18432
    v_mfma_f32_16x16x32_bf16 v[52:55], a[212:215], a[20:23], v[52:55]
    v_mfma_f32_16x16x32_bf16 v[52:55], a[208:211], a[4:7], v[52:55]
    v_mfma_f32_16x16x32_bf16 v[56:59], a[208:211], a[8:11], v[56:59]
    ds_read_b64_tr_b16 a[204:205], v17 offset:20480
    v_mfma_f32_16x16x32_bf16 v[56:59], a[212:215], a[24:27], v[56:59]
    ds_read_b64_tr_b16 a[206:207], v17 offset:22528
    v_mfma_f32_16x16x32_bf16 v[60:63], a[212:215], a[28:31], v[60:63]
    v_mfma_f32_16x16x32_bf16 v[60:63], a[208:211], a[12:15], v[60:63]
    s_waitcnt lgkmcnt(8)
    v_mfma_f32_16x16x32_bf16 v[60:63], a[216:219], a[44:47], v[60:63]
    ds_read_b64_tr_b16 a[208:209], v17 offset:49152
    v_mfma_f32_16x16x32_bf16 v[60:63], a[220:223], a[60:63], v[60:63]
    ds_read_b64_tr_b16 a[210:211], v17 offset:51200
    v_mfma_f32_16x16x32_bf16 v[56:59], a[220:223], a[56:59], v[56:59]
    v_mfma_f32_16x16x32_bf16 v[56:59], a[216:219], a[40:43], v[56:59]
    v_mfma_f32_16x16x32_bf16 v[52:55], a[216:219], a[36:39], v[52:55]
    ds_read_b64_tr_b16 a[212:213], v17 offset:53248
    v_mfma_f32_16x16x32_bf16 v[52:55], a[220:223], a[52:55], v[52:55]
    ds_read_b64_tr_b16 a[214:215], v17 offset:55296
    v_mfma_f32_16x16x32_bf16 v[48:51], a[220:223], a[48:51], v[48:51]
    v_mfma_f32_16x16x32_bf16 v[48:51], a[216:219], a[32:35], v[48:51]
    s_waitcnt lgkmcnt(8)
    s_xor_b32 s57, s39, 24
    s_lshl_b32 s57, s57, 9
    v_mfma_f32_16x16x32_bf16 v[48:51], a[192:195], a[64:67], v[48:51]
    ds_read_b64_tr_b16 a[216:217], v209 offset:0
    s_add_u32 s57, s57, 131328
    s_waitcnt vmcnt(1)
    v_mfma_f32_16x16x32_bf16 v[48:51], a[196:199], a[80:83], v[48:51]
    ds_read_b64_tr_b16 a[218:219], v209 offset:2048
    buffer_store_dwordx2 v[24:25], v26, s[20:23], s57 offen sc1
    v_mfma_f32_16x16x32_bf16 v[52:55], a[196:199], a[84:87], v[52:55]
    v_mfma_f32_16x16x32_bf16 v[52:55], a[192:195], a[68:71], v[52:55]
    v_mfma_f32_16x16x32_bf16 v[56:59], a[192:195], a[72:75], v[56:59]
    ds_read_b64_tr_b16 a[220:221], v209 offset:4096
    v_mfma_f32_16x16x32_bf16 v[56:59], a[196:199], a[88:91], v[56:59]
    ds_read_b64_tr_b16 a[222:223], v209 offset:6144
    v_mfma_f32_16x16x32_bf16 v[60:63], a[196:199], a[92:95], v[60:63]
    v_mfma_f32_16x16x32_bf16 v[60:63], a[192:195], a[76:79], v[60:63]
    s_waitcnt lgkmcnt(8)
    s_waitcnt vmcnt(1)
    v_cmp_ne_u64 vcc, s[98:99], v[28:29]
    s_nop 1
    s_cmp_lg_u64 vcc, 0
    s_cbranch_scc1 L_try2
    s_add_u32 s57, s38, 4096
    buffer_load_dwordx4 v[112:115], v12, s[52:55], s57 offen offset:0 sc1
    buffer_load_dwordx4 v[116:119], v12, s[52:55], s57 offen offset:1024 sc1
    buffer_load_dwordx4 v[120:123], v12, s[52:55], s57 offen offset:2048 sc1
    buffer_load_dwordx4 v[124:127], v12, s[52:55], s57 offen offset:3072 sc1
    s_mov_b32 s69, 1
L_try2:
    v_mfma_f32_16x16x32_bf16 v[60:63], a[200:203], a[108:111], v[60:63]
    v_mfma_f32_16x16x32_bf16 v[60:63], a[204:207], a[124:127], v[60:63]
    v_mfma_f32_16x16x32_bf16 v[56:59], a[204:207], a[120:123], v[56:59]
    v_mfma_f32_16x16x32_bf16 v[56:59], a[200:203], a[104:107], v[56:59]
    v_mfma_f32_16x16x32_bf16 v[52:55], a[200:203], a[100:103], v[52:55]
    v_mfma_f32_16x16x32_bf16 v[52:55], a[204:207], a[116:119], v[52:55]
    v_mfma_f32_16x16x32_bf16 v[48:51], a[204:207], a[112:115], v[48:51]
    v_mfma_f32_16x16x32_bf16 v[48:51], a[200:203], a[96:99], v[48:51]
    s_waitcnt lgkmcnt(4)
    v_mfma_f32_16x16x32_bf16 v[48:51], a[208:211], a[128:131], v[48:51]
    v_mfma_f32_16x16x32_bf16 v[48:51], a[212:215], a[144:147], v[48:51]
    v_mfma_f32_16x16x32_bf16 v[52:55], a[212:215], a[148:151], v[52:55]
    v_mfma_f32_16x16x32_bf16 v[52:55], a[208:211], a[132:135], v[52:55]
    v_mfma_f32_16x16x32_bf16 v[56:59], a[208:211], a[136:139], v[56:59]
    v_mfma_f32_16x16x32_bf16 v[56:59], a[212:215], a[152:155], v[56:59]
    v_mfma_f32_16x16x32_bf16 v[60:63], a[212:215], a[156:159], v[60:63]
    v_mfma_f32_16x16x32_bf16 v[60:63], a[208:211], a[140:143], v[60:63]
    s_waitcnt lgkmcnt(0)
    v_mfma_f32_16x16x32_bf16 v[60:63], a[216:219], a[172:175], v[60:63]
    v_mfma_f32_16x16x32_bf16 v[60:63], a[220:223], a[188:191], v[60:63]
    v_mfma_f32_16x16x32_bf16 v[56:59], a[220:223], a[184:187], v[56:59]
    v_mfma_f32_16x16x32_bf16 v[56:59], a[216:219], a[168:171], v[56:59]
    v_mfma_f32_16x16x32_bf16 v[52:55], a[216:219], a[164:167], v[52:55]
    v_mfma_f32_16x16x32_bf16 v[52:55], a[220:223], a[180:183], v[52:55]
    v_mfma_f32_16x16x32_bf16 v[48:51], a[220:223], a[176:179], v[48:51]
    v_mfma_f32_16x16x32_bf16 v[48:51], a[216:219], a[160:163], v[48:51]
    s_cmp_eq_u32 s68, 1
    s_cbranch_scc1 L_late1
    s_lshl_b32 s48, s39, 9
    s_add_u32 s48, s48, 131072
    buffer_load_dwordx2 v[28:29], v26, s[20:23], s48 offen sc1
    s_mov_b32 s7, 40000
L_poll_l1:
    s_waitcnt vmcnt(0)
    v_cmp_ne_u64 vcc, s[98:99], v[28:29]
    s_nop 1
    s_cmp_eq_u64 vcc, 0
    s_cbranch_scc1 L_pok_l1
    s_sleep 3
    buffer_load_dwordx2 v[28:29], v26, s[20:23], s48 offen sc1
    s_sub_u32 s7, s7, 1
    s_cmp_lg_u32 s7, 0
    s_cbranch_scc1 L_poll_l1
L_pok_l1:
    s_add_u32 s57, s38, 0
    buffer_load_dwordx4 v[80:83], v12, s[52:55], s57 offen offset:0 sc1
    buffer_load_dwordx4 v[84:87], v12, s[52:55], s57 offen offset:1024 sc1
    buffer_load_dwordx4 v[88:91], v12, s[52:55], s57 offen offset:2048 sc1
    buffer_load_dwordx4 v[92:95], v12, s[52:55], s57 offen offset:3072 sc1
L_late1:
    s_cmp_eq_u32 s69, 1
    s_cbranch_scc1 L_late2
    s_lshl_b32 s48, s39, 9
    s_add_u32 s48, s48, 131200
    buffer_load_dwordx2 v[28:29], v26, s[20:23], s48 offen sc1
    s_mov_b32 s7, 40000
L_poll_l2:
    s_waitcnt vmcnt(0)
    v_cmp_ne_u64 vcc, s[98:99], v[28:29]
    s_nop 1
    s_cmp_eq_u64 vcc, 0
    s_cbranch_scc1 L_pok_l2
    s_sleep 3
    buffer_load_dwordx2 v[28:29], v26, s[20:23], s48 offen sc1
    s_sub_u32 s7, s7, 1
    s_cmp_lg_u32 s7, 0
    s_cbranch_scc1 L_poll_l2
L_pok_l2:
    s_add_u32 s57, s38, 4096
    buffer_load_dwordx4 v[112:115], v12, s[52:55], s57 offen offset:0 sc1
    buffer_load_dwordx4 v[116:119], v12, s[52:55], s57 offen offset:1024 sc1
    buffer_load_dwordx4 v[120:123], v12, s[52:55], s57 offen offset:2048 sc1
    buffer_load_dwordx4 v[124:127], v12, s[52:55], s57 offen offset:3072 sc1
L_late2:
    s_lshl_b32 s48, s39, 9
    s_add_u32 s48, s48, 131328
    buffer_load_dwordx2 v[28:29], v26, s[20:23], s48 offen sc1
    v_permlane16_swap_b32 v32, v48
    v_permlane16_swap_b32 v33, v49
    v_permlane16_swap_b32 v34, v50
    v_permlane16_swap_b32 v35, v51
    v_permlane16_swap_b32 v36, v52
    v_permlane16_swap_b32 v37, v53
    v_permlane16_swap_b32 v38, v54
    v_permlane16_swap_b32 v39, v55
    v_permlane16_swap_b32 v40, v56
    v_permlane16_swap_b32 v41, v57
    v_permlane16_swap_b32 v42, v58
    v_permlane16_swap_b32 v43, v59
    v_permlane16_swap_b32 v44, v60
    v_permlane16_swap_b32 v45, v61
    v_permlane16_swap_b32 v46, v62
    v_permlane16_swap_b32 v47, v63
    v_pk_add_f32 v[32:33], v[32:33], v[160:161]
    v_pk_add_f32 v[34:35], v[34:35], v[162:163]
    v_pk_add_f32 v[48:49], v[48:49], v[164:165]
    v_pk_add_f32 v[50:51], v[50:51], v[166:167]
    v_pk_add_f32 v[36:37], v[36:37], v[168:169]
    v_pk_add_f32 v[38:39], v[38:39], v[170:171]
    v_pk_add_f32 v[52:53], v[52:53], v[172:173]
    v_pk_add_f32 v[54:55], v[54:55], v[174:175]
    v_pk_add_f32 v[40:41], v[40:41], v[176:177]
    v_pk_add_f32 v[42:43], v[42:43], v[178:179]
    v_pk_add_f32 v[56:57], v[56:57], v[180:181]
    v_pk_add_f32 v[58:59], v[58:59], v[182:183]
    v_pk_add_f32 v[44:45], v[44:45], v[184:185]
    v_pk_add_f32 v[46:47], v[46:47], v[186:187]
    v_pk_add_f32 v[60:61], v[60:61], v[188:189]
    v_pk_add_f32 v[62:63], v[62:63], v[190:191]
    s_waitcnt vmcnt(0)
    v_cmp_ne_u64 vcc, s[98:99], v[28:29]
    s_nop 1
    s_cmp_lg_u64 vcc, 0
    s_cbranch_scc1 L_slow_r3
L_back_r3:
    s_add_u32 s57, s38, 8192
    buffer_load_dwordx4 v[144:147], v12, s[52:55], s57 offen offset:0 sc1
    buffer_load_dwordx4 v[148:151], v12, s[52:55], s57 offen offset:1024 sc1
    buffer_load_dwordx4 v[152:155], v12, s[52:55], s57 offen offset:2048 sc1
    buffer_load_dwordx4 v[156:159], v12, s[52:55], s57 offen offset:3072 sc1
    v_lshlrev_b32 v240, 16, v80
    v_and_b32 v241, s58, v80
    v_lshlrev_b32 v242, 16, v81
    v_and_b32 v243, s58, v81
    v_lshlrev_b32 v244, 16, v82
    v_and_b32 v245, s58, v82
    v_lshlrev_b32 v246, 16, v83
    v_and_b32 v247, s58, v83
    v_pk_add_f32 v[32:33], v[32:33], v[240:241]
    v_pk_add_f32 v[34:35], v[34:35], v[242:243]
    v_pk_add_f32 v[48:49], v[48:49], v[244:245]
    v_pk_add_f32 v[50:51], v[50:51], v[246:247]
    v_lshlrev_b32 v240, 16, v84
    v_and_b32 v241, s58, v84
    v_lshlrev_b32 v242, 16, v85
    v_and_b32 v243, s58, v85
    v_lshlrev_b32 v244, 16, v86
    v_and_b32 v245, s58, v86
    v_lshlrev_b32 v246, 16, v87
    v_and_b32 v247, s58, v87
    v_pk_add_f32 v[36:37], v[36:37], v[240:241]
    v_pk_add_f32 v[38:39], v[38:39], v[242:243]
    v_pk_add_f32 v[52:53], v[52:53], v[244:245]
    v_pk_add_f32 v[54:55], v[54:55], v[246:247]
    v_lshlrev_b32 v240, 16, v88
    v_and_b32 v241, s58, v88
    v_lshlrev_b32 v242, 16, v89
    v_and_b32 v243, s58, v89
    v_lshlrev_b32 v244, 16, v90
    v_and_b32 v245, s58, v90
    v_lshlrev_b32 v246, 16, v91
    v_and_b32 v247, s58, v91
    v_pk_add_f32 v[40:41], v[40:41], v[240:241]
    v_pk_add_f32 v[42:43], v[42:43], v[242:243]
    v_pk_add_f32 v[56:57], v[56:57], v[244:245]
    v_pk_add_f32 v[58:59], v[58:59], v[246:247]
    v_lshlrev_b32 v240, 16, v92
    v_and_b32 v241, s58, v92
    v_lshlrev_b32 v242, 16, v93
    v_and_b32 v243, s58, v93
    v_lshlrev_b32 v244, 16, v94
    v_and_b32 v245, s58, v94
    v_lshlrev_b32 v246, 16, v95
    v_and_b32 v247, s58, v95
    v_pk_add_f32 v[44:45], v[44:45], v[240:241]
    v_pk_add_f32 v[46:47], v[46:47], v[242:243]
    v_pk_add_f32 v[60:61], v[60:61], v[244:245]
    v_pk_add_f32 v[62:63], v[62:63], v[246:247]
    v_lshlrev_b32 v240, 16, v112
    v_and_b32 v241, s58, v112
    v_lshlrev_b32 v242, 16, v113
    v_and_b32 v243, s58, v113
    v_lshlrev_b32 v244, 16, v114
    v_and_b32 v245, s58, v114
    v_lshlrev_b32 v246, 16, v115
    v_and_b32 v247, s58, v115
    v_pk_add_f32 v[32:33], v[32:33], v[240:241]
    v_pk_add_f32 v[34:35], v[34:35], v[242:243]
    v_pk_add_f32 v[48:49], v[48:49], v[244:245]
    v_pk_add_f32 v[50:51], v[50:51], v[246:247]
    v_lshlrev_b32 v240, 16, v116
    v_and_b32 v241, s58, v116
    v_lshlrev_b32 v242, 16, v117
    v_and_b32 v243, s58, v117
    v_lshlrev_b32 v244, 16, v118
    v_and_b32 v245, s58, v118
    v_lshlrev_b32 v246, 16, v119
    v_and_b32 v247, s58, v119
    v_pk_add_f32 v[36:37], v[36:37], v[240:241]
    v_pk_add_f32 v[38:39], v[38:39], v[242:243]
    v_pk_add_f32 v[52:53], v[52:53], v[244:245]
    v_pk_add_f32 v[54:55], v[54:55], v[246:247]
    v_lshlrev_b32 v240, 16, v120
    v_and_b32 v241, s58, v120
    v_lshlrev_b32 v242, 16, v121
    v_and_b32 v243, s58, v121
    v_lshlrev_b32 v244, 16, v122
    v_and_b32 v245, s58, v122
    v_lshlrev_b32 v246, 16, v123
    v_and_b32 v247, s58, v123
    v_pk_add_f32 v[40:41], v[40:41], v[240:241]
    v_pk_add_f32 v[42:43], v[42:43], v[242:243]
    v_pk_add_f32 v[56:57], v[56:57], v[244:245]
    v_pk_add_f32 v[58:59], v[58:59], v[246:247]
    v_lshlrev_b32 v240, 16, v124
    v_and_b32 v241, s58, v124
    v_lshlrev_b32 v242, 16, v125
    v_and_b32 v243, s58, v125
    v_lshlrev_b32 v244, 16, v126
    v_and_b32 v245, s58, v126
    v_lshlrev_b32 v246, 16, v127
    v_and_b32 v247, s58, v127
    v_pk_add_f32 v[44:45], v[44:45], v[240:241]
    v_pk_add_f32 v[46:47], v[46:47], v[242:243]
    v_pk_add_f32 v[60:61], v[60:61], v[244:245]
    v_pk_add_f32 v[62:63], v[62:63], v[246:247]
    s_waitcnt vmcnt(3)
    v_lshlrev_b32 v240, 16, v144
    v_and_b32 v241, s58, v144
    v_lshlrev_b32 v242, 16, v145
    v_and_b32 v243, s58, v145
    v_lshlrev_b32 v244, 16, v146
    v_and_b32 v245, s58, v146
    v_lshlrev_b32 v246, 16, v147
    v_and_b32 v247, s58, v147
    v_pk_add_f32 v[32:33], v[32:33], v[240:241]
    v_pk_add_f32 v[34:35], v[34:35], v[242:243]
    v_pk_add_f32 v[48:49], v[48:49], v[244:245]
    v_pk_add_f32 v[50:51], v[50:51], v[246:247]
    v_cvt_pk_bf16_f32 v32, v32, v33
    v_cvt_pk_bf16_f32 v33, v34, v35
    v_cvt_pk_bf16_f32 v34, v48, v49
    v_cvt_pk_bf16_f32 v35, v50, v51
    buffer_store_dwordx4 v[32:35], v30, s[44:47], s75 offen
    s_add_u32 s75, s75, 32768
    s_waitcnt vmcnt(3)
    v_lshlrev_b32 v240, 16, v148
    v_and_b32 v241, s58, v148
    v_lshlrev_b32 v242, 16, v149
    v_and_b32 v243, s58, v149
    v_lshlrev_b32 v244, 16, v150
    v_and_b32 v245, s58, v150
    v_lshlrev_b32 v246, 16, v151
    v_and_b32 v247, s58, v151
    v_pk_add_f32 v[36:37], v[36:37], v[240:241]
    v_pk_add_f32 v[38:39], v[38:39], v[242:243]
    v_pk_add_f32 v[52:53], v[52:53], v[244:245]
    v_pk_add_f32 v[54:55], v[54:55], v[246:247]
    v_cvt_pk_bf16_f32 v36, v36, v37
    v_cvt_pk_bf16_f32 v37, v38, v39
    v_cvt_pk_bf16_f32 v38, v52, v53
    v_cvt_pk_bf16_f32 v39, v54, v55
    buffer_store_dwordx4 v[36:39], v30, s[44:47], s75 offen
    s_add_u32 s75, s75, 32768
    s_waitcnt vmcnt(3)
    v_lshlrev_b32 v240, 16, v152
    v_and_b32 v241, s58, v152
    v_lshlrev_b32 v242, 16, v153
    v_and_b32 v243, s58, v153
    v_lshlrev_b32 v244, 16, v154
    v_and_b32 v245, s58, v154
    v_lshlrev_b32 v246, 16, v155
    v_and_b32 v247, s58, v155
    v_pk_add_f32 v[40:41], v[40:41], v[240:241]
    v_pk_add_f32 v[42:43], v[42:43], v[242:243]
    v_pk_add_f32 v[56:57], v[56:57], v[244:245]
    v_pk_add_f32 v[58:59], v[58:59], v[246:247]
    v_cvt_pk_bf16_f32 v40, v40, v41
    v_cvt_pk_bf16_f32 v41, v42, v43
    v_cvt_pk_bf16_f32 v42, v56, v57
    v_cvt_pk_bf16_f32 v43, v58, v59
    buffer_store_dwordx4 v[40:43], v30, s[44:47], s75 offen
    s_add_u32 s75, s75, 32768
    s_waitcnt vmcnt(3)
    v_lshlrev_b32 v240, 16, v156
    v_and_b32 v241, s58, v156
    v_lshlrev_b32 v242, 16, v157
    v_and_b32 v243, s58, v157
    v_lshlrev_b32 v244, 16, v158
    v_and_b32 v245, s58, v158
    v_lshlrev_b32 v246, 16, v159
    v_and_b32 v247, s58, v159
    v_pk_add_f32 v[44:45], v[44:45], v[240:241]
    v_pk_add_f32 v[46:47], v[46:47], v[242:243]
    v_pk_add_f32 v[60:61], v[60:61], v[244:245]
    v_pk_add_f32 v[62:63], v[62:63], v[246:247]
    v_cvt_pk_bf16_f32 v44, v44, v45
    v_cvt_pk_bf16_f32 v45, v46, v47
    v_cvt_pk_bf16_f32 v46, v60, v61
    v_cvt_pk_bf16_f32 v47, v62, v63
    buffer_store_dwordx4 v[44:47], v30, s[44:47], s75 offen
L_end:
    s_endpgm
L_slow_c1:
    s_add_u32 s48, s49, 34816
    buffer_load_dwordx2 v[28:29], v31, s[20:23], s48 offen sc1
    s_mov_b32 s7, 40000
L_poll_c1:
    s_waitcnt vmcnt(0)
    v_cmp_ne_u64 vcc, s[98:99], v[28:29]
    s_nop 1
    s_cmp_eq_u64 vcc, 0
    s_cbranch_scc1 L_pok_c1
    s_sleep 3
    buffer_load_dwordx2 v[28:29], v31, s[20:23], s48 offen sc1
    s_sub_u32 s7, s7, 1
    s_cmp_lg_u32 s7, 0
    s_cbranch_scc1 L_poll_c1
L_pok_c1:
    s_branch L_back_c1
L_slow_c2:
    s_add_u32 s48, s49, 67584
    buffer_load_dwordx2 v[28:29], v31, s[20:23], s48 offen sc1
    s_mov_b32 s7, 40000
L_poll_c2:
    s_waitcnt vmcnt(0)
    v_cmp_ne_u64 vcc, s[98:99], v[28:29]
    s_nop 1
    s_cmp_eq_u64 vcc, 0
    s_cbranch_scc1 L_pok_c2
    s_sleep 3
    buffer_load_dwordx2 v[28:29], v31, s[20:23], s48 offen sc1
    s_sub_u32 s7, s7, 1
    s_cmp_lg_u32 s7, 0
    s_cbranch_scc1 L_poll_c2
L_pok_c2:
    s_branch L_back_c2
L_slow_c3:
    s_add_u32 s48, s49, 98304
    buffer_load_dwordx2 v[28:29], v27, s[20:23], s48 offen sc1
    s_mov_b32 s7, 40000
L_poll_c3:
    s_waitcnt vmcnt(0)
    v_cmp_ne_u64 vcc, s[98:99], v[28:29]
    s_nop 1
    s_cmp_eq_u64 vcc, 0
    s_cbranch_scc1 L_pok_c3
    s_sleep 3
    buffer_load_dwordx2 v[28:29], v27, s[20:23], s48 offen sc1
    s_sub_u32 s7, s7, 1
    s_cmp_lg_u32 s7, 0
    s_cbranch_scc1 L_poll_c3
L_pok_c3:
    s_branch L_back_c3
L_slow_r3:
    s_lshl_b32 s48, s39, 9
    s_add_u32 s48, s48, 131328
    buffer_load_dwordx2 v[28:29], v26, s[20:23], s48 offen sc1
    s_mov_b32 s7, 40000
L_poll_r3:
    s_waitcnt vmcnt(0)
    v_cmp_ne_u64 vcc, s[98:99], v[28:29]
    s_nop 1
    s_cmp_eq_u64 vcc, 0
    s_cbranch_scc1 L_pok_r3
    s_sleep 3
    buffer_load_dwordx2 v[28:29], v26, s[20:23], s48 offen sc1
    s_sub_u32 s7, s7, 1
    s_cmp_lg_u32 s7, 0
    s_cbranch_scc1 L_poll_r3
L_pok_r3:
    s_branch L_back_r3
L_code_end:
.section .rodata,"a"
.p2align 6
.amdhsa_kernel parallel_sum__sliding_local_dilated__dense_activation_squared_relu__prompt_kernel
  .amdhsa_next_free_vgpr 512
  .amdhsa_next_free_sgpr 102
  .amdhsa_accum_offset 256
  .amdhsa_group_segment_fixed_size 0
  .amdhsa_kernarg_size 88
  .amdhsa_user_sgpr_count 2
  .amdhsa_user_sgpr_kernarg_segment_ptr 1
  .amdhsa_system_sgpr_workgroup_id_x 1
.end_amdhsa_kernel
```
